```python
import torch

def _softmax(x, axis=-1):
    return torch.softmax(x, dim=axis)

def _gelu(x):
    return torch.nn.functional.gelu(x, approximate='tanh')

def _silu(x):
    return torch.nn.functional.silu(x)

def _sigmoid(x):
    return torch.sigmoid(x)

def _layernorm(x, axis=-1, eps=1e-05):
    m = x.mean(dim=axis, keepdim=True)
    v = x.var(dim=axis, keepdim=True, unbiased=False)
    return (x - m) / torch.sqrt(v + eps)

def _scatter_add(tgt, idx, src, axis=0):
    return tgt.clone().index_add_(axis, idx, src)

def _segment_sum(src, seg, n):
    out = torch.zeros((n,) + src.shape[1:], dtype=src.dtype)
    return out.index_add_(0, seg, src)

def _pad(x, pw):
    flat = tuple((v for pair in reversed(pw) for v in pair))
    return torch.nn.functional.pad(x, flat)
kernel_name = 'adaLN_cond__memory_aug_recurrent_mem_tr__dense_activation_relu__prompt'

def setup_inputs():

    _w = lambda a: (lambda t: t.to(torch.bfloat16) if t.is_floating_point() else t)(torch.as_tensor(a))

    def _A_setup():
        B, S, Dm = (1, 2048, 512)
        H, Dh = (32, 128)
        M, seg = (8, 32)
        seg = min(seg, S)
        S = S // seg * seg
        return {'x': _w((lambda *s: torch.randn(*s, dtype=torch.bfloat16) * 0.05)(B, S, Dm)), 'mem0': _w((lambda *s: torch.randn(*s, dtype=torch.bfloat16) * 0.4)(B, M, Dm)), 'Wq': _w((lambda *s: torch.randn(*s, dtype=torch.bfloat16) * 3.2)(Dm, H, Dh) * Dm ** (-0.5)), 'Wk': _w((lambda *s: torch.randn(*s, dtype=torch.bfloat16) * 3.2)(Dm, H, Dh) * Dm ** (-0.5)), 'Wv': _w((lambda *s: torch.randn(*s, dtype=torch.bfloat16) * 0.4)(Dm, H, Dh) * Dm ** (-0.5)), 'Wo': _w((lambda *s: torch.randn(*s, dtype=torch.bfloat16) * 0.4)(H, Dh, Dm) * (H * Dh) ** (-0.5)), 'seg_len': seg}
    _A_in = _A_setup()

    def _B_setup():
        B, S, D, Dff = (1, 2048, 512, 1376)
        return {'x': _w((lambda *s: torch.randn(*s, dtype=torch.bfloat16) * 0.05)(B, S, D)), 'w1': _w((lambda *s: torch.randn(*s, dtype=torch.bfloat16) * 0.05)(D, Dff)), 'w2': _w((lambda *s: torch.randn(*s, dtype=torch.bfloat16) * 0.05)(Dff, D))}
    _B_in = _B_setup()
    return {'A_x': _A_in['x'], 'A_mem0': _A_in['mem0'], 'A_Wq': _A_in['Wq'], 'A_Wk': _A_in['Wk'], 'A_Wv': _A_in['Wv'], 'A_Wo': _A_in['Wo'], 'A_seg_len': _A_in['seg_len'], 'B_x': _B_in['x'], 'B_w1': _B_in['w1'], 'B_w2': _B_in['w2'], 'c': _w((lambda *s: torch.randn(*s, dtype=torch.bfloat16) * 0.1)(1, 512) * 8.0), 'w_mod': _w((lambda *s: torch.randn(*s, dtype=torch.bfloat16) * 0.1)(512, 6 * 512) * 512 ** (-0.5) * 8.0)}

def reference(A_x, A_mem0, A_Wq, A_Wk, A_Wv, A_Wo, A_seg_len, B_x, B_w1, B_w2, c, w_mod):

    def _A_ref(x, mem0, Wq, Wk, Wv, Wo, seg_len):
        B, S, Dm = x.shape
        H, Dh = (Wq.shape[1], Wq.shape[2])
        M = mem0.shape[1]
        scale = Dh ** (-0.5)
        n_seg = S // seg_len
        L = M + seg_len
        idx = torch.arange(L)
        mask = (idx[:, None] < M) | (idx[:, None] >= idx[None, :])
        mem = mem0
        outs = []
        for s in range(n_seg):
            xs = x[:, s * seg_len:(s + 1) * seg_len, :].clone()
            h = torch.concatenate([mem, xs], axis=1)
            q = torch.einsum('btd,dhe->bhte', h, Wq)
            k = torch.einsum('btd,dhe->bhte', h, Wk)
            v = torch.einsum('btd,dhe->bhte', h, Wv)
            scores = torch.einsum('bhqe,bhke->bhqk', q, k) * scale
            scores = torch.where(mask[None, None], scores, -1000000000.0)
            p = _softmax(scores, axis=-1)
            o = torch.einsum('bhqk,bhke->bhqe', p, v)
            o = torch.einsum('bhte,hed->btd', o, Wo)
            mem = o[:, :M, :].clone()
            outs.append(o[:, M:, :])
        return torch.concatenate(outs, axis=1)

    def _B_ref(x, w1, w2):
        h = torch.einsum('bsd,df->bsf', x, w1)
        zero = torch.zeros_like(h)
        h = torch.maximum(h, zero)
        return torch.einsum('bsf,fd->bsd', h, w2)
    x = A_x
    mod = (_silu(c) @ w_mod).reshape(c.shape[0], 6, 1, -1)
    sa, ca, ga, sb, cb, gb = (mod[:, 0].clone(), mod[:, 1].clone(), mod[:, 2].clone(), mod[:, 3].clone(), mod[:, 4].clone(), mod[:, 5].clone())
    h = _layernorm(x, axis=-1) * (1 + ca) + sa
    x = x + ga * _A_ref(h, A_mem0, A_Wq, A_Wk, A_Wv, A_Wo, A_seg_len)
    h = _layernorm(x, axis=-1) * (1 + cb) + sb
    x = x + gb * _B_ref(h, B_w1, B_w2)
    return x
```

```asm
; @launch grid=(256,1,1) block=(256,1,1) lds=163840
.amdgcn_target "amdgcn-amd-amdhsa--gfx950"
.text
.globl adaLN_cond__memory_aug_recurrent_mem_tr__dense_activation_relu__prompt_kernel
.p2align 8
.type adaLN_cond__memory_aug_recurrent_mem_tr__dense_activation_relu__prompt_kernel,@function
adaLN_cond__memory_aug_recurrent_mem_tr__dense_activation_relu__prompt_kernel:
s_cmp_ge_u32 s2, 256
s_cbranch_scc1 L_exit
s_load_dwordx4 s[60:63], s[0:1], 104
s_load_dwordx8 s[48:55], s[0:1], 8
s_load_dwordx2 s[56:57], s[0:1], 40
s_memrealtime s[96:97]
v_and_b32 v255, 63, v0
v_lshrrev_b32 v1, 6, v0
s_getreg_b32 s33, hwreg(HW_REG_XCC_ID, 0, 4)
v_readfirstlane_b32 s20, v1
s_waitcnt lgkmcnt(0)
s_mov_b32 s16, s60
s_mov_b32 s17, s61
s_mov_b32 s18, 0x100
s_mov_b32 s19, 0x00020000
s_mov_b32 s8, s62
s_mov_b32 s9, s63
s_mov_b32 s10, 0x10000000
s_mov_b32 s11, 0x00020000
s_mov_b32 s15, 0x00020000
s_mov_b32 s32, 0
s_cmp_lg_u32 s20, 0
s_cbranch_scc1 L_el_other
s_and_b32 s38, s33, 7
s_lshl_b32 s38, s38, 2
s_cmp_eq_u32 s38, 0
s_cselect_b32 s38, 128, s38
v_mov_b32 v2, 1
v_mov_b32 v3, s38
s_mov_b64 exec, 1
buffer_atomic_add v2, v3, s[16:19], 0 offen sc0
s_waitcnt vmcnt(0)
v_readfirstlane_b32 s39, v2
s_cmp_lg_u32 s39, 0
s_cbranch_scc1 L_el_nononce
s_or_b32 s39, s96, 1
v_mov_b32 v4, s39
v_mov_b32 v5, 0
v_mov_b32 v6, 132
buffer_atomic_cmpswap v[4:5], v6, s[16:19], 0 offen
L_el_nononce:
v_mov_b32 v3, 163776
ds_write_b32 v3, v2
s_mov_b64 exec, -1
s_branch L_el_wait
L_el_other:
L_el_wait:
s_waitcnt lgkmcnt(0)
s_barrier
v_mov_b32 v3, 163776
ds_read_b32 v2, v3
s_waitcnt lgkmcnt(0)
v_readfirstlane_b32 s21, v2
s_barrier
s_cmp_ge_u32 s21, 32
s_cbranch_scc1 L_overflow
L_dispatch:
s_cmp_lg_u32 s33, 0
s_cbranch_scc1 L_far_worker
s_branch L_chain
L_far_worker:
s_branch L_hop_worker
L_overflow:
s_cmp_lg_u32 s32, 0
s_cbranch_scc1 L_vfx_3
s_mov_b32 s90, 200000
L_vf_1:
v_mov_b32 v28, 0
buffer_load_dwordx4 v[16:19], v28, s[16:19], 0 offen sc1
buffer_load_dwordx4 v[20:23], v28, s[16:19], 0 offen offset:16 sc1
buffer_load_dwordx2 v[24:25], v28, s[16:19], 0 offen offset:128 sc1
s_sub_u32 s90, s90, 1
s_cmp_eq_u32 s90, 0
s_cbranch_scc1 L_abort
s_waitcnt vmcnt(0)
L_vfe_2:
v_add3_u32 v26, v17, v18, v19
v_add3_u32 v26, v26, v20, v21
v_add3_u32 v26, v26, v22, v23
v_add_u32 v26, v26, v24
v_max3_u32 v27, v17, v18, v19
v_max3_u32 v27, v27, v20, v21
v_max3_u32 v27, v27, v22, v23
v_max_u32 v27, v27, v24
v_cmp_lt_u32 vcc, 0x100, v26
s_cbranch_vccnz L_abort
v_cmp_ne_u32 vcc, 0x100, v26
s_cbranch_vccnz L_vf_1
v_cmp_eq_u32 vcc, 0, v25
s_cbranch_vccnz L_vf_1
v_readfirstlane_b32 s46, v25
v_readfirstlane_b32 s90, v27
s_cmp_lg_u32 s90, 32
s_cbranch_scc1 L_slow
L_vfx_3:
s_branch L_abort
L_slow:
s_waitcnt vmcnt(0) lgkmcnt(0)
s_barrier
s_cmp_lg_u32 s20, 0
s_cbranch_scc1 L_sl_wait
s_mov_b64 exec, 1
v_mov_b32 v2, 1
v_mov_b32 v3, 140
buffer_atomic_add v2, v3, s[16:19], 0 offen sc0
v_mov_b32 v3, 163776
s_waitcnt vmcnt(0)
ds_write_b32 v3, v2
s_mov_b64 exec, -1
L_sl_wait:
s_waitcnt lgkmcnt(0)
s_barrier
v_mov_b32 v3, 163776
ds_read_b32 v2, v3
s_waitcnt lgkmcnt(0)
v_readfirstlane_b32 s21, v2
s_barrier
s_lshr_b32 s33, s21, 5
s_and_b32 s21, s21, 31
s_mov_b32 s32, 1
v_mbcnt_lo_u32_b32 v1, -1, 0
v_mbcnt_hi_u32_b32 v1, -1, v1
s_lshl_b32 s38, s20, 6
v_add_u32 v0, s38, v1
v_and_b32 v255, 63, v0
s_branch L_dispatch
L_exit:
s_endpgm
L_abort0:
L_chain:
s_cmp_eq_u32 s20, 1
s_cbranch_scc1 L_wave1
s_cmp_eq_u32 s20, 2
s_cbranch_scc1 L_wave2
s_cmp_eq_u32 s20, 3
s_cbranch_scc1 L_wave3
L_wave0:
v_lshrrev_b32 v128, 4, v255
v_and_b32 v129, 15, v255
v_and_b32 v130, 1, v128
v_add_u32 v130, 0, v130
v_lshlrev_b32 v130, 1, v130
v_xor_b32 v130, v130, v129
v_lshlrev_b32 v130, 4, v130
s_lshl_b32 s38, s21, 8
v_lshl_add_u32 v131, v128, 13, v130
v_add_u32 v136, s38, v131
s_lshl_b32 s38, s21, 17
v_lshl_add_u32 v131, v128, 10, v130
v_add_u32 v138, s38, v131
v_and_b32 v130, 1, v128
v_add_u32 v130, 2, v130
v_lshlrev_b32 v130, 1, v130
v_xor_b32 v130, v130, v129
v_lshlrev_b32 v130, 4, v130
s_lshl_b32 s38, s21, 8
v_lshl_add_u32 v131, v128, 13, v130
v_add_u32 v137, s38, v131
s_lshl_b32 s38, s21, 17
v_lshl_add_u32 v131, v128, 10, v130
v_add_u32 v139, s38, v131
s_mov_b32 s12, s50
s_mov_b32 s13, s51
s_mov_b32 s14, 0x400000
s_mov_b32 m0, 0
s_mov_b32 s38, 0x0
buffer_load_dwordx4 v136, s[12:15], s38 offen  lds
s_mov_b32 m0, 1024
s_mov_b32 s38, 0x8000
buffer_load_dwordx4 v136, s[12:15], s38 offen  lds
s_mov_b32 m0, 2048
s_mov_b32 s38, 0x10000
buffer_load_dwordx4 v136, s[12:15], s38 offen  lds
s_mov_b32 m0, 3072
s_mov_b32 s38, 0x18000
buffer_load_dwordx4 v136, s[12:15], s38 offen  lds
s_mov_b32 m0, 4096
s_mov_b32 s38, 0x20000
buffer_load_dwordx4 v137, s[12:15], s38 offen  lds
s_mov_b32 m0, 5120
s_mov_b32 s38, 0x28000
buffer_load_dwordx4 v137, s[12:15], s38 offen  lds
s_mov_b32 m0, 6144
s_mov_b32 s38, 0x30000
buffer_load_dwordx4 v137, s[12:15], s38 offen  lds
s_mov_b32 m0, 7168
s_mov_b32 s38, 0x38000
buffer_load_dwordx4 v137, s[12:15], s38 offen  lds
s_mov_b32 m0, 32768
s_mov_b32 s38, 0x100000
buffer_load_dwordx4 v136, s[12:15], s38 offen  lds
s_mov_b32 m0, 33792
s_mov_b32 s38, 0x108000
buffer_load_dwordx4 v136, s[12:15], s38 offen  lds
s_mov_b32 m0, 34816
s_mov_b32 s38, 0x110000
buffer_load_dwordx4 v136, s[12:15], s38 offen  lds
s_mov_b32 m0, 35840
s_mov_b32 s38, 0x118000
buffer_load_dwordx4 v136, s[12:15], s38 offen  lds
s_mov_b32 m0, 36864
s_mov_b32 s38, 0x120000
buffer_load_dwordx4 v137, s[12:15], s38 offen  lds
s_mov_b32 m0, 37888
s_mov_b32 s38, 0x128000
buffer_load_dwordx4 v137, s[12:15], s38 offen  lds
s_mov_b32 m0, 38912
s_mov_b32 s38, 0x130000
buffer_load_dwordx4 v137, s[12:15], s38 offen  lds
s_mov_b32 m0, 39936
s_mov_b32 s38, 0x138000
buffer_load_dwordx4 v137, s[12:15], s38 offen  lds
s_mov_b32 m0, 65536
s_mov_b32 s38, 0x200000
buffer_load_dwordx4 v136, s[12:15], s38 offen  lds
s_mov_b32 m0, 66560
s_mov_b32 s38, 0x208000
buffer_load_dwordx4 v136, s[12:15], s38 offen  lds
s_mov_b32 m0, 67584
s_mov_b32 s38, 0x210000
buffer_load_dwordx4 v136, s[12:15], s38 offen  lds
s_mov_b32 m0, 68608
s_mov_b32 s38, 0x218000
buffer_load_dwordx4 v136, s[12:15], s38 offen  lds
s_mov_b32 m0, 69632
s_mov_b32 s38, 0x220000
buffer_load_dwordx4 v137, s[12:15], s38 offen  lds
s_mov_b32 m0, 70656
s_mov_b32 s38, 0x228000
buffer_load_dwordx4 v137, s[12:15], s38 offen  lds
s_mov_b32 m0, 71680
s_mov_b32 s38, 0x230000
buffer_load_dwordx4 v137, s[12:15], s38 offen  lds
s_mov_b32 m0, 72704
s_mov_b32 s38, 0x238000
buffer_load_dwordx4 v137, s[12:15], s38 offen  lds
s_mov_b32 m0, 98304
s_mov_b32 s38, 0x300000
buffer_load_dwordx4 v136, s[12:15], s38 offen  lds
s_mov_b32 m0, 99328
s_mov_b32 s38, 0x308000
buffer_load_dwordx4 v136, s[12:15], s38 offen  lds
s_mov_b32 m0, 100352
s_mov_b32 s38, 0x310000
buffer_load_dwordx4 v136, s[12:15], s38 offen  lds
s_mov_b32 m0, 101376
s_mov_b32 s38, 0x318000
buffer_load_dwordx4 v136, s[12:15], s38 offen  lds
s_mov_b32 m0, 102400
s_mov_b32 s38, 0x320000
buffer_load_dwordx4 v137, s[12:15], s38 offen  lds
s_mov_b32 m0, 103424
s_mov_b32 s38, 0x328000
buffer_load_dwordx4 v137, s[12:15], s38 offen  lds
s_mov_b32 m0, 104448
s_mov_b32 s38, 0x330000
buffer_load_dwordx4 v137, s[12:15], s38 offen  lds
s_mov_b32 m0, 105472
s_mov_b32 s38, 0x338000
buffer_load_dwordx4 v137, s[12:15], s38 offen  lds
v_lshlrev_b32 v247, 4, v255
v_add_u32 v248, 0, v247
v_add_u32 v249, 131072, v247
v_and_b32 v128, 15, v255
v_lshrrev_b32 v129, 4, v255
v_mov_b32 v246, 0x4444
v_mov_b32 v130, 0xeeee
v_and_b32 v131, 2, v128
v_cmp_ne_u32 vcc, 0, v131
s_nop 1
v_cndmask_b32 v246, v246, v130, vcc
v_lshlrev_b32 v130, 13, v129
v_lshrrev_b32 v131, 2, v128
v_lshl_add_u32 v130, v131, 11, v130
v_mov_b32 v131, s21
v_lshl_add_u32 v130, v131, 6, v130
v_and_b32 v131, 3, v128
v_lshl_add_u32 v250, v131, 4, v130
v_lshrrev_b32 v130, 2, v128
v_xor_b32 v130, v130, v129
v_lshlrev_b32 v130, 3, v130
v_lshl_add_u32 v130, v128, 5, v130
v_add_u32 v252, 147456, v130
v_lshrrev_b32 v130, 2, v128
v_lshl_add_u32 v130, v129, 2, v130
v_and_b32 v131, 3, v128
v_xor_b32 v131, v131, v129
v_lshlrev_b32 v131, 3, v131
v_lshl_add_u32 v130, v130, 5, v131
v_add_u32 v253, 147456, v130
v_lshrrev_b32 v130, 2, v128
v_and_b32 v131, 1, v128
v_lshl_add_u32 v130, v130, 1, v131
v_lshl_add_u32 v130, v129, 3, v130
v_lshlrev_b32 v130, 4, v130
v_mov_b32 v132, 0x40000000
v_and_b32 v131, 2, v128
v_cmp_ne_u32 vcc, 0, v131
s_nop 1
v_cndmask_b32 v254, v130, v132, vcc
s_lshr_b32 s38, s21, 3
s_bfe_u32 s39, s21, 0x10002
s_lshl_b32 s39, s39, 2
s_add_u32 s38, s38, s39
s_lshl_b32 s38, s38, 10
s_and_b32 s39, s21, 3
s_lshl_b32 s39, s39, 6
s_add_u32 s38, s38, s39
s_add_u32 s38, s38, 0
v_and_b32 v130, 3, v128
v_lshlrev_b32 v130, 4, v130
v_lshrrev_b32 v131, 2, v128
v_lshl_add_u32 v130, v131, 3, v130
v_lshrrev_b32 v131, 1, v129
v_lshl_add_u32 v130, v131, 2, v130
v_add_u32 v130, s38, v130
v_and_b32 v131, 24, v255
v_mov_b32 v251, 0x40000000
v_cmp_eq_u32 vcc, 0, v131
s_nop 1
v_cndmask_b32 v251, v251, v130, vcc
v_lshrrev_b32 v128, 4, v255
v_bfe_u32 v129, v255, 2, 2
v_and_b32 v130, 3, v255
v_and_b32 v131, 1, v128
v_lshl_add_u32 v134, v131, 2, v129
v_lshlrev_b32 v132, 5, v131
v_lshrrev_b32 v131, 1, v128
v_lshl_add_u32 v132, v131, 2, v132
v_and_b32 v131, 1, v129
v_add_u32 v132, v131, v132
v_lshrrev_b32 v131, 1, v129
v_lshl_add_u32 v132, v131, 4, v132
v_lshlrev_b32 v132, 8, v132
v_lshrrev_b32 v131, 1, v130
v_lshl_add_u32 v132, v131, 4, v132
v_and_b32 v131, 1, v130
v_lshl_add_u32 v132, v131, 3, v132
v_xor_b32 v131, 0, v134
v_lshl_add_u32 v140, v131, 5, v132
v_xor_b32 v131, 1, v134
v_lshl_add_u32 v141, v131, 5, v132
v_xor_b32 v131, 0, v134
v_lshl_add_u32 v148, v131, 5, v132
v_add_u32 v148, 0, v148
v_xor_b32 v131, 1, v134
v_lshl_add_u32 v149, v131, 5, v132
v_add_u32 v149, 0, v149
v_xor_b32 v131, 2, v134
v_lshl_add_u32 v150, v131, 5, v132
v_add_u32 v150, 0, v150
v_xor_b32 v131, 3, v134
v_lshl_add_u32 v151, v131, 5, v132
v_add_u32 v151, 0, v151
v_xor_b32 v131, 4, v134
v_lshl_add_u32 v152, v131, 5, v132
v_add_u32 v152, 0, v152
v_xor_b32 v131, 5, v134
v_lshl_add_u32 v153, v131, 5, v132
v_add_u32 v153, 0, v153
v_xor_b32 v131, 6, v134
v_lshl_add_u32 v154, v131, 5, v132
v_add_u32 v154, 0, v154
v_xor_b32 v131, 7, v134
v_lshl_add_u32 v155, v131, 5, v132
v_add_u32 v155, 0, v155
s_waitcnt vmcnt(24)
s_barrier
v_add_u32 v142, 0, v140
v_add_u32 v143, 0, v141
ds_read_b64_tr_b16 a[0:1], v142 offset:0
ds_read_b64_tr_b16 a[2:3], v142 offset:512
ds_read_b64_tr_b16 a[4:5], v142 offset:2048
ds_read_b64_tr_b16 a[6:7], v142 offset:2560
ds_read_b64_tr_b16 a[64:65], v143 offset:0
ds_read_b64_tr_b16 a[66:67], v143 offset:512
ds_read_b64_tr_b16 a[68:69], v143 offset:2048
ds_read_b64_tr_b16 a[70:71], v143 offset:2560
ds_read_b64_tr_b16 a[32:33], v142 offset:16384
ds_read_b64_tr_b16 a[34:35], v142 offset:16896
ds_read_b64_tr_b16 a[36:37], v142 offset:18432
ds_read_b64_tr_b16 a[38:39], v142 offset:18944
ds_read_b64_tr_b16 a[96:97], v143 offset:16384
ds_read_b64_tr_b16 a[98:99], v143 offset:16896
ds_read_b64_tr_b16 a[100:101], v143 offset:18432
ds_read_b64_tr_b16 a[102:103], v143 offset:18944
s_waitcnt lgkmcnt(0)
s_barrier
s_mov_b32 s12, s52
s_mov_b32 s13, s53
s_mov_b32 s14, 0x400000
s_mov_b32 m0, 0
s_mov_b32 s38, 0x0
buffer_load_dwordx4 v136, s[12:15], s38 offen  lds
s_mov_b32 m0, 1024
s_mov_b32 s38, 0x8000
buffer_load_dwordx4 v136, s[12:15], s38 offen  lds
s_mov_b32 m0, 2048
s_mov_b32 s38, 0x10000
buffer_load_dwordx4 v136, s[12:15], s38 offen  lds
s_mov_b32 m0, 3072
s_mov_b32 s38, 0x18000
buffer_load_dwordx4 v136, s[12:15], s38 offen  lds
s_mov_b32 m0, 4096
s_mov_b32 s38, 0x20000
buffer_load_dwordx4 v137, s[12:15], s38 offen  lds
s_mov_b32 m0, 5120
s_mov_b32 s38, 0x28000
buffer_load_dwordx4 v137, s[12:15], s38 offen  lds
s_mov_b32 m0, 6144
s_mov_b32 s38, 0x30000
buffer_load_dwordx4 v137, s[12:15], s38 offen  lds
s_mov_b32 m0, 7168
s_mov_b32 s38, 0x38000
buffer_load_dwordx4 v137, s[12:15], s38 offen  lds
s_waitcnt vmcnt(24)
s_barrier
v_add_u32 v142, 32768, v140
v_add_u32 v143, 32768, v141
ds_read_b64_tr_b16 a[8:9], v142 offset:0
ds_read_b64_tr_b16 a[10:11], v142 offset:512
ds_read_b64_tr_b16 a[12:13], v142 offset:2048
ds_read_b64_tr_b16 a[14:15], v142 offset:2560
ds_read_b64_tr_b16 a[72:73], v143 offset:0
ds_read_b64_tr_b16 a[74:75], v143 offset:512
ds_read_b64_tr_b16 a[76:77], v143 offset:2048
ds_read_b64_tr_b16 a[78:79], v143 offset:2560
ds_read_b64_tr_b16 a[40:41], v142 offset:16384
ds_read_b64_tr_b16 a[42:43], v142 offset:16896
ds_read_b64_tr_b16 a[44:45], v142 offset:18432
ds_read_b64_tr_b16 a[46:47], v142 offset:18944
ds_read_b64_tr_b16 a[104:105], v143 offset:16384
ds_read_b64_tr_b16 a[106:107], v143 offset:16896
ds_read_b64_tr_b16 a[108:109], v143 offset:18432
ds_read_b64_tr_b16 a[110:111], v143 offset:18944
s_waitcnt lgkmcnt(0)
s_barrier
v_mov_b32 v236, 0
buffer_load_dwordx4 v[224:227], v236, s[16:19], 0 offen sc1
buffer_load_dwordx4 v[228:231], v236, s[16:19], 0 offen offset:16 sc1
buffer_load_dwordx2 v[232:233], v236, s[16:19], 0 offen offset:128 sc1
v_and_b32 v200, 15, v255
v_lshrrev_b32 v201, 4, v255
s_and_b32 s39, s21, 3
s_lshl_b32 s39, s39, 11
s_lshr_b32 s40, s21, 2
s_lshl_b32 s40, s40, 7
s_add_u32 s39, s39, s40
s_add_u32 s39, s39, 0
v_and_b32 v202, 1, v200
v_lshlrev_b32 v202, 10, v202
v_bfe_u32 v203, v200, 1, 2
v_lshl_add_u32 v202, v203, 5, v202
v_lshrrev_b32 v203, 1, v201
v_lshl_add_u32 v202, v203, 2, v202
v_add_u32 v202, s39, v202
s_mov_b32 s4, s48
s_mov_b32 s5, s49
s_mov_b32 s6, 8192
s_mov_b32 s7, 0x00020000
buffer_load_dword v204, v202, s[4:7], 0 offen
s_mov_b32 m0, 32768
s_mov_b32 s38, 0x100000
buffer_load_dwordx4 v136, s[12:15], s38 offen  lds
s_mov_b32 m0, 33792
s_mov_b32 s38, 0x108000
buffer_load_dwordx4 v136, s[12:15], s38 offen  lds
s_mov_b32 m0, 34816
s_mov_b32 s38, 0x110000
buffer_load_dwordx4 v136, s[12:15], s38 offen  lds
s_mov_b32 m0, 35840
s_mov_b32 s38, 0x118000
buffer_load_dwordx4 v136, s[12:15], s38 offen  lds
s_mov_b32 m0, 36864
s_mov_b32 s38, 0x120000
buffer_load_dwordx4 v137, s[12:15], s38 offen  lds
s_mov_b32 m0, 37888
s_mov_b32 s38, 0x128000
buffer_load_dwordx4 v137, s[12:15], s38 offen  lds
s_mov_b32 m0, 38912
s_mov_b32 s38, 0x130000
buffer_load_dwordx4 v137, s[12:15], s38 offen  lds
s_mov_b32 m0, 39936
s_mov_b32 s38, 0x138000
buffer_load_dwordx4 v137, s[12:15], s38 offen  lds
s_waitcnt vmcnt(24)
s_barrier
v_add_u32 v142, 65536, v140
v_add_u32 v143, 65536, v141
ds_read_b64_tr_b16 a[16:17], v142 offset:0
ds_read_b64_tr_b16 a[18:19], v142 offset:512
ds_read_b64_tr_b16 a[20:21], v142 offset:2048
ds_read_b64_tr_b16 a[22:23], v142 offset:2560
ds_read_b64_tr_b16 a[80:81], v143 offset:0
ds_read_b64_tr_b16 a[82:83], v143 offset:512
ds_read_b64_tr_b16 a[84:85], v143 offset:2048
ds_read_b64_tr_b16 a[86:87], v143 offset:2560
ds_read_b64_tr_b16 a[48:49], v142 offset:16384
ds_read_b64_tr_b16 a[50:51], v142 offset:16896
ds_read_b64_tr_b16 a[52:53], v142 offset:18432
ds_read_b64_tr_b16 a[54:55], v142 offset:18944
ds_read_b64_tr_b16 a[112:113], v143 offset:16384
ds_read_b64_tr_b16 a[114:115], v143 offset:16896
ds_read_b64_tr_b16 a[116:117], v143 offset:18432
ds_read_b64_tr_b16 a[118:119], v143 offset:18944
s_waitcnt lgkmcnt(0)
s_barrier
s_mov_b32 m0, 65536
s_mov_b32 s38, 0x200000
buffer_load_dwordx4 v136, s[12:15], s38 offen  lds
s_mov_b32 m0, 66560
s_mov_b32 s38, 0x208000
buffer_load_dwordx4 v136, s[12:15], s38 offen  lds
s_mov_b32 m0, 67584
s_mov_b32 s38, 0x210000
buffer_load_dwordx4 v136, s[12:15], s38 offen  lds
s_mov_b32 m0, 68608
s_mov_b32 s38, 0x218000
buffer_load_dwordx4 v136, s[12:15], s38 offen  lds
s_mov_b32 m0, 69632
s_mov_b32 s38, 0x220000
buffer_load_dwordx4 v137, s[12:15], s38 offen  lds
s_mov_b32 m0, 70656
s_mov_b32 s38, 0x228000
buffer_load_dwordx4 v137, s[12:15], s38 offen  lds
s_mov_b32 m0, 71680
s_mov_b32 s38, 0x230000
buffer_load_dwordx4 v137, s[12:15], s38 offen  lds
s_mov_b32 m0, 72704
s_mov_b32 s38, 0x238000
buffer_load_dwordx4 v137, s[12:15], s38 offen  lds
s_waitcnt vmcnt(24)
s_barrier
v_add_u32 v142, 98304, v140
v_add_u32 v143, 98304, v141
ds_read_b64_tr_b16 a[24:25], v142 offset:0
ds_read_b64_tr_b16 a[26:27], v142 offset:512
ds_read_b64_tr_b16 a[28:29], v142 offset:2048
ds_read_b64_tr_b16 a[30:31], v142 offset:2560
ds_read_b64_tr_b16 a[88:89], v143 offset:0
ds_read_b64_tr_b16 a[90:91], v143 offset:512
ds_read_b64_tr_b16 a[92:93], v143 offset:2048
ds_read_b64_tr_b16 a[94:95], v143 offset:2560
ds_read_b64_tr_b16 a[56:57], v142 offset:16384
ds_read_b64_tr_b16 a[58:59], v142 offset:16896
ds_read_b64_tr_b16 a[60:61], v142 offset:18432
ds_read_b64_tr_b16 a[62:63], v142 offset:18944
ds_read_b64_tr_b16 a[120:121], v143 offset:16384
ds_read_b64_tr_b16 a[122:123], v143 offset:16896
ds_read_b64_tr_b16 a[124:125], v143 offset:18432
ds_read_b64_tr_b16 a[126:127], v143 offset:18944
s_waitcnt lgkmcnt(0)
s_barrier
s_mov_b32 m0, 98304
s_mov_b32 s38, 0x300000
buffer_load_dwordx4 v136, s[12:15], s38 offen  lds
s_mov_b32 m0, 99328
s_mov_b32 s38, 0x308000
buffer_load_dwordx4 v136, s[12:15], s38 offen  lds
s_mov_b32 m0, 100352
s_mov_b32 s38, 0x310000
buffer_load_dwordx4 v136, s[12:15], s38 offen  lds
s_mov_b32 m0, 101376
s_mov_b32 s38, 0x318000
buffer_load_dwordx4 v136, s[12:15], s38 offen  lds
s_mov_b32 m0, 102400
s_mov_b32 s38, 0x320000
buffer_load_dwordx4 v137, s[12:15], s38 offen  lds
s_mov_b32 m0, 103424
s_mov_b32 s38, 0x328000
buffer_load_dwordx4 v137, s[12:15], s38 offen  lds
s_mov_b32 m0, 104448
s_mov_b32 s38, 0x330000
buffer_load_dwordx4 v137, s[12:15], s38 offen  lds
s_mov_b32 m0, 105472
s_mov_b32 s38, 0x338000
buffer_load_dwordx4 v137, s[12:15], s38 offen  lds
s_waitcnt vmcnt(24)
s_barrier
v_add_u32 v142, 0, v140
v_add_u32 v143, 0, v141
ds_read_b64_tr_b16 a[128:129], v142 offset:0
ds_read_b64_tr_b16 a[130:131], v142 offset:512
ds_read_b64_tr_b16 a[132:133], v142 offset:2048
ds_read_b64_tr_b16 a[134:135], v142 offset:2560
ds_read_b64_tr_b16 a[192:193], v143 offset:0
ds_read_b64_tr_b16 a[194:195], v143 offset:512
ds_read_b64_tr_b16 a[196:197], v143 offset:2048
ds_read_b64_tr_b16 a[198:199], v143 offset:2560
ds_read_b64_tr_b16 a[160:161], v142 offset:16384
ds_read_b64_tr_b16 a[162:163], v142 offset:16896
ds_read_b64_tr_b16 a[164:165], v142 offset:18432
ds_read_b64_tr_b16 a[166:167], v142 offset:18944
ds_read_b64_tr_b16 a[224:225], v143 offset:16384
ds_read_b64_tr_b16 a[226:227], v143 offset:16896
ds_read_b64_tr_b16 a[228:229], v143 offset:18432
ds_read_b64_tr_b16 a[230:231], v143 offset:18944
s_waitcnt lgkmcnt(0)
s_barrier
s_mov_b32 s12, s54
s_mov_b32 s13, s55
s_mov_b32 s14, 0x400000
s_mov_b32 m0, 0
s_mov_b32 s38, 0x0
buffer_load_dwordx4 v136, s[12:15], s38 offen  lds
s_mov_b32 m0, 1024
s_mov_b32 s38, 0x8000
buffer_load_dwordx4 v136, s[12:15], s38 offen  lds
s_mov_b32 m0, 2048
s_mov_b32 s38, 0x10000
buffer_load_dwordx4 v136, s[12:15], s38 offen  lds
s_mov_b32 m0, 3072
s_mov_b32 s38, 0x18000
buffer_load_dwordx4 v136, s[12:15], s38 offen  lds
s_mov_b32 m0, 4096
s_mov_b32 s38, 0x20000
buffer_load_dwordx4 v137, s[12:15], s38 offen  lds
s_mov_b32 m0, 5120
s_mov_b32 s38, 0x28000
buffer_load_dwordx4 v137, s[12:15], s38 offen  lds
s_mov_b32 m0, 6144
s_mov_b32 s38, 0x30000
buffer_load_dwordx4 v137, s[12:15], s38 offen  lds
s_mov_b32 m0, 7168
s_mov_b32 s38, 0x38000
buffer_load_dwordx4 v137, s[12:15], s38 offen  lds
s_waitcnt vmcnt(24)
s_barrier
v_add_u32 v142, 32768, v140
v_add_u32 v143, 32768, v141
ds_read_b64_tr_b16 a[136:137], v142 offset:0
ds_read_b64_tr_b16 a[138:139], v142 offset:512
ds_read_b64_tr_b16 a[140:141], v142 offset:2048
ds_read_b64_tr_b16 a[142:143], v142 offset:2560
ds_read_b64_tr_b16 a[200:201], v143 offset:0
ds_read_b64_tr_b16 a[202:203], v143 offset:512
ds_read_b64_tr_b16 a[204:205], v143 offset:2048
ds_read_b64_tr_b16 a[206:207], v143 offset:2560
ds_read_b64_tr_b16 a[168:169], v142 offset:16384
ds_read_b64_tr_b16 a[170:171], v142 offset:16896
ds_read_b64_tr_b16 a[172:173], v142 offset:18432
ds_read_b64_tr_b16 a[174:175], v142 offset:18944
ds_read_b64_tr_b16 a[232:233], v143 offset:16384
ds_read_b64_tr_b16 a[234:235], v143 offset:16896
ds_read_b64_tr_b16 a[236:237], v143 offset:18432
ds_read_b64_tr_b16 a[238:239], v143 offset:18944
s_waitcnt lgkmcnt(0)
s_barrier
s_cmp_lg_u32 s32, 0
s_cbranch_scc1 L_vfx_6
s_mov_b32 s36, 200000
s_branch L_vfe_5
L_vf_4:
v_mov_b32 v236, 0
buffer_load_dwordx4 v[224:227], v236, s[16:19], 0 offen sc1
buffer_load_dwordx4 v[228:231], v236, s[16:19], 0 offen offset:16 sc1
buffer_load_dwordx2 v[232:233], v236, s[16:19], 0 offen offset:128 sc1
s_sub_u32 s36, s36, 1
s_cmp_eq_u32 s36, 0
s_cbranch_scc1 L_abort
s_waitcnt vmcnt(0)
L_vfe_5:
v_add3_u32 v234, v225, v226, v227
v_add3_u32 v234, v234, v228, v229
v_add3_u32 v234, v234, v230, v231
v_add_u32 v234, v234, v232
v_max3_u32 v235, v225, v226, v227
v_max3_u32 v235, v235, v228, v229
v_max3_u32 v235, v235, v230, v231
v_max_u32 v235, v235, v232
v_cmp_lt_u32 vcc, 0x100, v234
s_cbranch_vccnz L_abort
v_cmp_ne_u32 vcc, 0x100, v234
s_cbranch_vccnz L_vf_4
v_cmp_eq_u32 vcc, 0, v233
s_cbranch_vccnz L_vf_4
v_readfirstlane_b32 s46, v233
v_readfirstlane_b32 s36, v235
s_cmp_lg_u32 s36, 32
s_cbranch_scc1 L_slow
L_vfx_6:
s_cmp_lg_u32 s32, 0
s_cbranch_scc1 L_inis_7
s_mov_b32 s99, 160256
v_mov_b32 v208, -1
v_mov_b32 v209, -1
v_mov_b32 v210, -1
v_mov_b32 v211, -1
s_mov_b32 s39, 0x100000
v_min_u32 v204, 0xfffffffe, v204
buffer_store_dword v204, v251, s[8:11], s39 offen
s_add_u32 s39, s39, 8192
buffer_store_dword v208, v251, s[8:11], s39 offen
s_add_u32 s39, s39, 8192
buffer_store_dword v208, v251, s[8:11], s39 offen
s_add_u32 s39, s39, 8192
buffer_store_dword v208, v251, s[8:11], s39 offen
s_lshl_b32 s39, s21, 13
s_add_u32 s39, s39, 0x200000
buffer_store_dwordx4 v[208:211], v247, s[8:11], s39 offen offset:0
buffer_store_dwordx4 v[208:211], v247, s[8:11], s39 offen offset:1024
s_lshl_b32 s39, s21, 13
s_add_u32 s39, s39, 0x240000
buffer_store_dwordx4 v[208:211], v247, s[8:11], s39 offen offset:0
buffer_store_dwordx4 v[208:211], v247, s[8:11], s39 offen offset:1024
v_and_b32 v202, 1, v200
v_lshlrev_b32 v202, 4, v202
v_mov_b32 v203, 0x3f80
v_lshlrev_b32 v203, v202, v203
v_lshrrev_b32 v202, 1, v200
v_cmp_eq_u32 vcc, 0, v202
s_nop 1
v_cndmask_b32 v204, 0, v203, vcc
v_cmp_eq_u32 vcc, 1, v202
s_nop 1
v_cndmask_b32 v205, 0, v203, vcc
v_cmp_eq_u32 vcc, 2, v202
s_nop 1
v_cndmask_b32 v206, 0, v203, vcc
v_cmp_eq_u32 vcc, 3, v202
s_nop 1
v_cndmask_b32 v207, 0, v203, vcc
v_lshrrev_b32 v203, 9, v247
v_mul_u32_u24 v203, 512, v203
v_add3_u32 v202, v247, v203, s99
ds_write_b128 v202, v[204:207]
s_branch L_inie_8
L_inis_7:
s_mov_b32 s99, 160256
v_mov_b32 v208, -1
v_mov_b32 v209, -1
v_mov_b32 v210, -1
v_mov_b32 v211, -1
s_mov_b32 s39, 0x100000
v_min_u32 v204, 0xfffffffe, v204
buffer_store_dword v204, v251, s[8:11], s39 offen sc1
s_add_u32 s39, s39, 8192
buffer_store_dword v208, v251, s[8:11], s39 offen sc1
s_add_u32 s39, s39, 8192
buffer_store_dword v208, v251, s[8:11], s39 offen sc1
s_add_u32 s39, s39, 8192
buffer_store_dword v208, v251, s[8:11], s39 offen sc1
s_lshl_b32 s39, s21, 13
s_add_u32 s39, s39, 0x200000
buffer_store_dwordx4 v[208:211], v247, s[8:11], s39 offen offset:0 sc1
buffer_store_dwordx4 v[208:211], v247, s[8:11], s39 offen offset:1024 sc1
s_lshl_b32 s39, s21, 13
s_add_u32 s39, s39, 0x240000
buffer_store_dwordx4 v[208:211], v247, s[8:11], s39 offen offset:0 sc1
buffer_store_dwordx4 v[208:211], v247, s[8:11], s39 offen offset:1024 sc1
v_and_b32 v202, 1, v200
v_lshlrev_b32 v202, 4, v202
v_mov_b32 v203, 0x3f80
v_lshlrev_b32 v203, v202, v203
v_lshrrev_b32 v202, 1, v200
v_cmp_eq_u32 vcc, 0, v202
s_nop 1
v_cndmask_b32 v204, 0, v203, vcc
v_cmp_eq_u32 vcc, 1, v202
s_nop 1
v_cndmask_b32 v205, 0, v203, vcc
v_cmp_eq_u32 vcc, 2, v202
s_nop 1
v_cndmask_b32 v206, 0, v203, vcc
v_cmp_eq_u32 vcc, 3, v202
s_nop 1
v_cndmask_b32 v207, 0, v203, vcc
v_lshrrev_b32 v203, 9, v247
v_mul_u32_u24 v203, 512, v203
v_add3_u32 v202, v247, v203, s99
ds_write_b128 v202, v[204:207]
L_inie_8:
s_mov_b32 m0, 32768
s_mov_b32 s38, 0x100000
buffer_load_dwordx4 v136, s[12:15], s38 offen  lds
s_mov_b32 m0, 33792
s_mov_b32 s38, 0x108000
buffer_load_dwordx4 v136, s[12:15], s38 offen  lds
s_mov_b32 m0, 34816
s_mov_b32 s38, 0x110000
buffer_load_dwordx4 v136, s[12:15], s38 offen  lds
s_mov_b32 m0, 35840
s_mov_b32 s38, 0x118000
buffer_load_dwordx4 v136, s[12:15], s38 offen  lds
s_mov_b32 m0, 36864
s_mov_b32 s38, 0x120000
buffer_load_dwordx4 v137, s[12:15], s38 offen  lds
s_mov_b32 m0, 37888
s_mov_b32 s38, 0x128000
buffer_load_dwordx4 v137, s[12:15], s38 offen  lds
s_mov_b32 m0, 38912
s_mov_b32 s38, 0x130000
buffer_load_dwordx4 v137, s[12:15], s38 offen  lds
s_mov_b32 m0, 39936
s_mov_b32 s38, 0x138000
buffer_load_dwordx4 v137, s[12:15], s38 offen  lds
s_waitcnt vmcnt(24)
s_barrier
v_add_u32 v142, 65536, v140
v_add_u32 v143, 65536, v141
ds_read_b64_tr_b16 a[144:145], v142 offset:0
ds_read_b64_tr_b16 a[146:147], v142 offset:512
ds_read_b64_tr_b16 a[148:149], v142 offset:2048
ds_read_b64_tr_b16 a[150:151], v142 offset:2560
ds_read_b64_tr_b16 a[208:209], v143 offset:0
ds_read_b64_tr_b16 a[210:211], v143 offset:512
ds_read_b64_tr_b16 a[212:213], v143 offset:2048
ds_read_b64_tr_b16 a[214:215], v143 offset:2560
ds_read_b64_tr_b16 a[176:177], v142 offset:16384
ds_read_b64_tr_b16 a[178:179], v142 offset:16896
ds_read_b64_tr_b16 a[180:181], v142 offset:18432
ds_read_b64_tr_b16 a[182:183], v142 offset:18944
ds_read_b64_tr_b16 a[240:241], v143 offset:16384
ds_read_b64_tr_b16 a[242:243], v143 offset:16896
ds_read_b64_tr_b16 a[244:245], v143 offset:18432
ds_read_b64_tr_b16 a[246:247], v143 offset:18944
s_waitcnt lgkmcnt(0)
s_barrier
s_mov_b32 m0, 65536
s_mov_b32 s38, 0x200000
buffer_load_dwordx4 v136, s[12:15], s38 offen  lds
s_mov_b32 m0, 66560
s_mov_b32 s38, 0x208000
buffer_load_dwordx4 v136, s[12:15], s38 offen  lds
s_mov_b32 m0, 67584
s_mov_b32 s38, 0x210000
buffer_load_dwordx4 v136, s[12:15], s38 offen  lds
s_mov_b32 m0, 68608
s_mov_b32 s38, 0x218000
buffer_load_dwordx4 v136, s[12:15], s38 offen  lds
s_mov_b32 m0, 69632
s_mov_b32 s38, 0x220000
buffer_load_dwordx4 v137, s[12:15], s38 offen  lds
s_mov_b32 m0, 70656
s_mov_b32 s38, 0x228000
buffer_load_dwordx4 v137, s[12:15], s38 offen  lds
s_mov_b32 m0, 71680
s_mov_b32 s38, 0x230000
buffer_load_dwordx4 v137, s[12:15], s38 offen  lds
s_mov_b32 m0, 72704
s_mov_b32 s38, 0x238000
buffer_load_dwordx4 v137, s[12:15], s38 offen  lds
s_waitcnt vmcnt(24)
s_barrier
v_add_u32 v142, 98304, v140
v_add_u32 v143, 98304, v141
ds_read_b64_tr_b16 a[152:153], v142 offset:0
ds_read_b64_tr_b16 a[154:155], v142 offset:512
ds_read_b64_tr_b16 a[156:157], v142 offset:2048
ds_read_b64_tr_b16 a[158:159], v142 offset:2560
ds_read_b64_tr_b16 a[216:217], v143 offset:0
ds_read_b64_tr_b16 a[218:219], v143 offset:512
ds_read_b64_tr_b16 a[220:221], v143 offset:2048
ds_read_b64_tr_b16 a[222:223], v143 offset:2560
ds_read_b64_tr_b16 a[184:185], v142 offset:16384
ds_read_b64_tr_b16 a[186:187], v142 offset:16896
ds_read_b64_tr_b16 a[188:189], v142 offset:18432
ds_read_b64_tr_b16 a[190:191], v142 offset:18944
ds_read_b64_tr_b16 a[248:249], v143 offset:16384
ds_read_b64_tr_b16 a[250:251], v143 offset:16896
ds_read_b64_tr_b16 a[252:253], v143 offset:18432
ds_read_b64_tr_b16 a[254:255], v143 offset:18944
s_waitcnt lgkmcnt(0)
s_barrier
s_mov_b32 m0, 98304
s_mov_b32 s38, 0x300000
buffer_load_dwordx4 v136, s[12:15], s38 offen  lds
s_mov_b32 m0, 99328
s_mov_b32 s38, 0x308000
buffer_load_dwordx4 v136, s[12:15], s38 offen  lds
s_mov_b32 m0, 100352
s_mov_b32 s38, 0x310000
buffer_load_dwordx4 v136, s[12:15], s38 offen  lds
s_mov_b32 m0, 101376
s_mov_b32 s38, 0x318000
buffer_load_dwordx4 v136, s[12:15], s38 offen  lds
s_mov_b32 m0, 102400
s_mov_b32 s38, 0x320000
buffer_load_dwordx4 v137, s[12:15], s38 offen  lds
s_mov_b32 m0, 103424
s_mov_b32 s38, 0x328000
buffer_load_dwordx4 v137, s[12:15], s38 offen  lds
s_mov_b32 m0, 104448
s_mov_b32 s38, 0x330000
buffer_load_dwordx4 v137, s[12:15], s38 offen  lds
s_mov_b32 m0, 105472
s_mov_b32 s38, 0x338000
buffer_load_dwordx4 v137, s[12:15], s38 offen  lds
s_waitcnt vmcnt(24)
s_barrier
v_add_u32 v142, 0, v140
v_add_u32 v143, 0, v141
ds_read_b64_tr_b16 v[0:1], v142 offset:0
ds_read_b64_tr_b16 v[2:3], v142 offset:512
ds_read_b64_tr_b16 v[4:5], v142 offset:2048
ds_read_b64_tr_b16 v[6:7], v142 offset:2560
ds_read_b64_tr_b16 v[64:65], v143 offset:0
ds_read_b64_tr_b16 v[66:67], v143 offset:512
ds_read_b64_tr_b16 v[68:69], v143 offset:2048
ds_read_b64_tr_b16 v[70:71], v143 offset:2560
ds_read_b64_tr_b16 v[32:33], v142 offset:16384
ds_read_b64_tr_b16 v[34:35], v142 offset:16896
ds_read_b64_tr_b16 v[36:37], v142 offset:18432
ds_read_b64_tr_b16 v[38:39], v142 offset:18944
ds_read_b64_tr_b16 v[96:97], v143 offset:16384
ds_read_b64_tr_b16 v[98:99], v143 offset:16896
ds_read_b64_tr_b16 v[100:101], v143 offset:18432
ds_read_b64_tr_b16 v[102:103], v143 offset:18944
s_waitcnt lgkmcnt(0)
s_barrier
s_mov_b32 s12, s56
s_mov_b32 s13, s57
s_mov_b32 s14, 0x400000
s_mov_b32 m0, 0
s_mov_b32 s38, 0x0
buffer_load_dwordx4 v138, s[12:15], s38 offen  lds
s_mov_b32 m0, 1024
s_mov_b32 s38, 0x1000
buffer_load_dwordx4 v138, s[12:15], s38 offen  lds
s_mov_b32 m0, 2048
s_mov_b32 s38, 0x2000
buffer_load_dwordx4 v138, s[12:15], s38 offen  lds
s_mov_b32 m0, 3072
s_mov_b32 s38, 0x3000
buffer_load_dwordx4 v138, s[12:15], s38 offen  lds
s_mov_b32 m0, 4096
s_mov_b32 s38, 0x4000
buffer_load_dwordx4 v139, s[12:15], s38 offen  lds
s_mov_b32 m0, 5120
s_mov_b32 s38, 0x5000
buffer_load_dwordx4 v139, s[12:15], s38 offen  lds
s_mov_b32 m0, 6144
s_mov_b32 s38, 0x6000
buffer_load_dwordx4 v139, s[12:15], s38 offen  lds
s_mov_b32 m0, 7168
s_mov_b32 s38, 0x7000
buffer_load_dwordx4 v139, s[12:15], s38 offen  lds
s_waitcnt vmcnt(24)
s_barrier
v_add_u32 v142, 32768, v140
v_add_u32 v143, 32768, v141
ds_read_b64_tr_b16 v[8:9], v142 offset:0
ds_read_b64_tr_b16 v[10:11], v142 offset:512
ds_read_b64_tr_b16 v[12:13], v142 offset:2048
ds_read_b64_tr_b16 v[14:15], v142 offset:2560
ds_read_b64_tr_b16 v[72:73], v143 offset:0
ds_read_b64_tr_b16 v[74:75], v143 offset:512
ds_read_b64_tr_b16 v[76:77], v143 offset:2048
ds_read_b64_tr_b16 v[78:79], v143 offset:2560
ds_read_b64_tr_b16 v[40:41], v142 offset:16384
ds_read_b64_tr_b16 v[42:43], v142 offset:16896
ds_read_b64_tr_b16 v[44:45], v142 offset:18432
ds_read_b64_tr_b16 v[46:47], v142 offset:18944
ds_read_b64_tr_b16 v[104:105], v143 offset:16384
ds_read_b64_tr_b16 v[106:107], v143 offset:16896
ds_read_b64_tr_b16 v[108:109], v143 offset:18432
ds_read_b64_tr_b16 v[110:111], v143 offset:18944
s_waitcnt lgkmcnt(0)
s_barrier
s_barrier
s_mov_b32 s22, 0
s_mov_b32 s96, 0
s_mov_b32 s42, 0
s_mov_b32 s23, 0x100000
s_mov_b32 s24, 0x101000
s_mov_b32 s25, 0x200000
s_add_u32 s26, s25, 32768
s_lshl_b32 s27, s21, 13
s_add_u32 s27, s27, 0x200000
s_lshl_b32 s29, s21, 13
s_add_u32 s30, s29, 0x1800000
s_add_u32 s29, s29, 0x800000
s_lshl_b32 s31, s21, 11
s_add_u32 s37, s31, 0x3c00000
s_add_u32 s31, s31, 0x3800000
s_mov_b32 s34, 0x3e0293ee
s_mov_b32 s35, 0xbe0293ee
s_mov_b32 s100, 0x3f803f80
s_mov_b32 s101, 0x3f803f80
v_mov_b64 v[244:245], 0
s_lshl_b32 s98, s21, 6
s_add_u32 s98, s98, 0x10400
s_add_u32 s47, s98, 48
s_mov_b32 m0, 32768
s_mov_b32 s38, 0x100
buffer_load_dwordx4 v138, s[12:15], s38 offen  lds
s_mov_b32 m0, 33792
s_mov_b32 s38, 0x1100
buffer_load_dwordx4 v138, s[12:15], s38 offen  lds
s_mov_b32 m0, 34816
s_mov_b32 s38, 0x2100
buffer_load_dwordx4 v138, s[12:15], s38 offen  lds
s_mov_b32 m0, 35840
s_mov_b32 s38, 0x3100
buffer_load_dwordx4 v138, s[12:15], s38 offen  lds
s_mov_b32 m0, 36864
s_mov_b32 s38, 0x4100
buffer_load_dwordx4 v139, s[12:15], s38 offen  lds
s_mov_b32 m0, 37888
s_mov_b32 s38, 0x5100
buffer_load_dwordx4 v139, s[12:15], s38 offen  lds
s_mov_b32 m0, 38912
s_mov_b32 s38, 0x6100
buffer_load_dwordx4 v139, s[12:15], s38 offen  lds
s_mov_b32 m0, 39936
s_mov_b32 s38, 0x7100
buffer_load_dwordx4 v139, s[12:15], s38 offen  lds
s_waitcnt vmcnt(24)
s_barrier
v_add_u32 v142, 65536, v140
v_add_u32 v143, 65536, v141
ds_read_b64_tr_b16 v[16:17], v142 offset:0
ds_read_b64_tr_b16 v[18:19], v142 offset:512
ds_read_b64_tr_b16 v[20:21], v142 offset:2048
ds_read_b64_tr_b16 v[22:23], v142 offset:2560
ds_read_b64_tr_b16 v[80:81], v143 offset:0
ds_read_b64_tr_b16 v[82:83], v143 offset:512
ds_read_b64_tr_b16 v[84:85], v143 offset:2048
ds_read_b64_tr_b16 v[86:87], v143 offset:2560
ds_read_b64_tr_b16 v[48:49], v142 offset:16384
ds_read_b64_tr_b16 v[50:51], v142 offset:16896
ds_read_b64_tr_b16 v[52:53], v142 offset:18432
ds_read_b64_tr_b16 v[54:55], v142 offset:18944
ds_read_b64_tr_b16 v[112:113], v143 offset:16384
ds_read_b64_tr_b16 v[114:115], v143 offset:16896
ds_read_b64_tr_b16 v[116:117], v143 offset:18432
ds_read_b64_tr_b16 v[118:119], v143 offset:18944
s_waitcnt lgkmcnt(0)
s_barrier
buffer_load_dwordx4 v[224:227], v244, s[8:11], s98 offen offset:16 sc1
buffer_load_dwordx4 v[228:231], v244, s[8:11], s98 offen offset:32 sc1
s_mov_b32 m0, 65536
s_mov_b32 s38, 0x200
buffer_load_dwordx4 v138, s[12:15], s38 offen  lds
s_mov_b32 m0, 66560
s_mov_b32 s38, 0x1200
buffer_load_dwordx4 v138, s[12:15], s38 offen  lds
s_mov_b32 m0, 67584
s_mov_b32 s38, 0x2200
buffer_load_dwordx4 v138, s[12:15], s38 offen  lds
s_mov_b32 m0, 68608
s_mov_b32 s38, 0x3200
buffer_load_dwordx4 v138, s[12:15], s38 offen  lds
s_mov_b32 m0, 69632
s_mov_b32 s38, 0x4200
buffer_load_dwordx4 v139, s[12:15], s38 offen  lds
s_mov_b32 m0, 70656
s_mov_b32 s38, 0x5200
buffer_load_dwordx4 v139, s[12:15], s38 offen  lds
s_mov_b32 m0, 71680
s_mov_b32 s38, 0x6200
buffer_load_dwordx4 v139, s[12:15], s38 offen  lds
s_mov_b32 m0, 72704
s_mov_b32 s38, 0x7200
buffer_load_dwordx4 v139, s[12:15], s38 offen  lds
s_waitcnt vmcnt(24)
s_barrier
v_add_u32 v142, 98304, v140
v_add_u32 v143, 98304, v141
ds_read_b64_tr_b16 v[24:25], v142 offset:0
ds_read_b64_tr_b16 v[26:27], v142 offset:512
ds_read_b64_tr_b16 v[28:29], v142 offset:2048
ds_read_b64_tr_b16 v[30:31], v142 offset:2560
ds_read_b64_tr_b16 v[88:89], v143 offset:0
ds_read_b64_tr_b16 v[90:91], v143 offset:512
ds_read_b64_tr_b16 v[92:93], v143 offset:2048
ds_read_b64_tr_b16 v[94:95], v143 offset:2560
ds_read_b64_tr_b16 v[56:57], v142 offset:16384
ds_read_b64_tr_b16 v[58:59], v142 offset:16896
ds_read_b64_tr_b16 v[60:61], v142 offset:18432
ds_read_b64_tr_b16 v[62:63], v142 offset:18944
ds_read_b64_tr_b16 v[120:121], v143 offset:16384
ds_read_b64_tr_b16 v[122:123], v143 offset:16896
ds_read_b64_tr_b16 v[124:125], v143 offset:18432
ds_read_b64_tr_b16 v[126:127], v143 offset:18944
s_waitcnt lgkmcnt(0)
s_barrier
s_mov_b32 m0, 98304
s_mov_b32 s38, 0x300
buffer_load_dwordx4 v138, s[12:15], s38 offen  lds
s_mov_b32 m0, 99328
s_mov_b32 s38, 0x1300
buffer_load_dwordx4 v138, s[12:15], s38 offen  lds
s_mov_b32 m0, 100352
s_mov_b32 s38, 0x2300
buffer_load_dwordx4 v138, s[12:15], s38 offen  lds
s_mov_b32 m0, 101376
s_mov_b32 s38, 0x3300
buffer_load_dwordx4 v138, s[12:15], s38 offen  lds
s_mov_b32 m0, 102400
s_mov_b32 s38, 0x4300
buffer_load_dwordx4 v139, s[12:15], s38 offen  lds
s_mov_b32 m0, 103424
s_mov_b32 s38, 0x5300
buffer_load_dwordx4 v139, s[12:15], s38 offen  lds
s_mov_b32 m0, 104448
s_mov_b32 s38, 0x6300
buffer_load_dwordx4 v139, s[12:15], s38 offen  lds
s_mov_b32 m0, 105472
s_mov_b32 s38, 0x7300
buffer_load_dwordx4 v139, s[12:15], s38 offen  lds
s_waitcnt vmcnt(8)
s_mov_b32 s43, 0
s_cmp_ge_u32 s43, 64
s_cbranch_scc1 L_hx_10
s_mov_b32 s36, 200000
s_branch L_he_11
L_hq_9:
buffer_load_dwordx4 v[224:227], v244, s[8:11], s98 offen offset:16 sc1
buffer_load_dwordx4 v[228:231], v244, s[8:11], s98 offen offset:32 sc1
s_sub_u32 s36, s36, 1
s_cmp_eq_u32 s36, 0
s_cbranch_scc1 L_abort
s_waitcnt vmcnt(0)
L_he_11:
v_cmp_eq_u32 vcc, s46, v225
s_nop 1
v_cndmask_b32 v224, 0, v224, vcc
v_cmp_eq_u32 vcc, s46, v227
s_nop 1
v_cndmask_b32 v226, 0, v226, vcc
v_cmp_eq_u32 vcc, s46, v229
s_nop 1
v_cndmask_b32 v228, 0, v228, vcc
v_cmp_eq_u32 vcc, s46, v231
s_nop 1
v_cndmask_b32 v230, 0, v230, vcc
v_min_u32 v224, v224, v228
v_min_u32 v225, v226, v230
v_lshlrev_b32 v224, 1, v224
v_lshl_add_u32 v225, v225, 1, 1
v_min_u32 v224, v224, v225
s_nop 0
v_readfirstlane_b32 s97, v224
s_cmp_ge_u32 s97, 64
s_cselect_b32 s97, 1000, s97
s_cmp_lt_u32 s43, s97
s_cbranch_scc0 L_hq_9
L_hx_10:
s_mov_b32 m0, 131072
s_nop 0
buffer_load_dwordx4 v247, s[8:11], s29 offen offset:0 sc1 lds
buffer_load_dwordx4 v247, s[8:11], s29 offen offset:1024 sc1 lds
s_add_u32 s29, s29, 262144
s_mov_b32 s44, 139264
v_mov_b32 v232, 136
buffer_load_dword v233, v232, s[16:19], 0 offen sc1
s_xor_b32 s39, s27, 0
buffer_load_dwordx4 v[228:231], v247, s[8:11], s39 offen offset:0 sc1
buffer_load_dwordx4 v[228:231], v247, s[8:11], s39 offen offset:1024 sc1
s_xor_b32 s39, s27, 262144
buffer_load_dwordx4 v[228:231], v247, s[8:11], s39 offen offset:0 sc1
buffer_load_dwordx4 v[228:231], v247, s[8:11], s39 offen offset:1024 sc1
buffer_load_dwordx4 v[228:231], v247, s[8:11], s30 offen offset:0 sc1
buffer_load_dwordx4 v[228:231], v247, s[8:11], s30 offen offset:1024 sc1
buffer_load_dword v228, v244, s[8:11], s31 offen sc1
buffer_load_dword v228, v244, s[8:11], s37 offen sc1
s_mov_b32 s39, 0x100000
buffer_load_dwordx4 v[228:231], v247, s[8:11], s39 offen offset:0 sc1
buffer_load_dwordx4 v[228:231], v247, s[8:11], s39 offen offset:1024 sc1
s_mov_b32 s39, 0x102000
buffer_load_dwordx4 v[228:231], v247, s[8:11], s39 offen offset:0 sc1
buffer_load_dwordx4 v[228:231], v247, s[8:11], s39 offen offset:1024 sc1
s_mov_b32 s39, 0x104000
buffer_load_dwordx4 v[228:231], v247, s[8:11], s39 offen offset:0 sc1
buffer_load_dwordx4 v[228:231], v247, s[8:11], s39 offen offset:1024 sc1
s_mov_b32 s39, 0x106000
buffer_load_dwordx4 v[228:231], v247, s[8:11], s39 offen offset:0 sc1
buffer_load_dwordx4 v[228:231], v247, s[8:11], s39 offen offset:1024 sc1
s_getpc_b64 s[40:41]
L_pc_12:
s_add_u32 s40, s40, L_step_w0f-L_pc_12
s_addc_u32 s41, s41, 0
global_load_dwordx4 v[228:231], v247, s[40:41] offset:0
global_load_dwordx4 v[228:231], v247, s[40:41] offset:1024
global_load_dwordx4 v[228:231], v247, s[40:41] offset:2048
global_load_dwordx4 v[228:231], v247, s[40:41] offset:3072
s_waitcnt vmcnt(23)
s_barrier
ds_read_b64_tr_b16 v[160:161], v148 offset:0
ds_read_b64_tr_b16 v[162:163], v148 offset:512
ds_read_b64_tr_b16 v[164:165], v148 offset:2048
ds_read_b64_tr_b16 v[166:167], v148 offset:2560
ds_read_b64_tr_b16 v[168:169], v149 offset:0
ds_read_b64_tr_b16 v[170:171], v149 offset:512
ds_read_b64_tr_b16 v[172:173], v149 offset:2048
ds_read_b64_tr_b16 v[174:175], v149 offset:2560
ds_read_b64_tr_b16 v[176:177], v150 offset:0
ds_read_b64_tr_b16 v[178:179], v150 offset:512
ds_read_b64_tr_b16 v[180:181], v150 offset:2048
ds_read_b64_tr_b16 v[182:183], v150 offset:2560
ds_read_b64_tr_b16 v[184:185], v151 offset:0
ds_read_b64_tr_b16 v[186:187], v151 offset:512
ds_read_b64_tr_b16 v[188:189], v151 offset:2048
ds_read_b64_tr_b16 v[190:191], v151 offset:2560
ds_read_b64_tr_b16 v[192:193], v152 offset:0
ds_read_b64_tr_b16 v[194:195], v152 offset:512
ds_read_b64_tr_b16 v[196:197], v152 offset:2048
ds_read_b64_tr_b16 v[198:199], v152 offset:2560
ds_read_b64_tr_b16 v[200:201], v153 offset:0
ds_read_b64_tr_b16 v[202:203], v153 offset:512
ds_read_b64_tr_b16 v[204:205], v153 offset:2048
ds_read_b64_tr_b16 v[206:207], v153 offset:2560
ds_read_b64_tr_b16 v[208:209], v154 offset:0
ds_read_b64_tr_b16 v[210:211], v154 offset:512
ds_read_b64_tr_b16 v[212:213], v154 offset:2048
ds_read_b64_tr_b16 v[214:215], v154 offset:2560
ds_read_b64_tr_b16 v[216:217], v155 offset:0
ds_read_b64_tr_b16 v[218:219], v155 offset:512
ds_read_b64_tr_b16 v[220:221], v155 offset:2048
ds_read_b64_tr_b16 v[222:223], v155 offset:2560
s_waitcnt lgkmcnt(0)
ds_write_b128 v248, v[160:163] offset:0
ds_write_b128 v248, v[164:167] offset:1024
ds_write_b128 v248, v[168:171] offset:2048
ds_write_b128 v248, v[172:175] offset:3072
ds_write_b128 v248, v[176:179] offset:4096
ds_write_b128 v248, v[180:183] offset:5120
ds_write_b128 v248, v[184:187] offset:6144
ds_write_b128 v248, v[188:191] offset:7168
ds_write_b128 v248, v[192:195] offset:8192
ds_write_b128 v248, v[196:199] offset:9216
ds_write_b128 v248, v[200:203] offset:10240
ds_write_b128 v248, v[204:207] offset:11264
ds_write_b128 v248, v[208:211] offset:12288
ds_write_b128 v248, v[212:215] offset:13312
ds_write_b128 v248, v[216:219] offset:14336
ds_write_b128 v248, v[220:223] offset:15360
s_waitcnt lgkmcnt(0)
ds_read_b64_tr_b16 v[160:161], v148 offset:16384
ds_read_b64_tr_b16 v[162:163], v148 offset:16896
ds_read_b64_tr_b16 v[164:165], v148 offset:18432
ds_read_b64_tr_b16 v[166:167], v148 offset:18944
ds_read_b64_tr_b16 v[168:169], v149 offset:16384
ds_read_b64_tr_b16 v[170:171], v149 offset:16896
ds_read_b64_tr_b16 v[172:173], v149 offset:18432
ds_read_b64_tr_b16 v[174:175], v149 offset:18944
ds_read_b64_tr_b16 v[176:177], v150 offset:16384
ds_read_b64_tr_b16 v[178:179], v150 offset:16896
ds_read_b64_tr_b16 v[180:181], v150 offset:18432
ds_read_b64_tr_b16 v[182:183], v150 offset:18944
ds_read_b64_tr_b16 v[184:185], v151 offset:16384
ds_read_b64_tr_b16 v[186:187], v151 offset:16896
ds_read_b64_tr_b16 v[188:189], v151 offset:18432
ds_read_b64_tr_b16 v[190:191], v151 offset:18944
ds_read_b64_tr_b16 v[192:193], v152 offset:16384
ds_read_b64_tr_b16 v[194:195], v152 offset:16896
ds_read_b64_tr_b16 v[196:197], v152 offset:18432
ds_read_b64_tr_b16 v[198:199], v152 offset:18944
ds_read_b64_tr_b16 v[200:201], v153 offset:16384
ds_read_b64_tr_b16 v[202:203], v153 offset:16896
ds_read_b64_tr_b16 v[204:205], v153 offset:18432
ds_read_b64_tr_b16 v[206:207], v153 offset:18944
ds_read_b64_tr_b16 v[208:209], v154 offset:16384
ds_read_b64_tr_b16 v[210:211], v154 offset:16896
ds_read_b64_tr_b16 v[212:213], v154 offset:18432
ds_read_b64_tr_b16 v[214:215], v154 offset:18944
ds_read_b64_tr_b16 v[216:217], v155 offset:16384
ds_read_b64_tr_b16 v[218:219], v155 offset:16896
ds_read_b64_tr_b16 v[220:221], v155 offset:18432
ds_read_b64_tr_b16 v[222:223], v155 offset:18944
s_waitcnt lgkmcnt(0)
ds_write_b128 v248, v[160:163] offset:16384
ds_write_b128 v248, v[164:167] offset:17408
ds_write_b128 v248, v[168:171] offset:18432
ds_write_b128 v248, v[172:175] offset:19456
ds_write_b128 v248, v[176:179] offset:20480
ds_write_b128 v248, v[180:183] offset:21504
ds_write_b128 v248, v[184:187] offset:22528
ds_write_b128 v248, v[188:191] offset:23552
ds_write_b128 v248, v[192:195] offset:24576
ds_write_b128 v248, v[196:199] offset:25600
ds_write_b128 v248, v[200:203] offset:26624
ds_write_b128 v248, v[204:207] offset:27648
ds_write_b128 v248, v[208:211] offset:28672
ds_write_b128 v248, v[212:215] offset:29696
ds_write_b128 v248, v[216:219] offset:30720
ds_write_b128 v248, v[220:223] offset:31744
s_waitcnt lgkmcnt(0)
v_mov_b64 v[160:161], 0
v_mov_b64 v[162:163], 0
v_mov_b64 v[164:165], 0
v_mov_b64 v[166:167], 0
v_mov_b64 v[168:169], 0
v_mov_b64 v[170:171], 0
v_mov_b64 v[172:173], 0
v_mov_b64 v[174:175], 0
v_mov_b64 v[176:177], 0
v_mov_b64 v[178:179], 0
v_mov_b64 v[180:181], 0
v_mov_b64 v[182:183], 0
v_mov_b64 v[224:225], -1
v_mov_b64 v[226:227], -1
s_mov_b32 s41, 0x106000
v_mov_b64 v[244:245], 0
v_mov_b64 v[240:241], 0
v_mov_b64 v[242:243], 0
v_add_u32 v245, 151552, v247
s_mov_b32 s36, 200000
s_waitcnt vmcnt(0)
s_branch L_arq_14
L_arr_13:
buffer_load_dword v233, v232, s[16:19], 0 offen sc1
s_sub_u32 s36, s36, 1
s_cmp_eq_u32 s36, 0
s_cbranch_scc1 L_abort
s_waitcnt vmcnt(0)
L_arq_14:
v_cmp_ne_u32 vcc, 32, v233
s_cbranch_vccnz L_arr_13
s_waitcnt vmcnt(0)
s_barrier
s_cmp_lg_u32 s32, 0
s_cbranch_scc1 L_cslow0
L_step_w0f:
s_waitcnt vmcnt(0)
s_mov_b32 s36, 200000
buffer_load_dwordx4 v[184:187], v247, s[8:11], s23 offen offset:0 sc1
buffer_load_dwordx4 v[188:191], v247, s[8:11], s23 offen offset:1024 sc1
v_mov_b64 v[160:161], 0
v_mov_b64 v[162:163], 0
v_mov_b64 v[164:165], 0
v_mov_b64 v[166:167], 0
v_mov_b64 v[168:169], 0
v_mov_b64 v[170:171], 0
v_mov_b64 v[172:173], 0
v_mov_b64 v[174:175], 0
v_mov_b64 v[176:177], 0
v_mov_b64 v[178:179], 0
v_mov_b64 v[180:181], 0
v_mov_b64 v[182:183], 0
L_pl_18:
buffer_load_dwordx4 v[192:195], v247, s[8:11], s23 offen offset:0 sc1
buffer_load_dwordx4 v[196:199], v247, s[8:11], s23 offen offset:1024 sc1
s_waitcnt vmcnt(2)
ds_write_b128 v245, v[184:187] offset:0
ds_write_b128 v245, v[188:191] offset:1024
v_max3_u32 v255, v184, v185, v186
v_max3_u32 v255, v255, v187, v188
v_max3_u32 v255, v255, v189, v190
v_max_u32 v255, v255, v191
v_cmp_eq_u32 vcc, -1, v255
s_cbranch_vccz L_mok0_15
buffer_load_dwordx4 v[184:187], v247, s[8:11], s23 offen offset:0 sc1
buffer_load_dwordx4 v[188:191], v247, s[8:11], s23 offen offset:1024 sc1
s_waitcnt vmcnt(2)
ds_write_b128 v245, v[192:195] offset:0
ds_write_b128 v245, v[196:199] offset:1024
v_max3_u32 v255, v192, v193, v194
v_max3_u32 v255, v255, v195, v196
v_max3_u32 v255, v255, v197, v198
v_max_u32 v255, v255, v199
v_cmp_eq_u32 vcc, -1, v255
s_cbranch_vccz L_mok1_16
s_sub_u32 s36, s36, 1
s_cmp_lg_u32 s36, 0
s_cbranch_scc1 L_pl_18
s_branch L_abort
L_mok1_16:
v_smfmac_f32_16x16x64_bf16 v[160:163], v[192:195], a[0:7], v246
v_smfmac_f32_16x16x64_bf16 v[164:167], v[192:195], a[128:135], v246
v_smfmac_f32_16x16x64_bf16 v[168:171], v[192:195], a[64:71], v246
s_waitcnt lgkmcnt(0)
s_barrier
ds_read_b128 v[136:139], v245 offset:2048
ds_read_b128 v[140:143], v245 offset:3072
v_smfmac_f32_16x16x64_bf16 v[172:175], v[192:195], a[192:199], v246
ds_read_b128 v[144:147], v245 offset:4096
v_smfmac_f32_16x16x64_bf16 v[160:163], v[196:199], a[8:15], v246
ds_read_b128 v[148:151], v245 offset:5120
v_smfmac_f32_16x16x64_bf16 v[164:167], v[196:199], a[136:143], v246
ds_read_b128 v[152:155], v245 offset:6144
v_smfmac_f32_16x16x64_bf16 v[168:171], v[196:199], a[72:79], v246
ds_read_b128 v[156:159], v245 offset:7168
v_smfmac_f32_16x16x64_bf16 v[172:175], v[196:199], a[200:207], v246
ds_read_b128 v[128:131], v245 offset:0
ds_read_b128 v[132:135], v245 offset:1024
s_branch L_mjoin_17
L_mok0_15:
v_smfmac_f32_16x16x64_bf16 v[160:163], v[184:187], a[0:7], v246
v_smfmac_f32_16x16x64_bf16 v[164:167], v[184:187], a[128:135], v246
v_smfmac_f32_16x16x64_bf16 v[168:171], v[184:187], a[64:71], v246
s_waitcnt lgkmcnt(0)
s_barrier
ds_read_b128 v[136:139], v245 offset:2048
ds_read_b128 v[140:143], v245 offset:3072
v_smfmac_f32_16x16x64_bf16 v[172:175], v[184:187], a[192:199], v246
ds_read_b128 v[144:147], v245 offset:4096
v_smfmac_f32_16x16x64_bf16 v[160:163], v[188:191], a[8:15], v246
ds_read_b128 v[148:151], v245 offset:5120
v_smfmac_f32_16x16x64_bf16 v[164:167], v[188:191], a[136:143], v246
ds_read_b128 v[152:155], v245 offset:6144
v_smfmac_f32_16x16x64_bf16 v[168:171], v[188:191], a[72:79], v246
ds_read_b128 v[156:159], v245 offset:7168
v_smfmac_f32_16x16x64_bf16 v[172:175], v[188:191], a[200:207], v246
ds_read_b128 v[128:131], v245 offset:0
ds_read_b128 v[132:135], v245 offset:1024
L_mjoin_17:
buffer_store_dword v224, v251, s[8:11], s41 offen
s_waitcnt lgkmcnt(7)
v_smfmac_f32_16x16x64_bf16 v[160:163], v[136:139], a[16:23], v246
ds_read_b128 v[200:203], v249 offset:4096
v_smfmac_f32_16x16x64_bf16 v[164:167], v[136:139], a[144:151], v246
buffer_load_dwordx4 v[228:231], v247, s[8:11], s30 offen offset:0 sc1 nt
v_smfmac_f32_16x16x64_bf16 v[168:171], v[136:139], a[80:87], v246
ds_read_b128 v[204:207], v249 offset:5120
v_smfmac_f32_16x16x64_bf16 v[172:175], v[136:139], a[208:215], v246
s_waitcnt lgkmcnt(8)
v_smfmac_f32_16x16x64_bf16 v[160:163], v[140:143], a[24:31], v246
ds_read_b128 v[208:211], v249 offset:6144
v_smfmac_f32_16x16x64_bf16 v[164:167], v[140:143], a[152:159], v246
buffer_load_dwordx4 v[232:235], v247, s[8:11], s30 offen offset:1024 sc1 nt
v_smfmac_f32_16x16x64_bf16 v[168:171], v[140:143], a[88:95], v246
ds_read_b128 v[212:215], v249 offset:7168
v_smfmac_f32_16x16x64_bf16 v[172:175], v[140:143], a[216:223], v246
s_waitcnt lgkmcnt(9)
v_smfmac_f32_16x16x64_bf16 v[160:163], v[144:147], a[32:39], v246
s_waitcnt vmcnt(3)
s_add_u32 s43, s22, 3
s_cmp_ge_u32 s43, s97
s_cbranch_scc1 L_hz_19
L_hzb_20:
ds_read_b128 v[184:187], v249 offset:0
v_smfmac_f32_16x16x64_bf16 v[164:167], v[144:147], a[160:167], v246
s_mov_b32 m0, s44
s_nop 0
buffer_load_dwordx4 v247, s[8:11], s29 offen sc1 nt lds
v_smfmac_f32_16x16x64_bf16 v[168:171], v[144:147], a[96:103], v246
ds_read_b128 v[188:191], v249 offset:1024
v_smfmac_f32_16x16x64_bf16 v[172:175], v[144:147], a[224:231], v246
s_waitcnt lgkmcnt(10)
v_smfmac_f32_16x16x64_bf16 v[160:163], v[148:151], a[40:47], v246
ds_read_b128 v[192:195], v249 offset:2048
v_smfmac_f32_16x16x64_bf16 v[164:167], v[148:151], a[168:175], v246
buffer_load_dwordx4 v247, s[8:11], s29 offen offset:1024 sc1 nt lds
v_smfmac_f32_16x16x64_bf16 v[168:171], v[148:151], a[104:111], v246
ds_read_b128 v[196:199], v249 offset:3072
v_smfmac_f32_16x16x64_bf16 v[172:175], v[148:151], a[232:239], v246
s_waitcnt lgkmcnt(8)
v_smfmac_f32_16x16x64_bf16 v[160:163], v[152:155], a[48:55], v246
v_smfmac_f32_16x16x64_bf16 v[164:167], v[152:155], a[176:183], v246
v_smfmac_f32_16x16x64_bf16 v[160:163], v[156:159], a[56:63], v246
v_smfmac_f32_16x16x64_bf16 v[164:167], v[156:159], a[184:191], v246
v_smfmac_f32_16x16x64_bf16 v[168:171], v[152:155], a[112:119], v246
v_smfmac_f32_16x16x64_bf16 v[172:175], v[152:155], a[240:247], v246
v_smfmac_f32_16x16x64_bf16 v[168:171], v[156:159], a[120:127], v246
v_smfmac_f32_16x16x64_bf16 v[172:175], v[156:159], a[248:255], v246
v_smfmac_f32_16x16x64_bf16 v[176:179], v[128:131], v[0:7], v246
s_nop 1
v_add_f32 v160, v160, v162
v_add_f32 v161, v161, v163
v_smfmac_f32_16x16x64_bf16 v[180:183], v[128:131], v[64:71], v246
v_add_f32 v164, v164, v166
v_add_f32 v165, v165, v167
v_smfmac_f32_16x16x64_bf16 v[176:179], v[132:135], v[8:15], v246
v_cvt_pk_bf16_f32 v163, v160, v161
v_cvt_pk_bf16_f32 v162, v164, v165
ds_write_b64 v252, v[162:163] offset:0
v_add_f32 v168, v168, v170
v_add_f32 v169, v169, v171
v_add_f32 v172, v172, v174
v_add_f32 v173, v173, v175
v_cvt_pk_bf16_f32 v171, v168, v169
v_cvt_pk_bf16_f32 v170, v172, v173
ds_write_b64 v252, v[170:171] offset:512
v_smfmac_f32_16x16x64_bf16 v[180:183], v[132:135], v[72:79], v246
v_smfmac_f32_16x16x64_bf16 v[176:179], v[136:139], v[16:23], v246
v_smfmac_f32_16x16x64_bf16 v[180:183], v[136:139], v[80:87], v246
v_smfmac_f32_16x16x64_bf16 v[176:179], v[140:143], v[24:31], v246
s_waitcnt lgkmcnt(0)
s_barrier
ds_read_b64_tr_b16 v[160:161], v253 offset:0
ds_read_b64_tr_b16 v[162:163], v253 offset:512
ds_read_b64_tr_b16 v[164:165], v253 offset:1024
v_smfmac_f32_16x16x64_bf16 v[180:183], v[140:143], v[88:95], v246
ds_read_b64_tr_b16 v[166:167], v253 offset:1536
v_smfmac_f32_16x16x64_bf16 v[176:179], v[144:147], v[32:39], v246
ds_read_b64_tr_b16 v[168:169], v253 offset:2048
v_smfmac_f32_16x16x64_bf16 v[180:183], v[144:147], v[96:103], v246
ds_read_b64_tr_b16 v[170:171], v253 offset:2560
v_smfmac_f32_16x16x64_bf16 v[176:179], v[148:151], v[40:47], v246
ds_read_b64_tr_b16 v[172:173], v253 offset:3072
v_smfmac_f32_16x16x64_bf16 v[180:183], v[148:151], v[104:111], v246
ds_read_b64_tr_b16 v[174:175], v253 offset:3584
s_waitcnt lgkmcnt(6)
v_mfma_f32_16x16x32_bf16 v[216:219], v[184:187], v[160:163], 0
v_mfma_f32_16x16x32_bf16 v[220:223], v[200:203], v[160:163], 0
ds_read_b128 v[128:131], v248 offset:4096
v_mfma_f32_16x16x32_bf16 v[224:227], v[160:163], v[160:163], 0
ds_read_b128 v[132:135], v248 offset:5120
s_waitcnt lgkmcnt(6)
v_mfma_f32_16x16x32_bf16 v[216:219], v[188:191], v[164:167], v[216:219]
ds_read_b128 v[136:139], v248 offset:20480
v_mfma_f32_16x16x32_bf16 v[220:223], v[204:207], v[164:167], v[220:223]
ds_read_b128 v[140:143], v248 offset:21504
v_mfma_f32_16x16x32_bf16 v[224:227], v[164:167], v[164:167], v[224:227]
ds_read_b128 v[144:147], v248 offset:6144
s_waitcnt lgkmcnt(7)
v_mfma_f32_16x16x32_bf16 v[216:219], v[192:195], v[168:171], v[216:219]
ds_read_b128 v[148:151], v248 offset:7168
v_mfma_f32_16x16x32_bf16 v[220:223], v[208:211], v[168:171], v[220:223]
v_mfma_f32_16x16x32_bf16 v[224:227], v[168:171], v[168:171], v[224:227]
s_waitcnt lgkmcnt(6)
v_mfma_f32_16x16x32_bf16 v[216:219], v[196:199], v[172:175], v[216:219]
v_mfma_f32_16x16x32_bf16 v[220:223], v[212:215], v[172:175], v[220:223]
v_mfma_f32_16x16x32_bf16 v[224:227], v[172:175], v[172:175], v[224:227]
buffer_store_dwordx4 v[160:163], v254, s[8:11], s31 offen offset:0 sc1
v_smfmac_f32_16x16x64_bf16 v[176:179], v[152:155], v[48:55], v246
v_smfmac_f32_16x16x64_bf16 v[180:183], v[152:155], v[112:119], v246
v_smfmac_f32_16x16x64_bf16 v[176:179], v[156:159], v[56:63], v246
v_smfmac_f32_16x16x64_bf16 v[180:183], v[156:159], v[120:127], v246
ds_read_b128 v[152:155], v248 offset:22528
ds_read_b128 v[156:159], v248 offset:23552
v_max3_f32 v168, v216, v217, v218
v_max3_f32 v169, v219, v220, v221
v_max3_f32 v168, v168, v222, v223
v_max3_f32 v169, v169, v224, v225
v_max_f32 v168, v168, v169
v_mov_b32 v169, v168
ds_read_b128 v[184:187], v248 offset:0
v_mov_b64 v[164:165], s[100:101]
v_permlane32_swap_b32 v168, v169
v_max_f32 v168, v168, v169
v_mov_b32 v169, v168
ds_read_b128 v[188:191], v248 offset:1024
v_mov_b64 v[166:167], s[100:101]
v_permlane16_swap_b32 v168, v169
v_max_f32 v168, v168, v169
v_mul_f32 v170, s35, v168
v_pk_fma_f32 v[216:217], v[216:217], s[34:35], v[170:171] op_sel_hi:[1,0,0]
v_pk_fma_f32 v[218:219], v[218:219], s[34:35], v[170:171] op_sel_hi:[1,0,0]
ds_read_b128 v[192:195], v248 offset:16384
v_pk_fma_f32 v[220:221], v[220:221], s[34:35], v[170:171] op_sel_hi:[1,0,0]
v_pk_fma_f32 v[222:223], v[222:223], s[34:35], v[170:171] op_sel_hi:[1,0,0]
v_pk_fma_f32 v[224:225], v[224:225], s[34:35], v[170:171] op_sel_hi:[1,0,0]
ds_read_b128 v[196:199], v248 offset:17408
v_exp_f32 v216, v216
v_exp_f32 v217, v217
v_exp_f32 v218, v218
ds_read_b128 v[200:203], v248 offset:2048
v_exp_f32 v219, v219
v_exp_f32 v220, v220
v_exp_f32 v221, v221
ds_read_b128 v[204:207], v248 offset:3072
v_exp_f32 v222, v222
v_exp_f32 v223, v223
v_exp_f32 v224, v224
ds_read_b128 v[208:211], v248 offset:18432
v_exp_f32 v225, v225
ds_read_b128 v[212:215], v248 offset:19456
v_mov_b32 v161, 0
v_mov_b64 v[162:163], 0
s_cmp_lg_u32 s42, 0
s_cbranch_scc1 L_hze_21
L_hzf_22:
v_cvt_pk_bf16_f32 v236, v216, v217
v_cvt_pk_bf16_f32 v237, v218, v219
v_cvt_pk_bf16_f32 v238, v220, v221
v_cvt_pk_bf16_f32 v239, v222, v223
v_cvt_pk_bf16_f32 v160, v224, v225
v_add_f32 v176, v176, v178
v_mfma_f32_16x16x32_bf16 v[224:227], v[236:239], v[164:167], 0
s_waitcnt vmcnt(3)
v_add_f32 v177, v177, v179
v_mfma_f32_16x16x32_bf16 v[216:219], v[236:239], v[228:231], 0
v_add_f32 v180, v180, v182
v_mfma_f32_16x16x32_bf16 v[220:223], v[236:239], v[232:235], 0
v_add_f32 v181, v181, v183
v_mfma_f32_16x16x32_bf16 v[224:227], v[160:163], v[164:167], v[224:227]
v_cvt_pk_bf16_f32 v240, v176, v177
v_cvt_pk_bf16_f32 v242, v180, v181
v_lshrrev_b32 v255, 2, v247
s_nop 0
v_mfma_f32_16x16x32_bf16 v[216:219], v[160:163], v[240:243], v[216:219]
v_mfma_f32_16x16x32_bf16 v[220:223], v[160:163], v[242:245], v[220:223]
buffer_store_dword v240, v255, s[8:11], s37 offen sc1
buffer_store_dword v242, v255, s[8:11], s37 offen offset:256 sc1
v_rcp_f32 v172, v226
v_rcp_f32 v173, v227
s_nop 2
v_pk_mul_f32 v[218:219], v[218:219], v[172:173]
v_pk_mul_f32 v[222:223], v[222:223], v[172:173]
v_cvt_pk_bf16_f32 v216, v218, v219
v_cvt_pk_bf16_f32 v217, v222, v223
ds_write_b64 v252, v[216:217] offset:12288
v_mov_b64 v[168:169], 0
v_mov_b64 v[170:171], 0
v_mov_b64 v[172:173], 0
v_mov_b64 v[174:175], 0
v_mov_b64 v[176:177], 0
v_mov_b64 v[178:179], 0
v_mov_b64 v[180:181], 0
v_mov_b64 v[182:183], 0
s_waitcnt lgkmcnt(0)
s_barrier
ds_read_b64_tr_b16 v[236:237], v253 offset:12288
ds_read_b64_tr_b16 v[238:239], v253 offset:13312
ds_read_b64_tr_b16 v[240:241], v253 offset:14336
ds_read_b64_tr_b16 v[242:243], v253 offset:15360
v_mov_b64 v[160:161], 0
v_mov_b64 v[162:163], 0
v_mov_b64 v[164:165], 0
v_mov_b64 v[166:167], 0
v_mov_b64 v[228:229], 0
v_mov_b64 v[230:231], 0
v_mov_b64 v[232:233], 0
v_mov_b64 v[234:235], 0
s_waitcnt lgkmcnt(0)
v_smfmac_f32_16x16x64_bf16 v[160:163], v[236:239], v[184:191], v246
ds_read_b128 v[184:187], v248 offset:8192
ds_read_b128 v[188:191], v248 offset:9216
v_smfmac_f32_16x16x64_bf16 v[160:163], v[240:243], v[192:199], v246
ds_read_b128 v[192:195], v248 offset:24576
v_smfmac_f32_16x16x64_bf16 v[164:167], v[236:239], v[200:207], v246
ds_read_b128 v[196:199], v248 offset:25600
ds_read_b128 v[200:203], v248 offset:10240
v_smfmac_f32_16x16x64_bf16 v[164:167], v[240:243], v[208:215], v246
ds_read_b128 v[204:207], v248 offset:11264
s_nop 1
v_add_f32 v160, v160, v162
v_smfmac_f32_16x16x64_bf16 v[168:171], v[236:239], v[128:135], v246
ds_read_b128 v[208:211], v248 offset:26624
ds_read_b128 v[212:215], v248 offset:27648
v_add_f32 v161, v161, v163
v_smfmac_f32_16x16x64_bf16 v[168:171], v[240:243], v[136:143], v246
ds_read_b128 v[128:131], v248 offset:12288
v_cvt_pk_bf16_f32 v160, v160, v161
v_smfmac_f32_16x16x64_bf16 v[172:175], v[236:239], v[144:151], v246
ds_read_b128 v[132:135], v248 offset:13312
ds_read_b128 v[136:139], v248 offset:28672
v_add_f32 v164, v164, v166
v_smfmac_f32_16x16x64_bf16 v[172:175], v[240:243], v[152:159], v246
ds_read_b128 v[140:143], v248 offset:29696
v_add_f32 v165, v165, v167
s_waitcnt lgkmcnt(10)
v_smfmac_f32_16x16x64_bf16 v[176:179], v[236:239], v[184:191], v246
ds_read_b128 v[144:147], v248 offset:14336
ds_read_b128 v[148:151], v248 offset:15360
v_cvt_pk_bf16_f32 v161, v164, v165
v_add_f32 v168, v168, v170
s_waitcnt lgkmcnt(10)
v_smfmac_f32_16x16x64_bf16 v[176:179], v[240:243], v[192:199], v246
ds_read_b128 v[152:155], v248 offset:30720
v_add_f32 v169, v169, v171
v_cvt_pk_bf16_f32 v162, v168, v169
s_waitcnt lgkmcnt(9)
v_smfmac_f32_16x16x64_bf16 v[180:183], v[236:239], v[200:207], v246
ds_read_b128 v[156:159], v248 offset:31744
v_add_f32 v172, v172, v174
v_add_f32 v173, v173, v175
s_waitcnt lgkmcnt(8)
v_smfmac_f32_16x16x64_bf16 v[180:183], v[240:243], v[208:215], v246
v_cvt_pk_bf16_f32 v163, v172, v173
v_bfi_b32 v160, 1, s96, v160
s_waitcnt lgkmcnt(6)
v_smfmac_f32_16x16x64_bf16 v[228:231], v[236:239], v[128:135], v246
buffer_store_dwordx4 v[160:163], v250, s[8:11], s25 offen
v_add_f32 v176, v176, v178
s_waitcnt lgkmcnt(4)
v_smfmac_f32_16x16x64_bf16 v[228:231], v[240:243], v[136:143], v246
v_add_f32 v177, v177, v179
v_cvt_pk_bf16_f32 v176, v176, v177
s_waitcnt lgkmcnt(2)
v_smfmac_f32_16x16x64_bf16 v[232:235], v[236:239], v[144:151], v246
v_add_f32 v180, v180, v182
v_add_f32 v181, v181, v183
s_waitcnt lgkmcnt(0)
v_smfmac_f32_16x16x64_bf16 v[232:235], v[240:243], v[152:159], v246
v_cvt_pk_bf16_f32 v177, v180, v181
v_add_f32 v228, v228, v230
v_add_f32 v229, v229, v231
v_cvt_pk_bf16_f32 v178, v228, v229
s_nop 3
v_pk_add_f32 v[232:233], v[232:233], v[234:235]
v_cvt_pk_bf16_f32 v179, v232, v233
v_bfi_b32 v176, 1, s96, v176
buffer_store_dwordx4 v[176:179], v250, s[8:11], s26 offen
v_lshrrev_b32 v216, 9, v247
v_mul_u32_u24 v216, 512, v216
v_add3_u32 v255, v247, v216, s99
ds_read_b128 v[216:219], v255
s_add_u32 s29, s29, 262144
s_add_u32 s30, s30, 262144
s_add_u32 s37, s37, 65536
s_add_u32 s31, s31, 65536
s_add_u32 s22, s22, 1
s_xor_b32 s44, s44, 8192
v_xor_b32 v249, 8192, v249
s_waitcnt vmcnt(0)
s_waitcnt lgkmcnt(0)
s_mov_b32 s36, 200000
buffer_load_dwordx4 v[184:187], v247, s[8:11], s27 offen offset:0 sc1
buffer_load_dwordx4 v[188:191], v247, s[8:11], s27 offen offset:1024 sc1
s_waitcnt vmcnt(0)
v_bitop3_b32 v255, v184, v188, s96 bitop3:0x7e
v_and_b32 v255, 1, v255
v_cmp_ne_u32 vcc, 0, v255
s_cbranch_vccz L_rok0_23
buffer_load_dwordx4 v[184:187], v247, s[8:11], s27 offen offset:0 sc1
buffer_load_dwordx4 v[188:191], v247, s[8:11], s27 offen offset:1024 sc1
L_pl_26:
buffer_load_dwordx4 v[192:195], v247, s[8:11], s27 offen offset:0 sc1
buffer_load_dwordx4 v[196:199], v247, s[8:11], s27 offen offset:1024 sc1
s_waitcnt vmcnt(2)
v_bitop3_b32 v255, v184, v188, s96 bitop3:0x7e
v_and_b32 v255, 1, v255
v_cmp_ne_u32 vcc, 0, v255
s_cbranch_vccz L_rok0_23
buffer_load_dwordx4 v[184:187], v247, s[8:11], s27 offen offset:0 sc1
buffer_load_dwordx4 v[188:191], v247, s[8:11], s27 offen offset:1024 sc1
s_waitcnt vmcnt(2)
v_bitop3_b32 v255, v192, v196, s96 bitop3:0x7e
v_and_b32 v255, 1, v255
v_cmp_ne_u32 vcc, 0, v255
s_cbranch_vccz L_rok1_24
s_sub_u32 s36, s36, 1
s_cmp_lg_u32 s36, 0
s_cbranch_scc1 L_pl_26
s_branch L_abort
L_rok1_24:
v_mfma_f32_16x16x32_bf16 v[220:223], v[192:195], v[216:219], 0
v_mfma_f32_16x16x32_bf16 v[220:223], v[196:199], v[216:219], v[220:223]
s_branch L_rjoin_25
L_rok0_23:
v_mfma_f32_16x16x32_bf16 v[220:223], v[184:187], v[216:219], 0
v_mfma_f32_16x16x32_bf16 v[220:223], v[188:191], v[216:219], v[220:223]
L_rjoin_25:
s_add_u32 s23, s23, 8192
s_and_b32 s23, s23, 0x107fff
s_add_u32 s24, s23, 4096
s_add_u32 s41, s23, 2 * 8192
s_and_b32 s41, s41, 0x107fff
v_mov_b32 v224, -1
s_nop 2
v_permlane32_swap_b32 v220, v222
v_permlane32_swap_b32 v221, v223
v_add_f32 v220, v220, v222
v_add_f32 v221, v221, v223
s_nop 1
v_permlane16_swap_b32 v220, v221
v_add_f32 v220, v220, v221
v_mov_b32 v221, v220
s_nop 1
v_permlane16_swap_b32 v220, v221
v_cvt_pk_bf16_f32 v220, v220, v221
v_min_u32 v220, 0xfffffffe, v220
buffer_store_dword v220, v251, s[8:11], s23 offen
s_xor_b32 s25, s25, 262144
s_xor_b32 s26, s26, 262144
s_xor_b32 s27, s27, 262144
s_bfe_u32 s96, s22, 0x10001
s_cmp_lg_u32 s22, 63
s_cbranch_scc1 L_step_w0f
v_mov_b64 v[160:161], 0
v_mov_b64 v[162:163], 0
v_mov_b64 v[164:165], 0
v_mov_b64 v[166:167], 0
v_mov_b64 v[168:169], 0
v_mov_b64 v[170:171], 0
v_mov_b64 v[172:173], 0
v_mov_b64 v[174:175], 0
v_mov_b64 v[176:177], 0
v_mov_b64 v[178:179], 0
v_mov_b64 v[180:181], 0
v_mov_b64 v[182:183], 0
s_mov_b32 s36, 200000
L_lpoll_27:
buffer_load_dwordx4 v[128:131], v247, s[8:11], s23 offen offset:0 sc1
buffer_load_dwordx4 v[132:135], v247, s[8:11], s23 offen offset:1024 sc1
buffer_load_dwordx4 v[136:139], v247, s[8:11], s23 offen offset:2048 sc1
buffer_load_dwordx4 v[140:143], v247, s[8:11], s23 offen offset:3072 sc1
buffer_load_dwordx4 v[144:147], v247, s[8:11], s24 offen offset:0 sc1
buffer_load_dwordx4 v[148:151], v247, s[8:11], s24 offen offset:1024 sc1
buffer_load_dwordx4 v[152:155], v247, s[8:11], s24 offen offset:2048 sc1
buffer_load_dwordx4 v[156:159], v247, s[8:11], s24 offen offset:3072 sc1
s_waitcnt vmcnt(0)
v_max3_u32 v255, v128, v129, v130
v_max3_u32 v255, v255, v131, v132
v_max3_u32 v255, v255, v133, v134
v_max3_u32 v255, v255, v135, v136
v_max3_u32 v255, v255, v137, v138
v_max3_u32 v255, v255, v139, v140
v_max3_u32 v255, v255, v141, v142
v_max3_u32 v255, v255, v143, v144
v_max3_u32 v255, v255, v145, v146
v_max3_u32 v255, v255, v147, v148
v_max3_u32 v255, v255, v149, v150
v_max3_u32 v255, v255, v151, v152
v_max3_u32 v255, v255, v153, v154
v_max3_u32 v255, v255, v155, v156
v_max3_u32 v255, v255, v157, v158
v_max_u32 v255, v255, v159
v_cmp_eq_u32 vcc, -1, v255
s_cbranch_vccnz L_lretry_28
v_smfmac_f32_16x16x64_bf16 v[164:167], v[128:131], a[128:135], v246
v_smfmac_f32_16x16x64_bf16 v[172:175], v[128:131], a[192:199], v246
v_smfmac_f32_16x16x64_bf16 v[176:179], v[128:131], v[0:7], v246
v_smfmac_f32_16x16x64_bf16 v[180:183], v[128:131], v[64:71], v246
v_smfmac_f32_16x16x64_bf16 v[164:167], v[132:135], a[136:143], v246
v_smfmac_f32_16x16x64_bf16 v[172:175], v[132:135], a[200:207], v246
v_smfmac_f32_16x16x64_bf16 v[176:179], v[132:135], v[8:15], v246
v_smfmac_f32_16x16x64_bf16 v[180:183], v[132:135], v[72:79], v246
v_smfmac_f32_16x16x64_bf16 v[164:167], v[136:139], a[144:151], v246
v_smfmac_f32_16x16x64_bf16 v[172:175], v[136:139], a[208:215], v246
v_smfmac_f32_16x16x64_bf16 v[176:179], v[136:139], v[16:23], v246
v_smfmac_f32_16x16x64_bf16 v[180:183], v[136:139], v[80:87], v246
v_smfmac_f32_16x16x64_bf16 v[164:167], v[140:143], a[152:159], v246
v_smfmac_f32_16x16x64_bf16 v[172:175], v[140:143], a[216:223], v246
v_smfmac_f32_16x16x64_bf16 v[176:179], v[140:143], v[24:31], v246
v_smfmac_f32_16x16x64_bf16 v[180:183], v[140:143], v[88:95], v246
v_smfmac_f32_16x16x64_bf16 v[164:167], v[144:147], a[160:167], v246
v_smfmac_f32_16x16x64_bf16 v[172:175], v[144:147], a[224:231], v246
v_smfmac_f32_16x16x64_bf16 v[176:179], v[144:147], v[32:39], v246
v_smfmac_f32_16x16x64_bf16 v[180:183], v[144:147], v[96:103], v246
v_smfmac_f32_16x16x64_bf16 v[164:167], v[148:151], a[168:175], v246
v_smfmac_f32_16x16x64_bf16 v[172:175], v[148:151], a[232:239], v246
v_smfmac_f32_16x16x64_bf16 v[176:179], v[148:151], v[40:47], v246
v_smfmac_f32_16x16x64_bf16 v[180:183], v[148:151], v[104:111], v246
v_smfmac_f32_16x16x64_bf16 v[164:167], v[152:155], a[176:183], v246
v_smfmac_f32_16x16x64_bf16 v[172:175], v[152:155], a[240:247], v246
v_smfmac_f32_16x16x64_bf16 v[176:179], v[152:155], v[48:55], v246
v_smfmac_f32_16x16x64_bf16 v[180:183], v[152:155], v[112:119], v246
v_smfmac_f32_16x16x64_bf16 v[164:167], v[156:159], a[184:191], v246
v_smfmac_f32_16x16x64_bf16 v[172:175], v[156:159], a[248:255], v246
v_smfmac_f32_16x16x64_bf16 v[176:179], v[156:159], v[56:63], v246
v_smfmac_f32_16x16x64_bf16 v[180:183], v[156:159], v[120:127], v246
v_add_f32 v160, v160, v162
v_add_f32 v161, v161, v163
s_nop 2
v_add_f32 v164, v164, v166
v_add_f32 v165, v165, v167
v_cvt_pk_bf16_f32 v163, v160, v161
v_cvt_pk_bf16_f32 v162, v164, v165
ds_write_b64 v252, v[162:163] offset:0
v_add_f32 v168, v168, v170
v_add_f32 v169, v169, v171
v_add_f32 v172, v172, v174
v_add_f32 v173, v173, v175
v_cvt_pk_bf16_f32 v171, v168, v169
v_cvt_pk_bf16_f32 v170, v172, v173
ds_write_b64 v252, v[170:171] offset:512
v_add_f32 v176, v176, v178
v_add_f32 v177, v177, v179
v_add_f32 v180, v180, v182
v_add_f32 v181, v181, v183
v_cvt_pk_bf16_f32 v240, v176, v177
v_cvt_pk_bf16_f32 v242, v180, v181
v_lshrrev_b32 v255, 2, v247
buffer_store_dword v240, v255, s[8:11], s37 offen sc1
buffer_store_dword v242, v255, s[8:11], s37 offen offset:256 sc1
s_waitcnt lgkmcnt(0)
s_barrier
ds_read_b64_tr_b16 v[184:185], v253 offset:0
ds_read_b64_tr_b16 v[186:187], v253 offset:512
s_waitcnt lgkmcnt(0)
buffer_store_dwordx4 v[184:187], v254, s[8:11], s31 offen offset:0 sc1
s_waitcnt vmcnt(0)
s_barrier
L_done_w0f:
s_waitcnt vmcnt(0) lgkmcnt(0)
s_branch L_end_29
L_lretry_28:
s_sub_u32 s36, s36, 1
s_cmp_lg_u32 s36, 0
s_cbranch_scc1 L_lpoll_27
s_branch L_abort
L_hz_19:
s_cmp_ge_u32 s97, 64
s_cbranch_scc1 L_hzb_20
s_add_u32 s43, s22, 1
s_cmp_ge_u32 s43, s97
s_cbranch_scc1 L_hzblk_30
buffer_load_dwordx4 v[236:239], v244, s[8:11], s98 offen offset:16 sc1
buffer_load_dwordx4 v[240:243], v244, s[8:11], s98 offen offset:32 sc1
s_mov_b32 s42, 1
s_branch L_hzb_20
L_hzblk_30:
s_cmp_ge_u32 s43, 64
s_cbranch_scc1 L_hx_32
s_mov_b32 s36, 200000
L_hq_31:
buffer_load_dwordx4 v[216:219], v244, s[8:11], s98 offen offset:16 sc1
buffer_load_dwordx4 v[220:223], v244, s[8:11], s98 offen offset:32 sc1
s_sub_u32 s36, s36, 1
s_cmp_eq_u32 s36, 0
s_cbranch_scc1 L_abort
s_waitcnt vmcnt(0)
L_he_33:
v_cmp_eq_u32 vcc, s46, v217
s_nop 1
v_cndmask_b32 v216, 0, v216, vcc
v_cmp_eq_u32 vcc, s46, v219
s_nop 1
v_cndmask_b32 v218, 0, v218, vcc
v_cmp_eq_u32 vcc, s46, v221
s_nop 1
v_cndmask_b32 v220, 0, v220, vcc
v_cmp_eq_u32 vcc, s46, v223
s_nop 1
v_cndmask_b32 v222, 0, v222, vcc
v_min_u32 v216, v216, v220
v_min_u32 v217, v218, v222
v_lshlrev_b32 v216, 1, v216
v_lshl_add_u32 v217, v217, 1, 1
v_min_u32 v216, v216, v217
s_nop 0
v_readfirstlane_b32 s97, v216
s_cmp_ge_u32 s97, 64
s_cselect_b32 s97, 1000, s97
s_cmp_lt_u32 s43, s97
s_cbranch_scc0 L_hq_31
L_hx_32:
s_branch L_hzb_20
L_hze_21:
s_mov_b32 s42, 0
s_waitcnt vmcnt(3)
v_cmp_eq_u32 vcc, s46, v237
s_nop 1
v_cndmask_b32 v236, 0, v236, vcc
v_cmp_eq_u32 vcc, s46, v239
s_nop 1
v_cndmask_b32 v238, 0, v238, vcc
v_cmp_eq_u32 vcc, s46, v241
s_nop 1
v_cndmask_b32 v240, 0, v240, vcc
v_cmp_eq_u32 vcc, s46, v243
s_nop 1
v_cndmask_b32 v242, 0, v242, vcc
v_min_u32 v236, v236, v240
v_min_u32 v237, v238, v242
v_lshlrev_b32 v236, 1, v236
v_lshl_add_u32 v237, v237, 1, 1
v_min_u32 v236, v236, v237
s_nop 0
v_readfirstlane_b32 s97, v236
s_cmp_ge_u32 s97, 64
s_cselect_b32 s97, 1000, s97
v_mov_b32 v241, 0
v_mov_b32 v243, 0
s_branch L_hzf_22
L_end_29:
s_endpgm
L_wave1:
v_lshrrev_b32 v128, 4, v255
v_and_b32 v129, 15, v255
v_and_b32 v130, 1, v128
v_add_u32 v130, 4, v130
v_lshlrev_b32 v130, 1, v130
v_xor_b32 v130, v130, v129
v_lshlrev_b32 v130, 4, v130
s_lshl_b32 s38, s21, 8
v_lshl_add_u32 v131, v128, 13, v130
v_add_u32 v136, s38, v131
s_lshl_b32 s38, s21, 17
v_lshl_add_u32 v131, v128, 10, v130
v_add_u32 v138, s38, v131
v_and_b32 v130, 1, v128
v_add_u32 v130, 6, v130
v_lshlrev_b32 v130, 1, v130
v_xor_b32 v130, v130, v129
v_lshlrev_b32 v130, 4, v130
s_lshl_b32 s38, s21, 8
v_lshl_add_u32 v131, v128, 13, v130
v_add_u32 v137, s38, v131
s_lshl_b32 s38, s21, 17
v_lshl_add_u32 v131, v128, 10, v130
v_add_u32 v139, s38, v131
s_mov_b32 s12, s50
s_mov_b32 s13, s51
s_mov_b32 s14, 0x400000
s_mov_b32 m0, 8192
s_mov_b32 s38, 0x40000
buffer_load_dwordx4 v136, s[12:15], s38 offen  lds
s_mov_b32 m0, 9216
s_mov_b32 s38, 0x48000
buffer_load_dwordx4 v136, s[12:15], s38 offen  lds
s_mov_b32 m0, 10240
s_mov_b32 s38, 0x50000
buffer_load_dwordx4 v136, s[12:15], s38 offen  lds
s_mov_b32 m0, 11264
s_mov_b32 s38, 0x58000
buffer_load_dwordx4 v136, s[12:15], s38 offen  lds
s_mov_b32 m0, 12288
s_mov_b32 s38, 0x60000
buffer_load_dwordx4 v137, s[12:15], s38 offen  lds
s_mov_b32 m0, 13312
s_mov_b32 s38, 0x68000
buffer_load_dwordx4 v137, s[12:15], s38 offen  lds
s_mov_b32 m0, 14336
s_mov_b32 s38, 0x70000
buffer_load_dwordx4 v137, s[12:15], s38 offen  lds
s_mov_b32 m0, 15360
s_mov_b32 s38, 0x78000
buffer_load_dwordx4 v137, s[12:15], s38 offen  lds
s_mov_b32 m0, 40960
s_mov_b32 s38, 0x140000
buffer_load_dwordx4 v136, s[12:15], s38 offen  lds
s_mov_b32 m0, 41984
s_mov_b32 s38, 0x148000
buffer_load_dwordx4 v136, s[12:15], s38 offen  lds
s_mov_b32 m0, 43008
s_mov_b32 s38, 0x150000
buffer_load_dwordx4 v136, s[12:15], s38 offen  lds
s_mov_b32 m0, 44032
s_mov_b32 s38, 0x158000
buffer_load_dwordx4 v136, s[12:15], s38 offen  lds
s_mov_b32 m0, 45056
s_mov_b32 s38, 0x160000
buffer_load_dwordx4 v137, s[12:15], s38 offen  lds
s_mov_b32 m0, 46080
s_mov_b32 s38, 0x168000
buffer_load_dwordx4 v137, s[12:15], s38 offen  lds
s_mov_b32 m0, 47104
s_mov_b32 s38, 0x170000
buffer_load_dwordx4 v137, s[12:15], s38 offen  lds
s_mov_b32 m0, 48128
s_mov_b32 s38, 0x178000
buffer_load_dwordx4 v137, s[12:15], s38 offen  lds
s_mov_b32 m0, 73728
s_mov_b32 s38, 0x240000
buffer_load_dwordx4 v136, s[12:15], s38 offen  lds
s_mov_b32 m0, 74752
s_mov_b32 s38, 0x248000
buffer_load_dwordx4 v136, s[12:15], s38 offen  lds
s_mov_b32 m0, 75776
s_mov_b32 s38, 0x250000
buffer_load_dwordx4 v136, s[12:15], s38 offen  lds
s_mov_b32 m0, 76800
s_mov_b32 s38, 0x258000
buffer_load_dwordx4 v136, s[12:15], s38 offen  lds
s_mov_b32 m0, 77824
s_mov_b32 s38, 0x260000
buffer_load_dwordx4 v137, s[12:15], s38 offen  lds
s_mov_b32 m0, 78848
s_mov_b32 s38, 0x268000
buffer_load_dwordx4 v137, s[12:15], s38 offen  lds
s_mov_b32 m0, 79872
s_mov_b32 s38, 0x270000
buffer_load_dwordx4 v137, s[12:15], s38 offen  lds
s_mov_b32 m0, 80896
s_mov_b32 s38, 0x278000
buffer_load_dwordx4 v137, s[12:15], s38 offen  lds
s_mov_b32 m0, 106496
s_mov_b32 s38, 0x340000
buffer_load_dwordx4 v136, s[12:15], s38 offen  lds
s_mov_b32 m0, 107520
s_mov_b32 s38, 0x348000
buffer_load_dwordx4 v136, s[12:15], s38 offen  lds
s_mov_b32 m0, 108544
s_mov_b32 s38, 0x350000
buffer_load_dwordx4 v136, s[12:15], s38 offen  lds
s_mov_b32 m0, 109568
s_mov_b32 s38, 0x358000
buffer_load_dwordx4 v136, s[12:15], s38 offen  lds
s_mov_b32 m0, 110592
s_mov_b32 s38, 0x360000
buffer_load_dwordx4 v137, s[12:15], s38 offen  lds
s_mov_b32 m0, 111616
s_mov_b32 s38, 0x368000
buffer_load_dwordx4 v137, s[12:15], s38 offen  lds
s_mov_b32 m0, 112640
s_mov_b32 s38, 0x370000
buffer_load_dwordx4 v137, s[12:15], s38 offen  lds
s_mov_b32 m0, 113664
s_mov_b32 s38, 0x378000
buffer_load_dwordx4 v137, s[12:15], s38 offen  lds
v_lshlrev_b32 v247, 4, v255
v_add_u32 v248, 32768, v247
v_add_u32 v249, 131072, v247
v_and_b32 v128, 15, v255
v_lshrrev_b32 v129, 4, v255
v_mov_b32 v246, 0x4444
v_mov_b32 v130, 0xeeee
v_and_b32 v131, 2, v128
v_cmp_ne_u32 vcc, 0, v131
s_nop 1
v_cndmask_b32 v246, v246, v130, vcc
v_lshlrev_b32 v130, 13, v129
v_lshrrev_b32 v131, 2, v128
v_lshl_add_u32 v130, v131, 11, v130
v_mov_b32 v131, s21
v_lshl_add_u32 v130, v131, 6, v130
v_and_b32 v131, 3, v128
v_lshl_add_u32 v250, v131, 4, v130
v_lshrrev_b32 v130, 2, v128
v_xor_b32 v130, v130, v129
v_lshlrev_b32 v130, 3, v130
v_lshl_add_u32 v130, v128, 5, v130
v_add_u32 v252, 148480, v130
v_lshrrev_b32 v130, 2, v128
v_lshl_add_u32 v130, v129, 2, v130
v_and_b32 v131, 3, v128
v_xor_b32 v131, v131, v129
v_lshlrev_b32 v131, 3, v131
v_lshl_add_u32 v130, v130, 5, v131
v_add_u32 v253, 147456, v130
v_lshrrev_b32 v130, 2, v128
v_and_b32 v131, 1, v128
v_lshl_add_u32 v130, v130, 1, v131
v_lshl_add_u32 v130, v129, 3, v130
v_lshlrev_b32 v130, 4, v130
v_mov_b32 v132, 0x40000000
v_and_b32 v131, 2, v128
v_cmp_ne_u32 vcc, 0, v131
s_nop 1
v_cndmask_b32 v254, v130, v132, vcc
s_lshr_b32 s38, s21, 3
s_bfe_u32 s39, s21, 0x10002
s_lshl_b32 s39, s39, 2
s_add_u32 s38, s38, s39
s_lshl_b32 s38, s38, 10
s_and_b32 s39, s21, 3
s_lshl_b32 s39, s39, 6
s_add_u32 s38, s38, s39
s_add_u32 s38, s38, 256
v_and_b32 v130, 3, v128
v_lshlrev_b32 v130, 4, v130
v_lshrrev_b32 v131, 2, v128
v_lshl_add_u32 v130, v131, 3, v130
v_lshrrev_b32 v131, 1, v129
v_lshl_add_u32 v130, v131, 2, v130
v_add_u32 v130, s38, v130
v_and_b32 v131, 24, v255
v_mov_b32 v251, 0x40000000
v_cmp_eq_u32 vcc, 0, v131
s_nop 1
v_cndmask_b32 v251, v251, v130, vcc
v_lshrrev_b32 v128, 4, v255
v_bfe_u32 v129, v255, 2, 2
v_and_b32 v130, 3, v255
v_and_b32 v131, 1, v128
v_lshl_add_u32 v134, v131, 2, v129
v_lshlrev_b32 v132, 5, v131
v_lshrrev_b32 v131, 1, v128
v_lshl_add_u32 v132, v131, 2, v132
v_and_b32 v131, 1, v129
v_add_u32 v132, v131, v132
v_lshrrev_b32 v131, 1, v129
v_lshl_add_u32 v132, v131, 4, v132
v_lshlrev_b32 v132, 8, v132
v_lshrrev_b32 v131, 1, v130
v_lshl_add_u32 v132, v131, 4, v132
v_and_b32 v131, 1, v130
v_lshl_add_u32 v132, v131, 3, v132
v_xor_b32 v131, 2, v134
v_lshl_add_u32 v140, v131, 5, v132
v_xor_b32 v131, 3, v134
v_lshl_add_u32 v141, v131, 5, v132
v_xor_b32 v131, 0, v134
v_lshl_add_u32 v148, v131, 5, v132
v_add_u32 v148, 32768, v148
v_xor_b32 v131, 1, v134
v_lshl_add_u32 v149, v131, 5, v132
v_add_u32 v149, 32768, v149
v_xor_b32 v131, 2, v134
v_lshl_add_u32 v150, v131, 5, v132
v_add_u32 v150, 32768, v150
v_xor_b32 v131, 3, v134
v_lshl_add_u32 v151, v131, 5, v132
v_add_u32 v151, 32768, v151
v_xor_b32 v131, 4, v134
v_lshl_add_u32 v152, v131, 5, v132
v_add_u32 v152, 32768, v152
v_xor_b32 v131, 5, v134
v_lshl_add_u32 v153, v131, 5, v132
v_add_u32 v153, 32768, v153
v_xor_b32 v131, 6, v134
v_lshl_add_u32 v154, v131, 5, v132
v_add_u32 v154, 32768, v154
v_xor_b32 v131, 7, v134
v_lshl_add_u32 v155, v131, 5, v132
v_add_u32 v155, 32768, v155
s_waitcnt vmcnt(24)
s_barrier
v_add_u32 v142, 0, v140
v_add_u32 v143, 0, v141
ds_read_b64_tr_b16 a[0:1], v142 offset:0
ds_read_b64_tr_b16 a[2:3], v142 offset:512
ds_read_b64_tr_b16 a[4:5], v142 offset:2048
ds_read_b64_tr_b16 a[6:7], v142 offset:2560
ds_read_b64_tr_b16 a[64:65], v143 offset:0
ds_read_b64_tr_b16 a[66:67], v143 offset:512
ds_read_b64_tr_b16 a[68:69], v143 offset:2048
ds_read_b64_tr_b16 a[70:71], v143 offset:2560
ds_read_b64_tr_b16 a[32:33], v142 offset:16384
ds_read_b64_tr_b16 a[34:35], v142 offset:16896
ds_read_b64_tr_b16 a[36:37], v142 offset:18432
ds_read_b64_tr_b16 a[38:39], v142 offset:18944
ds_read_b64_tr_b16 a[96:97], v143 offset:16384
ds_read_b64_tr_b16 a[98:99], v143 offset:16896
ds_read_b64_tr_b16 a[100:101], v143 offset:18432
ds_read_b64_tr_b16 a[102:103], v143 offset:18944
s_waitcnt lgkmcnt(0)
s_barrier
s_mov_b32 s12, s52
s_mov_b32 s13, s53
s_mov_b32 s14, 0x400000
s_mov_b32 m0, 8192
s_mov_b32 s38, 0x40000
buffer_load_dwordx4 v136, s[12:15], s38 offen  lds
s_mov_b32 m0, 9216
s_mov_b32 s38, 0x48000
buffer_load_dwordx4 v136, s[12:15], s38 offen  lds
s_mov_b32 m0, 10240
s_mov_b32 s38, 0x50000
buffer_load_dwordx4 v136, s[12:15], s38 offen  lds
s_mov_b32 m0, 11264
s_mov_b32 s38, 0x58000
buffer_load_dwordx4 v136, s[12:15], s38 offen  lds
s_mov_b32 m0, 12288
s_mov_b32 s38, 0x60000
buffer_load_dwordx4 v137, s[12:15], s38 offen  lds
s_mov_b32 m0, 13312
s_mov_b32 s38, 0x68000
buffer_load_dwordx4 v137, s[12:15], s38 offen  lds
s_mov_b32 m0, 14336
s_mov_b32 s38, 0x70000
buffer_load_dwordx4 v137, s[12:15], s38 offen  lds
s_mov_b32 m0, 15360
s_mov_b32 s38, 0x78000
buffer_load_dwordx4 v137, s[12:15], s38 offen  lds
s_waitcnt vmcnt(24)
s_barrier
v_add_u32 v142, 32768, v140
v_add_u32 v143, 32768, v141
ds_read_b64_tr_b16 a[8:9], v142 offset:0
ds_read_b64_tr_b16 a[10:11], v142 offset:512
ds_read_b64_tr_b16 a[12:13], v142 offset:2048
ds_read_b64_tr_b16 a[14:15], v142 offset:2560
ds_read_b64_tr_b16 a[72:73], v143 offset:0
ds_read_b64_tr_b16 a[74:75], v143 offset:512
ds_read_b64_tr_b16 a[76:77], v143 offset:2048
ds_read_b64_tr_b16 a[78:79], v143 offset:2560
ds_read_b64_tr_b16 a[40:41], v142 offset:16384
ds_read_b64_tr_b16 a[42:43], v142 offset:16896
ds_read_b64_tr_b16 a[44:45], v142 offset:18432
ds_read_b64_tr_b16 a[46:47], v142 offset:18944
ds_read_b64_tr_b16 a[104:105], v143 offset:16384
ds_read_b64_tr_b16 a[106:107], v143 offset:16896
ds_read_b64_tr_b16 a[108:109], v143 offset:18432
ds_read_b64_tr_b16 a[110:111], v143 offset:18944
s_waitcnt lgkmcnt(0)
s_barrier
v_mov_b32 v236, 0
buffer_load_dwordx4 v[224:227], v236, s[16:19], 0 offen sc1
buffer_load_dwordx4 v[228:231], v236, s[16:19], 0 offen offset:16 sc1
buffer_load_dwordx2 v[232:233], v236, s[16:19], 0 offen offset:128 sc1
v_and_b32 v200, 15, v255
v_lshrrev_b32 v201, 4, v255
s_and_b32 s39, s21, 3
s_lshl_b32 s39, s39, 11
s_lshr_b32 s40, s21, 2
s_lshl_b32 s40, s40, 7
s_add_u32 s39, s39, s40
s_add_u32 s39, s39, 8
v_and_b32 v202, 1, v200
v_lshlrev_b32 v202, 10, v202
v_bfe_u32 v203, v200, 1, 2
v_lshl_add_u32 v202, v203, 5, v202
v_lshrrev_b32 v203, 1, v201
v_lshl_add_u32 v202, v203, 2, v202
v_add_u32 v202, s39, v202
s_mov_b32 s4, s48
s_mov_b32 s5, s49
s_mov_b32 s6, 8192
s_mov_b32 s7, 0x00020000
buffer_load_dword v204, v202, s[4:7], 0 offen
s_mov_b32 m0, 40960
s_mov_b32 s38, 0x140000
buffer_load_dwordx4 v136, s[12:15], s38 offen  lds
s_mov_b32 m0, 41984
s_mov_b32 s38, 0x148000
buffer_load_dwordx4 v136, s[12:15], s38 offen  lds
s_mov_b32 m0, 43008
s_mov_b32 s38, 0x150000
buffer_load_dwordx4 v136, s[12:15], s38 offen  lds
s_mov_b32 m0, 44032
s_mov_b32 s38, 0x158000
buffer_load_dwordx4 v136, s[12:15], s38 offen  lds
s_mov_b32 m0, 45056
s_mov_b32 s38, 0x160000
buffer_load_dwordx4 v137, s[12:15], s38 offen  lds
s_mov_b32 m0, 46080
s_mov_b32 s38, 0x168000
buffer_load_dwordx4 v137, s[12:15], s38 offen  lds
s_mov_b32 m0, 47104
s_mov_b32 s38, 0x170000
buffer_load_dwordx4 v137, s[12:15], s38 offen  lds
s_mov_b32 m0, 48128
s_mov_b32 s38, 0x178000
buffer_load_dwordx4 v137, s[12:15], s38 offen  lds
s_waitcnt vmcnt(24)
s_barrier
v_add_u32 v142, 65536, v140
v_add_u32 v143, 65536, v141
ds_read_b64_tr_b16 a[16:17], v142 offset:0
ds_read_b64_tr_b16 a[18:19], v142 offset:512
ds_read_b64_tr_b16 a[20:21], v142 offset:2048
ds_read_b64_tr_b16 a[22:23], v142 offset:2560
ds_read_b64_tr_b16 a[80:81], v143 offset:0
ds_read_b64_tr_b16 a[82:83], v143 offset:512
ds_read_b64_tr_b16 a[84:85], v143 offset:2048
ds_read_b64_tr_b16 a[86:87], v143 offset:2560
ds_read_b64_tr_b16 a[48:49], v142 offset:16384
ds_read_b64_tr_b16 a[50:51], v142 offset:16896
ds_read_b64_tr_b16 a[52:53], v142 offset:18432
ds_read_b64_tr_b16 a[54:55], v142 offset:18944
ds_read_b64_tr_b16 a[112:113], v143 offset:16384
ds_read_b64_tr_b16 a[114:115], v143 offset:16896
ds_read_b64_tr_b16 a[116:117], v143 offset:18432
ds_read_b64_tr_b16 a[118:119], v143 offset:18944
s_waitcnt lgkmcnt(0)
s_barrier
s_mov_b32 m0, 73728
s_mov_b32 s38, 0x240000
buffer_load_dwordx4 v136, s[12:15], s38 offen  lds
s_mov_b32 m0, 74752
s_mov_b32 s38, 0x248000
buffer_load_dwordx4 v136, s[12:15], s38 offen  lds
s_mov_b32 m0, 75776
s_mov_b32 s38, 0x250000
buffer_load_dwordx4 v136, s[12:15], s38 offen  lds
s_mov_b32 m0, 76800
s_mov_b32 s38, 0x258000
buffer_load_dwordx4 v136, s[12:15], s38 offen  lds
s_mov_b32 m0, 77824
s_mov_b32 s38, 0x260000
buffer_load_dwordx4 v137, s[12:15], s38 offen  lds
s_mov_b32 m0, 78848
s_mov_b32 s38, 0x268000
buffer_load_dwordx4 v137, s[12:15], s38 offen  lds
s_mov_b32 m0, 79872
s_mov_b32 s38, 0x270000
buffer_load_dwordx4 v137, s[12:15], s38 offen  lds
s_mov_b32 m0, 80896
s_mov_b32 s38, 0x278000
buffer_load_dwordx4 v137, s[12:15], s38 offen  lds
s_waitcnt vmcnt(24)
s_barrier
v_add_u32 v142, 98304, v140
v_add_u32 v143, 98304, v141
ds_read_b64_tr_b16 a[24:25], v142 offset:0
ds_read_b64_tr_b16 a[26:27], v142 offset:512
ds_read_b64_tr_b16 a[28:29], v142 offset:2048
ds_read_b64_tr_b16 a[30:31], v142 offset:2560
ds_read_b64_tr_b16 a[88:89], v143 offset:0
ds_read_b64_tr_b16 a[90:91], v143 offset:512
ds_read_b64_tr_b16 a[92:93], v143 offset:2048
ds_read_b64_tr_b16 a[94:95], v143 offset:2560
ds_read_b64_tr_b16 a[56:57], v142 offset:16384
ds_read_b64_tr_b16 a[58:59], v142 offset:16896
ds_read_b64_tr_b16 a[60:61], v142 offset:18432
ds_read_b64_tr_b16 a[62:63], v142 offset:18944
ds_read_b64_tr_b16 a[120:121], v143 offset:16384
ds_read_b64_tr_b16 a[122:123], v143 offset:16896
ds_read_b64_tr_b16 a[124:125], v143 offset:18432
ds_read_b64_tr_b16 a[126:127], v143 offset:18944
s_waitcnt lgkmcnt(0)
s_barrier
s_mov_b32 m0, 106496
s_mov_b32 s38, 0x340000
buffer_load_dwordx4 v136, s[12:15], s38 offen  lds
s_mov_b32 m0, 107520
s_mov_b32 s38, 0x348000
buffer_load_dwordx4 v136, s[12:15], s38 offen  lds
s_mov_b32 m0, 108544
s_mov_b32 s38, 0x350000
buffer_load_dwordx4 v136, s[12:15], s38 offen  lds
s_mov_b32 m0, 109568
s_mov_b32 s38, 0x358000
buffer_load_dwordx4 v136, s[12:15], s38 offen  lds
s_mov_b32 m0, 110592
s_mov_b32 s38, 0x360000
buffer_load_dwordx4 v137, s[12:15], s38 offen  lds
s_mov_b32 m0, 111616
s_mov_b32 s38, 0x368000
buffer_load_dwordx4 v137, s[12:15], s38 offen  lds
s_mov_b32 m0, 112640
s_mov_b32 s38, 0x370000
buffer_load_dwordx4 v137, s[12:15], s38 offen  lds
s_mov_b32 m0, 113664
s_mov_b32 s38, 0x378000
buffer_load_dwordx4 v137, s[12:15], s38 offen  lds
s_waitcnt vmcnt(24)
s_barrier
v_add_u32 v142, 0, v140
v_add_u32 v143, 0, v141
ds_read_b64_tr_b16 a[128:129], v142 offset:0
ds_read_b64_tr_b16 a[130:131], v142 offset:512
ds_read_b64_tr_b16 a[132:133], v142 offset:2048
ds_read_b64_tr_b16 a[134:135], v142 offset:2560
ds_read_b64_tr_b16 a[192:193], v143 offset:0
ds_read_b64_tr_b16 a[194:195], v143 offset:512
ds_read_b64_tr_b16 a[196:197], v143 offset:2048
ds_read_b64_tr_b16 a[198:199], v143 offset:2560
ds_read_b64_tr_b16 a[160:161], v142 offset:16384
ds_read_b64_tr_b16 a[162:163], v142 offset:16896
ds_read_b64_tr_b16 a[164:165], v142 offset:18432
ds_read_b64_tr_b16 a[166:167], v142 offset:18944
ds_read_b64_tr_b16 a[224:225], v143 offset:16384
ds_read_b64_tr_b16 a[226:227], v143 offset:16896
ds_read_b64_tr_b16 a[228:229], v143 offset:18432
ds_read_b64_tr_b16 a[230:231], v143 offset:18944
s_waitcnt lgkmcnt(0)
s_barrier
s_mov_b32 s12, s54
s_mov_b32 s13, s55
s_mov_b32 s14, 0x400000
s_mov_b32 m0, 8192
s_mov_b32 s38, 0x40000
buffer_load_dwordx4 v136, s[12:15], s38 offen  lds
s_mov_b32 m0, 9216
s_mov_b32 s38, 0x48000
buffer_load_dwordx4 v136, s[12:15], s38 offen  lds
s_mov_b32 m0, 10240
s_mov_b32 s38, 0x50000
buffer_load_dwordx4 v136, s[12:15], s38 offen  lds
s_mov_b32 m0, 11264
s_mov_b32 s38, 0x58000
buffer_load_dwordx4 v136, s[12:15], s38 offen  lds
s_mov_b32 m0, 12288
s_mov_b32 s38, 0x60000
buffer_load_dwordx4 v137, s[12:15], s38 offen  lds
s_mov_b32 m0, 13312
s_mov_b32 s38, 0x68000
buffer_load_dwordx4 v137, s[12:15], s38 offen  lds
s_mov_b32 m0, 14336
s_mov_b32 s38, 0x70000
buffer_load_dwordx4 v137, s[12:15], s38 offen  lds
s_mov_b32 m0, 15360
s_mov_b32 s38, 0x78000
buffer_load_dwordx4 v137, s[12:15], s38 offen  lds
s_waitcnt vmcnt(24)
s_barrier
v_add_u32 v142, 32768, v140
v_add_u32 v143, 32768, v141
ds_read_b64_tr_b16 a[136:137], v142 offset:0
ds_read_b64_tr_b16 a[138:139], v142 offset:512
ds_read_b64_tr_b16 a[140:141], v142 offset:2048
ds_read_b64_tr_b16 a[142:143], v142 offset:2560
ds_read_b64_tr_b16 a[200:201], v143 offset:0
ds_read_b64_tr_b16 a[202:203], v143 offset:512
ds_read_b64_tr_b16 a[204:205], v143 offset:2048
ds_read_b64_tr_b16 a[206:207], v143 offset:2560
ds_read_b64_tr_b16 a[168:169], v142 offset:16384
ds_read_b64_tr_b16 a[170:171], v142 offset:16896
ds_read_b64_tr_b16 a[172:173], v142 offset:18432
ds_read_b64_tr_b16 a[174:175], v142 offset:18944
ds_read_b64_tr_b16 a[232:233], v143 offset:16384
ds_read_b64_tr_b16 a[234:235], v143 offset:16896
ds_read_b64_tr_b16 a[236:237], v143 offset:18432
ds_read_b64_tr_b16 a[238:239], v143 offset:18944
s_waitcnt lgkmcnt(0)
s_barrier
s_cmp_lg_u32 s32, 0
s_cbranch_scc1 L_vfx_36
s_mov_b32 s36, 200000
s_branch L_vfe_35
L_vf_34:
v_mov_b32 v236, 0
buffer_load_dwordx4 v[224:227], v236, s[16:19], 0 offen sc1
buffer_load_dwordx4 v[228:231], v236, s[16:19], 0 offen offset:16 sc1
buffer_load_dwordx2 v[232:233], v236, s[16:19], 0 offen offset:128 sc1
s_sub_u32 s36, s36, 1
s_cmp_eq_u32 s36, 0
s_cbranch_scc1 L_abort
s_waitcnt vmcnt(0)
L_vfe_35:
v_add3_u32 v234, v225, v226, v227
v_add3_u32 v234, v234, v228, v229
v_add3_u32 v234, v234, v230, v231
v_add_u32 v234, v234, v232
v_max3_u32 v235, v225, v226, v227
v_max3_u32 v235, v235, v228, v229
v_max3_u32 v235, v235, v230, v231
v_max_u32 v235, v235, v232
v_cmp_lt_u32 vcc, 0x100, v234
s_cbranch_vccnz L_abort
v_cmp_ne_u32 vcc, 0x100, v234
s_cbranch_vccnz L_vf_34
v_cmp_eq_u32 vcc, 0, v233
s_cbranch_vccnz L_vf_34
v_readfirstlane_b32 s46, v233
v_readfirstlane_b32 s36, v235
s_cmp_lg_u32 s36, 32
s_cbranch_scc1 L_slow
L_vfx_36:
s_cmp_lg_u32 s32, 0
s_cbranch_scc1 L_inis_37
s_mov_b32 s99, 160256
v_mov_b32 v208, -1
v_mov_b32 v209, -1
v_mov_b32 v210, -1
v_mov_b32 v211, -1
s_mov_b32 s39, 0x100000
v_min_u32 v204, 0xfffffffe, v204
buffer_store_dword v204, v251, s[8:11], s39 offen
s_add_u32 s39, s39, 8192
buffer_store_dword v208, v251, s[8:11], s39 offen
s_add_u32 s39, s39, 8192
buffer_store_dword v208, v251, s[8:11], s39 offen
s_add_u32 s39, s39, 8192
buffer_store_dword v208, v251, s[8:11], s39 offen
s_lshl_b32 s39, s21, 13
s_add_u32 s39, s39, 0x200800
buffer_store_dwordx4 v[208:211], v247, s[8:11], s39 offen offset:0
buffer_store_dwordx4 v[208:211], v247, s[8:11], s39 offen offset:1024
s_lshl_b32 s39, s21, 13
s_add_u32 s39, s39, 0x240800
buffer_store_dwordx4 v[208:211], v247, s[8:11], s39 offen offset:0
buffer_store_dwordx4 v[208:211], v247, s[8:11], s39 offen offset:1024
s_branch L_inie_38
L_inis_37:
s_mov_b32 s99, 160256
v_mov_b32 v208, -1
v_mov_b32 v209, -1
v_mov_b32 v210, -1
v_mov_b32 v211, -1
s_mov_b32 s39, 0x100000
v_min_u32 v204, 0xfffffffe, v204
buffer_store_dword v204, v251, s[8:11], s39 offen sc1
s_add_u32 s39, s39, 8192
buffer_store_dword v208, v251, s[8:11], s39 offen sc1
s_add_u32 s39, s39, 8192
buffer_store_dword v208, v251, s[8:11], s39 offen sc1
s_add_u32 s39, s39, 8192
buffer_store_dword v208, v251, s[8:11], s39 offen sc1
s_lshl_b32 s39, s21, 13
s_add_u32 s39, s39, 0x200800
buffer_store_dwordx4 v[208:211], v247, s[8:11], s39 offen offset:0 sc1
buffer_store_dwordx4 v[208:211], v247, s[8:11], s39 offen offset:1024 sc1
s_lshl_b32 s39, s21, 13
s_add_u32 s39, s39, 0x240800
buffer_store_dwordx4 v[208:211], v247, s[8:11], s39 offen offset:0 sc1
buffer_store_dwordx4 v[208:211], v247, s[8:11], s39 offen offset:1024 sc1
L_inie_38:
s_mov_b32 m0, 40960
s_mov_b32 s38, 0x140000
buffer_load_dwordx4 v136, s[12:15], s38 offen  lds
s_mov_b32 m0, 41984
s_mov_b32 s38, 0x148000
buffer_load_dwordx4 v136, s[12:15], s38 offen  lds
s_mov_b32 m0, 43008
s_mov_b32 s38, 0x150000
buffer_load_dwordx4 v136, s[12:15], s38 offen  lds
s_mov_b32 m0, 44032
s_mov_b32 s38, 0x158000
buffer_load_dwordx4 v136, s[12:15], s38 offen  lds
s_mov_b32 m0, 45056
s_mov_b32 s38, 0x160000
buffer_load_dwordx4 v137, s[12:15], s38 offen  lds
s_mov_b32 m0, 46080
s_mov_b32 s38, 0x168000
buffer_load_dwordx4 v137, s[12:15], s38 offen  lds
s_mov_b32 m0, 47104
s_mov_b32 s38, 0x170000
buffer_load_dwordx4 v137, s[12:15], s38 offen  lds
s_mov_b32 m0, 48128
s_mov_b32 s38, 0x178000
buffer_load_dwordx4 v137, s[12:15], s38 offen  lds
s_waitcnt vmcnt(24)
s_barrier
v_add_u32 v142, 65536, v140
v_add_u32 v143, 65536, v141
ds_read_b64_tr_b16 a[144:145], v142 offset:0
ds_read_b64_tr_b16 a[146:147], v142 offset:512
ds_read_b64_tr_b16 a[148:149], v142 offset:2048
ds_read_b64_tr_b16 a[150:151], v142 offset:2560
ds_read_b64_tr_b16 a[208:209], v143 offset:0
ds_read_b64_tr_b16 a[210:211], v143 offset:512
ds_read_b64_tr_b16 a[212:213], v143 offset:2048
ds_read_b64_tr_b16 a[214:215], v143 offset:2560
ds_read_b64_tr_b16 a[176:177], v142 offset:16384
ds_read_b64_tr_b16 a[178:179], v142 offset:16896
ds_read_b64_tr_b16 a[180:181], v142 offset:18432
ds_read_b64_tr_b16 a[182:183], v142 offset:18944
ds_read_b64_tr_b16 a[240:241], v143 offset:16384
ds_read_b64_tr_b16 a[242:243], v143 offset:16896
ds_read_b64_tr_b16 a[244:245], v143 offset:18432
ds_read_b64_tr_b16 a[246:247], v143 offset:18944
s_waitcnt lgkmcnt(0)
s_barrier
s_mov_b32 m0, 73728
s_mov_b32 s38, 0x240000
buffer_load_dwordx4 v136, s[12:15], s38 offen  lds
s_mov_b32 m0, 74752
s_mov_b32 s38, 0x248000
buffer_load_dwordx4 v136, s[12:15], s38 offen  lds
s_mov_b32 m0, 75776
s_mov_b32 s38, 0x250000
buffer_load_dwordx4 v136, s[12:15], s38 offen  lds
s_mov_b32 m0, 76800
s_mov_b32 s38, 0x258000
buffer_load_dwordx4 v136, s[12:15], s38 offen  lds
s_mov_b32 m0, 77824
s_mov_b32 s38, 0x260000
buffer_load_dwordx4 v137, s[12:15], s38 offen  lds
s_mov_b32 m0, 78848
s_mov_b32 s38, 0x268000
buffer_load_dwordx4 v137, s[12:15], s38 offen  lds
s_mov_b32 m0, 79872
s_mov_b32 s38, 0x270000
buffer_load_dwordx4 v137, s[12:15], s38 offen  lds
s_mov_b32 m0, 80896
s_mov_b32 s38, 0x278000
buffer_load_dwordx4 v137, s[12:15], s38 offen  lds
s_waitcnt vmcnt(24)
s_barrier
v_add_u32 v142, 98304, v140
v_add_u32 v143, 98304, v141
ds_read_b64_tr_b16 a[152:153], v142 offset:0
ds_read_b64_tr_b16 a[154:155], v142 offset:512
ds_read_b64_tr_b16 a[156:157], v142 offset:2048
ds_read_b64_tr_b16 a[158:159], v142 offset:2560
ds_read_b64_tr_b16 a[216:217], v143 offset:0
ds_read_b64_tr_b16 a[218:219], v143 offset:512
ds_read_b64_tr_b16 a[220:221], v143 offset:2048
ds_read_b64_tr_b16 a[222:223], v143 offset:2560
ds_read_b64_tr_b16 a[184:185], v142 offset:16384
ds_read_b64_tr_b16 a[186:187], v142 offset:16896
ds_read_b64_tr_b16 a[188:189], v142 offset:18432
ds_read_b64_tr_b16 a[190:191], v142 offset:18944
ds_read_b64_tr_b16 a[248:249], v143 offset:16384
ds_read_b64_tr_b16 a[250:251], v143 offset:16896
ds_read_b64_tr_b16 a[252:253], v143 offset:18432
ds_read_b64_tr_b16 a[254:255], v143 offset:18944
s_waitcnt lgkmcnt(0)
s_barrier
s_mov_b32 m0, 106496
s_mov_b32 s38, 0x340000
buffer_load_dwordx4 v136, s[12:15], s38 offen  lds
s_mov_b32 m0, 107520
s_mov_b32 s38, 0x348000
buffer_load_dwordx4 v136, s[12:15], s38 offen  lds
s_mov_b32 m0, 108544
s_mov_b32 s38, 0x350000
buffer_load_dwordx4 v136, s[12:15], s38 offen  lds
s_mov_b32 m0, 109568
s_mov_b32 s38, 0x358000
buffer_load_dwordx4 v136, s[12:15], s38 offen  lds
s_mov_b32 m0, 110592
s_mov_b32 s38, 0x360000
buffer_load_dwordx4 v137, s[12:15], s38 offen  lds
s_mov_b32 m0, 111616
s_mov_b32 s38, 0x368000
buffer_load_dwordx4 v137, s[12:15], s38 offen  lds
s_mov_b32 m0, 112640
s_mov_b32 s38, 0x370000
buffer_load_dwordx4 v137, s[12:15], s38 offen  lds
s_mov_b32 m0, 113664
s_mov_b32 s38, 0x378000
buffer_load_dwordx4 v137, s[12:15], s38 offen  lds
s_waitcnt vmcnt(24)
s_barrier
v_add_u32 v142, 0, v140
v_add_u32 v143, 0, v141
ds_read_b64_tr_b16 v[0:1], v142 offset:0
ds_read_b64_tr_b16 v[2:3], v142 offset:512
ds_read_b64_tr_b16 v[4:5], v142 offset:2048
ds_read_b64_tr_b16 v[6:7], v142 offset:2560
ds_read_b64_tr_b16 v[64:65], v143 offset:0
ds_read_b64_tr_b16 v[66:67], v143 offset:512
ds_read_b64_tr_b16 v[68:69], v143 offset:2048
ds_read_b64_tr_b16 v[70:71], v143 offset:2560
ds_read_b64_tr_b16 v[32:33], v142 offset:16384
ds_read_b64_tr_b16 v[34:35], v142 offset:16896
ds_read_b64_tr_b16 v[36:37], v142 offset:18432
ds_read_b64_tr_b16 v[38:39], v142 offset:18944
ds_read_b64_tr_b16 v[96:97], v143 offset:16384
ds_read_b64_tr_b16 v[98:99], v143 offset:16896
ds_read_b64_tr_b16 v[100:101], v143 offset:18432
ds_read_b64_tr_b16 v[102:103], v143 offset:18944
s_waitcnt lgkmcnt(0)
s_barrier
s_mov_b32 s12, s56
s_mov_b32 s13, s57
s_mov_b32 s14, 0x400000
s_mov_b32 m0, 8192
s_mov_b32 s38, 0x8000
buffer_load_dwordx4 v138, s[12:15], s38 offen  lds
s_mov_b32 m0, 9216
s_mov_b32 s38, 0x9000
buffer_load_dwordx4 v138, s[12:15], s38 offen  lds
s_mov_b32 m0, 10240
s_mov_b32 s38, 0xa000
buffer_load_dwordx4 v138, s[12:15], s38 offen  lds
s_mov_b32 m0, 11264
s_mov_b32 s38, 0xb000
buffer_load_dwordx4 v138, s[12:15], s38 offen  lds
s_mov_b32 m0, 12288
s_mov_b32 s38, 0xc000
buffer_load_dwordx4 v139, s[12:15], s38 offen  lds
s_mov_b32 m0, 13312
s_mov_b32 s38, 0xd000
buffer_load_dwordx4 v139, s[12:15], s38 offen  lds
s_mov_b32 m0, 14336
s_mov_b32 s38, 0xe000
buffer_load_dwordx4 v139, s[12:15], s38 offen  lds
s_mov_b32 m0, 15360
s_mov_b32 s38, 0xf000
buffer_load_dwordx4 v139, s[12:15], s38 offen  lds
s_waitcnt vmcnt(24)
s_barrier
v_add_u32 v142, 32768, v140
v_add_u32 v143, 32768, v141
ds_read_b64_tr_b16 v[8:9], v142 offset:0
ds_read_b64_tr_b16 v[10:11], v142 offset:512
ds_read_b64_tr_b16 v[12:13], v142 offset:2048
ds_read_b64_tr_b16 v[14:15], v142 offset:2560
ds_read_b64_tr_b16 v[72:73], v143 offset:0
ds_read_b64_tr_b16 v[74:75], v143 offset:512
ds_read_b64_tr_b16 v[76:77], v143 offset:2048
ds_read_b64_tr_b16 v[78:79], v143 offset:2560
ds_read_b64_tr_b16 v[40:41], v142 offset:16384
ds_read_b64_tr_b16 v[42:43], v142 offset:16896
ds_read_b64_tr_b16 v[44:45], v142 offset:18432
ds_read_b64_tr_b16 v[46:47], v142 offset:18944
ds_read_b64_tr_b16 v[104:105], v143 offset:16384
ds_read_b64_tr_b16 v[106:107], v143 offset:16896
ds_read_b64_tr_b16 v[108:109], v143 offset:18432
ds_read_b64_tr_b16 v[110:111], v143 offset:18944
s_waitcnt lgkmcnt(0)
s_barrier
s_barrier
s_mov_b32 s22, 0
s_mov_b32 s96, 0
s_mov_b32 s42, 0
s_mov_b32 s23, 0x100000
s_mov_b32 s24, 0x101000
s_mov_b32 s25, 0x210000
s_add_u32 s26, s25, 32768
s_lshl_b32 s27, s21, 13
s_add_u32 s27, s27, 0x200800
s_lshl_b32 s29, s21, 13
s_add_u32 s30, s29, 0x1800800
s_add_u32 s29, s29, 0x800800
s_lshl_b32 s31, s21, 11
s_add_u32 s37, s31, 0x3c00200
s_add_u32 s31, s31, 0x3800000
s_mov_b32 s34, 0x3e0293ee
s_mov_b32 s35, 0xbe0293ee
s_mov_b32 s100, 0x3f803f80
s_mov_b32 s101, 0x3f803f80
v_mov_b64 v[244:245], 0
s_lshl_b32 s98, s21, 6
s_add_u32 s98, s98, 0x10400
s_add_u32 s47, s98, 48
s_mov_b32 m0, 40960
s_mov_b32 s38, 0x8100
buffer_load_dwordx4 v138, s[12:15], s38 offen  lds
s_mov_b32 m0, 41984
s_mov_b32 s38, 0x9100
buffer_load_dwordx4 v138, s[12:15], s38 offen  lds
s_mov_b32 m0, 43008
s_mov_b32 s38, 0xa100
buffer_load_dwordx4 v138, s[12:15], s38 offen  lds
s_mov_b32 m0, 44032
s_mov_b32 s38, 0xb100
buffer_load_dwordx4 v138, s[12:15], s38 offen  lds
s_mov_b32 m0, 45056
s_mov_b32 s38, 0xc100
buffer_load_dwordx4 v139, s[12:15], s38 offen  lds
s_mov_b32 m0, 46080
s_mov_b32 s38, 0xd100
buffer_load_dwordx4 v139, s[12:15], s38 offen  lds
s_mov_b32 m0, 47104
s_mov_b32 s38, 0xe100
buffer_load_dwordx4 v139, s[12:15], s38 offen  lds
s_mov_b32 m0, 48128
s_mov_b32 s38, 0xf100
buffer_load_dwordx4 v139, s[12:15], s38 offen  lds
s_waitcnt vmcnt(24)
s_barrier
v_add_u32 v142, 65536, v140
v_add_u32 v143, 65536, v141
ds_read_b64_tr_b16 v[16:17], v142 offset:0
ds_read_b64_tr_b16 v[18:19], v142 offset:512
ds_read_b64_tr_b16 v[20:21], v142 offset:2048
ds_read_b64_tr_b16 v[22:23], v142 offset:2560
ds_read_b64_tr_b16 v[80:81], v143 offset:0
ds_read_b64_tr_b16 v[82:83], v143 offset:512
ds_read_b64_tr_b16 v[84:85], v143 offset:2048
ds_read_b64_tr_b16 v[86:87], v143 offset:2560
ds_read_b64_tr_b16 v[48:49], v142 offset:16384
ds_read_b64_tr_b16 v[50:51], v142 offset:16896
ds_read_b64_tr_b16 v[52:53], v142 offset:18432
ds_read_b64_tr_b16 v[54:55], v142 offset:18944
ds_read_b64_tr_b16 v[112:113], v143 offset:16384
ds_read_b64_tr_b16 v[114:115], v143 offset:16896
ds_read_b64_tr_b16 v[116:117], v143 offset:18432
ds_read_b64_tr_b16 v[118:119], v143 offset:18944
s_waitcnt lgkmcnt(0)
s_barrier
buffer_load_dwordx4 v[224:227], v244, s[8:11], s98 offen offset:16 sc1
buffer_load_dwordx4 v[228:231], v244, s[8:11], s98 offen offset:32 sc1
s_mov_b32 m0, 73728
s_mov_b32 s38, 0x8200
buffer_load_dwordx4 v138, s[12:15], s38 offen  lds
s_mov_b32 m0, 74752
s_mov_b32 s38, 0x9200
buffer_load_dwordx4 v138, s[12:15], s38 offen  lds
s_mov_b32 m0, 75776
s_mov_b32 s38, 0xa200
buffer_load_dwordx4 v138, s[12:15], s38 offen  lds
s_mov_b32 m0, 76800
s_mov_b32 s38, 0xb200
buffer_load_dwordx4 v138, s[12:15], s38 offen  lds
s_mov_b32 m0, 77824
s_mov_b32 s38, 0xc200
buffer_load_dwordx4 v139, s[12:15], s38 offen  lds
s_mov_b32 m0, 78848
s_mov_b32 s38, 0xd200
buffer_load_dwordx4 v139, s[12:15], s38 offen  lds
s_mov_b32 m0, 79872
s_mov_b32 s38, 0xe200
buffer_load_dwordx4 v139, s[12:15], s38 offen  lds
s_mov_b32 m0, 80896
s_mov_b32 s38, 0xf200
buffer_load_dwordx4 v139, s[12:15], s38 offen  lds
s_waitcnt vmcnt(24)
s_barrier
v_add_u32 v142, 98304, v140
v_add_u32 v143, 98304, v141
ds_read_b64_tr_b16 v[24:25], v142 offset:0
ds_read_b64_tr_b16 v[26:27], v142 offset:512
ds_read_b64_tr_b16 v[28:29], v142 offset:2048
ds_read_b64_tr_b16 v[30:31], v142 offset:2560
ds_read_b64_tr_b16 v[88:89], v143 offset:0
ds_read_b64_tr_b16 v[90:91], v143 offset:512
ds_read_b64_tr_b16 v[92:93], v143 offset:2048
ds_read_b64_tr_b16 v[94:95], v143 offset:2560
ds_read_b64_tr_b16 v[56:57], v142 offset:16384
ds_read_b64_tr_b16 v[58:59], v142 offset:16896
ds_read_b64_tr_b16 v[60:61], v142 offset:18432
ds_read_b64_tr_b16 v[62:63], v142 offset:18944
ds_read_b64_tr_b16 v[120:121], v143 offset:16384
ds_read_b64_tr_b16 v[122:123], v143 offset:16896
ds_read_b64_tr_b16 v[124:125], v143 offset:18432
ds_read_b64_tr_b16 v[126:127], v143 offset:18944
s_waitcnt lgkmcnt(0)
s_barrier
s_mov_b32 m0, 106496
s_mov_b32 s38, 0x8300
buffer_load_dwordx4 v138, s[12:15], s38 offen  lds
s_mov_b32 m0, 107520
s_mov_b32 s38, 0x9300
buffer_load_dwordx4 v138, s[12:15], s38 offen  lds
s_mov_b32 m0, 108544
s_mov_b32 s38, 0xa300
buffer_load_dwordx4 v138, s[12:15], s38 offen  lds
s_mov_b32 m0, 109568
s_mov_b32 s38, 0xb300
buffer_load_dwordx4 v138, s[12:15], s38 offen  lds
s_mov_b32 m0, 110592
s_mov_b32 s38, 0xc300
buffer_load_dwordx4 v139, s[12:15], s38 offen  lds
s_mov_b32 m0, 111616
s_mov_b32 s38, 0xd300
buffer_load_dwordx4 v139, s[12:15], s38 offen  lds
s_mov_b32 m0, 112640
s_mov_b32 s38, 0xe300
buffer_load_dwordx4 v139, s[12:15], s38 offen  lds
s_mov_b32 m0, 113664
s_mov_b32 s38, 0xf300
buffer_load_dwordx4 v139, s[12:15], s38 offen  lds
s_waitcnt vmcnt(8)
s_mov_b32 s43, 0
s_cmp_ge_u32 s43, 64
s_cbranch_scc1 L_hx_40
s_mov_b32 s36, 200000
s_branch L_he_41
L_hq_39:
buffer_load_dwordx4 v[224:227], v244, s[8:11], s98 offen offset:16 sc1
buffer_load_dwordx4 v[228:231], v244, s[8:11], s98 offen offset:32 sc1
s_sub_u32 s36, s36, 1
s_cmp_eq_u32 s36, 0
s_cbranch_scc1 L_abort
s_waitcnt vmcnt(0)
L_he_41:
v_cmp_eq_u32 vcc, s46, v225
s_nop 1
v_cndmask_b32 v224, 0, v224, vcc
v_cmp_eq_u32 vcc, s46, v227
s_nop 1
v_cndmask_b32 v226, 0, v226, vcc
v_cmp_eq_u32 vcc, s46, v229
s_nop 1
v_cndmask_b32 v228, 0, v228, vcc
v_cmp_eq_u32 vcc, s46, v231
s_nop 1
v_cndmask_b32 v230, 0, v230, vcc
v_min_u32 v224, v224, v228
v_min_u32 v225, v226, v230
v_lshlrev_b32 v224, 1, v224
v_lshl_add_u32 v225, v225, 1, 1
v_min_u32 v224, v224, v225
s_nop 0
v_readfirstlane_b32 s97, v224
s_cmp_ge_u32 s97, 64
s_cselect_b32 s97, 1000, s97
s_cmp_lt_u32 s43, s97
s_cbranch_scc0 L_hq_39
L_hx_40:
s_mov_b32 m0, 133120
s_nop 0
buffer_load_dwordx4 v247, s[8:11], s29 offen offset:0 sc1 lds
buffer_load_dwordx4 v247, s[8:11], s29 offen offset:1024 sc1 lds
s_add_u32 s29, s29, 262144
s_mov_b32 s44, 141312
v_mov_b32 v232, 136
buffer_load_dword v233, v232, s[16:19], 0 offen sc1
s_xor_b32 s39, s27, 0
buffer_load_dwordx4 v[228:231], v247, s[8:11], s39 offen offset:0 sc1
buffer_load_dwordx4 v[228:231], v247, s[8:11], s39 offen offset:1024 sc1
s_xor_b32 s39, s27, 262144
buffer_load_dwordx4 v[228:231], v247, s[8:11], s39 offen offset:0 sc1
buffer_load_dwordx4 v[228:231], v247, s[8:11], s39 offen offset:1024 sc1
buffer_load_dwordx4 v[228:231], v247, s[8:11], s30 offen offset:0 sc1
buffer_load_dwordx4 v[228:231], v247, s[8:11], s30 offen offset:1024 sc1
buffer_load_dword v228, v244, s[8:11], s31 offen sc1
buffer_load_dword v228, v244, s[8:11], s37 offen sc1
s_mov_b32 s39, 0x100800
buffer_load_dwordx4 v[228:231], v247, s[8:11], s39 offen offset:0 sc1
buffer_load_dwordx4 v[228:231], v247, s[8:11], s39 offen offset:1024 sc1
s_mov_b32 s39, 0x102800
buffer_load_dwordx4 v[228:231], v247, s[8:11], s39 offen offset:0 sc1
buffer_load_dwordx4 v[228:231], v247, s[8:11], s39 offen offset:1024 sc1
s_mov_b32 s39, 0x104800
buffer_load_dwordx4 v[228:231], v247, s[8:11], s39 offen offset:0 sc1
buffer_load_dwordx4 v[228:231], v247, s[8:11], s39 offen offset:1024 sc1
s_mov_b32 s39, 0x106800
buffer_load_dwordx4 v[228:231], v247, s[8:11], s39 offen offset:0 sc1
buffer_load_dwordx4 v[228:231], v247, s[8:11], s39 offen offset:1024 sc1
s_getpc_b64 s[40:41]
L_pc_42:
s_add_u32 s40, s40, L_step_w1f-L_pc_42
s_addc_u32 s41, s41, 0
global_load_dwordx4 v[228:231], v247, s[40:41] offset:0
global_load_dwordx4 v[228:231], v247, s[40:41] offset:1024
global_load_dwordx4 v[228:231], v247, s[40:41] offset:2048
global_load_dwordx4 v[228:231], v247, s[40:41] offset:3072
s_waitcnt vmcnt(23)
s_barrier
ds_read_b64_tr_b16 v[160:161], v148 offset:0
ds_read_b64_tr_b16 v[162:163], v148 offset:512
ds_read_b64_tr_b16 v[164:165], v148 offset:2048
ds_read_b64_tr_b16 v[166:167], v148 offset:2560
ds_read_b64_tr_b16 v[168:169], v149 offset:0
ds_read_b64_tr_b16 v[170:171], v149 offset:512
ds_read_b64_tr_b16 v[172:173], v149 offset:2048
ds_read_b64_tr_b16 v[174:175], v149 offset:2560
ds_read_b64_tr_b16 v[176:177], v150 offset:0
ds_read_b64_tr_b16 v[178:179], v150 offset:512
ds_read_b64_tr_b16 v[180:181], v150 offset:2048
ds_read_b64_tr_b16 v[182:183], v150 offset:2560
ds_read_b64_tr_b16 v[184:185], v151 offset:0
ds_read_b64_tr_b16 v[186:187], v151 offset:512
ds_read_b64_tr_b16 v[188:189], v151 offset:2048
ds_read_b64_tr_b16 v[190:191], v151 offset:2560
ds_read_b64_tr_b16 v[192:193], v152 offset:0
ds_read_b64_tr_b16 v[194:195], v152 offset:512
ds_read_b64_tr_b16 v[196:197], v152 offset:2048
ds_read_b64_tr_b16 v[198:199], v152 offset:2560
ds_read_b64_tr_b16 v[200:201], v153 offset:0
ds_read_b64_tr_b16 v[202:203], v153 offset:512
ds_read_b64_tr_b16 v[204:205], v153 offset:2048
ds_read_b64_tr_b16 v[206:207], v153 offset:2560
ds_read_b64_tr_b16 v[208:209], v154 offset:0
ds_read_b64_tr_b16 v[210:211], v154 offset:512
ds_read_b64_tr_b16 v[212:213], v154 offset:2048
ds_read_b64_tr_b16 v[214:215], v154 offset:2560
ds_read_b64_tr_b16 v[216:217], v155 offset:0
ds_read_b64_tr_b16 v[218:219], v155 offset:512
ds_read_b64_tr_b16 v[220:221], v155 offset:2048
ds_read_b64_tr_b16 v[222:223], v155 offset:2560
s_waitcnt lgkmcnt(0)
ds_write_b128 v248, v[160:163] offset:0
ds_write_b128 v248, v[164:167] offset:1024
ds_write_b128 v248, v[168:171] offset:2048
ds_write_b128 v248, v[172:175] offset:3072
ds_write_b128 v248, v[176:179] offset:4096
ds_write_b128 v248, v[180:183] offset:5120
ds_write_b128 v248, v[184:187] offset:6144
ds_write_b128 v248, v[188:191] offset:7168
ds_write_b128 v248, v[192:195] offset:8192
ds_write_b128 v248, v[196:199] offset:9216
ds_write_b128 v248, v[200:203] offset:10240
ds_write_b128 v248, v[204:207] offset:11264
ds_write_b128 v248, v[208:211] offset:12288
ds_write_b128 v248, v[212:215] offset:13312
ds_write_b128 v248, v[216:219] offset:14336
ds_write_b128 v248, v[220:223] offset:15360
s_waitcnt lgkmcnt(0)
ds_read_b64_tr_b16 v[160:161], v148 offset:16384
ds_read_b64_tr_b16 v[162:163], v148 offset:16896
ds_read_b64_tr_b16 v[164:165], v148 offset:18432
ds_read_b64_tr_b16 v[166:167], v148 offset:18944
ds_read_b64_tr_b16 v[168:169], v149 offset:16384
ds_read_b64_tr_b16 v[170:171], v149 offset:16896
ds_read_b64_tr_b16 v[172:173], v149 offset:18432
ds_read_b64_tr_b16 v[174:175], v149 offset:18944
ds_read_b64_tr_b16 v[176:177], v150 offset:16384
ds_read_b64_tr_b16 v[178:179], v150 offset:16896
ds_read_b64_tr_b16 v[180:181], v150 offset:18432
ds_read_b64_tr_b16 v[182:183], v150 offset:18944
ds_read_b64_tr_b16 v[184:185], v151 offset:16384
ds_read_b64_tr_b16 v[186:187], v151 offset:16896
ds_read_b64_tr_b16 v[188:189], v151 offset:18432
ds_read_b64_tr_b16 v[190:191], v151 offset:18944
ds_read_b64_tr_b16 v[192:193], v152 offset:16384
ds_read_b64_tr_b16 v[194:195], v152 offset:16896
ds_read_b64_tr_b16 v[196:197], v152 offset:18432
ds_read_b64_tr_b16 v[198:199], v152 offset:18944
ds_read_b64_tr_b16 v[200:201], v153 offset:16384
ds_read_b64_tr_b16 v[202:203], v153 offset:16896
ds_read_b64_tr_b16 v[204:205], v153 offset:18432
ds_read_b64_tr_b16 v[206:207], v153 offset:18944
ds_read_b64_tr_b16 v[208:209], v154 offset:16384
ds_read_b64_tr_b16 v[210:211], v154 offset:16896
ds_read_b64_tr_b16 v[212:213], v154 offset:18432
ds_read_b64_tr_b16 v[214:215], v154 offset:18944
ds_read_b64_tr_b16 v[216:217], v155 offset:16384
ds_read_b64_tr_b16 v[218:219], v155 offset:16896
ds_read_b64_tr_b16 v[220:221], v155 offset:18432
ds_read_b64_tr_b16 v[222:223], v155 offset:18944
s_waitcnt lgkmcnt(0)
ds_write_b128 v248, v[160:163] offset:16384
ds_write_b128 v248, v[164:167] offset:17408
ds_write_b128 v248, v[168:171] offset:18432
ds_write_b128 v248, v[172:175] offset:19456
ds_write_b128 v248, v[176:179] offset:20480
ds_write_b128 v248, v[180:183] offset:21504
ds_write_b128 v248, v[184:187] offset:22528
ds_write_b128 v248, v[188:191] offset:23552
ds_write_b128 v248, v[192:195] offset:24576
ds_write_b128 v248, v[196:199] offset:25600
ds_write_b128 v248, v[200:203] offset:26624
ds_write_b128 v248, v[204:207] offset:27648
ds_write_b128 v248, v[208:211] offset:28672
ds_write_b128 v248, v[212:215] offset:29696
ds_write_b128 v248, v[216:219] offset:30720
ds_write_b128 v248, v[220:223] offset:31744
s_waitcnt lgkmcnt(0)
v_mov_b64 v[160:161], 0
v_mov_b64 v[162:163], 0
v_mov_b64 v[164:165], 0
v_mov_b64 v[166:167], 0
v_mov_b64 v[168:169], 0
v_mov_b64 v[170:171], 0
v_mov_b64 v[172:173], 0
v_mov_b64 v[174:175], 0
v_mov_b64 v[176:177], 0
v_mov_b64 v[178:179], 0
v_mov_b64 v[180:181], 0
v_mov_b64 v[182:183], 0
v_mov_b64 v[224:225], -1
v_mov_b64 v[226:227], -1
s_mov_b32 s41, 0x106000
v_mov_b64 v[244:245], 0
v_mov_b64 v[240:241], 0
v_mov_b64 v[242:243], 0
v_add_u32 v245, 151552, v247
s_mov_b32 s36, 200000
s_waitcnt vmcnt(0)
s_branch L_arq_44
L_arr_43:
buffer_load_dword v233, v232, s[16:19], 0 offen sc1
s_sub_u32 s36, s36, 1
s_cmp_eq_u32 s36, 0
s_cbranch_scc1 L_abort
s_waitcnt vmcnt(0)
L_arq_44:
v_cmp_ne_u32 vcc, 32, v233
s_cbranch_vccnz L_arr_43
s_waitcnt vmcnt(0)
s_barrier
s_cmp_lg_u32 s32, 0
s_cbranch_scc1 L_cslow1
L_step_w1f:
s_waitcnt vmcnt(0)
s_mov_b32 s36, 200000
buffer_load_dwordx4 v[184:187], v247, s[8:11], s23 offen offset:2048 sc1
buffer_load_dwordx4 v[188:191], v247, s[8:11], s23 offen offset:3072 sc1
v_mov_b64 v[160:161], 0
v_mov_b64 v[162:163], 0
v_mov_b64 v[164:165], 0
v_mov_b64 v[166:167], 0
v_mov_b64 v[168:169], 0
v_mov_b64 v[170:171], 0
v_mov_b64 v[172:173], 0
v_mov_b64 v[174:175], 0
v_mov_b64 v[176:177], 0
v_mov_b64 v[178:179], 0
v_mov_b64 v[180:181], 0
v_mov_b64 v[182:183], 0
L_pl_48:
buffer_load_dwordx4 v[192:195], v247, s[8:11], s23 offen offset:2048 sc1
buffer_load_dwordx4 v[196:199], v247, s[8:11], s23 offen offset:3072 sc1
s_waitcnt vmcnt(2)
ds_write_b128 v245, v[184:187] offset:2048
ds_write_b128 v245, v[188:191] offset:3072
v_max3_u32 v255, v184, v185, v186
v_max3_u32 v255, v255, v187, v188
v_max3_u32 v255, v255, v189, v190
v_max_u32 v255, v255, v191
v_cmp_eq_u32 vcc, -1, v255
s_cbranch_vccz L_mok0_45
buffer_load_dwordx4 v[184:187], v247, s[8:11], s23 offen offset:2048 sc1
buffer_load_dwordx4 v[188:191], v247, s[8:11], s23 offen offset:3072 sc1
s_waitcnt vmcnt(2)
ds_write_b128 v245, v[192:195] offset:2048
ds_write_b128 v245, v[196:199] offset:3072
v_max3_u32 v255, v192, v193, v194
v_max3_u32 v255, v255, v195, v196
v_max3_u32 v255, v255, v197, v198
v_max_u32 v255, v255, v199
v_cmp_eq_u32 vcc, -1, v255
s_cbranch_vccz L_mok1_46
s_sub_u32 s36, s36, 1
s_cmp_lg_u32 s36, 0
s_cbranch_scc1 L_pl_48
s_branch L_abort
L_mok1_46:
v_smfmac_f32_16x16x64_bf16 v[160:163], v[192:195], a[16:23], v246
v_smfmac_f32_16x16x64_bf16 v[164:167], v[192:195], a[144:151], v246
v_smfmac_f32_16x16x64_bf16 v[168:171], v[192:195], a[80:87], v246
s_waitcnt lgkmcnt(0)
s_barrier
ds_read_b128 v[128:131], v245 offset:0
ds_read_b128 v[132:135], v245 offset:1024
v_smfmac_f32_16x16x64_bf16 v[172:175], v[192:195], a[208:215], v246
ds_read_b128 v[144:147], v245 offset:4096
v_smfmac_f32_16x16x64_bf16 v[160:163], v[196:199], a[24:31], v246
ds_read_b128 v[148:151], v245 offset:5120
v_smfmac_f32_16x16x64_bf16 v[164:167], v[196:199], a[152:159], v246
ds_read_b128 v[152:155], v245 offset:6144
v_smfmac_f32_16x16x64_bf16 v[168:171], v[196:199], a[88:95], v246
ds_read_b128 v[156:159], v245 offset:7168
v_smfmac_f32_16x16x64_bf16 v[172:175], v[196:199], a[216:223], v246
ds_read_b128 v[136:139], v245 offset:2048
ds_read_b128 v[140:143], v245 offset:3072
s_branch L_mjoin_47
L_mok0_45:
v_smfmac_f32_16x16x64_bf16 v[160:163], v[184:187], a[16:23], v246
v_smfmac_f32_16x16x64_bf16 v[164:167], v[184:187], a[144:151], v246
v_smfmac_f32_16x16x64_bf16 v[168:171], v[184:187], a[80:87], v246
s_waitcnt lgkmcnt(0)
s_barrier
ds_read_b128 v[128:131], v245 offset:0
ds_read_b128 v[132:135], v245 offset:1024
v_smfmac_f32_16x16x64_bf16 v[172:175], v[184:187], a[208:215], v246
ds_read_b128 v[144:147], v245 offset:4096
v_smfmac_f32_16x16x64_bf16 v[160:163], v[188:191], a[24:31], v246
ds_read_b128 v[148:151], v245 offset:5120
v_smfmac_f32_16x16x64_bf16 v[164:167], v[188:191], a[152:159], v246
ds_read_b128 v[152:155], v245 offset:6144
v_smfmac_f32_16x16x64_bf16 v[168:171], v[188:191], a[88:95], v246
ds_read_b128 v[156:159], v245 offset:7168
v_smfmac_f32_16x16x64_bf16 v[172:175], v[188:191], a[216:223], v246
ds_read_b128 v[136:139], v245 offset:2048
ds_read_b128 v[140:143], v245 offset:3072
L_mjoin_47:
buffer_store_dword v224, v251, s[8:11], s41 offen
s_waitcnt lgkmcnt(7)
v_smfmac_f32_16x16x64_bf16 v[160:163], v[128:131], a[0:7], v246
ds_read_b128 v[200:203], v249 offset:4096
v_smfmac_f32_16x16x64_bf16 v[164:167], v[128:131], a[128:135], v246
buffer_load_dwordx4 v[228:231], v247, s[8:11], s30 offen offset:0 sc1 nt
v_smfmac_f32_16x16x64_bf16 v[168:171], v[128:131], a[64:71], v246
ds_read_b128 v[204:207], v249 offset:5120
v_smfmac_f32_16x16x64_bf16 v[172:175], v[128:131], a[192:199], v246
s_waitcnt lgkmcnt(8)
v_smfmac_f32_16x16x64_bf16 v[160:163], v[132:135], a[8:15], v246
ds_read_b128 v[208:211], v249 offset:6144
v_smfmac_f32_16x16x64_bf16 v[164:167], v[132:135], a[136:143], v246
buffer_load_dwordx4 v[232:235], v247, s[8:11], s30 offen offset:1024 sc1 nt
v_smfmac_f32_16x16x64_bf16 v[168:171], v[132:135], a[72:79], v246
ds_read_b128 v[212:215], v249 offset:7168
v_smfmac_f32_16x16x64_bf16 v[172:175], v[132:135], a[200:207], v246
s_waitcnt lgkmcnt(9)
v_smfmac_f32_16x16x64_bf16 v[160:163], v[144:147], a[32:39], v246
s_waitcnt vmcnt(3)
s_add_u32 s43, s22, 3
s_cmp_ge_u32 s43, s97
s_cbranch_scc1 L_hz_49
L_hzb_50:
ds_read_b128 v[184:187], v249 offset:0
v_smfmac_f32_16x16x64_bf16 v[164:167], v[144:147], a[160:167], v246
s_mov_b32 m0, s44
s_nop 0
buffer_load_dwordx4 v247, s[8:11], s29 offen sc1 nt lds
v_smfmac_f32_16x16x64_bf16 v[168:171], v[144:147], a[96:103], v246
ds_read_b128 v[188:191], v249 offset:1024
v_smfmac_f32_16x16x64_bf16 v[172:175], v[144:147], a[224:231], v246
s_waitcnt lgkmcnt(10)
v_smfmac_f32_16x16x64_bf16 v[160:163], v[148:151], a[40:47], v246
ds_read_b128 v[192:195], v249 offset:2048
v_smfmac_f32_16x16x64_bf16 v[164:167], v[148:151], a[168:175], v246
buffer_load_dwordx4 v247, s[8:11], s29 offen offset:1024 sc1 nt lds
v_smfmac_f32_16x16x64_bf16 v[168:171], v[148:151], a[104:111], v246
ds_read_b128 v[196:199], v249 offset:3072
v_smfmac_f32_16x16x64_bf16 v[172:175], v[148:151], a[232:239], v246
s_waitcnt lgkmcnt(8)
v_smfmac_f32_16x16x64_bf16 v[160:163], v[152:155], a[48:55], v246
v_smfmac_f32_16x16x64_bf16 v[164:167], v[152:155], a[176:183], v246
v_smfmac_f32_16x16x64_bf16 v[160:163], v[156:159], a[56:63], v246
v_smfmac_f32_16x16x64_bf16 v[164:167], v[156:159], a[184:191], v246
v_smfmac_f32_16x16x64_bf16 v[168:171], v[152:155], a[112:119], v246
v_smfmac_f32_16x16x64_bf16 v[172:175], v[152:155], a[240:247], v246
v_smfmac_f32_16x16x64_bf16 v[168:171], v[156:159], a[120:127], v246
v_smfmac_f32_16x16x64_bf16 v[172:175], v[156:159], a[248:255], v246
v_smfmac_f32_16x16x64_bf16 v[176:179], v[128:131], v[0:7], v246
s_nop 1
v_add_f32 v160, v160, v162
v_add_f32 v161, v161, v163
v_smfmac_f32_16x16x64_bf16 v[180:183], v[128:131], v[64:71], v246
v_add_f32 v164, v164, v166
v_add_f32 v165, v165, v167
v_smfmac_f32_16x16x64_bf16 v[176:179], v[132:135], v[8:15], v246
v_cvt_pk_bf16_f32 v163, v160, v161
v_cvt_pk_bf16_f32 v162, v164, v165
ds_write_b64 v252, v[162:163] offset:0
v_add_f32 v168, v168, v170
v_add_f32 v169, v169, v171
v_add_f32 v172, v172, v174
v_add_f32 v173, v173, v175
v_cvt_pk_bf16_f32 v171, v168, v169
v_cvt_pk_bf16_f32 v170, v172, v173
ds_write_b64 v252, v[170:171] offset:512
v_smfmac_f32_16x16x64_bf16 v[180:183], v[132:135], v[72:79], v246
v_smfmac_f32_16x16x64_bf16 v[176:179], v[136:139], v[16:23], v246
v_smfmac_f32_16x16x64_bf16 v[180:183], v[136:139], v[80:87], v246
v_smfmac_f32_16x16x64_bf16 v[176:179], v[140:143], v[24:31], v246
s_waitcnt lgkmcnt(0)
s_barrier
ds_read_b64_tr_b16 v[160:161], v253 offset:0
ds_read_b64_tr_b16 v[162:163], v253 offset:512
ds_read_b64_tr_b16 v[164:165], v253 offset:1024
v_smfmac_f32_16x16x64_bf16 v[180:183], v[140:143], v[88:95], v246
ds_read_b64_tr_b16 v[166:167], v253 offset:1536
v_smfmac_f32_16x16x64_bf16 v[176:179], v[144:147], v[32:39], v246
ds_read_b64_tr_b16 v[168:169], v253 offset:2048
v_smfmac_f32_16x16x64_bf16 v[180:183], v[144:147], v[96:103], v246
ds_read_b64_tr_b16 v[170:171], v253 offset:2560
v_smfmac_f32_16x16x64_bf16 v[176:179], v[148:151], v[40:47], v246
ds_read_b64_tr_b16 v[172:173], v253 offset:3072
v_smfmac_f32_16x16x64_bf16 v[180:183], v[148:151], v[104:111], v246
ds_read_b64_tr_b16 v[174:175], v253 offset:3584
s_waitcnt lgkmcnt(6)
v_mfma_f32_16x16x32_bf16 v[216:219], v[184:187], v[160:163], 0
v_mfma_f32_16x16x32_bf16 v[220:223], v[200:203], v[160:163], 0
ds_read_b128 v[128:131], v248 offset:4096
v_mfma_f32_16x16x32_bf16 v[224:227], v[160:163], v[160:163], 0
ds_read_b128 v[132:135], v248 offset:5120
s_waitcnt lgkmcnt(6)
v_mfma_f32_16x16x32_bf16 v[216:219], v[188:191], v[164:167], v[216:219]
ds_read_b128 v[136:139], v248 offset:20480
v_mfma_f32_16x16x32_bf16 v[220:223], v[204:207], v[164:167], v[220:223]
ds_read_b128 v[140:143], v248 offset:21504
v_mfma_f32_16x16x32_bf16 v[224:227], v[164:167], v[164:167], v[224:227]
ds_read_b128 v[144:147], v248 offset:6144
s_waitcnt lgkmcnt(7)
v_mfma_f32_16x16x32_bf16 v[216:219], v[192:195], v[168:171], v[216:219]
ds_read_b128 v[148:151], v248 offset:7168
v_mfma_f32_16x16x32_bf16 v[220:223], v[208:211], v[168:171], v[220:223]
v_mfma_f32_16x16x32_bf16 v[224:227], v[168:171], v[168:171], v[224:227]
s_waitcnt lgkmcnt(6)
v_mfma_f32_16x16x32_bf16 v[216:219], v[196:199], v[172:175], v[216:219]
v_mfma_f32_16x16x32_bf16 v[220:223], v[212:215], v[172:175], v[220:223]
v_mfma_f32_16x16x32_bf16 v[224:227], v[172:175], v[172:175], v[224:227]
buffer_store_dwordx4 v[164:167], v254, s[8:11], s31 offen offset:512 sc1
v_smfmac_f32_16x16x64_bf16 v[176:179], v[152:155], v[48:55], v246
v_smfmac_f32_16x16x64_bf16 v[180:183], v[152:155], v[112:119], v246
v_smfmac_f32_16x16x64_bf16 v[176:179], v[156:159], v[56:63], v246
v_smfmac_f32_16x16x64_bf16 v[180:183], v[156:159], v[120:127], v246
ds_read_b128 v[152:155], v248 offset:22528
ds_read_b128 v[156:159], v248 offset:23552
v_max3_f32 v168, v216, v217, v218
v_max3_f32 v169, v219, v220, v221
v_max3_f32 v168, v168, v222, v223
v_max3_f32 v169, v169, v224, v225
v_max_f32 v168, v168, v169
v_mov_b32 v169, v168
ds_read_b128 v[184:187], v248 offset:0
v_mov_b64 v[164:165], s[100:101]
v_permlane32_swap_b32 v168, v169
v_max_f32 v168, v168, v169
v_mov_b32 v169, v168
ds_read_b128 v[188:191], v248 offset:1024
v_mov_b64 v[166:167], s[100:101]
v_permlane16_swap_b32 v168, v169
v_max_f32 v168, v168, v169
v_mul_f32 v170, s35, v168
v_pk_fma_f32 v[216:217], v[216:217], s[34:35], v[170:171] op_sel_hi:[1,0,0]
v_pk_fma_f32 v[218:219], v[218:219], s[34:35], v[170:171] op_sel_hi:[1,0,0]
ds_read_b128 v[192:195], v248 offset:16384
v_pk_fma_f32 v[220:221], v[220:221], s[34:35], v[170:171] op_sel_hi:[1,0,0]
v_pk_fma_f32 v[222:223], v[222:223], s[34:35], v[170:171] op_sel_hi:[1,0,0]
v_pk_fma_f32 v[224:225], v[224:225], s[34:35], v[170:171] op_sel_hi:[1,0,0]
ds_read_b128 v[196:199], v248 offset:17408
v_exp_f32 v216, v216
v_exp_f32 v217, v217
v_exp_f32 v218, v218
ds_read_b128 v[200:203], v248 offset:2048
v_exp_f32 v219, v219
v_exp_f32 v220, v220
v_exp_f32 v221, v221
ds_read_b128 v[204:207], v248 offset:3072
v_exp_f32 v222, v222
v_exp_f32 v223, v223
v_exp_f32 v224, v224
ds_read_b128 v[208:211], v248 offset:18432
v_exp_f32 v225, v225
ds_read_b128 v[212:215], v248 offset:19456
v_mov_b32 v161, 0
v_mov_b64 v[162:163], 0
s_cmp_lg_u32 s42, 0
s_cbranch_scc1 L_hze_51
L_hzf_52:
v_cvt_pk_bf16_f32 v236, v216, v217
v_cvt_pk_bf16_f32 v237, v218, v219
v_cvt_pk_bf16_f32 v238, v220, v221
v_cvt_pk_bf16_f32 v239, v222, v223
v_cvt_pk_bf16_f32 v160, v224, v225
v_add_f32 v176, v176, v178
v_mfma_f32_16x16x32_bf16 v[224:227], v[236:239], v[164:167], 0
s_waitcnt vmcnt(3)
v_add_f32 v177, v177, v179
v_mfma_f32_16x16x32_bf16 v[216:219], v[236:239], v[228:231], 0
v_add_f32 v180, v180, v182
v_mfma_f32_16x16x32_bf16 v[220:223], v[236:239], v[232:235], 0
v_add_f32 v181, v181, v183
v_mfma_f32_16x16x32_bf16 v[224:227], v[160:163], v[164:167], v[224:227]
v_cvt_pk_bf16_f32 v240, v176, v177
v_cvt_pk_bf16_f32 v242, v180, v181
v_lshrrev_b32 v255, 2, v247
s_nop 0
v_mfma_f32_16x16x32_bf16 v[216:219], v[160:163], v[240:243], v[216:219]
v_mfma_f32_16x16x32_bf16 v[220:223], v[160:163], v[242:245], v[220:223]
buffer_store_dword v240, v255, s[8:11], s37 offen sc1
buffer_store_dword v242, v255, s[8:11], s37 offen offset:256 sc1
v_rcp_f32 v172, v226
v_rcp_f32 v173, v227
s_nop 2
v_pk_mul_f32 v[218:219], v[218:219], v[172:173]
v_pk_mul_f32 v[222:223], v[222:223], v[172:173]
v_cvt_pk_bf16_f32 v216, v218, v219
v_cvt_pk_bf16_f32 v217, v222, v223
ds_write_b64 v252, v[216:217] offset:12288
v_mov_b64 v[168:169], 0
v_mov_b64 v[170:171], 0
v_mov_b64 v[172:173], 0
v_mov_b64 v[174:175], 0
v_mov_b64 v[176:177], 0
v_mov_b64 v[178:179], 0
v_mov_b64 v[180:181], 0
v_mov_b64 v[182:183], 0
s_waitcnt lgkmcnt(0)
s_barrier
ds_read_b64_tr_b16 v[236:237], v253 offset:12288
ds_read_b64_tr_b16 v[238:239], v253 offset:13312
ds_read_b64_tr_b16 v[240:241], v253 offset:14336
ds_read_b64_tr_b16 v[242:243], v253 offset:15360
v_mov_b64 v[160:161], 0
v_mov_b64 v[162:163], 0
v_mov_b64 v[164:165], 0
v_mov_b64 v[166:167], 0
v_mov_b64 v[228:229], 0
v_mov_b64 v[230:231], 0
v_mov_b64 v[232:233], 0
v_mov_b64 v[234:235], 0
s_waitcnt lgkmcnt(0)
v_smfmac_f32_16x16x64_bf16 v[160:163], v[236:239], v[184:191], v246
ds_read_b128 v[184:187], v248 offset:8192
ds_read_b128 v[188:191], v248 offset:9216
v_smfmac_f32_16x16x64_bf16 v[160:163], v[240:243], v[192:199], v246
ds_read_b128 v[192:195], v248 offset:24576
v_smfmac_f32_16x16x64_bf16 v[164:167], v[236:239], v[200:207], v246
ds_read_b128 v[196:199], v248 offset:25600
ds_read_b128 v[200:203], v248 offset:10240
v_smfmac_f32_16x16x64_bf16 v[164:167], v[240:243], v[208:215], v246
ds_read_b128 v[204:207], v248 offset:11264
s_nop 1
v_add_f32 v160, v160, v162
v_smfmac_f32_16x16x64_bf16 v[168:171], v[236:239], v[128:135], v246
ds_read_b128 v[208:211], v248 offset:26624
ds_read_b128 v[212:215], v248 offset:27648
v_add_f32 v161, v161, v163
v_smfmac_f32_16x16x64_bf16 v[168:171], v[240:243], v[136:143], v246
ds_read_b128 v[128:131], v248 offset:12288
v_cvt_pk_bf16_f32 v160, v160, v161
v_smfmac_f32_16x16x64_bf16 v[172:175], v[236:239], v[144:151], v246
ds_read_b128 v[132:135], v248 offset:13312
ds_read_b128 v[136:139], v248 offset:28672
v_add_f32 v164, v164, v166
v_smfmac_f32_16x16x64_bf16 v[172:175], v[240:243], v[152:159], v246
ds_read_b128 v[140:143], v248 offset:29696
v_add_f32 v165, v165, v167
s_waitcnt lgkmcnt(10)
v_smfmac_f32_16x16x64_bf16 v[176:179], v[236:239], v[184:191], v246
ds_read_b128 v[144:147], v248 offset:14336
ds_read_b128 v[148:151], v248 offset:15360
v_cvt_pk_bf16_f32 v161, v164, v165
v_add_f32 v168, v168, v170
s_waitcnt lgkmcnt(10)
v_smfmac_f32_16x16x64_bf16 v[176:179], v[240:243], v[192:199], v246
ds_read_b128 v[152:155], v248 offset:30720
v_add_f32 v169, v169, v171
v_cvt_pk_bf16_f32 v162, v168, v169
s_waitcnt lgkmcnt(9)
v_smfmac_f32_16x16x64_bf16 v[180:183], v[236:239], v[200:207], v246
ds_read_b128 v[156:159], v248 offset:31744
v_add_f32 v172, v172, v174
v_add_f32 v173, v173, v175
s_waitcnt lgkmcnt(8)
v_smfmac_f32_16x16x64_bf16 v[180:183], v[240:243], v[208:215], v246
v_cvt_pk_bf16_f32 v163, v172, v173
v_bfi_b32 v160, 1, s96, v160
s_waitcnt lgkmcnt(6)
v_smfmac_f32_16x16x64_bf16 v[228:231], v[236:239], v[128:135], v246
buffer_store_dwordx4 v[160:163], v250, s[8:11], s25 offen
v_add_f32 v176, v176, v178
s_waitcnt lgkmcnt(4)
v_smfmac_f32_16x16x64_bf16 v[228:231], v[240:243], v[136:143], v246
v_add_f32 v177, v177, v179
v_cvt_pk_bf16_f32 v176, v176, v177
s_waitcnt lgkmcnt(2)
v_smfmac_f32_16x16x64_bf16 v[232:235], v[236:239], v[144:151], v246
v_add_f32 v180, v180, v182
v_add_f32 v181, v181, v183
s_waitcnt lgkmcnt(0)
v_smfmac_f32_16x16x64_bf16 v[232:235], v[240:243], v[152:159], v246
v_cvt_pk_bf16_f32 v177, v180, v181
v_add_f32 v228, v228, v230
v_add_f32 v229, v229, v231
v_cvt_pk_bf16_f32 v178, v228, v229
s_nop 3
v_pk_add_f32 v[232:233], v[232:233], v[234:235]
v_cvt_pk_bf16_f32 v179, v232, v233
v_bfi_b32 v176, 1, s96, v176
buffer_store_dwordx4 v[176:179], v250, s[8:11], s26 offen
v_lshrrev_b32 v216, 9, v247
v_mul_u32_u24 v216, 512, v216
v_add3_u32 v255, v247, v216, s99
ds_read_b128 v[216:219], v255
s_add_u32 s29, s29, 262144
s_add_u32 s30, s30, 262144
s_add_u32 s37, s37, 65536
s_add_u32 s31, s31, 65536
s_add_u32 s22, s22, 1
s_xor_b32 s44, s44, 8192
v_xor_b32 v249, 8192, v249
s_waitcnt vmcnt(0)
s_waitcnt lgkmcnt(0)
s_mov_b32 s36, 200000
buffer_load_dwordx4 v[184:187], v247, s[8:11], s27 offen offset:0 sc1
buffer_load_dwordx4 v[188:191], v247, s[8:11], s27 offen offset:1024 sc1
s_waitcnt vmcnt(0)
v_bitop3_b32 v255, v184, v188, s96 bitop3:0x7e
v_and_b32 v255, 1, v255
v_cmp_ne_u32 vcc, 0, v255
s_cbranch_vccz L_rok0_53
buffer_load_dwordx4 v[184:187], v247, s[8:11], s27 offen offset:0 sc1
buffer_load_dwordx4 v[188:191], v247, s[8:11], s27 offen offset:1024 sc1
L_pl_56:
buffer_load_dwordx4 v[192:195], v247, s[8:11], s27 offen offset:0 sc1
buffer_load_dwordx4 v[196:199], v247, s[8:11], s27 offen offset:1024 sc1
s_waitcnt vmcnt(2)
v_bitop3_b32 v255, v184, v188, s96 bitop3:0x7e
v_and_b32 v255, 1, v255
v_cmp_ne_u32 vcc, 0, v255
s_cbranch_vccz L_rok0_53
buffer_load_dwordx4 v[184:187], v247, s[8:11], s27 offen offset:0 sc1
buffer_load_dwordx4 v[188:191], v247, s[8:11], s27 offen offset:1024 sc1
s_waitcnt vmcnt(2)
v_bitop3_b32 v255, v192, v196, s96 bitop3:0x7e
v_and_b32 v255, 1, v255
v_cmp_ne_u32 vcc, 0, v255
s_cbranch_vccz L_rok1_54
s_sub_u32 s36, s36, 1
s_cmp_lg_u32 s36, 0
s_cbranch_scc1 L_pl_56
s_branch L_abort
L_rok1_54:
v_mfma_f32_16x16x32_bf16 v[220:223], v[192:195], v[216:219], 0
v_mfma_f32_16x16x32_bf16 v[220:223], v[196:199], v[216:219], v[220:223]
s_branch L_rjoin_55
L_rok0_53:
v_mfma_f32_16x16x32_bf16 v[220:223], v[184:187], v[216:219], 0
v_mfma_f32_16x16x32_bf16 v[220:223], v[188:191], v[216:219], v[220:223]
L_rjoin_55:
s_add_u32 s23, s23, 8192
s_and_b32 s23, s23, 0x107fff
s_add_u32 s24, s23, 4096
s_add_u32 s41, s23, 2 * 8192
s_and_b32 s41, s41, 0x107fff
v_mov_b32 v224, -1
s_nop 2
v_permlane32_swap_b32 v220, v222
v_permlane32_swap_b32 v221, v223
v_add_f32 v220, v220, v222
v_add_f32 v221, v221, v223
s_nop 1
v_permlane16_swap_b32 v220, v221
v_add_f32 v220, v220, v221
v_mov_b32 v221, v220
s_nop 1
v_permlane16_swap_b32 v220, v221
v_cvt_pk_bf16_f32 v220, v220, v221
v_min_u32 v220, 0xfffffffe, v220
buffer_store_dword v220, v251, s[8:11], s23 offen
s_xor_b32 s25, s25, 262144
s_xor_b32 s26, s26, 262144
s_xor_b32 s27, s27, 262144
s_bfe_u32 s96, s22, 0x10001
s_cmp_lg_u32 s22, 63
s_cbranch_scc1 L_step_w1f
v_mov_b64 v[160:161], 0
v_mov_b64 v[162:163], 0
v_mov_b64 v[164:165], 0
v_mov_b64 v[166:167], 0
v_mov_b64 v[168:169], 0
v_mov_b64 v[170:171], 0
v_mov_b64 v[172:173], 0
v_mov_b64 v[174:175], 0
v_mov_b64 v[176:177], 0
v_mov_b64 v[178:179], 0
v_mov_b64 v[180:181], 0
v_mov_b64 v[182:183], 0
s_mov_b32 s36, 200000
L_lpoll_57:
buffer_load_dwordx4 v[128:131], v247, s[8:11], s23 offen offset:0 sc1
buffer_load_dwordx4 v[132:135], v247, s[8:11], s23 offen offset:1024 sc1
buffer_load_dwordx4 v[136:139], v247, s[8:11], s23 offen offset:2048 sc1
buffer_load_dwordx4 v[140:143], v247, s[8:11], s23 offen offset:3072 sc1
buffer_load_dwordx4 v[144:147], v247, s[8:11], s24 offen offset:0 sc1
buffer_load_dwordx4 v[148:151], v247, s[8:11], s24 offen offset:1024 sc1
buffer_load_dwordx4 v[152:155], v247, s[8:11], s24 offen offset:2048 sc1
buffer_load_dwordx4 v[156:159], v247, s[8:11], s24 offen offset:3072 sc1
s_waitcnt vmcnt(0)
v_max3_u32 v255, v128, v129, v130
v_max3_u32 v255, v255, v131, v132
v_max3_u32 v255, v255, v133, v134
v_max3_u32 v255, v255, v135, v136
v_max3_u32 v255, v255, v137, v138
v_max3_u32 v255, v255, v139, v140
v_max3_u32 v255, v255, v141, v142
v_max3_u32 v255, v255, v143, v144
v_max3_u32 v255, v255, v145, v146
v_max3_u32 v255, v255, v147, v148
v_max3_u32 v255, v255, v149, v150
v_max3_u32 v255, v255, v151, v152
v_max3_u32 v255, v255, v153, v154
v_max3_u32 v255, v255, v155, v156
v_max3_u32 v255, v255, v157, v158
v_max_u32 v255, v255, v159
v_cmp_eq_u32 vcc, -1, v255
s_cbranch_vccnz L_lretry_58
v_smfmac_f32_16x16x64_bf16 v[164:167], v[128:131], a[128:135], v246
v_smfmac_f32_16x16x64_bf16 v[172:175], v[128:131], a[192:199], v246
v_smfmac_f32_16x16x64_bf16 v[176:179], v[128:131], v[0:7], v246
v_smfmac_f32_16x16x64_bf16 v[180:183], v[128:131], v[64:71], v246
v_smfmac_f32_16x16x64_bf16 v[164:167], v[132:135], a[136:143], v246
v_smfmac_f32_16x16x64_bf16 v[172:175], v[132:135], a[200:207], v246
v_smfmac_f32_16x16x64_bf16 v[176:179], v[132:135], v[8:15], v246
v_smfmac_f32_16x16x64_bf16 v[180:183], v[132:135], v[72:79], v246
v_smfmac_f32_16x16x64_bf16 v[164:167], v[136:139], a[144:151], v246
v_smfmac_f32_16x16x64_bf16 v[172:175], v[136:139], a[208:215], v246
v_smfmac_f32_16x16x64_bf16 v[176:179], v[136:139], v[16:23], v246
v_smfmac_f32_16x16x64_bf16 v[180:183], v[136:139], v[80:87], v246
v_smfmac_f32_16x16x64_bf16 v[164:167], v[140:143], a[152:159], v246
v_smfmac_f32_16x16x64_bf16 v[172:175], v[140:143], a[216:223], v246
v_smfmac_f32_16x16x64_bf16 v[176:179], v[140:143], v[24:31], v246
v_smfmac_f32_16x16x64_bf16 v[180:183], v[140:143], v[88:95], v246
v_smfmac_f32_16x16x64_bf16 v[164:167], v[144:147], a[160:167], v246
v_smfmac_f32_16x16x64_bf16 v[172:175], v[144:147], a[224:231], v246
v_smfmac_f32_16x16x64_bf16 v[176:179], v[144:147], v[32:39], v246
v_smfmac_f32_16x16x64_bf16 v[180:183], v[144:147], v[96:103], v246
v_smfmac_f32_16x16x64_bf16 v[164:167], v[148:151], a[168:175], v246
v_smfmac_f32_16x16x64_bf16 v[172:175], v[148:151], a[232:239], v246
v_smfmac_f32_16x16x64_bf16 v[176:179], v[148:151], v[40:47], v246
v_smfmac_f32_16x16x64_bf16 v[180:183], v[148:151], v[104:111], v246
v_smfmac_f32_16x16x64_bf16 v[164:167], v[152:155], a[176:183], v246
v_smfmac_f32_16x16x64_bf16 v[172:175], v[152:155], a[240:247], v246
v_smfmac_f32_16x16x64_bf16 v[176:179], v[152:155], v[48:55], v246
v_smfmac_f32_16x16x64_bf16 v[180:183], v[152:155], v[112:119], v246
v_smfmac_f32_16x16x64_bf16 v[164:167], v[156:159], a[184:191], v246
v_smfmac_f32_16x16x64_bf16 v[172:175], v[156:159], a[248:255], v246
v_smfmac_f32_16x16x64_bf16 v[176:179], v[156:159], v[56:63], v246
v_smfmac_f32_16x16x64_bf16 v[180:183], v[156:159], v[120:127], v246
v_add_f32 v160, v160, v162
v_add_f32 v161, v161, v163
s_nop 2
v_add_f32 v164, v164, v166
v_add_f32 v165, v165, v167
v_cvt_pk_bf16_f32 v163, v160, v161
v_cvt_pk_bf16_f32 v162, v164, v165
ds_write_b64 v252, v[162:163] offset:0
v_add_f32 v168, v168, v170
v_add_f32 v169, v169, v171
v_add_f32 v172, v172, v174
v_add_f32 v173, v173, v175
v_cvt_pk_bf16_f32 v171, v168, v169
v_cvt_pk_bf16_f32 v170, v172, v173
ds_write_b64 v252, v[170:171] offset:512
v_add_f32 v176, v176, v178
v_add_f32 v177, v177, v179
v_add_f32 v180, v180, v182
v_add_f32 v181, v181, v183
v_cvt_pk_bf16_f32 v240, v176, v177
v_cvt_pk_bf16_f32 v242, v180, v181
v_lshrrev_b32 v255, 2, v247
buffer_store_dword v240, v255, s[8:11], s37 offen sc1
buffer_store_dword v242, v255, s[8:11], s37 offen offset:256 sc1
s_waitcnt lgkmcnt(0)
s_barrier
ds_read_b64_tr_b16 v[184:185], v253 offset:1024
ds_read_b64_tr_b16 v[186:187], v253 offset:1536
s_waitcnt lgkmcnt(0)
buffer_store_dwordx4 v[184:187], v254, s[8:11], s31 offen offset:512 sc1
s_waitcnt vmcnt(0)
s_barrier
L_done_w1f:
s_waitcnt vmcnt(0) lgkmcnt(0)
s_branch L_end_59
L_lretry_58:
s_sub_u32 s36, s36, 1
s_cmp_lg_u32 s36, 0
s_cbranch_scc1 L_lpoll_57
s_branch L_abort
L_hz_49:
s_cmp_ge_u32 s97, 64
s_cbranch_scc1 L_hzb_50
s_add_u32 s43, s22, 1
s_cmp_ge_u32 s43, s97
s_cbranch_scc1 L_hzblk_60
buffer_load_dwordx4 v[236:239], v244, s[8:11], s98 offen offset:16 sc1
buffer_load_dwordx4 v[240:243], v244, s[8:11], s98 offen offset:32 sc1
s_mov_b32 s42, 1
s_branch L_hzb_50
L_hzblk_60:
s_cmp_ge_u32 s43, 64
s_cbranch_scc1 L_hx_62
s_mov_b32 s36, 200000
L_hq_61:
buffer_load_dwordx4 v[216:219], v244, s[8:11], s98 offen offset:16 sc1
buffer_load_dwordx4 v[220:223], v244, s[8:11], s98 offen offset:32 sc1
s_sub_u32 s36, s36, 1
s_cmp_eq_u32 s36, 0
s_cbranch_scc1 L_abort
s_waitcnt vmcnt(0)
L_he_63:
v_cmp_eq_u32 vcc, s46, v217
s_nop 1
v_cndmask_b32 v216, 0, v216, vcc
v_cmp_eq_u32 vcc, s46, v219
s_nop 1
v_cndmask_b32 v218, 0, v218, vcc
v_cmp_eq_u32 vcc, s46, v221
s_nop 1
v_cndmask_b32 v220, 0, v220, vcc
v_cmp_eq_u32 vcc, s46, v223
s_nop 1
v_cndmask_b32 v222, 0, v222, vcc
v_min_u32 v216, v216, v220
v_min_u32 v217, v218, v222
v_lshlrev_b32 v216, 1, v216
v_lshl_add_u32 v217, v217, 1, 1
v_min_u32 v216, v216, v217
s_nop 0
v_readfirstlane_b32 s97, v216
s_cmp_ge_u32 s97, 64
s_cselect_b32 s97, 1000, s97
s_cmp_lt_u32 s43, s97
s_cbranch_scc0 L_hq_61
L_hx_62:
s_branch L_hzb_50
L_hze_51:
s_mov_b32 s42, 0
s_waitcnt vmcnt(3)
v_cmp_eq_u32 vcc, s46, v237
s_nop 1
v_cndmask_b32 v236, 0, v236, vcc
v_cmp_eq_u32 vcc, s46, v239
s_nop 1
v_cndmask_b32 v238, 0, v238, vcc
v_cmp_eq_u32 vcc, s46, v241
s_nop 1
v_cndmask_b32 v240, 0, v240, vcc
v_cmp_eq_u32 vcc, s46, v243
s_nop 1
v_cndmask_b32 v242, 0, v242, vcc
v_min_u32 v236, v236, v240
v_min_u32 v237, v238, v242
v_lshlrev_b32 v236, 1, v236
v_lshl_add_u32 v237, v237, 1, 1
v_min_u32 v236, v236, v237
s_nop 0
v_readfirstlane_b32 s97, v236
s_cmp_ge_u32 s97, 64
s_cselect_b32 s97, 1000, s97
v_mov_b32 v241, 0
v_mov_b32 v243, 0
s_branch L_hzf_52
L_end_59:
s_endpgm
L_wave2:
v_lshrrev_b32 v128, 4, v255
v_and_b32 v129, 15, v255
v_and_b32 v130, 1, v128
v_add_u32 v130, 0, v130
v_lshlrev_b32 v130, 1, v130
v_xor_b32 v130, v130, v129
v_lshlrev_b32 v130, 4, v130
s_lshl_b32 s38, s21, 8
v_lshl_add_u32 v131, v128, 13, v130
v_add_u32 v136, s38, v131
s_lshl_b32 s38, s21, 17
v_lshl_add_u32 v131, v128, 10, v130
v_add_u32 v138, s38, v131
v_and_b32 v130, 1, v128
v_add_u32 v130, 2, v130
v_lshlrev_b32 v130, 1, v130
v_xor_b32 v130, v130, v129
v_lshlrev_b32 v130, 4, v130
s_lshl_b32 s38, s21, 8
v_lshl_add_u32 v131, v128, 13, v130
v_add_u32 v137, s38, v131
s_lshl_b32 s38, s21, 17
v_lshl_add_u32 v131, v128, 10, v130
v_add_u32 v139, s38, v131
s_mov_b32 s12, s50
s_mov_b32 s13, s51
s_mov_b32 s14, 0x400000
s_mov_b32 m0, 16384
s_mov_b32 s38, 0x80000
buffer_load_dwordx4 v136, s[12:15], s38 offen  lds
s_mov_b32 m0, 17408
s_mov_b32 s38, 0x88000
buffer_load_dwordx4 v136, s[12:15], s38 offen  lds
s_mov_b32 m0, 18432
s_mov_b32 s38, 0x90000
buffer_load_dwordx4 v136, s[12:15], s38 offen  lds
s_mov_b32 m0, 19456
s_mov_b32 s38, 0x98000
buffer_load_dwordx4 v136, s[12:15], s38 offen  lds
s_mov_b32 m0, 20480
s_mov_b32 s38, 0xa0000
buffer_load_dwordx4 v137, s[12:15], s38 offen  lds
s_mov_b32 m0, 21504
s_mov_b32 s38, 0xa8000
buffer_load_dwordx4 v137, s[12:15], s38 offen  lds
s_mov_b32 m0, 22528
s_mov_b32 s38, 0xb0000
buffer_load_dwordx4 v137, s[12:15], s38 offen  lds
s_mov_b32 m0, 23552
s_mov_b32 s38, 0xb8000
buffer_load_dwordx4 v137, s[12:15], s38 offen  lds
s_mov_b32 m0, 49152
s_mov_b32 s38, 0x180000
buffer_load_dwordx4 v136, s[12:15], s38 offen  lds
s_mov_b32 m0, 50176
s_mov_b32 s38, 0x188000
buffer_load_dwordx4 v136, s[12:15], s38 offen  lds
s_mov_b32 m0, 51200
s_mov_b32 s38, 0x190000
buffer_load_dwordx4 v136, s[12:15], s38 offen  lds
s_mov_b32 m0, 52224
s_mov_b32 s38, 0x198000
buffer_load_dwordx4 v136, s[12:15], s38 offen  lds
s_mov_b32 m0, 53248
s_mov_b32 s38, 0x1a0000
buffer_load_dwordx4 v137, s[12:15], s38 offen  lds
s_mov_b32 m0, 54272
s_mov_b32 s38, 0x1a8000
buffer_load_dwordx4 v137, s[12:15], s38 offen  lds
s_mov_b32 m0, 55296
s_mov_b32 s38, 0x1b0000
buffer_load_dwordx4 v137, s[12:15], s38 offen  lds
s_mov_b32 m0, 56320
s_mov_b32 s38, 0x1b8000
buffer_load_dwordx4 v137, s[12:15], s38 offen  lds
s_mov_b32 m0, 81920
s_mov_b32 s38, 0x280000
buffer_load_dwordx4 v136, s[12:15], s38 offen  lds
s_mov_b32 m0, 82944
s_mov_b32 s38, 0x288000
buffer_load_dwordx4 v136, s[12:15], s38 offen  lds
s_mov_b32 m0, 83968
s_mov_b32 s38, 0x290000
buffer_load_dwordx4 v136, s[12:15], s38 offen  lds
s_mov_b32 m0, 84992
s_mov_b32 s38, 0x298000
buffer_load_dwordx4 v136, s[12:15], s38 offen  lds
s_mov_b32 m0, 86016
s_mov_b32 s38, 0x2a0000
buffer_load_dwordx4 v137, s[12:15], s38 offen  lds
s_mov_b32 m0, 87040
s_mov_b32 s38, 0x2a8000
buffer_load_dwordx4 v137, s[12:15], s38 offen  lds
s_mov_b32 m0, 88064
s_mov_b32 s38, 0x2b0000
buffer_load_dwordx4 v137, s[12:15], s38 offen  lds
s_mov_b32 m0, 89088
s_mov_b32 s38, 0x2b8000
buffer_load_dwordx4 v137, s[12:15], s38 offen  lds
s_mov_b32 m0, 114688
s_mov_b32 s38, 0x380000
buffer_load_dwordx4 v136, s[12:15], s38 offen  lds
s_mov_b32 m0, 115712
s_mov_b32 s38, 0x388000
buffer_load_dwordx4 v136, s[12:15], s38 offen  lds
s_mov_b32 m0, 116736
s_mov_b32 s38, 0x390000
buffer_load_dwordx4 v136, s[12:15], s38 offen  lds
s_mov_b32 m0, 117760
s_mov_b32 s38, 0x398000
buffer_load_dwordx4 v136, s[12:15], s38 offen  lds
s_mov_b32 m0, 118784
s_mov_b32 s38, 0x3a0000
buffer_load_dwordx4 v137, s[12:15], s38 offen  lds
s_mov_b32 m0, 119808
s_mov_b32 s38, 0x3a8000
buffer_load_dwordx4 v137, s[12:15], s38 offen  lds
s_mov_b32 m0, 120832
s_mov_b32 s38, 0x3b0000
buffer_load_dwordx4 v137, s[12:15], s38 offen  lds
s_mov_b32 m0, 121856
s_mov_b32 s38, 0x3b8000
buffer_load_dwordx4 v137, s[12:15], s38 offen  lds
v_lshlrev_b32 v247, 4, v255
v_add_u32 v248, 65536, v247
v_add_u32 v249, 131072, v247
v_and_b32 v128, 15, v255
v_lshrrev_b32 v129, 4, v255
v_mov_b32 v246, 0x4444
v_mov_b32 v130, 0xeeee
v_and_b32 v131, 2, v128
v_cmp_ne_u32 vcc, 0, v131
s_nop 1
v_cndmask_b32 v246, v246, v130, vcc
v_lshlrev_b32 v130, 13, v129
v_lshrrev_b32 v131, 2, v128
v_lshl_add_u32 v130, v131, 11, v130
v_mov_b32 v131, s21
v_lshl_add_u32 v130, v131, 6, v130
v_and_b32 v131, 3, v128
v_lshl_add_u32 v250, v131, 4, v130
v_lshrrev_b32 v130, 2, v128
v_xor_b32 v130, v130, v129
v_lshlrev_b32 v130, 3, v130
v_lshl_add_u32 v130, v128, 5, v130
v_add_u32 v252, 149504, v130
v_lshrrev_b32 v130, 2, v128
v_lshl_add_u32 v130, v129, 2, v130
v_and_b32 v131, 3, v128
v_xor_b32 v131, v131, v129
v_lshlrev_b32 v131, 3, v131
v_lshl_add_u32 v130, v130, 5, v131
v_add_u32 v253, 147456, v130
v_lshrrev_b32 v130, 2, v128
v_and_b32 v131, 1, v128
v_lshl_add_u32 v130, v130, 1, v131
v_lshl_add_u32 v130, v129, 3, v130
v_lshlrev_b32 v130, 4, v130
v_mov_b32 v132, 0x40000000
v_and_b32 v131, 2, v128
v_cmp_ne_u32 vcc, 0, v131
s_nop 1
v_cndmask_b32 v254, v130, v132, vcc
s_lshr_b32 s38, s21, 3
s_bfe_u32 s39, s21, 0x10002
s_lshl_b32 s39, s39, 2
s_add_u32 s38, s38, s39
s_lshl_b32 s38, s38, 10
s_and_b32 s39, s21, 3
s_lshl_b32 s39, s39, 6
s_add_u32 s38, s38, s39
s_add_u32 s38, s38, 512
v_and_b32 v130, 3, v128
v_lshlrev_b32 v130, 4, v130
v_lshrrev_b32 v131, 2, v128
v_lshl_add_u32 v130, v131, 3, v130
v_lshrrev_b32 v131, 1, v129
v_lshl_add_u32 v130, v131, 2, v130
v_add_u32 v130, s38, v130
v_and_b32 v131, 24, v255
v_mov_b32 v251, 0x40000000
v_cmp_eq_u32 vcc, 0, v131
s_nop 1
v_cndmask_b32 v251, v251, v130, vcc
v_lshrrev_b32 v128, 4, v255
v_bfe_u32 v129, v255, 2, 2
v_and_b32 v130, 3, v255
v_and_b32 v131, 1, v128
v_lshl_add_u32 v134, v131, 2, v129
v_lshlrev_b32 v132, 5, v131
v_lshrrev_b32 v131, 1, v128
v_lshl_add_u32 v132, v131, 2, v132
v_and_b32 v131, 1, v129
v_add_u32 v132, v131, v132
v_lshrrev_b32 v131, 1, v129
v_lshl_add_u32 v132, v131, 4, v132
v_lshlrev_b32 v132, 8, v132
v_lshrrev_b32 v131, 1, v130
v_lshl_add_u32 v132, v131, 4, v132
v_and_b32 v131, 1, v130
v_lshl_add_u32 v132, v131, 3, v132
v_xor_b32 v131, 4, v134
v_lshl_add_u32 v140, v131, 5, v132
v_xor_b32 v131, 5, v134
v_lshl_add_u32 v141, v131, 5, v132
v_xor_b32 v131, 0, v134
v_lshl_add_u32 v148, v131, 5, v132
v_add_u32 v148, 65536, v148
v_xor_b32 v131, 1, v134
v_lshl_add_u32 v149, v131, 5, v132
v_add_u32 v149, 65536, v149
v_xor_b32 v131, 2, v134
v_lshl_add_u32 v150, v131, 5, v132
v_add_u32 v150, 65536, v150
v_xor_b32 v131, 3, v134
v_lshl_add_u32 v151, v131, 5, v132
v_add_u32 v151, 65536, v151
v_xor_b32 v131, 4, v134
v_lshl_add_u32 v152, v131, 5, v132
v_add_u32 v152, 65536, v152
v_xor_b32 v131, 5, v134
v_lshl_add_u32 v153, v131, 5, v132
v_add_u32 v153, 65536, v153
v_xor_b32 v131, 6, v134
v_lshl_add_u32 v154, v131, 5, v132
v_add_u32 v154, 65536, v154
v_xor_b32 v131, 7, v134
v_lshl_add_u32 v155, v131, 5, v132
v_add_u32 v155, 65536, v155
s_waitcnt vmcnt(24)
s_barrier
v_add_u32 v142, 0, v140
v_add_u32 v143, 0, v141
ds_read_b64_tr_b16 a[0:1], v142 offset:0
ds_read_b64_tr_b16 a[2:3], v142 offset:512
ds_read_b64_tr_b16 a[4:5], v142 offset:2048
ds_read_b64_tr_b16 a[6:7], v142 offset:2560
ds_read_b64_tr_b16 a[64:65], v143 offset:0
ds_read_b64_tr_b16 a[66:67], v143 offset:512
ds_read_b64_tr_b16 a[68:69], v143 offset:2048
ds_read_b64_tr_b16 a[70:71], v143 offset:2560
ds_read_b64_tr_b16 a[32:33], v142 offset:16384
ds_read_b64_tr_b16 a[34:35], v142 offset:16896
ds_read_b64_tr_b16 a[36:37], v142 offset:18432
ds_read_b64_tr_b16 a[38:39], v142 offset:18944
ds_read_b64_tr_b16 a[96:97], v143 offset:16384
ds_read_b64_tr_b16 a[98:99], v143 offset:16896
ds_read_b64_tr_b16 a[100:101], v143 offset:18432
ds_read_b64_tr_b16 a[102:103], v143 offset:18944
s_waitcnt lgkmcnt(0)
s_barrier
s_mov_b32 s12, s52
s_mov_b32 s13, s53
s_mov_b32 s14, 0x400000
s_mov_b32 m0, 16384
s_mov_b32 s38, 0x80000
buffer_load_dwordx4 v136, s[12:15], s38 offen  lds
s_mov_b32 m0, 17408
s_mov_b32 s38, 0x88000
buffer_load_dwordx4 v136, s[12:15], s38 offen  lds
s_mov_b32 m0, 18432
s_mov_b32 s38, 0x90000
buffer_load_dwordx4 v136, s[12:15], s38 offen  lds
s_mov_b32 m0, 19456
s_mov_b32 s38, 0x98000
buffer_load_dwordx4 v136, s[12:15], s38 offen  lds
s_mov_b32 m0, 20480
s_mov_b32 s38, 0xa0000
buffer_load_dwordx4 v137, s[12:15], s38 offen  lds
s_mov_b32 m0, 21504
s_mov_b32 s38, 0xa8000
buffer_load_dwordx4 v137, s[12:15], s38 offen  lds
s_mov_b32 m0, 22528
s_mov_b32 s38, 0xb0000
buffer_load_dwordx4 v137, s[12:15], s38 offen  lds
s_mov_b32 m0, 23552
s_mov_b32 s38, 0xb8000
buffer_load_dwordx4 v137, s[12:15], s38 offen  lds
s_waitcnt vmcnt(24)
s_barrier
v_add_u32 v142, 32768, v140
v_add_u32 v143, 32768, v141
ds_read_b64_tr_b16 a[8:9], v142 offset:0
ds_read_b64_tr_b16 a[10:11], v142 offset:512
ds_read_b64_tr_b16 a[12:13], v142 offset:2048
ds_read_b64_tr_b16 a[14:15], v142 offset:2560
ds_read_b64_tr_b16 a[72:73], v143 offset:0
ds_read_b64_tr_b16 a[74:75], v143 offset:512
ds_read_b64_tr_b16 a[76:77], v143 offset:2048
ds_read_b64_tr_b16 a[78:79], v143 offset:2560
ds_read_b64_tr_b16 a[40:41], v142 offset:16384
ds_read_b64_tr_b16 a[42:43], v142 offset:16896
ds_read_b64_tr_b16 a[44:45], v142 offset:18432
ds_read_b64_tr_b16 a[46:47], v142 offset:18944
ds_read_b64_tr_b16 a[104:105], v143 offset:16384
ds_read_b64_tr_b16 a[106:107], v143 offset:16896
ds_read_b64_tr_b16 a[108:109], v143 offset:18432
ds_read_b64_tr_b16 a[110:111], v143 offset:18944
s_waitcnt lgkmcnt(0)
s_barrier
v_mov_b32 v236, 0
buffer_load_dwordx4 v[224:227], v236, s[16:19], 0 offen sc1
buffer_load_dwordx4 v[228:231], v236, s[16:19], 0 offen offset:16 sc1
buffer_load_dwordx2 v[232:233], v236, s[16:19], 0 offen offset:128 sc1
v_and_b32 v200, 15, v255
v_lshrrev_b32 v201, 4, v255
s_and_b32 s39, s21, 3
s_lshl_b32 s39, s39, 11
s_lshr_b32 s40, s21, 2
s_lshl_b32 s40, s40, 7
s_add_u32 s39, s39, s40
s_add_u32 s39, s39, 16
v_and_b32 v202, 1, v200
v_lshlrev_b32 v202, 10, v202
v_bfe_u32 v203, v200, 1, 2
v_lshl_add_u32 v202, v203, 5, v202
v_lshrrev_b32 v203, 1, v201
v_lshl_add_u32 v202, v203, 2, v202
v_add_u32 v202, s39, v202
s_mov_b32 s4, s48
s_mov_b32 s5, s49
s_mov_b32 s6, 8192
s_mov_b32 s7, 0x00020000
buffer_load_dword v204, v202, s[4:7], 0 offen
s_mov_b32 m0, 49152
s_mov_b32 s38, 0x180000
buffer_load_dwordx4 v136, s[12:15], s38 offen  lds
s_mov_b32 m0, 50176
s_mov_b32 s38, 0x188000
buffer_load_dwordx4 v136, s[12:15], s38 offen  lds
s_mov_b32 m0, 51200
s_mov_b32 s38, 0x190000
buffer_load_dwordx4 v136, s[12:15], s38 offen  lds
s_mov_b32 m0, 52224
s_mov_b32 s38, 0x198000
buffer_load_dwordx4 v136, s[12:15], s38 offen  lds
s_mov_b32 m0, 53248
s_mov_b32 s38, 0x1a0000
buffer_load_dwordx4 v137, s[12:15], s38 offen  lds
s_mov_b32 m0, 54272
s_mov_b32 s38, 0x1a8000
buffer_load_dwordx4 v137, s[12:15], s38 offen  lds
s_mov_b32 m0, 55296
s_mov_b32 s38, 0x1b0000
buffer_load_dwordx4 v137, s[12:15], s38 offen  lds
s_mov_b32 m0, 56320
s_mov_b32 s38, 0x1b8000
buffer_load_dwordx4 v137, s[12:15], s38 offen  lds
s_waitcnt vmcnt(24)
s_barrier
v_add_u32 v142, 65536, v140
v_add_u32 v143, 65536, v141
ds_read_b64_tr_b16 a[16:17], v142 offset:0
ds_read_b64_tr_b16 a[18:19], v142 offset:512
ds_read_b64_tr_b16 a[20:21], v142 offset:2048
ds_read_b64_tr_b16 a[22:23], v142 offset:2560
ds_read_b64_tr_b16 a[80:81], v143 offset:0
ds_read_b64_tr_b16 a[82:83], v143 offset:512
ds_read_b64_tr_b16 a[84:85], v143 offset:2048
ds_read_b64_tr_b16 a[86:87], v143 offset:2560
ds_read_b64_tr_b16 a[48:49], v142 offset:16384
ds_read_b64_tr_b16 a[50:51], v142 offset:16896
ds_read_b64_tr_b16 a[52:53], v142 offset:18432
ds_read_b64_tr_b16 a[54:55], v142 offset:18944
ds_read_b64_tr_b16 a[112:113], v143 offset:16384
ds_read_b64_tr_b16 a[114:115], v143 offset:16896
ds_read_b64_tr_b16 a[116:117], v143 offset:18432
ds_read_b64_tr_b16 a[118:119], v143 offset:18944
s_waitcnt lgkmcnt(0)
s_barrier
s_mov_b32 m0, 81920
s_mov_b32 s38, 0x280000
buffer_load_dwordx4 v136, s[12:15], s38 offen  lds
s_mov_b32 m0, 82944
s_mov_b32 s38, 0x288000
buffer_load_dwordx4 v136, s[12:15], s38 offen  lds
s_mov_b32 m0, 83968
s_mov_b32 s38, 0x290000
buffer_load_dwordx4 v136, s[12:15], s38 offen  lds
s_mov_b32 m0, 84992
s_mov_b32 s38, 0x298000
buffer_load_dwordx4 v136, s[12:15], s38 offen  lds
s_mov_b32 m0, 86016
s_mov_b32 s38, 0x2a0000
buffer_load_dwordx4 v137, s[12:15], s38 offen  lds
s_mov_b32 m0, 87040
s_mov_b32 s38, 0x2a8000
buffer_load_dwordx4 v137, s[12:15], s38 offen  lds
s_mov_b32 m0, 88064
s_mov_b32 s38, 0x2b0000
buffer_load_dwordx4 v137, s[12:15], s38 offen  lds
s_mov_b32 m0, 89088
s_mov_b32 s38, 0x2b8000
buffer_load_dwordx4 v137, s[12:15], s38 offen  lds
s_waitcnt vmcnt(24)
s_barrier
v_add_u32 v142, 98304, v140
v_add_u32 v143, 98304, v141
ds_read_b64_tr_b16 a[24:25], v142 offset:0
ds_read_b64_tr_b16 a[26:27], v142 offset:512
ds_read_b64_tr_b16 a[28:29], v142 offset:2048
ds_read_b64_tr_b16 a[30:31], v142 offset:2560
ds_read_b64_tr_b16 a[88:89], v143 offset:0
ds_read_b64_tr_b16 a[90:91], v143 offset:512
ds_read_b64_tr_b16 a[92:93], v143 offset:2048
ds_read_b64_tr_b16 a[94:95], v143 offset:2560
ds_read_b64_tr_b16 a[56:57], v142 offset:16384
ds_read_b64_tr_b16 a[58:59], v142 offset:16896
ds_read_b64_tr_b16 a[60:61], v142 offset:18432
ds_read_b64_tr_b16 a[62:63], v142 offset:18944
ds_read_b64_tr_b16 a[120:121], v143 offset:16384
ds_read_b64_tr_b16 a[122:123], v143 offset:16896
ds_read_b64_tr_b16 a[124:125], v143 offset:18432
ds_read_b64_tr_b16 a[126:127], v143 offset:18944
s_waitcnt lgkmcnt(0)
s_barrier
s_mov_b32 m0, 114688
s_mov_b32 s38, 0x380000
buffer_load_dwordx4 v136, s[12:15], s38 offen  lds
s_mov_b32 m0, 115712
s_mov_b32 s38, 0x388000
buffer_load_dwordx4 v136, s[12:15], s38 offen  lds
s_mov_b32 m0, 116736
s_mov_b32 s38, 0x390000
buffer_load_dwordx4 v136, s[12:15], s38 offen  lds
s_mov_b32 m0, 117760
s_mov_b32 s38, 0x398000
buffer_load_dwordx4 v136, s[12:15], s38 offen  lds
s_mov_b32 m0, 118784
s_mov_b32 s38, 0x3a0000
buffer_load_dwordx4 v137, s[12:15], s38 offen  lds
s_mov_b32 m0, 119808
s_mov_b32 s38, 0x3a8000
buffer_load_dwordx4 v137, s[12:15], s38 offen  lds
s_mov_b32 m0, 120832
s_mov_b32 s38, 0x3b0000
buffer_load_dwordx4 v137, s[12:15], s38 offen  lds
s_mov_b32 m0, 121856
s_mov_b32 s38, 0x3b8000
buffer_load_dwordx4 v137, s[12:15], s38 offen  lds
s_waitcnt vmcnt(24)
s_barrier
v_add_u32 v142, 0, v140
v_add_u32 v143, 0, v141
ds_read_b64_tr_b16 a[128:129], v142 offset:0
ds_read_b64_tr_b16 a[130:131], v142 offset:512
ds_read_b64_tr_b16 a[132:133], v142 offset:2048
ds_read_b64_tr_b16 a[134:135], v142 offset:2560
ds_read_b64_tr_b16 a[192:193], v143 offset:0
ds_read_b64_tr_b16 a[194:195], v143 offset:512
ds_read_b64_tr_b16 a[196:197], v143 offset:2048
ds_read_b64_tr_b16 a[198:199], v143 offset:2560
ds_read_b64_tr_b16 a[160:161], v142 offset:16384
ds_read_b64_tr_b16 a[162:163], v142 offset:16896
ds_read_b64_tr_b16 a[164:165], v142 offset:18432
ds_read_b64_tr_b16 a[166:167], v142 offset:18944
ds_read_b64_tr_b16 a[224:225], v143 offset:16384
ds_read_b64_tr_b16 a[226:227], v143 offset:16896
ds_read_b64_tr_b16 a[228:229], v143 offset:18432
ds_read_b64_tr_b16 a[230:231], v143 offset:18944
s_waitcnt lgkmcnt(0)
s_barrier
s_mov_b32 s12, s54
s_mov_b32 s13, s55
s_mov_b32 s14, 0x400000
s_mov_b32 m0, 16384
s_mov_b32 s38, 0x80000
buffer_load_dwordx4 v136, s[12:15], s38 offen  lds
s_mov_b32 m0, 17408
s_mov_b32 s38, 0x88000
buffer_load_dwordx4 v136, s[12:15], s38 offen  lds
s_mov_b32 m0, 18432
s_mov_b32 s38, 0x90000
buffer_load_dwordx4 v136, s[12:15], s38 offen  lds
s_mov_b32 m0, 19456
s_mov_b32 s38, 0x98000
buffer_load_dwordx4 v136, s[12:15], s38 offen  lds
s_mov_b32 m0, 20480
s_mov_b32 s38, 0xa0000
buffer_load_dwordx4 v137, s[12:15], s38 offen  lds
s_mov_b32 m0, 21504
s_mov_b32 s38, 0xa8000
buffer_load_dwordx4 v137, s[12:15], s38 offen  lds
s_mov_b32 m0, 22528
s_mov_b32 s38, 0xb0000
buffer_load_dwordx4 v137, s[12:15], s38 offen  lds
s_mov_b32 m0, 23552
s_mov_b32 s38, 0xb8000
buffer_load_dwordx4 v137, s[12:15], s38 offen  lds
s_waitcnt vmcnt(24)
s_barrier
v_add_u32 v142, 32768, v140
v_add_u32 v143, 32768, v141
ds_read_b64_tr_b16 a[136:137], v142 offset:0
ds_read_b64_tr_b16 a[138:139], v142 offset:512
ds_read_b64_tr_b16 a[140:141], v142 offset:2048
ds_read_b64_tr_b16 a[142:143], v142 offset:2560
ds_read_b64_tr_b16 a[200:201], v143 offset:0
ds_read_b64_tr_b16 a[202:203], v143 offset:512
ds_read_b64_tr_b16 a[204:205], v143 offset:2048
ds_read_b64_tr_b16 a[206:207], v143 offset:2560
ds_read_b64_tr_b16 a[168:169], v142 offset:16384
ds_read_b64_tr_b16 a[170:171], v142 offset:16896
ds_read_b64_tr_b16 a[172:173], v142 offset:18432
ds_read_b64_tr_b16 a[174:175], v142 offset:18944
ds_read_b64_tr_b16 a[232:233], v143 offset:16384
ds_read_b64_tr_b16 a[234:235], v143 offset:16896
ds_read_b64_tr_b16 a[236:237], v143 offset:18432
ds_read_b64_tr_b16 a[238:239], v143 offset:18944
s_waitcnt lgkmcnt(0)
s_barrier
s_cmp_lg_u32 s32, 0
s_cbranch_scc1 L_vfx_66
s_mov_b32 s36, 200000
s_branch L_vfe_65
L_vf_64:
v_mov_b32 v236, 0
buffer_load_dwordx4 v[224:227], v236, s[16:19], 0 offen sc1
buffer_load_dwordx4 v[228:231], v236, s[16:19], 0 offen offset:16 sc1
buffer_load_dwordx2 v[232:233], v236, s[16:19], 0 offen offset:128 sc1
s_sub_u32 s36, s36, 1
s_cmp_eq_u32 s36, 0
s_cbranch_scc1 L_abort
s_waitcnt vmcnt(0)
L_vfe_65:
v_add3_u32 v234, v225, v226, v227
v_add3_u32 v234, v234, v228, v229
v_add3_u32 v234, v234, v230, v231
v_add_u32 v234, v234, v232
v_max3_u32 v235, v225, v226, v227
v_max3_u32 v235, v235, v228, v229
v_max3_u32 v235, v235, v230, v231
v_max_u32 v235, v235, v232
v_cmp_lt_u32 vcc, 0x100, v234
s_cbranch_vccnz L_abort
v_cmp_ne_u32 vcc, 0x100, v234
s_cbranch_vccnz L_vf_64
v_cmp_eq_u32 vcc, 0, v233
s_cbranch_vccnz L_vf_64
v_readfirstlane_b32 s46, v233
v_readfirstlane_b32 s36, v235
s_cmp_lg_u32 s36, 32
s_cbranch_scc1 L_slow
L_vfx_66:
s_cmp_lg_u32 s32, 0
s_cbranch_scc1 L_inis_67
s_mov_b32 s99, 160256
v_mov_b32 v208, -1
v_mov_b32 v209, -1
v_mov_b32 v210, -1
v_mov_b32 v211, -1
s_mov_b32 s39, 0x100000
v_min_u32 v204, 0xfffffffe, v204
buffer_store_dword v204, v251, s[8:11], s39 offen
s_add_u32 s39, s39, 8192
buffer_store_dword v208, v251, s[8:11], s39 offen
s_add_u32 s39, s39, 8192
buffer_store_dword v208, v251, s[8:11], s39 offen
s_add_u32 s39, s39, 8192
buffer_store_dword v208, v251, s[8:11], s39 offen
s_lshl_b32 s39, s21, 13
s_add_u32 s39, s39, 0x201000
buffer_store_dwordx4 v[208:211], v247, s[8:11], s39 offen offset:0
buffer_store_dwordx4 v[208:211], v247, s[8:11], s39 offen offset:1024
s_lshl_b32 s39, s21, 13
s_add_u32 s39, s39, 0x241000
buffer_store_dwordx4 v[208:211], v247, s[8:11], s39 offen offset:0
buffer_store_dwordx4 v[208:211], v247, s[8:11], s39 offen offset:1024
s_branch L_inie_68
L_inis_67:
s_mov_b32 s99, 160256
v_mov_b32 v208, -1
v_mov_b32 v209, -1
v_mov_b32 v210, -1
v_mov_b32 v211, -1
s_mov_b32 s39, 0x100000
v_min_u32 v204, 0xfffffffe, v204
buffer_store_dword v204, v251, s[8:11], s39 offen sc1
s_add_u32 s39, s39, 8192
buffer_store_dword v208, v251, s[8:11], s39 offen sc1
s_add_u32 s39, s39, 8192
buffer_store_dword v208, v251, s[8:11], s39 offen sc1
s_add_u32 s39, s39, 8192
buffer_store_dword v208, v251, s[8:11], s39 offen sc1
s_lshl_b32 s39, s21, 13
s_add_u32 s39, s39, 0x201000
buffer_store_dwordx4 v[208:211], v247, s[8:11], s39 offen offset:0 sc1
buffer_store_dwordx4 v[208:211], v247, s[8:11], s39 offen offset:1024 sc1
s_lshl_b32 s39, s21, 13
s_add_u32 s39, s39, 0x241000
buffer_store_dwordx4 v[208:211], v247, s[8:11], s39 offen offset:0 sc1
buffer_store_dwordx4 v[208:211], v247, s[8:11], s39 offen offset:1024 sc1
L_inie_68:
s_mov_b32 m0, 49152
s_mov_b32 s38, 0x180000
buffer_load_dwordx4 v136, s[12:15], s38 offen  lds
s_mov_b32 m0, 50176
s_mov_b32 s38, 0x188000
buffer_load_dwordx4 v136, s[12:15], s38 offen  lds
s_mov_b32 m0, 51200
s_mov_b32 s38, 0x190000
buffer_load_dwordx4 v136, s[12:15], s38 offen  lds
s_mov_b32 m0, 52224
s_mov_b32 s38, 0x198000
buffer_load_dwordx4 v136, s[12:15], s38 offen  lds
s_mov_b32 m0, 53248
s_mov_b32 s38, 0x1a0000
buffer_load_dwordx4 v137, s[12:15], s38 offen  lds
s_mov_b32 m0, 54272
s_mov_b32 s38, 0x1a8000
buffer_load_dwordx4 v137, s[12:15], s38 offen  lds
s_mov_b32 m0, 55296
s_mov_b32 s38, 0x1b0000
buffer_load_dwordx4 v137, s[12:15], s38 offen  lds
s_mov_b32 m0, 56320
s_mov_b32 s38, 0x1b8000
buffer_load_dwordx4 v137, s[12:15], s38 offen  lds
s_waitcnt vmcnt(24)
s_barrier
v_add_u32 v142, 65536, v140
v_add_u32 v143, 65536, v141
ds_read_b64_tr_b16 a[144:145], v142 offset:0
ds_read_b64_tr_b16 a[146:147], v142 offset:512
ds_read_b64_tr_b16 a[148:149], v142 offset:2048
ds_read_b64_tr_b16 a[150:151], v142 offset:2560
ds_read_b64_tr_b16 a[208:209], v143 offset:0
ds_read_b64_tr_b16 a[210:211], v143 offset:512
ds_read_b64_tr_b16 a[212:213], v143 offset:2048
ds_read_b64_tr_b16 a[214:215], v143 offset:2560
ds_read_b64_tr_b16 a[176:177], v142 offset:16384
ds_read_b64_tr_b16 a[178:179], v142 offset:16896
ds_read_b64_tr_b16 a[180:181], v142 offset:18432
ds_read_b64_tr_b16 a[182:183], v142 offset:18944
ds_read_b64_tr_b16 a[240:241], v143 offset:16384
ds_read_b64_tr_b16 a[242:243], v143 offset:16896
ds_read_b64_tr_b16 a[244:245], v143 offset:18432
ds_read_b64_tr_b16 a[246:247], v143 offset:18944
s_waitcnt lgkmcnt(0)
s_barrier
s_mov_b32 m0, 81920
s_mov_b32 s38, 0x280000
buffer_load_dwordx4 v136, s[12:15], s38 offen  lds
s_mov_b32 m0, 82944
s_mov_b32 s38, 0x288000
buffer_load_dwordx4 v136, s[12:15], s38 offen  lds
s_mov_b32 m0, 83968
s_mov_b32 s38, 0x290000
buffer_load_dwordx4 v136, s[12:15], s38 offen  lds
s_mov_b32 m0, 84992
s_mov_b32 s38, 0x298000
buffer_load_dwordx4 v136, s[12:15], s38 offen  lds
s_mov_b32 m0, 86016
s_mov_b32 s38, 0x2a0000
buffer_load_dwordx4 v137, s[12:15], s38 offen  lds
s_mov_b32 m0, 87040
s_mov_b32 s38, 0x2a8000
buffer_load_dwordx4 v137, s[12:15], s38 offen  lds
s_mov_b32 m0, 88064
s_mov_b32 s38, 0x2b0000
buffer_load_dwordx4 v137, s[12:15], s38 offen  lds
s_mov_b32 m0, 89088
s_mov_b32 s38, 0x2b8000
buffer_load_dwordx4 v137, s[12:15], s38 offen  lds
s_waitcnt vmcnt(24)
s_barrier
v_add_u32 v142, 98304, v140
v_add_u32 v143, 98304, v141
ds_read_b64_tr_b16 a[152:153], v142 offset:0
ds_read_b64_tr_b16 a[154:155], v142 offset:512
ds_read_b64_tr_b16 a[156:157], v142 offset:2048
ds_read_b64_tr_b16 a[158:159], v142 offset:2560
ds_read_b64_tr_b16 a[216:217], v143 offset:0
ds_read_b64_tr_b16 a[218:219], v143 offset:512
ds_read_b64_tr_b16 a[220:221], v143 offset:2048
ds_read_b64_tr_b16 a[222:223], v143 offset:2560
ds_read_b64_tr_b16 a[184:185], v142 offset:16384
ds_read_b64_tr_b16 a[186:187], v142 offset:16896
ds_read_b64_tr_b16 a[188:189], v142 offset:18432
ds_read_b64_tr_b16 a[190:191], v142 offset:18944
ds_read_b64_tr_b16 a[248:249], v143 offset:16384
ds_read_b64_tr_b16 a[250:251], v143 offset:16896
ds_read_b64_tr_b16 a[252:253], v143 offset:18432
ds_read_b64_tr_b16 a[254:255], v143 offset:18944
s_waitcnt lgkmcnt(0)
s_barrier
s_mov_b32 m0, 114688
s_mov_b32 s38, 0x380000
buffer_load_dwordx4 v136, s[12:15], s38 offen  lds
s_mov_b32 m0, 115712
s_mov_b32 s38, 0x388000
buffer_load_dwordx4 v136, s[12:15], s38 offen  lds
s_mov_b32 m0, 116736
s_mov_b32 s38, 0x390000
buffer_load_dwordx4 v136, s[12:15], s38 offen  lds
s_mov_b32 m0, 117760
s_mov_b32 s38, 0x398000
buffer_load_dwordx4 v136, s[12:15], s38 offen  lds
s_mov_b32 m0, 118784
s_mov_b32 s38, 0x3a0000
buffer_load_dwordx4 v137, s[12:15], s38 offen  lds
s_mov_b32 m0, 119808
s_mov_b32 s38, 0x3a8000
buffer_load_dwordx4 v137, s[12:15], s38 offen  lds
s_mov_b32 m0, 120832
s_mov_b32 s38, 0x3b0000
buffer_load_dwordx4 v137, s[12:15], s38 offen  lds
s_mov_b32 m0, 121856
s_mov_b32 s38, 0x3b8000
buffer_load_dwordx4 v137, s[12:15], s38 offen  lds
s_waitcnt vmcnt(24)
s_barrier
v_add_u32 v142, 0, v140
v_add_u32 v143, 0, v141
ds_read_b64_tr_b16 v[0:1], v142 offset:0
ds_read_b64_tr_b16 v[2:3], v142 offset:512
ds_read_b64_tr_b16 v[4:5], v142 offset:2048
ds_read_b64_tr_b16 v[6:7], v142 offset:2560
ds_read_b64_tr_b16 v[64:65], v143 offset:0
ds_read_b64_tr_b16 v[66:67], v143 offset:512
ds_read_b64_tr_b16 v[68:69], v143 offset:2048
ds_read_b64_tr_b16 v[70:71], v143 offset:2560
ds_read_b64_tr_b16 v[32:33], v142 offset:16384
ds_read_b64_tr_b16 v[34:35], v142 offset:16896
ds_read_b64_tr_b16 v[36:37], v142 offset:18432
ds_read_b64_tr_b16 v[38:39], v142 offset:18944
ds_read_b64_tr_b16 v[96:97], v143 offset:16384
ds_read_b64_tr_b16 v[98:99], v143 offset:16896
ds_read_b64_tr_b16 v[100:101], v143 offset:18432
ds_read_b64_tr_b16 v[102:103], v143 offset:18944
s_waitcnt lgkmcnt(0)
s_barrier
s_mov_b32 s12, s56
s_mov_b32 s13, s57
s_mov_b32 s14, 0x400000
s_mov_b32 m0, 16384
s_mov_b32 s38, 0x10000
buffer_load_dwordx4 v138, s[12:15], s38 offen  lds
s_mov_b32 m0, 17408
s_mov_b32 s38, 0x11000
buffer_load_dwordx4 v138, s[12:15], s38 offen  lds
s_mov_b32 m0, 18432
s_mov_b32 s38, 0x12000
buffer_load_dwordx4 v138, s[12:15], s38 offen  lds
s_mov_b32 m0, 19456
s_mov_b32 s38, 0x13000
buffer_load_dwordx4 v138, s[12:15], s38 offen  lds
s_mov_b32 m0, 20480
s_mov_b32 s38, 0x14000
buffer_load_dwordx4 v139, s[12:15], s38 offen  lds
s_mov_b32 m0, 21504
s_mov_b32 s38, 0x15000
buffer_load_dwordx4 v139, s[12:15], s38 offen  lds
s_mov_b32 m0, 22528
s_mov_b32 s38, 0x16000
buffer_load_dwordx4 v139, s[12:15], s38 offen  lds
s_mov_b32 m0, 23552
s_mov_b32 s38, 0x17000
buffer_load_dwordx4 v139, s[12:15], s38 offen  lds
s_waitcnt vmcnt(24)
s_barrier
v_add_u32 v142, 32768, v140
v_add_u32 v143, 32768, v141
ds_read_b64_tr_b16 v[8:9], v142 offset:0
ds_read_b64_tr_b16 v[10:11], v142 offset:512
ds_read_b64_tr_b16 v[12:13], v142 offset:2048
ds_read_b64_tr_b16 v[14:15], v142 offset:2560
ds_read_b64_tr_b16 v[72:73], v143 offset:0
ds_read_b64_tr_b16 v[74:75], v143 offset:512
ds_read_b64_tr_b16 v[76:77], v143 offset:2048
ds_read_b64_tr_b16 v[78:79], v143 offset:2560
ds_read_b64_tr_b16 v[40:41], v142 offset:16384
ds_read_b64_tr_b16 v[42:43], v142 offset:16896
ds_read_b64_tr_b16 v[44:45], v142 offset:18432
ds_read_b64_tr_b16 v[46:47], v142 offset:18944
ds_read_b64_tr_b16 v[104:105], v143 offset:16384
ds_read_b64_tr_b16 v[106:107], v143 offset:16896
ds_read_b64_tr_b16 v[108:109], v143 offset:18432
ds_read_b64_tr_b16 v[110:111], v143 offset:18944
s_waitcnt lgkmcnt(0)
s_barrier
s_barrier
s_mov_b64 exec, 1
v_mov_b32 v200, 1
v_mov_b32 v201, 136
buffer_atomic_add v200, v201, s[16:19], 0 offen
s_mov_b64 exec, -1
s_mov_b32 s22, 0
s_mov_b32 s96, 0
s_mov_b32 s42, 0
s_mov_b32 s23, 0x100000
s_mov_b32 s24, 0x101000
s_mov_b32 s25, 0x220000
s_add_u32 s26, s25, 32768
s_lshl_b32 s27, s21, 13
s_add_u32 s27, s27, 0x201000
s_lshl_b32 s29, s21, 13
s_add_u32 s30, s29, 0x1801000
s_add_u32 s29, s29, 0x801000
s_lshl_b32 s31, s21, 11
s_add_u32 s37, s31, 0x3c00400
s_add_u32 s31, s31, 0x3800000
s_mov_b32 s34, 0x3e0293ee
s_mov_b32 s35, 0xbe0293ee
s_mov_b32 s100, 0x3f803f80
s_mov_b32 s101, 0x3f803f80
v_mov_b64 v[244:245], 0
s_lshl_b32 s98, s21, 6
s_add_u32 s98, s98, 0x10400
s_add_u32 s47, s98, 48
s_mov_b32 m0, 49152
s_mov_b32 s38, 0x10100
buffer_load_dwordx4 v138, s[12:15], s38 offen  lds
s_mov_b32 m0, 50176
s_mov_b32 s38, 0x11100
buffer_load_dwordx4 v138, s[12:15], s38 offen  lds
s_mov_b32 m0, 51200
s_mov_b32 s38, 0x12100
buffer_load_dwordx4 v138, s[12:15], s38 offen  lds
s_mov_b32 m0, 52224
s_mov_b32 s38, 0x13100
buffer_load_dwordx4 v138, s[12:15], s38 offen  lds
s_mov_b32 m0, 53248
s_mov_b32 s38, 0x14100
buffer_load_dwordx4 v139, s[12:15], s38 offen  lds
s_mov_b32 m0, 54272
s_mov_b32 s38, 0x15100
buffer_load_dwordx4 v139, s[12:15], s38 offen  lds
s_mov_b32 m0, 55296
s_mov_b32 s38, 0x16100
buffer_load_dwordx4 v139, s[12:15], s38 offen  lds
s_mov_b32 m0, 56320
s_mov_b32 s38, 0x17100
buffer_load_dwordx4 v139, s[12:15], s38 offen  lds
s_waitcnt vmcnt(24)
s_barrier
v_add_u32 v142, 65536, v140
v_add_u32 v143, 65536, v141
ds_read_b64_tr_b16 v[16:17], v142 offset:0
ds_read_b64_tr_b16 v[18:19], v142 offset:512
ds_read_b64_tr_b16 v[20:21], v142 offset:2048
ds_read_b64_tr_b16 v[22:23], v142 offset:2560
ds_read_b64_tr_b16 v[80:81], v143 offset:0
ds_read_b64_tr_b16 v[82:83], v143 offset:512
ds_read_b64_tr_b16 v[84:85], v143 offset:2048
ds_read_b64_tr_b16 v[86:87], v143 offset:2560
ds_read_b64_tr_b16 v[48:49], v142 offset:16384
ds_read_b64_tr_b16 v[50:51], v142 offset:16896
ds_read_b64_tr_b16 v[52:53], v142 offset:18432
ds_read_b64_tr_b16 v[54:55], v142 offset:18944
ds_read_b64_tr_b16 v[112:113], v143 offset:16384
ds_read_b64_tr_b16 v[114:115], v143 offset:16896
ds_read_b64_tr_b16 v[116:117], v143 offset:18432
ds_read_b64_tr_b16 v[118:119], v143 offset:18944
s_waitcnt lgkmcnt(0)
s_barrier
buffer_load_dwordx4 v[224:227], v244, s[8:11], s98 offen offset:16 sc1
buffer_load_dwordx4 v[228:231], v244, s[8:11], s98 offen offset:32 sc1
s_mov_b32 m0, 81920
s_mov_b32 s38, 0x10200
buffer_load_dwordx4 v138, s[12:15], s38 offen  lds
s_mov_b32 m0, 82944
s_mov_b32 s38, 0x11200
buffer_load_dwordx4 v138, s[12:15], s38 offen  lds
s_mov_b32 m0, 83968
s_mov_b32 s38, 0x12200
buffer_load_dwordx4 v138, s[12:15], s38 offen  lds
s_mov_b32 m0, 84992
s_mov_b32 s38, 0x13200
buffer_load_dwordx4 v138, s[12:15], s38 offen  lds
s_mov_b32 m0, 86016
s_mov_b32 s38, 0x14200
buffer_load_dwordx4 v139, s[12:15], s38 offen  lds
s_mov_b32 m0, 87040
s_mov_b32 s38, 0x15200
buffer_load_dwordx4 v139, s[12:15], s38 offen  lds
s_mov_b32 m0, 88064
s_mov_b32 s38, 0x16200
buffer_load_dwordx4 v139, s[12:15], s38 offen  lds
s_mov_b32 m0, 89088
s_mov_b32 s38, 0x17200
buffer_load_dwordx4 v139, s[12:15], s38 offen  lds
s_waitcnt vmcnt(24)
s_barrier
v_add_u32 v142, 98304, v140
v_add_u32 v143, 98304, v141
ds_read_b64_tr_b16 v[24:25], v142 offset:0
ds_read_b64_tr_b16 v[26:27], v142 offset:512
ds_read_b64_tr_b16 v[28:29], v142 offset:2048
ds_read_b64_tr_b16 v[30:31], v142 offset:2560
ds_read_b64_tr_b16 v[88:89], v143 offset:0
ds_read_b64_tr_b16 v[90:91], v143 offset:512
ds_read_b64_tr_b16 v[92:93], v143 offset:2048
ds_read_b64_tr_b16 v[94:95], v143 offset:2560
ds_read_b64_tr_b16 v[56:57], v142 offset:16384
ds_read_b64_tr_b16 v[58:59], v142 offset:16896
ds_read_b64_tr_b16 v[60:61], v142 offset:18432
ds_read_b64_tr_b16 v[62:63], v142 offset:18944
ds_read_b64_tr_b16 v[120:121], v143 offset:16384
ds_read_b64_tr_b16 v[122:123], v143 offset:16896
ds_read_b64_tr_b16 v[124:125], v143 offset:18432
ds_read_b64_tr_b16 v[126:127], v143 offset:18944
s_waitcnt lgkmcnt(0)
s_barrier
s_mov_b32 m0, 114688
s_mov_b32 s38, 0x10300
buffer_load_dwordx4 v138, s[12:15], s38 offen  lds
s_mov_b32 m0, 115712
s_mov_b32 s38, 0x11300
buffer_load_dwordx4 v138, s[12:15], s38 offen  lds
s_mov_b32 m0, 116736
s_mov_b32 s38, 0x12300
buffer_load_dwordx4 v138, s[12:15], s38 offen  lds
s_mov_b32 m0, 117760
s_mov_b32 s38, 0x13300
buffer_load_dwordx4 v138, s[12:15], s38 offen  lds
s_mov_b32 m0, 118784
s_mov_b32 s38, 0x14300
buffer_load_dwordx4 v139, s[12:15], s38 offen  lds
s_mov_b32 m0, 119808
s_mov_b32 s38, 0x15300
buffer_load_dwordx4 v139, s[12:15], s38 offen  lds
s_mov_b32 m0, 120832
s_mov_b32 s38, 0x16300
buffer_load_dwordx4 v139, s[12:15], s38 offen  lds
s_mov_b32 m0, 121856
s_mov_b32 s38, 0x17300
buffer_load_dwordx4 v139, s[12:15], s38 offen  lds
s_waitcnt vmcnt(8)
s_mov_b32 s43, 0
s_cmp_ge_u32 s43, 64
s_cbranch_scc1 L_hx_70
s_mov_b32 s36, 200000
s_branch L_he_71
L_hq_69:
buffer_load_dwordx4 v[224:227], v244, s[8:11], s98 offen offset:16 sc1
buffer_load_dwordx4 v[228:231], v244, s[8:11], s98 offen offset:32 sc1
s_sub_u32 s36, s36, 1
s_cmp_eq_u32 s36, 0
s_cbranch_scc1 L_abort
s_waitcnt vmcnt(0)
L_he_71:
v_cmp_eq_u32 vcc, s46, v225
s_nop 1
v_cndmask_b32 v224, 0, v224, vcc
v_cmp_eq_u32 vcc, s46, v227
s_nop 1
v_cndmask_b32 v226, 0, v226, vcc
v_cmp_eq_u32 vcc, s46, v229
s_nop 1
v_cndmask_b32 v228, 0, v228, vcc
v_cmp_eq_u32 vcc, s46, v231
s_nop 1
v_cndmask_b32 v230, 0, v230, vcc
v_min_u32 v224, v224, v228
v_min_u32 v225, v226, v230
v_lshlrev_b32 v224, 1, v224
v_lshl_add_u32 v225, v225, 1, 1
v_min_u32 v224, v224, v225
s_nop 0
v_readfirstlane_b32 s97, v224
s_cmp_ge_u32 s97, 64
s_cselect_b32 s97, 1000, s97
s_cmp_lt_u32 s43, s97
s_cbranch_scc0 L_hq_69
L_hx_70:
s_mov_b32 m0, 135168
s_nop 0
buffer_load_dwordx4 v247, s[8:11], s29 offen offset:0 sc1 lds
buffer_load_dwordx4 v247, s[8:11], s29 offen offset:1024 sc1 lds
s_add_u32 s29, s29, 262144
s_mov_b32 s44, 143360
v_mov_b32 v232, 136
buffer_load_dword v233, v232, s[16:19], 0 offen sc1
s_xor_b32 s39, s27, 0
buffer_load_dwordx4 v[228:231], v247, s[8:11], s39 offen offset:0 sc1
buffer_load_dwordx4 v[228:231], v247, s[8:11], s39 offen offset:1024 sc1
s_xor_b32 s39, s27, 262144
buffer_load_dwordx4 v[228:231], v247, s[8:11], s39 offen offset:0 sc1
buffer_load_dwordx4 v[228:231], v247, s[8:11], s39 offen offset:1024 sc1
buffer_load_dwordx4 v[228:231], v247, s[8:11], s30 offen offset:0 sc1
buffer_load_dwordx4 v[228:231], v247, s[8:11], s30 offen offset:1024 sc1
buffer_load_dword v228, v244, s[8:11], s31 offen sc1
buffer_load_dword v228, v244, s[8:11], s37 offen sc1
s_mov_b32 s39, 0x101000
buffer_load_dwordx4 v[228:231], v247, s[8:11], s39 offen offset:0 sc1
buffer_load_dwordx4 v[228:231], v247, s[8:11], s39 offen offset:1024 sc1
s_mov_b32 s39, 0x103000
buffer_load_dwordx4 v[228:231], v247, s[8:11], s39 offen offset:0 sc1
buffer_load_dwordx4 v[228:231], v247, s[8:11], s39 offen offset:1024 sc1
s_mov_b32 s39, 0x105000
buffer_load_dwordx4 v[228:231], v247, s[8:11], s39 offen offset:0 sc1
buffer_load_dwordx4 v[228:231], v247, s[8:11], s39 offen offset:1024 sc1
s_mov_b32 s39, 0x107000
buffer_load_dwordx4 v[228:231], v247, s[8:11], s39 offen offset:0 sc1
buffer_load_dwordx4 v[228:231], v247, s[8:11], s39 offen offset:1024 sc1
s_getpc_b64 s[40:41]
L_pc_72:
s_add_u32 s40, s40, L_step_w2f-L_pc_72
s_addc_u32 s41, s41, 0
global_load_dwordx4 v[228:231], v247, s[40:41] offset:0
global_load_dwordx4 v[228:231], v247, s[40:41] offset:1024
global_load_dwordx4 v[228:231], v247, s[40:41] offset:2048
global_load_dwordx4 v[228:231], v247, s[40:41] offset:3072
s_waitcnt vmcnt(23)
s_barrier
ds_read_b64_tr_b16 v[160:161], v148 offset:0
ds_read_b64_tr_b16 v[162:163], v148 offset:512
ds_read_b64_tr_b16 v[164:165], v148 offset:2048
ds_read_b64_tr_b16 v[166:167], v148 offset:2560
ds_read_b64_tr_b16 v[168:169], v149 offset:0
ds_read_b64_tr_b16 v[170:171], v149 offset:512
ds_read_b64_tr_b16 v[172:173], v149 offset:2048
ds_read_b64_tr_b16 v[174:175], v149 offset:2560
ds_read_b64_tr_b16 v[176:177], v150 offset:0
ds_read_b64_tr_b16 v[178:179], v150 offset:512
ds_read_b64_tr_b16 v[180:181], v150 offset:2048
ds_read_b64_tr_b16 v[182:183], v150 offset:2560
ds_read_b64_tr_b16 v[184:185], v151 offset:0
ds_read_b64_tr_b16 v[186:187], v151 offset:512
ds_read_b64_tr_b16 v[188:189], v151 offset:2048
ds_read_b64_tr_b16 v[190:191], v151 offset:2560
ds_read_b64_tr_b16 v[192:193], v152 offset:0
ds_read_b64_tr_b16 v[194:195], v152 offset:512
ds_read_b64_tr_b16 v[196:197], v152 offset:2048
ds_read_b64_tr_b16 v[198:199], v152 offset:2560
ds_read_b64_tr_b16 v[200:201], v153 offset:0
ds_read_b64_tr_b16 v[202:203], v153 offset:512
ds_read_b64_tr_b16 v[204:205], v153 offset:2048
ds_read_b64_tr_b16 v[206:207], v153 offset:2560
ds_read_b64_tr_b16 v[208:209], v154 offset:0
ds_read_b64_tr_b16 v[210:211], v154 offset:512
ds_read_b64_tr_b16 v[212:213], v154 offset:2048
ds_read_b64_tr_b16 v[214:215], v154 offset:2560
ds_read_b64_tr_b16 v[216:217], v155 offset:0
ds_read_b64_tr_b16 v[218:219], v155 offset:512
ds_read_b64_tr_b16 v[220:221], v155 offset:2048
ds_read_b64_tr_b16 v[222:223], v155 offset:2560
s_waitcnt lgkmcnt(0)
ds_write_b128 v248, v[160:163] offset:0
ds_write_b128 v248, v[164:167] offset:1024
ds_write_b128 v248, v[168:171] offset:2048
ds_write_b128 v248, v[172:175] offset:3072
ds_write_b128 v248, v[176:179] offset:4096
ds_write_b128 v248, v[180:183] offset:5120
ds_write_b128 v248, v[184:187] offset:6144
ds_write_b128 v248, v[188:191] offset:7168
ds_write_b128 v248, v[192:195] offset:8192
ds_write_b128 v248, v[196:199] offset:9216
ds_write_b128 v248, v[200:203] offset:10240
ds_write_b128 v248, v[204:207] offset:11264
ds_write_b128 v248, v[208:211] offset:12288
ds_write_b128 v248, v[212:215] offset:13312
ds_write_b128 v248, v[216:219] offset:14336
ds_write_b128 v248, v[220:223] offset:15360
s_waitcnt lgkmcnt(0)
ds_read_b64_tr_b16 v[160:161], v148 offset:16384
ds_read_b64_tr_b16 v[162:163], v148 offset:16896
ds_read_b64_tr_b16 v[164:165], v148 offset:18432
ds_read_b64_tr_b16 v[166:167], v148 offset:18944
ds_read_b64_tr_b16 v[168:169], v149 offset:16384
ds_read_b64_tr_b16 v[170:171], v149 offset:16896
ds_read_b64_tr_b16 v[172:173], v149 offset:18432
ds_read_b64_tr_b16 v[174:175], v149 offset:18944
ds_read_b64_tr_b16 v[176:177], v150 offset:16384
ds_read_b64_tr_b16 v[178:179], v150 offset:16896
ds_read_b64_tr_b16 v[180:181], v150 offset:18432
ds_read_b64_tr_b16 v[182:183], v150 offset:18944
ds_read_b64_tr_b16 v[184:185], v151 offset:16384
ds_read_b64_tr_b16 v[186:187], v151 offset:16896
ds_read_b64_tr_b16 v[188:189], v151 offset:18432
ds_read_b64_tr_b16 v[190:191], v151 offset:18944
ds_read_b64_tr_b16 v[192:193], v152 offset:16384
ds_read_b64_tr_b16 v[194:195], v152 offset:16896
ds_read_b64_tr_b16 v[196:197], v152 offset:18432
ds_read_b64_tr_b16 v[198:199], v152 offset:18944
ds_read_b64_tr_b16 v[200:201], v153 offset:16384
ds_read_b64_tr_b16 v[202:203], v153 offset:16896
ds_read_b64_tr_b16 v[204:205], v153 offset:18432
ds_read_b64_tr_b16 v[206:207], v153 offset:18944
ds_read_b64_tr_b16 v[208:209], v154 offset:16384
ds_read_b64_tr_b16 v[210:211], v154 offset:16896
ds_read_b64_tr_b16 v[212:213], v154 offset:18432
ds_read_b64_tr_b16 v[214:215], v154 offset:18944
ds_read_b64_tr_b16 v[216:217], v155 offset:16384
ds_read_b64_tr_b16 v[218:219], v155 offset:16896
ds_read_b64_tr_b16 v[220:221], v155 offset:18432
ds_read_b64_tr_b16 v[222:223], v155 offset:18944
s_waitcnt lgkmcnt(0)
ds_write_b128 v248, v[160:163] offset:16384
ds_write_b128 v248, v[164:167] offset:17408
ds_write_b128 v248, v[168:171] offset:18432
ds_write_b128 v248, v[172:175] offset:19456
ds_write_b128 v248, v[176:179] offset:20480
ds_write_b128 v248, v[180:183] offset:21504
ds_write_b128 v248, v[184:187] offset:22528
ds_write_b128 v248, v[188:191] offset:23552
ds_write_b128 v248, v[192:195] offset:24576
ds_write_b128 v248, v[196:199] offset:25600
ds_write_b128 v248, v[200:203] offset:26624
ds_write_b128 v248, v[204:207] offset:27648
ds_write_b128 v248, v[208:211] offset:28672
ds_write_b128 v248, v[212:215] offset:29696
ds_write_b128 v248, v[216:219] offset:30720
ds_write_b128 v248, v[220:223] offset:31744
s_waitcnt lgkmcnt(0)
v_mov_b64 v[160:161], 0
v_mov_b64 v[162:163], 0
v_mov_b64 v[164:165], 0
v_mov_b64 v[166:167], 0
v_mov_b64 v[168:169], 0
v_mov_b64 v[170:171], 0
v_mov_b64 v[172:173], 0
v_mov_b64 v[174:175], 0
v_mov_b64 v[176:177], 0
v_mov_b64 v[178:179], 0
v_mov_b64 v[180:181], 0
v_mov_b64 v[182:183], 0
v_mov_b64 v[224:225], -1
v_mov_b64 v[226:227], -1
s_mov_b32 s41, 0x106000
v_mov_b64 v[244:245], 0
v_mov_b64 v[240:241], 0
v_mov_b64 v[242:243], 0
v_add_u32 v245, 151552, v247
s_mov_b32 s36, 200000
s_waitcnt vmcnt(0)
s_branch L_arq_74
L_arr_73:
buffer_load_dword v233, v232, s[16:19], 0 offen sc1
s_sub_u32 s36, s36, 1
s_cmp_eq_u32 s36, 0
s_cbranch_scc1 L_abort
s_waitcnt vmcnt(0)
L_arq_74:
v_cmp_ne_u32 vcc, 32, v233
s_cbranch_vccnz L_arr_73
s_waitcnt vmcnt(0)
s_barrier
s_cmp_lg_u32 s32, 0
s_cbranch_scc1 L_cslow2
L_step_w2f:
s_waitcnt vmcnt(0)
s_mov_b32 s36, 200000
buffer_load_dwordx4 v[184:187], v247, s[8:11], s24 offen offset:0 sc1
buffer_load_dwordx4 v[188:191], v247, s[8:11], s24 offen offset:1024 sc1
v_mov_b64 v[160:161], 0
v_mov_b64 v[162:163], 0
v_mov_b64 v[164:165], 0
v_mov_b64 v[166:167], 0
v_mov_b64 v[168:169], 0
v_mov_b64 v[170:171], 0
v_mov_b64 v[172:173], 0
v_mov_b64 v[174:175], 0
v_mov_b64 v[176:177], 0
v_mov_b64 v[178:179], 0
v_mov_b64 v[180:181], 0
v_mov_b64 v[182:183], 0
L_pl_78:
buffer_load_dwordx4 v[192:195], v247, s[8:11], s24 offen offset:0 sc1
buffer_load_dwordx4 v[196:199], v247, s[8:11], s24 offen offset:1024 sc1
s_waitcnt vmcnt(2)
ds_write_b128 v245, v[184:187] offset:4096
ds_write_b128 v245, v[188:191] offset:5120
v_max3_u32 v255, v184, v185, v186
v_max3_u32 v255, v255, v187, v188
v_max3_u32 v255, v255, v189, v190
v_max_u32 v255, v255, v191
v_cmp_eq_u32 vcc, -1, v255
s_cbranch_vccz L_mok0_75
buffer_load_dwordx4 v[184:187], v247, s[8:11], s24 offen offset:0 sc1
buffer_load_dwordx4 v[188:191], v247, s[8:11], s24 offen offset:1024 sc1
s_waitcnt vmcnt(2)
ds_write_b128 v245, v[192:195] offset:4096
ds_write_b128 v245, v[196:199] offset:5120
v_max3_u32 v255, v192, v193, v194
v_max3_u32 v255, v255, v195, v196
v_max3_u32 v255, v255, v197, v198
v_max_u32 v255, v255, v199
v_cmp_eq_u32 vcc, -1, v255
s_cbranch_vccz L_mok1_76
s_sub_u32 s36, s36, 1
s_cmp_lg_u32 s36, 0
s_cbranch_scc1 L_pl_78
s_branch L_abort
L_mok1_76:
v_smfmac_f32_16x16x64_bf16 v[160:163], v[192:195], a[32:39], v246
v_smfmac_f32_16x16x64_bf16 v[164:167], v[192:195], a[160:167], v246
v_smfmac_f32_16x16x64_bf16 v[168:171], v[192:195], a[96:103], v246
s_waitcnt lgkmcnt(0)
s_barrier
ds_read_b128 v[128:131], v245 offset:0
ds_read_b128 v[132:135], v245 offset:1024
v_smfmac_f32_16x16x64_bf16 v[172:175], v[192:195], a[224:231], v246
ds_read_b128 v[136:139], v245 offset:2048
v_smfmac_f32_16x16x64_bf16 v[160:163], v[196:199], a[40:47], v246
ds_read_b128 v[140:143], v245 offset:3072
v_smfmac_f32_16x16x64_bf16 v[164:167], v[196:199], a[168:175], v246
ds_read_b128 v[152:155], v245 offset:6144
v_smfmac_f32_16x16x64_bf16 v[168:171], v[196:199], a[104:111], v246
ds_read_b128 v[156:159], v245 offset:7168
v_smfmac_f32_16x16x64_bf16 v[172:175], v[196:199], a[232:239], v246
ds_read_b128 v[144:147], v245 offset:4096
ds_read_b128 v[148:151], v245 offset:5120
s_branch L_mjoin_77
L_mok0_75:
v_smfmac_f32_16x16x64_bf16 v[160:163], v[184:187], a[32:39], v246
v_smfmac_f32_16x16x64_bf16 v[164:167], v[184:187], a[160:167], v246
v_smfmac_f32_16x16x64_bf16 v[168:171], v[184:187], a[96:103], v246
s_waitcnt lgkmcnt(0)
s_barrier
ds_read_b128 v[128:131], v245 offset:0
ds_read_b128 v[132:135], v245 offset:1024
v_smfmac_f32_16x16x64_bf16 v[172:175], v[184:187], a[224:231], v246
ds_read_b128 v[136:139], v245 offset:2048
v_smfmac_f32_16x16x64_bf16 v[160:163], v[188:191], a[40:47], v246
ds_read_b128 v[140:143], v245 offset:3072
v_smfmac_f32_16x16x64_bf16 v[164:167], v[188:191], a[168:175], v246
ds_read_b128 v[152:155], v245 offset:6144
v_smfmac_f32_16x16x64_bf16 v[168:171], v[188:191], a[104:111], v246
ds_read_b128 v[156:159], v245 offset:7168
v_smfmac_f32_16x16x64_bf16 v[172:175], v[188:191], a[232:239], v246
ds_read_b128 v[144:147], v245 offset:4096
ds_read_b128 v[148:151], v245 offset:5120
L_mjoin_77:
buffer_store_dword v224, v251, s[8:11], s41 offen
s_waitcnt lgkmcnt(7)
v_smfmac_f32_16x16x64_bf16 v[160:163], v[128:131], a[0:7], v246
ds_read_b128 v[200:203], v249 offset:4096
v_smfmac_f32_16x16x64_bf16 v[164:167], v[128:131], a[128:135], v246
buffer_load_dwordx4 v[228:231], v247, s[8:11], s30 offen offset:0 sc1 nt
v_smfmac_f32_16x16x64_bf16 v[168:171], v[128:131], a[64:71], v246
ds_read_b128 v[204:207], v249 offset:5120
v_smfmac_f32_16x16x64_bf16 v[172:175], v[128:131], a[192:199], v246
s_waitcnt lgkmcnt(8)
v_smfmac_f32_16x16x64_bf16 v[160:163], v[132:135], a[8:15], v246
ds_read_b128 v[208:211], v249 offset:6144
v_smfmac_f32_16x16x64_bf16 v[164:167], v[132:135], a[136:143], v246
buffer_load_dwordx4 v[232:235], v247, s[8:11], s30 offen offset:1024 sc1 nt
v_smfmac_f32_16x16x64_bf16 v[168:171], v[132:135], a[72:79], v246
ds_read_b128 v[212:215], v249 offset:7168
v_smfmac_f32_16x16x64_bf16 v[172:175], v[132:135], a[200:207], v246
s_waitcnt lgkmcnt(9)
v_smfmac_f32_16x16x64_bf16 v[160:163], v[136:139], a[16:23], v246
s_waitcnt vmcnt(3)
s_add_u32 s43, s22, 3
s_cmp_ge_u32 s43, s97
s_cbranch_scc1 L_hz_79
L_hzb_80:
ds_read_b128 v[184:187], v249 offset:0
v_smfmac_f32_16x16x64_bf16 v[164:167], v[136:139], a[144:151], v246
s_mov_b32 m0, s44
s_nop 0
buffer_load_dwordx4 v247, s[8:11], s29 offen sc1 nt lds
v_smfmac_f32_16x16x64_bf16 v[168:171], v[136:139], a[80:87], v246
ds_read_b128 v[188:191], v249 offset:1024
v_smfmac_f32_16x16x64_bf16 v[172:175], v[136:139], a[208:215], v246
s_waitcnt lgkmcnt(10)
v_smfmac_f32_16x16x64_bf16 v[160:163], v[140:143], a[24:31], v246
ds_read_b128 v[192:195], v249 offset:2048
v_smfmac_f32_16x16x64_bf16 v[164:167], v[140:143], a[152:159], v246
buffer_load_dwordx4 v247, s[8:11], s29 offen offset:1024 sc1 nt lds
v_smfmac_f32_16x16x64_bf16 v[168:171], v[140:143], a[88:95], v246
ds_read_b128 v[196:199], v249 offset:3072
v_smfmac_f32_16x16x64_bf16 v[172:175], v[140:143], a[216:223], v246
s_waitcnt lgkmcnt(8)
v_smfmac_f32_16x16x64_bf16 v[160:163], v[152:155], a[48:55], v246
v_smfmac_f32_16x16x64_bf16 v[164:167], v[152:155], a[176:183], v246
v_smfmac_f32_16x16x64_bf16 v[160:163], v[156:159], a[56:63], v246
v_smfmac_f32_16x16x64_bf16 v[164:167], v[156:159], a[184:191], v246
v_smfmac_f32_16x16x64_bf16 v[168:171], v[152:155], a[112:119], v246
v_smfmac_f32_16x16x64_bf16 v[172:175], v[152:155], a[240:247], v246
v_smfmac_f32_16x16x64_bf16 v[168:171], v[156:159], a[120:127], v246
v_smfmac_f32_16x16x64_bf16 v[172:175], v[156:159], a[248:255], v246
v_smfmac_f32_16x16x64_bf16 v[176:179], v[128:131], v[0:7], v246
s_nop 1
v_add_f32 v160, v160, v162
v_add_f32 v161, v161, v163
v_smfmac_f32_16x16x64_bf16 v[180:183], v[128:131], v[64:71], v246
v_add_f32 v164, v164, v166
v_add_f32 v165, v165, v167
v_smfmac_f32_16x16x64_bf16 v[176:179], v[132:135], v[8:15], v246
v_cvt_pk_bf16_f32 v163, v160, v161
v_cvt_pk_bf16_f32 v162, v164, v165
ds_write_b64 v252, v[162:163] offset:0
v_add_f32 v168, v168, v170
v_add_f32 v169, v169, v171
v_add_f32 v172, v172, v174
v_add_f32 v173, v173, v175
v_cvt_pk_bf16_f32 v171, v168, v169
v_cvt_pk_bf16_f32 v170, v172, v173
ds_write_b64 v252, v[170:171] offset:512
v_smfmac_f32_16x16x64_bf16 v[180:183], v[132:135], v[72:79], v246
v_smfmac_f32_16x16x64_bf16 v[176:179], v[136:139], v[16:23], v246
v_smfmac_f32_16x16x64_bf16 v[180:183], v[136:139], v[80:87], v246
v_smfmac_f32_16x16x64_bf16 v[176:179], v[140:143], v[24:31], v246
s_waitcnt lgkmcnt(0)
s_barrier
ds_read_b64_tr_b16 v[160:161], v253 offset:0
ds_read_b64_tr_b16 v[162:163], v253 offset:512
ds_read_b64_tr_b16 v[164:165], v253 offset:1024
v_smfmac_f32_16x16x64_bf16 v[180:183], v[140:143], v[88:95], v246
ds_read_b64_tr_b16 v[166:167], v253 offset:1536
v_smfmac_f32_16x16x64_bf16 v[176:179], v[144:147], v[32:39], v246
ds_read_b64_tr_b16 v[168:169], v253 offset:2048
v_smfmac_f32_16x16x64_bf16 v[180:183], v[144:147], v[96:103], v246
ds_read_b64_tr_b16 v[170:171], v253 offset:2560
v_smfmac_f32_16x16x64_bf16 v[176:179], v[148:151], v[40:47], v246
ds_read_b64_tr_b16 v[172:173], v253 offset:3072
v_smfmac_f32_16x16x64_bf16 v[180:183], v[148:151], v[104:111], v246
ds_read_b64_tr_b16 v[174:175], v253 offset:3584
s_waitcnt lgkmcnt(6)
v_mfma_f32_16x16x32_bf16 v[216:219], v[184:187], v[160:163], 0
v_mfma_f32_16x16x32_bf16 v[220:223], v[200:203], v[160:163], 0
ds_read_b128 v[128:131], v248 offset:4096
v_mfma_f32_16x16x32_bf16 v[224:227], v[160:163], v[160:163], 0
ds_read_b128 v[132:135], v248 offset:5120
s_waitcnt lgkmcnt(6)
v_mfma_f32_16x16x32_bf16 v[216:219], v[188:191], v[164:167], v[216:219]
ds_read_b128 v[136:139], v248 offset:20480
v_mfma_f32_16x16x32_bf16 v[220:223], v[204:207], v[164:167], v[220:223]
ds_read_b128 v[140:143], v248 offset:21504
v_mfma_f32_16x16x32_bf16 v[224:227], v[164:167], v[164:167], v[224:227]
ds_read_b128 v[144:147], v248 offset:6144
s_waitcnt lgkmcnt(7)
v_mfma_f32_16x16x32_bf16 v[216:219], v[192:195], v[168:171], v[216:219]
ds_read_b128 v[148:151], v248 offset:7168
v_mfma_f32_16x16x32_bf16 v[220:223], v[208:211], v[168:171], v[220:223]
v_mfma_f32_16x16x32_bf16 v[224:227], v[168:171], v[168:171], v[224:227]
s_waitcnt lgkmcnt(6)
v_mfma_f32_16x16x32_bf16 v[216:219], v[196:199], v[172:175], v[216:219]
v_mfma_f32_16x16x32_bf16 v[220:223], v[212:215], v[172:175], v[220:223]
v_mfma_f32_16x16x32_bf16 v[224:227], v[172:175], v[172:175], v[224:227]
buffer_store_dwordx4 v[168:171], v254, s[8:11], s31 offen offset:1024 sc1
v_smfmac_f32_16x16x64_bf16 v[176:179], v[152:155], v[48:55], v246
v_smfmac_f32_16x16x64_bf16 v[180:183], v[152:155], v[112:119], v246
v_smfmac_f32_16x16x64_bf16 v[176:179], v[156:159], v[56:63], v246
v_smfmac_f32_16x16x64_bf16 v[180:183], v[156:159], v[120:127], v246
ds_read_b128 v[152:155], v248 offset:22528
ds_read_b128 v[156:159], v248 offset:23552
v_max3_f32 v168, v216, v217, v218
v_max3_f32 v169, v219, v220, v221
v_max3_f32 v168, v168, v222, v223
v_max3_f32 v169, v169, v224, v225
v_max_f32 v168, v168, v169
v_mov_b32 v169, v168
ds_read_b128 v[184:187], v248 offset:0
v_mov_b64 v[164:165], s[100:101]
v_permlane32_swap_b32 v168, v169
v_max_f32 v168, v168, v169
v_mov_b32 v169, v168
ds_read_b128 v[188:191], v248 offset:1024
v_mov_b64 v[166:167], s[100:101]
v_permlane16_swap_b32 v168, v169
v_max_f32 v168, v168, v169
v_mul_f32 v170, s35, v168
v_pk_fma_f32 v[216:217], v[216:217], s[34:35], v[170:171] op_sel_hi:[1,0,0]
v_pk_fma_f32 v[218:219], v[218:219], s[34:35], v[170:171] op_sel_hi:[1,0,0]
ds_read_b128 v[192:195], v248 offset:16384
v_pk_fma_f32 v[220:221], v[220:221], s[34:35], v[170:171] op_sel_hi:[1,0,0]
v_pk_fma_f32 v[222:223], v[222:223], s[34:35], v[170:171] op_sel_hi:[1,0,0]
v_pk_fma_f32 v[224:225], v[224:225], s[34:35], v[170:171] op_sel_hi:[1,0,0]
ds_read_b128 v[196:199], v248 offset:17408
v_exp_f32 v216, v216
v_exp_f32 v217, v217
v_exp_f32 v218, v218
ds_read_b128 v[200:203], v248 offset:2048
v_exp_f32 v219, v219
v_exp_f32 v220, v220
v_exp_f32 v221, v221
ds_read_b128 v[204:207], v248 offset:3072
v_exp_f32 v222, v222
v_exp_f32 v223, v223
v_exp_f32 v224, v224
ds_read_b128 v[208:211], v248 offset:18432
v_exp_f32 v225, v225
ds_read_b128 v[212:215], v248 offset:19456
v_mov_b32 v161, 0
v_mov_b64 v[162:163], 0
s_cmp_lg_u32 s42, 0
s_cbranch_scc1 L_hze_81
L_hzf_82:
v_cvt_pk_bf16_f32 v236, v216, v217
v_cvt_pk_bf16_f32 v237, v218, v219
v_cvt_pk_bf16_f32 v238, v220, v221
v_cvt_pk_bf16_f32 v239, v222, v223
v_cvt_pk_bf16_f32 v160, v224, v225
v_add_f32 v176, v176, v178
v_mfma_f32_16x16x32_bf16 v[224:227], v[236:239], v[164:167], 0
s_waitcnt vmcnt(3)
v_add_f32 v177, v177, v179
v_mfma_f32_16x16x32_bf16 v[216:219], v[236:239], v[228:231], 0
v_add_f32 v180, v180, v182
v_mfma_f32_16x16x32_bf16 v[220:223], v[236:239], v[232:235], 0
v_add_f32 v181, v181, v183
v_mfma_f32_16x16x32_bf16 v[224:227], v[160:163], v[164:167], v[224:227]
v_cvt_pk_bf16_f32 v240, v176, v177
v_cvt_pk_bf16_f32 v242, v180, v181
v_lshrrev_b32 v255, 2, v247
s_nop 0
v_mfma_f32_16x16x32_bf16 v[216:219], v[160:163], v[240:243], v[216:219]
v_mfma_f32_16x16x32_bf16 v[220:223], v[160:163], v[242:245], v[220:223]
buffer_store_dword v240, v255, s[8:11], s37 offen sc1
buffer_store_dword v242, v255, s[8:11], s37 offen offset:256 sc1
v_rcp_f32 v172, v226
v_rcp_f32 v173, v227
s_nop 2
v_pk_mul_f32 v[218:219], v[218:219], v[172:173]
v_pk_mul_f32 v[222:223], v[222:223], v[172:173]
v_cvt_pk_bf16_f32 v216, v218, v219
v_cvt_pk_bf16_f32 v217, v222, v223
ds_write_b64 v252, v[216:217] offset:12288
v_mov_b64 v[168:169], 0
v_mov_b64 v[170:171], 0
v_mov_b64 v[172:173], 0
v_mov_b64 v[174:175], 0
v_mov_b64 v[176:177], 0
v_mov_b64 v[178:179], 0
v_mov_b64 v[180:181], 0
v_mov_b64 v[182:183], 0
s_waitcnt lgkmcnt(0)
s_barrier
ds_read_b64_tr_b16 v[236:237], v253 offset:12288
ds_read_b64_tr_b16 v[238:239], v253 offset:13312
ds_read_b64_tr_b16 v[240:241], v253 offset:14336
ds_read_b64_tr_b16 v[242:243], v253 offset:15360
v_mov_b64 v[160:161], 0
v_mov_b64 v[162:163], 0
v_mov_b64 v[164:165], 0
v_mov_b64 v[166:167], 0
v_mov_b64 v[228:229], 0
v_mov_b64 v[230:231], 0
v_mov_b64 v[232:233], 0
v_mov_b64 v[234:235], 0
s_waitcnt lgkmcnt(0)
v_smfmac_f32_16x16x64_bf16 v[160:163], v[236:239], v[184:191], v246
ds_read_b128 v[184:187], v248 offset:8192
ds_read_b128 v[188:191], v248 offset:9216
v_smfmac_f32_16x16x64_bf16 v[160:163], v[240:243], v[192:199], v246
ds_read_b128 v[192:195], v248 offset:24576
v_smfmac_f32_16x16x64_bf16 v[164:167], v[236:239], v[200:207], v246
ds_read_b128 v[196:199], v248 offset:25600
ds_read_b128 v[200:203], v248 offset:10240
v_smfmac_f32_16x16x64_bf16 v[164:167], v[240:243], v[208:215], v246
ds_read_b128 v[204:207], v248 offset:11264
s_nop 1
v_add_f32 v160, v160, v162
v_smfmac_f32_16x16x64_bf16 v[168:171], v[236:239], v[128:135], v246
ds_read_b128 v[208:211], v248 offset:26624
ds_read_b128 v[212:215], v248 offset:27648
v_add_f32 v161, v161, v163
v_smfmac_f32_16x16x64_bf16 v[168:171], v[240:243], v[136:143], v246
ds_read_b128 v[128:131], v248 offset:12288
v_cvt_pk_bf16_f32 v160, v160, v161
v_smfmac_f32_16x16x64_bf16 v[172:175], v[236:239], v[144:151], v246
ds_read_b128 v[132:135], v248 offset:13312
ds_read_b128 v[136:139], v248 offset:28672
v_add_f32 v164, v164, v166
v_smfmac_f32_16x16x64_bf16 v[172:175], v[240:243], v[152:159], v246
ds_read_b128 v[140:143], v248 offset:29696
v_add_f32 v165, v165, v167
s_waitcnt lgkmcnt(10)
v_smfmac_f32_16x16x64_bf16 v[176:179], v[236:239], v[184:191], v246
ds_read_b128 v[144:147], v248 offset:14336
ds_read_b128 v[148:151], v248 offset:15360
v_cvt_pk_bf16_f32 v161, v164, v165
v_add_f32 v168, v168, v170
s_waitcnt lgkmcnt(10)
v_smfmac_f32_16x16x64_bf16 v[176:179], v[240:243], v[192:199], v246
ds_read_b128 v[152:155], v248 offset:30720
v_add_f32 v169, v169, v171
v_cvt_pk_bf16_f32 v162, v168, v169
s_waitcnt lgkmcnt(9)
v_smfmac_f32_16x16x64_bf16 v[180:183], v[236:239], v[200:207], v246
ds_read_b128 v[156:159], v248 offset:31744
v_add_f32 v172, v172, v174
v_add_f32 v173, v173, v175
s_waitcnt lgkmcnt(8)
v_smfmac_f32_16x16x64_bf16 v[180:183], v[240:243], v[208:215], v246
v_cvt_pk_bf16_f32 v163, v172, v173
v_bfi_b32 v160, 1, s96, v160
s_waitcnt lgkmcnt(6)
v_smfmac_f32_16x16x64_bf16 v[228:231], v[236:239], v[128:135], v246
buffer_store_dwordx4 v[160:163], v250, s[8:11], s25 offen
v_add_f32 v176, v176, v178
s_waitcnt lgkmcnt(4)
v_smfmac_f32_16x16x64_bf16 v[228:231], v[240:243], v[136:143], v246
v_add_f32 v177, v177, v179
v_cvt_pk_bf16_f32 v176, v176, v177
s_waitcnt lgkmcnt(2)
v_smfmac_f32_16x16x64_bf16 v[232:235], v[236:239], v[144:151], v246
v_add_f32 v180, v180, v182
v_add_f32 v181, v181, v183
s_waitcnt lgkmcnt(0)
v_smfmac_f32_16x16x64_bf16 v[232:235], v[240:243], v[152:159], v246
v_cvt_pk_bf16_f32 v177, v180, v181
v_add_f32 v228, v228, v230
v_add_f32 v229, v229, v231
v_cvt_pk_bf16_f32 v178, v228, v229
s_nop 3
v_pk_add_f32 v[232:233], v[232:233], v[234:235]
v_cvt_pk_bf16_f32 v179, v232, v233
v_bfi_b32 v176, 1, s96, v176
buffer_store_dwordx4 v[176:179], v250, s[8:11], s26 offen
v_lshrrev_b32 v216, 9, v247
v_mul_u32_u24 v216, 512, v216
v_add3_u32 v255, v247, v216, s99
ds_read_b128 v[216:219], v255
s_add_u32 s29, s29, 262144
s_add_u32 s30, s30, 262144
s_add_u32 s37, s37, 65536
s_add_u32 s31, s31, 65536
s_add_u32 s22, s22, 1
s_xor_b32 s44, s44, 8192
v_xor_b32 v249, 8192, v249
s_waitcnt vmcnt(0)
s_waitcnt lgkmcnt(0)
s_mov_b32 s36, 200000
buffer_load_dwordx4 v[184:187], v247, s[8:11], s27 offen offset:0 sc1
buffer_load_dwordx4 v[188:191], v247, s[8:11], s27 offen offset:1024 sc1
s_waitcnt vmcnt(0)
v_bitop3_b32 v255, v184, v188, s96 bitop3:0x7e
v_and_b32 v255, 1, v255
v_cmp_ne_u32 vcc, 0, v255
s_cbranch_vccz L_rok0_83
buffer_load_dwordx4 v[184:187], v247, s[8:11], s27 offen offset:0 sc1
buffer_load_dwordx4 v[188:191], v247, s[8:11], s27 offen offset:1024 sc1
L_pl_86:
buffer_load_dwordx4 v[192:195], v247, s[8:11], s27 offen offset:0 sc1
buffer_load_dwordx4 v[196:199], v247, s[8:11], s27 offen offset:1024 sc1
s_waitcnt vmcnt(2)
v_bitop3_b32 v255, v184, v188, s96 bitop3:0x7e
v_and_b32 v255, 1, v255
v_cmp_ne_u32 vcc, 0, v255
s_cbranch_vccz L_rok0_83
buffer_load_dwordx4 v[184:187], v247, s[8:11], s27 offen offset:0 sc1
buffer_load_dwordx4 v[188:191], v247, s[8:11], s27 offen offset:1024 sc1
s_waitcnt vmcnt(2)
v_bitop3_b32 v255, v192, v196, s96 bitop3:0x7e
v_and_b32 v255, 1, v255
v_cmp_ne_u32 vcc, 0, v255
s_cbranch_vccz L_rok1_84
s_sub_u32 s36, s36, 1
s_cmp_lg_u32 s36, 0
s_cbranch_scc1 L_pl_86
s_branch L_abort
L_rok1_84:
v_mfma_f32_16x16x32_bf16 v[220:223], v[192:195], v[216:219], 0
v_mfma_f32_16x16x32_bf16 v[220:223], v[196:199], v[216:219], v[220:223]
s_branch L_rjoin_85
L_rok0_83:
v_mfma_f32_16x16x32_bf16 v[220:223], v[184:187], v[216:219], 0
v_mfma_f32_16x16x32_bf16 v[220:223], v[188:191], v[216:219], v[220:223]
L_rjoin_85:
s_add_u32 s23, s23, 8192
s_and_b32 s23, s23, 0x107fff
s_add_u32 s24, s23, 4096
s_add_u32 s41, s23, 2 * 8192
s_and_b32 s41, s41, 0x107fff
v_mov_b32 v224, -1
s_nop 2
v_permlane32_swap_b32 v220, v222
v_permlane32_swap_b32 v221, v223
v_add_f32 v220, v220, v222
v_add_f32 v221, v221, v223
s_nop 1
v_permlane16_swap_b32 v220, v221
v_add_f32 v220, v220, v221
v_mov_b32 v221, v220
s_nop 1
v_permlane16_swap_b32 v220, v221
v_cvt_pk_bf16_f32 v220, v220, v221
v_min_u32 v220, 0xfffffffe, v220
buffer_store_dword v220, v251, s[8:11], s23 offen
s_xor_b32 s25, s25, 262144
s_xor_b32 s26, s26, 262144
s_xor_b32 s27, s27, 262144
s_bfe_u32 s96, s22, 0x10001
s_cmp_lg_u32 s22, 63
s_cbranch_scc1 L_step_w2f
v_mov_b64 v[160:161], 0
v_mov_b64 v[162:163], 0
v_mov_b64 v[164:165], 0
v_mov_b64 v[166:167], 0
v_mov_b64 v[168:169], 0
v_mov_b64 v[170:171], 0
v_mov_b64 v[172:173], 0
v_mov_b64 v[174:175], 0
v_mov_b64 v[176:177], 0
v_mov_b64 v[178:179], 0
v_mov_b64 v[180:181], 0
v_mov_b64 v[182:183], 0
s_mov_b32 s36, 200000
L_lpoll_87:
buffer_load_dwordx4 v[128:131], v247, s[8:11], s23 offen offset:0 sc1
buffer_load_dwordx4 v[132:135], v247, s[8:11], s23 offen offset:1024 sc1
buffer_load_dwordx4 v[136:139], v247, s[8:11], s23 offen offset:2048 sc1
buffer_load_dwordx4 v[140:143], v247, s[8:11], s23 offen offset:3072 sc1
buffer_load_dwordx4 v[144:147], v247, s[8:11], s24 offen offset:0 sc1
buffer_load_dwordx4 v[148:151], v247, s[8:11], s24 offen offset:1024 sc1
buffer_load_dwordx4 v[152:155], v247, s[8:11], s24 offen offset:2048 sc1
buffer_load_dwordx4 v[156:159], v247, s[8:11], s24 offen offset:3072 sc1
s_waitcnt vmcnt(0)
v_max3_u32 v255, v128, v129, v130
v_max3_u32 v255, v255, v131, v132
v_max3_u32 v255, v255, v133, v134
v_max3_u32 v255, v255, v135, v136
v_max3_u32 v255, v255, v137, v138
v_max3_u32 v255, v255, v139, v140
v_max3_u32 v255, v255, v141, v142
v_max3_u32 v255, v255, v143, v144
v_max3_u32 v255, v255, v145, v146
v_max3_u32 v255, v255, v147, v148
v_max3_u32 v255, v255, v149, v150
v_max3_u32 v255, v255, v151, v152
v_max3_u32 v255, v255, v153, v154
v_max3_u32 v255, v255, v155, v156
v_max3_u32 v255, v255, v157, v158
v_max_u32 v255, v255, v159
v_cmp_eq_u32 vcc, -1, v255
s_cbranch_vccnz L_lretry_88
v_smfmac_f32_16x16x64_bf16 v[164:167], v[128:131], a[128:135], v246
v_smfmac_f32_16x16x64_bf16 v[172:175], v[128:131], a[192:199], v246
v_smfmac_f32_16x16x64_bf16 v[176:179], v[128:131], v[0:7], v246
v_smfmac_f32_16x16x64_bf16 v[180:183], v[128:131], v[64:71], v246
v_smfmac_f32_16x16x64_bf16 v[164:167], v[132:135], a[136:143], v246
v_smfmac_f32_16x16x64_bf16 v[172:175], v[132:135], a[200:207], v246
v_smfmac_f32_16x16x64_bf16 v[176:179], v[132:135], v[8:15], v246
v_smfmac_f32_16x16x64_bf16 v[180:183], v[132:135], v[72:79], v246
v_smfmac_f32_16x16x64_bf16 v[164:167], v[136:139], a[144:151], v246
v_smfmac_f32_16x16x64_bf16 v[172:175], v[136:139], a[208:215], v246
v_smfmac_f32_16x16x64_bf16 v[176:179], v[136:139], v[16:23], v246
v_smfmac_f32_16x16x64_bf16 v[180:183], v[136:139], v[80:87], v246
v_smfmac_f32_16x16x64_bf16 v[164:167], v[140:143], a[152:159], v246
v_smfmac_f32_16x16x64_bf16 v[172:175], v[140:143], a[216:223], v246
v_smfmac_f32_16x16x64_bf16 v[176:179], v[140:143], v[24:31], v246
v_smfmac_f32_16x16x64_bf16 v[180:183], v[140:143], v[88:95], v246
v_smfmac_f32_16x16x64_bf16 v[164:167], v[144:147], a[160:167], v246
v_smfmac_f32_16x16x64_bf16 v[172:175], v[144:147], a[224:231], v246
v_smfmac_f32_16x16x64_bf16 v[176:179], v[144:147], v[32:39], v246
v_smfmac_f32_16x16x64_bf16 v[180:183], v[144:147], v[96:103], v246
v_smfmac_f32_16x16x64_bf16 v[164:167], v[148:151], a[168:175], v246
v_smfmac_f32_16x16x64_bf16 v[172:175], v[148:151], a[232:239], v246
v_smfmac_f32_16x16x64_bf16 v[176:179], v[148:151], v[40:47], v246
v_smfmac_f32_16x16x64_bf16 v[180:183], v[148:151], v[104:111], v246
v_smfmac_f32_16x16x64_bf16 v[164:167], v[152:155], a[176:183], v246
v_smfmac_f32_16x16x64_bf16 v[172:175], v[152:155], a[240:247], v246
v_smfmac_f32_16x16x64_bf16 v[176:179], v[152:155], v[48:55], v246
v_smfmac_f32_16x16x64_bf16 v[180:183], v[152:155], v[112:119], v246
v_smfmac_f32_16x16x64_bf16 v[164:167], v[156:159], a[184:191], v246
v_smfmac_f32_16x16x64_bf16 v[172:175], v[156:159], a[248:255], v246
v_smfmac_f32_16x16x64_bf16 v[176:179], v[156:159], v[56:63], v246
v_smfmac_f32_16x16x64_bf16 v[180:183], v[156:159], v[120:127], v246
v_add_f32 v160, v160, v162
v_add_f32 v161, v161, v163
s_nop 2
v_add_f32 v164, v164, v166
v_add_f32 v165, v165, v167
v_cvt_pk_bf16_f32 v163, v160, v161
v_cvt_pk_bf16_f32 v162, v164, v165
ds_write_b64 v252, v[162:163] offset:0
v_add_f32 v168, v168, v170
v_add_f32 v169, v169, v171
v_add_f32 v172, v172, v174
v_add_f32 v173, v173, v175
v_cvt_pk_bf16_f32 v171, v168, v169
v_cvt_pk_bf16_f32 v170, v172, v173
ds_write_b64 v252, v[170:171] offset:512
v_add_f32 v176, v176, v178
v_add_f32 v177, v177, v179
v_add_f32 v180, v180, v182
v_add_f32 v181, v181, v183
v_cvt_pk_bf16_f32 v240, v176, v177
v_cvt_pk_bf16_f32 v242, v180, v181
v_lshrrev_b32 v255, 2, v247
buffer_store_dword v240, v255, s[8:11], s37 offen sc1
buffer_store_dword v242, v255, s[8:11], s37 offen offset:256 sc1
s_waitcnt lgkmcnt(0)
s_barrier
ds_read_b64_tr_b16 v[184:185], v253 offset:2048
ds_read_b64_tr_b16 v[186:187], v253 offset:2560
s_waitcnt lgkmcnt(0)
buffer_store_dwordx4 v[184:187], v254, s[8:11], s31 offen offset:1024 sc1
s_waitcnt vmcnt(0)
s_barrier
L_done_w2f:
s_waitcnt vmcnt(0) lgkmcnt(0)
s_branch L_end_89
L_lretry_88:
s_sub_u32 s36, s36, 1
s_cmp_lg_u32 s36, 0
s_cbranch_scc1 L_lpoll_87
s_branch L_abort
L_hz_79:
s_cmp_ge_u32 s97, 64
s_cbranch_scc1 L_hzb_80
s_add_u32 s43, s22, 1
s_cmp_ge_u32 s43, s97
s_cbranch_scc1 L_hzblk_90
buffer_load_dwordx4 v[236:239], v244, s[8:11], s98 offen offset:16 sc1
buffer_load_dwordx4 v[240:243], v244, s[8:11], s98 offen offset:32 sc1
s_mov_b32 s42, 1
s_branch L_hzb_80
L_hzblk_90:
s_cmp_ge_u32 s43, 64
s_cbranch_scc1 L_hx_92
s_mov_b32 s36, 200000
L_hq_91:
buffer_load_dwordx4 v[216:219], v244, s[8:11], s98 offen offset:16 sc1
buffer_load_dwordx4 v[220:223], v244, s[8:11], s98 offen offset:32 sc1
s_sub_u32 s36, s36, 1
s_cmp_eq_u32 s36, 0
s_cbranch_scc1 L_abort
s_waitcnt vmcnt(0)
L_he_93:
v_cmp_eq_u32 vcc, s46, v217
s_nop 1
v_cndmask_b32 v216, 0, v216, vcc
v_cmp_eq_u32 vcc, s46, v219
s_nop 1
v_cndmask_b32 v218, 0, v218, vcc
v_cmp_eq_u32 vcc, s46, v221
s_nop 1
v_cndmask_b32 v220, 0, v220, vcc
v_cmp_eq_u32 vcc, s46, v223
s_nop 1
v_cndmask_b32 v222, 0, v222, vcc
v_min_u32 v216, v216, v220
v_min_u32 v217, v218, v222
v_lshlrev_b32 v216, 1, v216
v_lshl_add_u32 v217, v217, 1, 1
v_min_u32 v216, v216, v217
s_nop 0
v_readfirstlane_b32 s97, v216
s_cmp_ge_u32 s97, 64
s_cselect_b32 s97, 1000, s97
s_cmp_lt_u32 s43, s97
s_cbranch_scc0 L_hq_91
L_hx_92:
s_branch L_hzb_80
L_hze_81:
s_mov_b32 s42, 0
s_waitcnt vmcnt(3)
v_cmp_eq_u32 vcc, s46, v237
s_nop 1
v_cndmask_b32 v236, 0, v236, vcc
v_cmp_eq_u32 vcc, s46, v239
s_nop 1
v_cndmask_b32 v238, 0, v238, vcc
v_cmp_eq_u32 vcc, s46, v241
s_nop 1
v_cndmask_b32 v240, 0, v240, vcc
v_cmp_eq_u32 vcc, s46, v243
s_nop 1
v_cndmask_b32 v242, 0, v242, vcc
v_min_u32 v236, v236, v240
v_min_u32 v237, v238, v242
v_lshlrev_b32 v236, 1, v236
v_lshl_add_u32 v237, v237, 1, 1
v_min_u32 v236, v236, v237
s_nop 0
v_readfirstlane_b32 s97, v236
s_cmp_ge_u32 s97, 64
s_cselect_b32 s97, 1000, s97
v_mov_b32 v241, 0
v_mov_b32 v243, 0
s_branch L_hzf_82
L_end_89:
s_endpgm
L_wave3:
v_lshrrev_b32 v128, 4, v255
v_and_b32 v129, 15, v255
v_and_b32 v130, 1, v128
v_add_u32 v130, 4, v130
v_lshlrev_b32 v130, 1, v130
v_xor_b32 v130, v130, v129
v_lshlrev_b32 v130, 4, v130
s_lshl_b32 s38, s21, 8
v_lshl_add_u32 v131, v128, 13, v130
v_add_u32 v136, s38, v131
s_lshl_b32 s38, s21, 17
v_lshl_add_u32 v131, v128, 10, v130
v_add_u32 v138, s38, v131
v_and_b32 v130, 1, v128
v_add_u32 v130, 6, v130
v_lshlrev_b32 v130, 1, v130
v_xor_b32 v130, v130, v129
v_lshlrev_b32 v130, 4, v130
s_lshl_b32 s38, s21, 8
v_lshl_add_u32 v131, v128, 13, v130
v_add_u32 v137, s38, v131
s_lshl_b32 s38, s21, 17
v_lshl_add_u32 v131, v128, 10, v130
v_add_u32 v139, s38, v131
s_mov_b32 s12, s50
s_mov_b32 s13, s51
s_mov_b32 s14, 0x400000
s_mov_b32 m0, 24576
s_mov_b32 s38, 0xc0000
buffer_load_dwordx4 v136, s[12:15], s38 offen  lds
s_mov_b32 m0, 25600
s_mov_b32 s38, 0xc8000
buffer_load_dwordx4 v136, s[12:15], s38 offen  lds
s_mov_b32 m0, 26624
s_mov_b32 s38, 0xd0000
buffer_load_dwordx4 v136, s[12:15], s38 offen  lds
s_mov_b32 m0, 27648
s_mov_b32 s38, 0xd8000
buffer_load_dwordx4 v136, s[12:15], s38 offen  lds
s_mov_b32 m0, 28672
s_mov_b32 s38, 0xe0000
buffer_load_dwordx4 v137, s[12:15], s38 offen  lds
s_mov_b32 m0, 29696
s_mov_b32 s38, 0xe8000
buffer_load_dwordx4 v137, s[12:15], s38 offen  lds
s_mov_b32 m0, 30720
s_mov_b32 s38, 0xf0000
buffer_load_dwordx4 v137, s[12:15], s38 offen  lds
s_mov_b32 m0, 31744
s_mov_b32 s38, 0xf8000
buffer_load_dwordx4 v137, s[12:15], s38 offen  lds
s_mov_b32 m0, 57344
s_mov_b32 s38, 0x1c0000
buffer_load_dwordx4 v136, s[12:15], s38 offen  lds
s_mov_b32 m0, 58368
s_mov_b32 s38, 0x1c8000
buffer_load_dwordx4 v136, s[12:15], s38 offen  lds
s_mov_b32 m0, 59392
s_mov_b32 s38, 0x1d0000
buffer_load_dwordx4 v136, s[12:15], s38 offen  lds
s_mov_b32 m0, 60416
s_mov_b32 s38, 0x1d8000
buffer_load_dwordx4 v136, s[12:15], s38 offen  lds
s_mov_b32 m0, 61440
s_mov_b32 s38, 0x1e0000
buffer_load_dwordx4 v137, s[12:15], s38 offen  lds
s_mov_b32 m0, 62464
s_mov_b32 s38, 0x1e8000
buffer_load_dwordx4 v137, s[12:15], s38 offen  lds
s_mov_b32 m0, 63488
s_mov_b32 s38, 0x1f0000
buffer_load_dwordx4 v137, s[12:15], s38 offen  lds
s_mov_b32 m0, 64512
s_mov_b32 s38, 0x1f8000
buffer_load_dwordx4 v137, s[12:15], s38 offen  lds
s_mov_b32 m0, 90112
s_mov_b32 s38, 0x2c0000
buffer_load_dwordx4 v136, s[12:15], s38 offen  lds
s_mov_b32 m0, 91136
s_mov_b32 s38, 0x2c8000
buffer_load_dwordx4 v136, s[12:15], s38 offen  lds
s_mov_b32 m0, 92160
s_mov_b32 s38, 0x2d0000
buffer_load_dwordx4 v136, s[12:15], s38 offen  lds
s_mov_b32 m0, 93184
s_mov_b32 s38, 0x2d8000
buffer_load_dwordx4 v136, s[12:15], s38 offen  lds
s_mov_b32 m0, 94208
s_mov_b32 s38, 0x2e0000
buffer_load_dwordx4 v137, s[12:15], s38 offen  lds
s_mov_b32 m0, 95232
s_mov_b32 s38, 0x2e8000
buffer_load_dwordx4 v137, s[12:15], s38 offen  lds
s_mov_b32 m0, 96256
s_mov_b32 s38, 0x2f0000
buffer_load_dwordx4 v137, s[12:15], s38 offen  lds
s_mov_b32 m0, 97280
s_mov_b32 s38, 0x2f8000
buffer_load_dwordx4 v137, s[12:15], s38 offen  lds
s_mov_b32 m0, 122880
s_mov_b32 s38, 0x3c0000
buffer_load_dwordx4 v136, s[12:15], s38 offen  lds
s_mov_b32 m0, 123904
s_mov_b32 s38, 0x3c8000
buffer_load_dwordx4 v136, s[12:15], s38 offen  lds
s_mov_b32 m0, 124928
s_mov_b32 s38, 0x3d0000
buffer_load_dwordx4 v136, s[12:15], s38 offen  lds
s_mov_b32 m0, 125952
s_mov_b32 s38, 0x3d8000
buffer_load_dwordx4 v136, s[12:15], s38 offen  lds
s_mov_b32 m0, 126976
s_mov_b32 s38, 0x3e0000
buffer_load_dwordx4 v137, s[12:15], s38 offen  lds
s_mov_b32 m0, 128000
s_mov_b32 s38, 0x3e8000
buffer_load_dwordx4 v137, s[12:15], s38 offen  lds
s_mov_b32 m0, 129024
s_mov_b32 s38, 0x3f0000
buffer_load_dwordx4 v137, s[12:15], s38 offen  lds
s_mov_b32 m0, 130048
s_mov_b32 s38, 0x3f8000
buffer_load_dwordx4 v137, s[12:15], s38 offen  lds
v_lshlrev_b32 v247, 4, v255
v_add_u32 v248, 98304, v247
v_add_u32 v249, 131072, v247
v_and_b32 v128, 15, v255
v_lshrrev_b32 v129, 4, v255
v_mov_b32 v246, 0x4444
v_mov_b32 v130, 0xeeee
v_and_b32 v131, 2, v128
v_cmp_ne_u32 vcc, 0, v131
s_nop 1
v_cndmask_b32 v246, v246, v130, vcc
v_lshlrev_b32 v130, 13, v129
v_lshrrev_b32 v131, 2, v128
v_lshl_add_u32 v130, v131, 11, v130
v_mov_b32 v131, s21
v_lshl_add_u32 v130, v131, 6, v130
v_and_b32 v131, 3, v128
v_lshl_add_u32 v250, v131, 4, v130
v_lshrrev_b32 v130, 2, v128
v_xor_b32 v130, v130, v129
v_lshlrev_b32 v130, 3, v130
v_lshl_add_u32 v130, v128, 5, v130
v_add_u32 v252, 150528, v130
v_lshrrev_b32 v130, 2, v128
v_lshl_add_u32 v130, v129, 2, v130
v_and_b32 v131, 3, v128
v_xor_b32 v131, v131, v129
v_lshlrev_b32 v131, 3, v131
v_lshl_add_u32 v130, v130, 5, v131
v_add_u32 v253, 147456, v130
v_lshrrev_b32 v130, 2, v128
v_and_b32 v131, 1, v128
v_lshl_add_u32 v130, v130, 1, v131
v_lshl_add_u32 v130, v129, 3, v130
v_lshlrev_b32 v130, 4, v130
v_mov_b32 v132, 0x40000000
v_and_b32 v131, 2, v128
v_cmp_ne_u32 vcc, 0, v131
s_nop 1
v_cndmask_b32 v254, v130, v132, vcc
s_lshr_b32 s38, s21, 3
s_bfe_u32 s39, s21, 0x10002
s_lshl_b32 s39, s39, 2
s_add_u32 s38, s38, s39
s_lshl_b32 s38, s38, 10
s_and_b32 s39, s21, 3
s_lshl_b32 s39, s39, 6
s_add_u32 s38, s38, s39
s_add_u32 s38, s38, 768
v_and_b32 v130, 3, v128
v_lshlrev_b32 v130, 4, v130
v_lshrrev_b32 v131, 2, v128
v_lshl_add_u32 v130, v131, 3, v130
v_lshrrev_b32 v131, 1, v129
v_lshl_add_u32 v130, v131, 2, v130
v_add_u32 v130, s38, v130
v_and_b32 v131, 24, v255
v_mov_b32 v251, 0x40000000
v_cmp_eq_u32 vcc, 0, v131
s_nop 1
v_cndmask_b32 v251, v251, v130, vcc
v_lshrrev_b32 v128, 4, v255
v_bfe_u32 v129, v255, 2, 2
v_and_b32 v130, 3, v255
v_and_b32 v131, 1, v128
v_lshl_add_u32 v134, v131, 2, v129
v_lshlrev_b32 v132, 5, v131
v_lshrrev_b32 v131, 1, v128
v_lshl_add_u32 v132, v131, 2, v132
v_and_b32 v131, 1, v129
v_add_u32 v132, v131, v132
v_lshrrev_b32 v131, 1, v129
v_lshl_add_u32 v132, v131, 4, v132
v_lshlrev_b32 v132, 8, v132
v_lshrrev_b32 v131, 1, v130
v_lshl_add_u32 v132, v131, 4, v132
v_and_b32 v131, 1, v130
v_lshl_add_u32 v132, v131, 3, v132
v_xor_b32 v131, 6, v134
v_lshl_add_u32 v140, v131, 5, v132
v_xor_b32 v131, 7, v134
v_lshl_add_u32 v141, v131, 5, v132
v_xor_b32 v131, 0, v134
v_lshl_add_u32 v148, v131, 5, v132
v_add_u32 v148, 98304, v148
v_xor_b32 v131, 1, v134
v_lshl_add_u32 v149, v131, 5, v132
v_add_u32 v149, 98304, v149
v_xor_b32 v131, 2, v134
v_lshl_add_u32 v150, v131, 5, v132
v_add_u32 v150, 98304, v150
v_xor_b32 v131, 3, v134
v_lshl_add_u32 v151, v131, 5, v132
v_add_u32 v151, 98304, v151
v_xor_b32 v131, 4, v134
v_lshl_add_u32 v152, v131, 5, v132
v_add_u32 v152, 98304, v152
v_xor_b32 v131, 5, v134
v_lshl_add_u32 v153, v131, 5, v132
v_add_u32 v153, 98304, v153
v_xor_b32 v131, 6, v134
v_lshl_add_u32 v154, v131, 5, v132
v_add_u32 v154, 98304, v154
v_xor_b32 v131, 7, v134
v_lshl_add_u32 v155, v131, 5, v132
v_add_u32 v155, 98304, v155
s_waitcnt vmcnt(24)
s_barrier
v_add_u32 v142, 0, v140
v_add_u32 v143, 0, v141
ds_read_b64_tr_b16 a[0:1], v142 offset:0
ds_read_b64_tr_b16 a[2:3], v142 offset:512
ds_read_b64_tr_b16 a[4:5], v142 offset:2048
ds_read_b64_tr_b16 a[6:7], v142 offset:2560
ds_read_b64_tr_b16 a[64:65], v143 offset:0
ds_read_b64_tr_b16 a[66:67], v143 offset:512
ds_read_b64_tr_b16 a[68:69], v143 offset:2048
ds_read_b64_tr_b16 a[70:71], v143 offset:2560
ds_read_b64_tr_b16 a[32:33], v142 offset:16384
ds_read_b64_tr_b16 a[34:35], v142 offset:16896
ds_read_b64_tr_b16 a[36:37], v142 offset:18432
ds_read_b64_tr_b16 a[38:39], v142 offset:18944
ds_read_b64_tr_b16 a[96:97], v143 offset:16384
ds_read_b64_tr_b16 a[98:99], v143 offset:16896
ds_read_b64_tr_b16 a[100:101], v143 offset:18432
ds_read_b64_tr_b16 a[102:103], v143 offset:18944
s_waitcnt lgkmcnt(0)
s_barrier
s_mov_b32 s12, s52
s_mov_b32 s13, s53
s_mov_b32 s14, 0x400000
s_mov_b32 m0, 24576
s_mov_b32 s38, 0xc0000
buffer_load_dwordx4 v136, s[12:15], s38 offen  lds
s_mov_b32 m0, 25600
s_mov_b32 s38, 0xc8000
buffer_load_dwordx4 v136, s[12:15], s38 offen  lds
s_mov_b32 m0, 26624
s_mov_b32 s38, 0xd0000
buffer_load_dwordx4 v136, s[12:15], s38 offen  lds
s_mov_b32 m0, 27648
s_mov_b32 s38, 0xd8000
buffer_load_dwordx4 v136, s[12:15], s38 offen  lds
s_mov_b32 m0, 28672
s_mov_b32 s38, 0xe0000
buffer_load_dwordx4 v137, s[12:15], s38 offen  lds
s_mov_b32 m0, 29696
s_mov_b32 s38, 0xe8000
buffer_load_dwordx4 v137, s[12:15], s38 offen  lds
s_mov_b32 m0, 30720
s_mov_b32 s38, 0xf0000
buffer_load_dwordx4 v137, s[12:15], s38 offen  lds
s_mov_b32 m0, 31744
s_mov_b32 s38, 0xf8000
buffer_load_dwordx4 v137, s[12:15], s38 offen  lds
s_waitcnt vmcnt(24)
s_barrier
v_add_u32 v142, 32768, v140
v_add_u32 v143, 32768, v141
ds_read_b64_tr_b16 a[8:9], v142 offset:0
ds_read_b64_tr_b16 a[10:11], v142 offset:512
ds_read_b64_tr_b16 a[12:13], v142 offset:2048
ds_read_b64_tr_b16 a[14:15], v142 offset:2560
ds_read_b64_tr_b16 a[72:73], v143 offset:0
ds_read_b64_tr_b16 a[74:75], v143 offset:512
ds_read_b64_tr_b16 a[76:77], v143 offset:2048
ds_read_b64_tr_b16 a[78:79], v143 offset:2560
ds_read_b64_tr_b16 a[40:41], v142 offset:16384
ds_read_b64_tr_b16 a[42:43], v142 offset:16896
ds_read_b64_tr_b16 a[44:45], v142 offset:18432
ds_read_b64_tr_b16 a[46:47], v142 offset:18944
ds_read_b64_tr_b16 a[104:105], v143 offset:16384
ds_read_b64_tr_b16 a[106:107], v143 offset:16896
ds_read_b64_tr_b16 a[108:109], v143 offset:18432
ds_read_b64_tr_b16 a[110:111], v143 offset:18944
s_waitcnt lgkmcnt(0)
s_barrier
v_mov_b32 v236, 0
buffer_load_dwordx4 v[224:227], v236, s[16:19], 0 offen sc1
buffer_load_dwordx4 v[228:231], v236, s[16:19], 0 offen offset:16 sc1
buffer_load_dwordx2 v[232:233], v236, s[16:19], 0 offen offset:128 sc1
v_and_b32 v200, 15, v255
v_lshrrev_b32 v201, 4, v255
s_and_b32 s39, s21, 3
s_lshl_b32 s39, s39, 11
s_lshr_b32 s40, s21, 2
s_lshl_b32 s40, s40, 7
s_add_u32 s39, s39, s40
s_add_u32 s39, s39, 24
v_and_b32 v202, 1, v200
v_lshlrev_b32 v202, 10, v202
v_bfe_u32 v203, v200, 1, 2
v_lshl_add_u32 v202, v203, 5, v202
v_lshrrev_b32 v203, 1, v201
v_lshl_add_u32 v202, v203, 2, v202
v_add_u32 v202, s39, v202
s_mov_b32 s4, s48
s_mov_b32 s5, s49
s_mov_b32 s6, 8192
s_mov_b32 s7, 0x00020000
buffer_load_dword v204, v202, s[4:7], 0 offen
s_mov_b32 m0, 57344
s_mov_b32 s38, 0x1c0000
buffer_load_dwordx4 v136, s[12:15], s38 offen  lds
s_mov_b32 m0, 58368
s_mov_b32 s38, 0x1c8000
buffer_load_dwordx4 v136, s[12:15], s38 offen  lds
s_mov_b32 m0, 59392
s_mov_b32 s38, 0x1d0000
buffer_load_dwordx4 v136, s[12:15], s38 offen  lds
s_mov_b32 m0, 60416
s_mov_b32 s38, 0x1d8000
buffer_load_dwordx4 v136, s[12:15], s38 offen  lds
s_mov_b32 m0, 61440
s_mov_b32 s38, 0x1e0000
buffer_load_dwordx4 v137, s[12:15], s38 offen  lds
s_mov_b32 m0, 62464
s_mov_b32 s38, 0x1e8000
buffer_load_dwordx4 v137, s[12:15], s38 offen  lds
s_mov_b32 m0, 63488
s_mov_b32 s38, 0x1f0000
buffer_load_dwordx4 v137, s[12:15], s38 offen  lds
s_mov_b32 m0, 64512
s_mov_b32 s38, 0x1f8000
buffer_load_dwordx4 v137, s[12:15], s38 offen  lds
s_waitcnt vmcnt(24)
s_barrier
v_add_u32 v142, 65536, v140
v_add_u32 v143, 65536, v141
ds_read_b64_tr_b16 a[16:17], v142 offset:0
ds_read_b64_tr_b16 a[18:19], v142 offset:512
ds_read_b64_tr_b16 a[20:21], v142 offset:2048
ds_read_b64_tr_b16 a[22:23], v142 offset:2560
ds_read_b64_tr_b16 a[80:81], v143 offset:0
ds_read_b64_tr_b16 a[82:83], v143 offset:512
ds_read_b64_tr_b16 a[84:85], v143 offset:2048
ds_read_b64_tr_b16 a[86:87], v143 offset:2560
ds_read_b64_tr_b16 a[48:49], v142 offset:16384
ds_read_b64_tr_b16 a[50:51], v142 offset:16896
ds_read_b64_tr_b16 a[52:53], v142 offset:18432
ds_read_b64_tr_b16 a[54:55], v142 offset:18944
ds_read_b64_tr_b16 a[112:113], v143 offset:16384
ds_read_b64_tr_b16 a[114:115], v143 offset:16896
ds_read_b64_tr_b16 a[116:117], v143 offset:18432
ds_read_b64_tr_b16 a[118:119], v143 offset:18944
s_waitcnt lgkmcnt(0)
s_barrier
s_mov_b32 m0, 90112
s_mov_b32 s38, 0x2c0000
buffer_load_dwordx4 v136, s[12:15], s38 offen  lds
s_mov_b32 m0, 91136
s_mov_b32 s38, 0x2c8000
buffer_load_dwordx4 v136, s[12:15], s38 offen  lds
s_mov_b32 m0, 92160
s_mov_b32 s38, 0x2d0000
buffer_load_dwordx4 v136, s[12:15], s38 offen  lds
s_mov_b32 m0, 93184
s_mov_b32 s38, 0x2d8000
buffer_load_dwordx4 v136, s[12:15], s38 offen  lds
s_mov_b32 m0, 94208
s_mov_b32 s38, 0x2e0000
buffer_load_dwordx4 v137, s[12:15], s38 offen  lds
s_mov_b32 m0, 95232
s_mov_b32 s38, 0x2e8000
buffer_load_dwordx4 v137, s[12:15], s38 offen  lds
s_mov_b32 m0, 96256
s_mov_b32 s38, 0x2f0000
buffer_load_dwordx4 v137, s[12:15], s38 offen  lds
s_mov_b32 m0, 97280
s_mov_b32 s38, 0x2f8000
buffer_load_dwordx4 v137, s[12:15], s38 offen  lds
s_waitcnt vmcnt(24)
s_barrier
v_add_u32 v142, 98304, v140
v_add_u32 v143, 98304, v141
ds_read_b64_tr_b16 a[24:25], v142 offset:0
ds_read_b64_tr_b16 a[26:27], v142 offset:512
ds_read_b64_tr_b16 a[28:29], v142 offset:2048
ds_read_b64_tr_b16 a[30:31], v142 offset:2560
ds_read_b64_tr_b16 a[88:89], v143 offset:0
ds_read_b64_tr_b16 a[90:91], v143 offset:512
ds_read_b64_tr_b16 a[92:93], v143 offset:2048
ds_read_b64_tr_b16 a[94:95], v143 offset:2560
ds_read_b64_tr_b16 a[56:57], v142 offset:16384
ds_read_b64_tr_b16 a[58:59], v142 offset:16896
ds_read_b64_tr_b16 a[60:61], v142 offset:18432
ds_read_b64_tr_b16 a[62:63], v142 offset:18944
ds_read_b64_tr_b16 a[120:121], v143 offset:16384
ds_read_b64_tr_b16 a[122:123], v143 offset:16896
ds_read_b64_tr_b16 a[124:125], v143 offset:18432
ds_read_b64_tr_b16 a[126:127], v143 offset:18944
s_waitcnt lgkmcnt(0)
s_barrier
s_mov_b32 m0, 122880
s_mov_b32 s38, 0x3c0000
buffer_load_dwordx4 v136, s[12:15], s38 offen  lds
s_mov_b32 m0, 123904
s_mov_b32 s38, 0x3c8000
buffer_load_dwordx4 v136, s[12:15], s38 offen  lds
s_mov_b32 m0, 124928
s_mov_b32 s38, 0x3d0000
buffer_load_dwordx4 v136, s[12:15], s38 offen  lds
s_mov_b32 m0, 125952
s_mov_b32 s38, 0x3d8000
buffer_load_dwordx4 v136, s[12:15], s38 offen  lds
s_mov_b32 m0, 126976
s_mov_b32 s38, 0x3e0000
buffer_load_dwordx4 v137, s[12:15], s38 offen  lds
s_mov_b32 m0, 128000
s_mov_b32 s38, 0x3e8000
buffer_load_dwordx4 v137, s[12:15], s38 offen  lds
s_mov_b32 m0, 129024
s_mov_b32 s38, 0x3f0000
buffer_load_dwordx4 v137, s[12:15], s38 offen  lds
s_mov_b32 m0, 130048
s_mov_b32 s38, 0x3f8000
buffer_load_dwordx4 v137, s[12:15], s38 offen  lds
s_waitcnt vmcnt(24)
s_barrier
v_add_u32 v142, 0, v140
v_add_u32 v143, 0, v141
ds_read_b64_tr_b16 a[128:129], v142 offset:0
ds_read_b64_tr_b16 a[130:131], v142 offset:512
ds_read_b64_tr_b16 a[132:133], v142 offset:2048
ds_read_b64_tr_b16 a[134:135], v142 offset:2560
ds_read_b64_tr_b16 a[192:193], v143 offset:0
ds_read_b64_tr_b16 a[194:195], v143 offset:512
ds_read_b64_tr_b16 a[196:197], v143 offset:2048
ds_read_b64_tr_b16 a[198:199], v143 offset:2560
ds_read_b64_tr_b16 a[160:161], v142 offset:16384
ds_read_b64_tr_b16 a[162:163], v142 offset:16896
ds_read_b64_tr_b16 a[164:165], v142 offset:18432
ds_read_b64_tr_b16 a[166:167], v142 offset:18944
ds_read_b64_tr_b16 a[224:225], v143 offset:16384
ds_read_b64_tr_b16 a[226:227], v143 offset:16896
ds_read_b64_tr_b16 a[228:229], v143 offset:18432
ds_read_b64_tr_b16 a[230:231], v143 offset:18944
s_waitcnt lgkmcnt(0)
s_barrier
s_mov_b32 s12, s54
s_mov_b32 s13, s55
s_mov_b32 s14, 0x400000
s_mov_b32 m0, 24576
s_mov_b32 s38, 0xc0000
buffer_load_dwordx4 v136, s[12:15], s38 offen  lds
s_mov_b32 m0, 25600
s_mov_b32 s38, 0xc8000
buffer_load_dwordx4 v136, s[12:15], s38 offen  lds
s_mov_b32 m0, 26624
s_mov_b32 s38, 0xd0000
buffer_load_dwordx4 v136, s[12:15], s38 offen  lds
s_mov_b32 m0, 27648
s_mov_b32 s38, 0xd8000
buffer_load_dwordx4 v136, s[12:15], s38 offen  lds
s_mov_b32 m0, 28672
s_mov_b32 s38, 0xe0000
buffer_load_dwordx4 v137, s[12:15], s38 offen  lds
s_mov_b32 m0, 29696
s_mov_b32 s38, 0xe8000
buffer_load_dwordx4 v137, s[12:15], s38 offen  lds
s_mov_b32 m0, 30720
s_mov_b32 s38, 0xf0000
buffer_load_dwordx4 v137, s[12:15], s38 offen  lds
s_mov_b32 m0, 31744
s_mov_b32 s38, 0xf8000
buffer_load_dwordx4 v137, s[12:15], s38 offen  lds
s_waitcnt vmcnt(24)
s_barrier
v_add_u32 v142, 32768, v140
v_add_u32 v143, 32768, v141
ds_read_b64_tr_b16 a[136:137], v142 offset:0
ds_read_b64_tr_b16 a[138:139], v142 offset:512
ds_read_b64_tr_b16 a[140:141], v142 offset:2048
ds_read_b64_tr_b16 a[142:143], v142 offset:2560
ds_read_b64_tr_b16 a[200:201], v143 offset:0
ds_read_b64_tr_b16 a[202:203], v143 offset:512
ds_read_b64_tr_b16 a[204:205], v143 offset:2048
ds_read_b64_tr_b16 a[206:207], v143 offset:2560
ds_read_b64_tr_b16 a[168:169], v142 offset:16384
ds_read_b64_tr_b16 a[170:171], v142 offset:16896
ds_read_b64_tr_b16 a[172:173], v142 offset:18432
ds_read_b64_tr_b16 a[174:175], v142 offset:18944
ds_read_b64_tr_b16 a[232:233], v143 offset:16384
ds_read_b64_tr_b16 a[234:235], v143 offset:16896
ds_read_b64_tr_b16 a[236:237], v143 offset:18432
ds_read_b64_tr_b16 a[238:239], v143 offset:18944
s_waitcnt lgkmcnt(0)
s_barrier
s_cmp_lg_u32 s32, 0
s_cbranch_scc1 L_vfx_96
s_mov_b32 s36, 200000
s_branch L_vfe_95
L_vf_94:
v_mov_b32 v236, 0
buffer_load_dwordx4 v[224:227], v236, s[16:19], 0 offen sc1
buffer_load_dwordx4 v[228:231], v236, s[16:19], 0 offen offset:16 sc1
buffer_load_dwordx2 v[232:233], v236, s[16:19], 0 offen offset:128 sc1
s_sub_u32 s36, s36, 1
s_cmp_eq_u32 s36, 0
s_cbranch_scc1 L_abort
s_waitcnt vmcnt(0)
L_vfe_95:
v_add3_u32 v234, v225, v226, v227
v_add3_u32 v234, v234, v228, v229
v_add3_u32 v234, v234, v230, v231
v_add_u32 v234, v234, v232
v_max3_u32 v235, v225, v226, v227
v_max3_u32 v235, v235, v228, v229
v_max3_u32 v235, v235, v230, v231
v_max_u32 v235, v235, v232
v_cmp_lt_u32 vcc, 0x100, v234
s_cbranch_vccnz L_abort
v_cmp_ne_u32 vcc, 0x100, v234
s_cbranch_vccnz L_vf_94
v_cmp_eq_u32 vcc, 0, v233
s_cbranch_vccnz L_vf_94
v_readfirstlane_b32 s46, v233
v_readfirstlane_b32 s36, v235
s_cmp_lg_u32 s36, 32
s_cbranch_scc1 L_slow
L_vfx_96:
s_cmp_lg_u32 s32, 0
s_cbranch_scc1 L_inis_97
s_mov_b32 s99, 160256
v_mov_b32 v208, -1
v_mov_b32 v209, -1
v_mov_b32 v210, -1
v_mov_b32 v211, -1
s_mov_b32 s39, 0x100000
v_min_u32 v204, 0xfffffffe, v204
buffer_store_dword v204, v251, s[8:11], s39 offen
s_add_u32 s39, s39, 8192
buffer_store_dword v208, v251, s[8:11], s39 offen
s_add_u32 s39, s39, 8192
buffer_store_dword v208, v251, s[8:11], s39 offen
s_add_u32 s39, s39, 8192
buffer_store_dword v208, v251, s[8:11], s39 offen
s_lshl_b32 s39, s21, 13
s_add_u32 s39, s39, 0x201800
buffer_store_dwordx4 v[208:211], v247, s[8:11], s39 offen offset:0
buffer_store_dwordx4 v[208:211], v247, s[8:11], s39 offen offset:1024
s_lshl_b32 s39, s21, 13
s_add_u32 s39, s39, 0x241800
buffer_store_dwordx4 v[208:211], v247, s[8:11], s39 offen offset:0
buffer_store_dwordx4 v[208:211], v247, s[8:11], s39 offen offset:1024
s_branch L_inie_98
L_inis_97:
s_mov_b32 s99, 160256
v_mov_b32 v208, -1
v_mov_b32 v209, -1
v_mov_b32 v210, -1
v_mov_b32 v211, -1
s_mov_b32 s39, 0x100000
v_min_u32 v204, 0xfffffffe, v204
buffer_store_dword v204, v251, s[8:11], s39 offen sc1
s_add_u32 s39, s39, 8192
buffer_store_dword v208, v251, s[8:11], s39 offen sc1
s_add_u32 s39, s39, 8192
buffer_store_dword v208, v251, s[8:11], s39 offen sc1
s_add_u32 s39, s39, 8192
buffer_store_dword v208, v251, s[8:11], s39 offen sc1
s_lshl_b32 s39, s21, 13
s_add_u32 s39, s39, 0x201800
buffer_store_dwordx4 v[208:211], v247, s[8:11], s39 offen offset:0 sc1
buffer_store_dwordx4 v[208:211], v247, s[8:11], s39 offen offset:1024 sc1
s_lshl_b32 s39, s21, 13
s_add_u32 s39, s39, 0x241800
buffer_store_dwordx4 v[208:211], v247, s[8:11], s39 offen offset:0 sc1
buffer_store_dwordx4 v[208:211], v247, s[8:11], s39 offen offset:1024 sc1
L_inie_98:
s_mov_b32 m0, 57344
s_mov_b32 s38, 0x1c0000
buffer_load_dwordx4 v136, s[12:15], s38 offen  lds
s_mov_b32 m0, 58368
s_mov_b32 s38, 0x1c8000
buffer_load_dwordx4 v136, s[12:15], s38 offen  lds
s_mov_b32 m0, 59392
s_mov_b32 s38, 0x1d0000
buffer_load_dwordx4 v136, s[12:15], s38 offen  lds
s_mov_b32 m0, 60416
s_mov_b32 s38, 0x1d8000
buffer_load_dwordx4 v136, s[12:15], s38 offen  lds
s_mov_b32 m0, 61440
s_mov_b32 s38, 0x1e0000
buffer_load_dwordx4 v137, s[12:15], s38 offen  lds
s_mov_b32 m0, 62464
s_mov_b32 s38, 0x1e8000
buffer_load_dwordx4 v137, s[12:15], s38 offen  lds
s_mov_b32 m0, 63488
s_mov_b32 s38, 0x1f0000
buffer_load_dwordx4 v137, s[12:15], s38 offen  lds
s_mov_b32 m0, 64512
s_mov_b32 s38, 0x1f8000
buffer_load_dwordx4 v137, s[12:15], s38 offen  lds
s_waitcnt vmcnt(24)
s_barrier
v_add_u32 v142, 65536, v140
v_add_u32 v143, 65536, v141
ds_read_b64_tr_b16 a[144:145], v142 offset:0
ds_read_b64_tr_b16 a[146:147], v142 offset:512
ds_read_b64_tr_b16 a[148:149], v142 offset:2048
ds_read_b64_tr_b16 a[150:151], v142 offset:2560
ds_read_b64_tr_b16 a[208:209], v143 offset:0
ds_read_b64_tr_b16 a[210:211], v143 offset:512
ds_read_b64_tr_b16 a[212:213], v143 offset:2048
ds_read_b64_tr_b16 a[214:215], v143 offset:2560
ds_read_b64_tr_b16 a[176:177], v142 offset:16384
ds_read_b64_tr_b16 a[178:179], v142 offset:16896
ds_read_b64_tr_b16 a[180:181], v142 offset:18432
ds_read_b64_tr_b16 a[182:183], v142 offset:18944
ds_read_b64_tr_b16 a[240:241], v143 offset:16384
ds_read_b64_tr_b16 a[242:243], v143 offset:16896
ds_read_b64_tr_b16 a[244:245], v143 offset:18432
ds_read_b64_tr_b16 a[246:247], v143 offset:18944
s_waitcnt lgkmcnt(0)
s_barrier
s_mov_b32 m0, 90112
s_mov_b32 s38, 0x2c0000
buffer_load_dwordx4 v136, s[12:15], s38 offen  lds
s_mov_b32 m0, 91136
s_mov_b32 s38, 0x2c8000
buffer_load_dwordx4 v136, s[12:15], s38 offen  lds
s_mov_b32 m0, 92160
s_mov_b32 s38, 0x2d0000
buffer_load_dwordx4 v136, s[12:15], s38 offen  lds
s_mov_b32 m0, 93184
s_mov_b32 s38, 0x2d8000
buffer_load_dwordx4 v136, s[12:15], s38 offen  lds
s_mov_b32 m0, 94208
s_mov_b32 s38, 0x2e0000
buffer_load_dwordx4 v137, s[12:15], s38 offen  lds
s_mov_b32 m0, 95232
s_mov_b32 s38, 0x2e8000
buffer_load_dwordx4 v137, s[12:15], s38 offen  lds
s_mov_b32 m0, 96256
s_mov_b32 s38, 0x2f0000
buffer_load_dwordx4 v137, s[12:15], s38 offen  lds
s_mov_b32 m0, 97280
s_mov_b32 s38, 0x2f8000
buffer_load_dwordx4 v137, s[12:15], s38 offen  lds
s_waitcnt vmcnt(24)
s_barrier
v_add_u32 v142, 98304, v140
v_add_u32 v143, 98304, v141
ds_read_b64_tr_b16 a[152:153], v142 offset:0
ds_read_b64_tr_b16 a[154:155], v142 offset:512
ds_read_b64_tr_b16 a[156:157], v142 offset:2048
ds_read_b64_tr_b16 a[158:159], v142 offset:2560
ds_read_b64_tr_b16 a[216:217], v143 offset:0
ds_read_b64_tr_b16 a[218:219], v143 offset:512
ds_read_b64_tr_b16 a[220:221], v143 offset:2048
ds_read_b64_tr_b16 a[222:223], v143 offset:2560
ds_read_b64_tr_b16 a[184:185], v142 offset:16384
ds_read_b64_tr_b16 a[186:187], v142 offset:16896
ds_read_b64_tr_b16 a[188:189], v142 offset:18432
ds_read_b64_tr_b16 a[190:191], v142 offset:18944
ds_read_b64_tr_b16 a[248:249], v143 offset:16384
ds_read_b64_tr_b16 a[250:251], v143 offset:16896
ds_read_b64_tr_b16 a[252:253], v143 offset:18432
ds_read_b64_tr_b16 a[254:255], v143 offset:18944
s_waitcnt lgkmcnt(0)
s_barrier
s_mov_b32 m0, 122880
s_mov_b32 s38, 0x3c0000
buffer_load_dwordx4 v136, s[12:15], s38 offen  lds
s_mov_b32 m0, 123904
s_mov_b32 s38, 0x3c8000
buffer_load_dwordx4 v136, s[12:15], s38 offen  lds
s_mov_b32 m0, 124928
s_mov_b32 s38, 0x3d0000
buffer_load_dwordx4 v136, s[12:15], s38 offen  lds
s_mov_b32 m0, 125952
s_mov_b32 s38, 0x3d8000
buffer_load_dwordx4 v136, s[12:15], s38 offen  lds
s_mov_b32 m0, 126976
s_mov_b32 s38, 0x3e0000
buffer_load_dwordx4 v137, s[12:15], s38 offen  lds
s_mov_b32 m0, 128000
s_mov_b32 s38, 0x3e8000
buffer_load_dwordx4 v137, s[12:15], s38 offen  lds
s_mov_b32 m0, 129024
s_mov_b32 s38, 0x3f0000
buffer_load_dwordx4 v137, s[12:15], s38 offen  lds
s_mov_b32 m0, 130048
s_mov_b32 s38, 0x3f8000
buffer_load_dwordx4 v137, s[12:15], s38 offen  lds
s_waitcnt vmcnt(24)
s_barrier
v_add_u32 v142, 0, v140
v_add_u32 v143, 0, v141
ds_read_b64_tr_b16 v[0:1], v142 offset:0
ds_read_b64_tr_b16 v[2:3], v142 offset:512
ds_read_b64_tr_b16 v[4:5], v142 offset:2048
ds_read_b64_tr_b16 v[6:7], v142 offset:2560
ds_read_b64_tr_b16 v[64:65], v143 offset:0
ds_read_b64_tr_b16 v[66:67], v143 offset:512
ds_read_b64_tr_b16 v[68:69], v143 offset:2048
ds_read_b64_tr_b16 v[70:71], v143 offset:2560
ds_read_b64_tr_b16 v[32:33], v142 offset:16384
ds_read_b64_tr_b16 v[34:35], v142 offset:16896
ds_read_b64_tr_b16 v[36:37], v142 offset:18432
ds_read_b64_tr_b16 v[38:39], v142 offset:18944
ds_read_b64_tr_b16 v[96:97], v143 offset:16384
ds_read_b64_tr_b16 v[98:99], v143 offset:16896
ds_read_b64_tr_b16 v[100:101], v143 offset:18432
ds_read_b64_tr_b16 v[102:103], v143 offset:18944
s_waitcnt lgkmcnt(0)
s_barrier
s_mov_b32 s12, s56
s_mov_b32 s13, s57
s_mov_b32 s14, 0x400000
s_mov_b32 m0, 24576
s_mov_b32 s38, 0x18000
buffer_load_dwordx4 v138, s[12:15], s38 offen  lds
s_mov_b32 m0, 25600
s_mov_b32 s38, 0x19000
buffer_load_dwordx4 v138, s[12:15], s38 offen  lds
s_mov_b32 m0, 26624
s_mov_b32 s38, 0x1a000
buffer_load_dwordx4 v138, s[12:15], s38 offen  lds
s_mov_b32 m0, 27648
s_mov_b32 s38, 0x1b000
buffer_load_dwordx4 v138, s[12:15], s38 offen  lds
s_mov_b32 m0, 28672
s_mov_b32 s38, 0x1c000
buffer_load_dwordx4 v139, s[12:15], s38 offen  lds
s_mov_b32 m0, 29696
s_mov_b32 s38, 0x1d000
buffer_load_dwordx4 v139, s[12:15], s38 offen  lds
s_mov_b32 m0, 30720
s_mov_b32 s38, 0x1e000
buffer_load_dwordx4 v139, s[12:15], s38 offen  lds
s_mov_b32 m0, 31744
s_mov_b32 s38, 0x1f000
buffer_load_dwordx4 v139, s[12:15], s38 offen  lds
s_waitcnt vmcnt(24)
s_barrier
v_add_u32 v142, 32768, v140
v_add_u32 v143, 32768, v141
ds_read_b64_tr_b16 v[8:9], v142 offset:0
ds_read_b64_tr_b16 v[10:11], v142 offset:512
ds_read_b64_tr_b16 v[12:13], v142 offset:2048
ds_read_b64_tr_b16 v[14:15], v142 offset:2560
ds_read_b64_tr_b16 v[72:73], v143 offset:0
ds_read_b64_tr_b16 v[74:75], v143 offset:512
ds_read_b64_tr_b16 v[76:77], v143 offset:2048
ds_read_b64_tr_b16 v[78:79], v143 offset:2560
ds_read_b64_tr_b16 v[40:41], v142 offset:16384
ds_read_b64_tr_b16 v[42:43], v142 offset:16896
ds_read_b64_tr_b16 v[44:45], v142 offset:18432
ds_read_b64_tr_b16 v[46:47], v142 offset:18944
ds_read_b64_tr_b16 v[104:105], v143 offset:16384
ds_read_b64_tr_b16 v[106:107], v143 offset:16896
ds_read_b64_tr_b16 v[108:109], v143 offset:18432
ds_read_b64_tr_b16 v[110:111], v143 offset:18944
s_waitcnt lgkmcnt(0)
s_barrier
s_barrier
s_mov_b32 s22, 0
s_mov_b32 s96, 0
s_mov_b32 s42, 0
s_mov_b32 s23, 0x100000
s_mov_b32 s24, 0x101000
s_mov_b32 s25, 0x230000
s_add_u32 s26, s25, 32768
s_lshl_b32 s27, s21, 13
s_add_u32 s27, s27, 0x201800
s_lshl_b32 s29, s21, 13
s_add_u32 s30, s29, 0x1801800
s_add_u32 s29, s29, 0x801800
s_lshl_b32 s31, s21, 11
s_add_u32 s37, s31, 0x3c00600
s_add_u32 s31, s31, 0x3800000
s_mov_b32 s34, 0x3e0293ee
s_mov_b32 s35, 0xbe0293ee
s_mov_b32 s100, 0x3f803f80
s_mov_b32 s101, 0x3f803f80
v_mov_b64 v[244:245], 0
s_lshl_b32 s98, s21, 6
s_add_u32 s98, s98, 0x10400
s_add_u32 s47, s98, 48
s_mov_b32 m0, 57344
s_mov_b32 s38, 0x18100
buffer_load_dwordx4 v138, s[12:15], s38 offen  lds
s_mov_b32 m0, 58368
s_mov_b32 s38, 0x19100
buffer_load_dwordx4 v138, s[12:15], s38 offen  lds
s_mov_b32 m0, 59392
s_mov_b32 s38, 0x1a100
buffer_load_dwordx4 v138, s[12:15], s38 offen  lds
s_mov_b32 m0, 60416
s_mov_b32 s38, 0x1b100
buffer_load_dwordx4 v138, s[12:15], s38 offen  lds
s_mov_b32 m0, 61440
s_mov_b32 s38, 0x1c100
buffer_load_dwordx4 v139, s[12:15], s38 offen  lds
s_mov_b32 m0, 62464
s_mov_b32 s38, 0x1d100
buffer_load_dwordx4 v139, s[12:15], s38 offen  lds
s_mov_b32 m0, 63488
s_mov_b32 s38, 0x1e100
buffer_load_dwordx4 v139, s[12:15], s38 offen  lds
s_mov_b32 m0, 64512
s_mov_b32 s38, 0x1f100
buffer_load_dwordx4 v139, s[12:15], s38 offen  lds
s_waitcnt vmcnt(24)
s_barrier
v_add_u32 v142, 65536, v140
v_add_u32 v143, 65536, v141
ds_read_b64_tr_b16 v[16:17], v142 offset:0
ds_read_b64_tr_b16 v[18:19], v142 offset:512
ds_read_b64_tr_b16 v[20:21], v142 offset:2048
ds_read_b64_tr_b16 v[22:23], v142 offset:2560
ds_read_b64_tr_b16 v[80:81], v143 offset:0
ds_read_b64_tr_b16 v[82:83], v143 offset:512
ds_read_b64_tr_b16 v[84:85], v143 offset:2048
ds_read_b64_tr_b16 v[86:87], v143 offset:2560
ds_read_b64_tr_b16 v[48:49], v142 offset:16384
ds_read_b64_tr_b16 v[50:51], v142 offset:16896
ds_read_b64_tr_b16 v[52:53], v142 offset:18432
ds_read_b64_tr_b16 v[54:55], v142 offset:18944
ds_read_b64_tr_b16 v[112:113], v143 offset:16384
ds_read_b64_tr_b16 v[114:115], v143 offset:16896
ds_read_b64_tr_b16 v[116:117], v143 offset:18432
ds_read_b64_tr_b16 v[118:119], v143 offset:18944
s_waitcnt lgkmcnt(0)
s_barrier
buffer_load_dwordx4 v[224:227], v244, s[8:11], s98 offen offset:16 sc1
buffer_load_dwordx4 v[228:231], v244, s[8:11], s98 offen offset:32 sc1
s_mov_b32 m0, 90112
s_mov_b32 s38, 0x18200
buffer_load_dwordx4 v138, s[12:15], s38 offen  lds
s_mov_b32 m0, 91136
s_mov_b32 s38, 0x19200
buffer_load_dwordx4 v138, s[12:15], s38 offen  lds
s_mov_b32 m0, 92160
s_mov_b32 s38, 0x1a200
buffer_load_dwordx4 v138, s[12:15], s38 offen  lds
s_mov_b32 m0, 93184
s_mov_b32 s38, 0x1b200
buffer_load_dwordx4 v138, s[12:15], s38 offen  lds
s_mov_b32 m0, 94208
s_mov_b32 s38, 0x1c200
buffer_load_dwordx4 v139, s[12:15], s38 offen  lds
s_mov_b32 m0, 95232
s_mov_b32 s38, 0x1d200
buffer_load_dwordx4 v139, s[12:15], s38 offen  lds
s_mov_b32 m0, 96256
s_mov_b32 s38, 0x1e200
buffer_load_dwordx4 v139, s[12:15], s38 offen  lds
s_mov_b32 m0, 97280
s_mov_b32 s38, 0x1f200
buffer_load_dwordx4 v139, s[12:15], s38 offen  lds
s_waitcnt vmcnt(24)
s_barrier
v_add_u32 v142, 98304, v140
v_add_u32 v143, 98304, v141
ds_read_b64_tr_b16 v[24:25], v142 offset:0
ds_read_b64_tr_b16 v[26:27], v142 offset:512
ds_read_b64_tr_b16 v[28:29], v142 offset:2048
ds_read_b64_tr_b16 v[30:31], v142 offset:2560
ds_read_b64_tr_b16 v[88:89], v143 offset:0
ds_read_b64_tr_b16 v[90:91], v143 offset:512
ds_read_b64_tr_b16 v[92:93], v143 offset:2048
ds_read_b64_tr_b16 v[94:95], v143 offset:2560
ds_read_b64_tr_b16 v[56:57], v142 offset:16384
ds_read_b64_tr_b16 v[58:59], v142 offset:16896
ds_read_b64_tr_b16 v[60:61], v142 offset:18432
ds_read_b64_tr_b16 v[62:63], v142 offset:18944
ds_read_b64_tr_b16 v[120:121], v143 offset:16384
ds_read_b64_tr_b16 v[122:123], v143 offset:16896
ds_read_b64_tr_b16 v[124:125], v143 offset:18432
ds_read_b64_tr_b16 v[126:127], v143 offset:18944
s_waitcnt lgkmcnt(0)
s_barrier
s_mov_b32 m0, 122880
s_mov_b32 s38, 0x18300
buffer_load_dwordx4 v138, s[12:15], s38 offen  lds
s_mov_b32 m0, 123904
s_mov_b32 s38, 0x19300
buffer_load_dwordx4 v138, s[12:15], s38 offen  lds
s_mov_b32 m0, 124928
s_mov_b32 s38, 0x1a300
buffer_load_dwordx4 v138, s[12:15], s38 offen  lds
s_mov_b32 m0, 125952
s_mov_b32 s38, 0x1b300
buffer_load_dwordx4 v138, s[12:15], s38 offen  lds
s_mov_b32 m0, 126976
s_mov_b32 s38, 0x1c300
buffer_load_dwordx4 v139, s[12:15], s38 offen  lds
s_mov_b32 m0, 128000
s_mov_b32 s38, 0x1d300
buffer_load_dwordx4 v139, s[12:15], s38 offen  lds
s_mov_b32 m0, 129024
s_mov_b32 s38, 0x1e300
buffer_load_dwordx4 v139, s[12:15], s38 offen  lds
s_mov_b32 m0, 130048
s_mov_b32 s38, 0x1f300
buffer_load_dwordx4 v139, s[12:15], s38 offen  lds
s_waitcnt vmcnt(8)
s_mov_b32 s43, 0
s_cmp_ge_u32 s43, 64
s_cbranch_scc1 L_hx_100
s_mov_b32 s36, 200000
s_branch L_he_101
L_hq_99:
buffer_load_dwordx4 v[224:227], v244, s[8:11], s98 offen offset:16 sc1
buffer_load_dwordx4 v[228:231], v244, s[8:11], s98 offen offset:32 sc1
s_sub_u32 s36, s36, 1
s_cmp_eq_u32 s36, 0
s_cbranch_scc1 L_abort
s_waitcnt vmcnt(0)
L_he_101:
v_cmp_eq_u32 vcc, s46, v225
s_nop 1
v_cndmask_b32 v224, 0, v224, vcc
v_cmp_eq_u32 vcc, s46, v227
s_nop 1
v_cndmask_b32 v226, 0, v226, vcc
v_cmp_eq_u32 vcc, s46, v229
s_nop 1
v_cndmask_b32 v228, 0, v228, vcc
v_cmp_eq_u32 vcc, s46, v231
s_nop 1
v_cndmask_b32 v230, 0, v230, vcc
v_min_u32 v224, v224, v228
v_min_u32 v225, v226, v230
v_lshlrev_b32 v224, 1, v224
v_lshl_add_u32 v225, v225, 1, 1
v_min_u32 v224, v224, v225
s_nop 0
v_readfirstlane_b32 s97, v224
s_cmp_ge_u32 s97, 64
s_cselect_b32 s97, 1000, s97
s_cmp_lt_u32 s43, s97
s_cbranch_scc0 L_hq_99
L_hx_100:
s_mov_b32 m0, 137216
s_nop 0
buffer_load_dwordx4 v247, s[8:11], s29 offen offset:0 sc1 lds
buffer_load_dwordx4 v247, s[8:11], s29 offen offset:1024 sc1 lds
s_add_u32 s29, s29, 262144
s_mov_b32 s44, 145408
v_mov_b32 v232, 136
buffer_load_dword v233, v232, s[16:19], 0 offen sc1
s_xor_b32 s39, s27, 0
buffer_load_dwordx4 v[228:231], v247, s[8:11], s39 offen offset:0 sc1
buffer_load_dwordx4 v[228:231], v247, s[8:11], s39 offen offset:1024 sc1
s_xor_b32 s39, s27, 262144
buffer_load_dwordx4 v[228:231], v247, s[8:11], s39 offen offset:0 sc1
buffer_load_dwordx4 v[228:231], v247, s[8:11], s39 offen offset:1024 sc1
buffer_load_dwordx4 v[228:231], v247, s[8:11], s30 offen offset:0 sc1
buffer_load_dwordx4 v[228:231], v247, s[8:11], s30 offen offset:1024 sc1
buffer_load_dword v228, v244, s[8:11], s31 offen sc1
buffer_load_dword v228, v244, s[8:11], s37 offen sc1
s_mov_b32 s39, 0x101800
buffer_load_dwordx4 v[228:231], v247, s[8:11], s39 offen offset:0 sc1
buffer_load_dwordx4 v[228:231], v247, s[8:11], s39 offen offset:1024 sc1
s_mov_b32 s39, 0x103800
buffer_load_dwordx4 v[228:231], v247, s[8:11], s39 offen offset:0 sc1
buffer_load_dwordx4 v[228:231], v247, s[8:11], s39 offen offset:1024 sc1
s_mov_b32 s39, 0x105800
buffer_load_dwordx4 v[228:231], v247, s[8:11], s39 offen offset:0 sc1
buffer_load_dwordx4 v[228:231], v247, s[8:11], s39 offen offset:1024 sc1
s_mov_b32 s39, 0x107800
buffer_load_dwordx4 v[228:231], v247, s[8:11], s39 offen offset:0 sc1
buffer_load_dwordx4 v[228:231], v247, s[8:11], s39 offen offset:1024 sc1
s_getpc_b64 s[40:41]
L_pc_102:
s_add_u32 s40, s40, L_step_w3f-L_pc_102
s_addc_u32 s41, s41, 0
global_load_dwordx4 v[228:231], v247, s[40:41] offset:0
global_load_dwordx4 v[228:231], v247, s[40:41] offset:1024
global_load_dwordx4 v[228:231], v247, s[40:41] offset:2048
global_load_dwordx4 v[228:231], v247, s[40:41] offset:3072
s_waitcnt vmcnt(23)
s_barrier
ds_read_b64_tr_b16 v[160:161], v148 offset:0
ds_read_b64_tr_b16 v[162:163], v148 offset:512
ds_read_b64_tr_b16 v[164:165], v148 offset:2048
ds_read_b64_tr_b16 v[166:167], v148 offset:2560
ds_read_b64_tr_b16 v[168:169], v149 offset:0
ds_read_b64_tr_b16 v[170:171], v149 offset:512
ds_read_b64_tr_b16 v[172:173], v149 offset:2048
ds_read_b64_tr_b16 v[174:175], v149 offset:2560
ds_read_b64_tr_b16 v[176:177], v150 offset:0
ds_read_b64_tr_b16 v[178:179], v150 offset:512
ds_read_b64_tr_b16 v[180:181], v150 offset:2048
ds_read_b64_tr_b16 v[182:183], v150 offset:2560
ds_read_b64_tr_b16 v[184:185], v151 offset:0
ds_read_b64_tr_b16 v[186:187], v151 offset:512
ds_read_b64_tr_b16 v[188:189], v151 offset:2048
ds_read_b64_tr_b16 v[190:191], v151 offset:2560
ds_read_b64_tr_b16 v[192:193], v152 offset:0
ds_read_b64_tr_b16 v[194:195], v152 offset:512
ds_read_b64_tr_b16 v[196:197], v152 offset:2048
ds_read_b64_tr_b16 v[198:199], v152 offset:2560
ds_read_b64_tr_b16 v[200:201], v153 offset:0
ds_read_b64_tr_b16 v[202:203], v153 offset:512
ds_read_b64_tr_b16 v[204:205], v153 offset:2048
ds_read_b64_tr_b16 v[206:207], v153 offset:2560
ds_read_b64_tr_b16 v[208:209], v154 offset:0
ds_read_b64_tr_b16 v[210:211], v154 offset:512
ds_read_b64_tr_b16 v[212:213], v154 offset:2048
ds_read_b64_tr_b16 v[214:215], v154 offset:2560
ds_read_b64_tr_b16 v[216:217], v155 offset:0
ds_read_b64_tr_b16 v[218:219], v155 offset:512
ds_read_b64_tr_b16 v[220:221], v155 offset:2048
ds_read_b64_tr_b16 v[222:223], v155 offset:2560
s_waitcnt lgkmcnt(0)
ds_write_b128 v248, v[160:163] offset:0
ds_write_b128 v248, v[164:167] offset:1024
ds_write_b128 v248, v[168:171] offset:2048
ds_write_b128 v248, v[172:175] offset:3072
ds_write_b128 v248, v[176:179] offset:4096
ds_write_b128 v248, v[180:183] offset:5120
ds_write_b128 v248, v[184:187] offset:6144
ds_write_b128 v248, v[188:191] offset:7168
ds_write_b128 v248, v[192:195] offset:8192
ds_write_b128 v248, v[196:199] offset:9216
ds_write_b128 v248, v[200:203] offset:10240
ds_write_b128 v248, v[204:207] offset:11264
ds_write_b128 v248, v[208:211] offset:12288
ds_write_b128 v248, v[212:215] offset:13312
ds_write_b128 v248, v[216:219] offset:14336
ds_write_b128 v248, v[220:223] offset:15360
s_waitcnt lgkmcnt(0)
ds_read_b64_tr_b16 v[160:161], v148 offset:16384
ds_read_b64_tr_b16 v[162:163], v148 offset:16896
ds_read_b64_tr_b16 v[164:165], v148 offset:18432
ds_read_b64_tr_b16 v[166:167], v148 offset:18944
ds_read_b64_tr_b16 v[168:169], v149 offset:16384
ds_read_b64_tr_b16 v[170:171], v149 offset:16896
ds_read_b64_tr_b16 v[172:173], v149 offset:18432
ds_read_b64_tr_b16 v[174:175], v149 offset:18944
ds_read_b64_tr_b16 v[176:177], v150 offset:16384
ds_read_b64_tr_b16 v[178:179], v150 offset:16896
ds_read_b64_tr_b16 v[180:181], v150 offset:18432
ds_read_b64_tr_b16 v[182:183], v150 offset:18944
ds_read_b64_tr_b16 v[184:185], v151 offset:16384
ds_read_b64_tr_b16 v[186:187], v151 offset:16896
ds_read_b64_tr_b16 v[188:189], v151 offset:18432
ds_read_b64_tr_b16 v[190:191], v151 offset:18944
ds_read_b64_tr_b16 v[192:193], v152 offset:16384
ds_read_b64_tr_b16 v[194:195], v152 offset:16896
ds_read_b64_tr_b16 v[196:197], v152 offset:18432
ds_read_b64_tr_b16 v[198:199], v152 offset:18944
ds_read_b64_tr_b16 v[200:201], v153 offset:16384
ds_read_b64_tr_b16 v[202:203], v153 offset:16896
ds_read_b64_tr_b16 v[204:205], v153 offset:18432
ds_read_b64_tr_b16 v[206:207], v153 offset:18944
ds_read_b64_tr_b16 v[208:209], v154 offset:16384
ds_read_b64_tr_b16 v[210:211], v154 offset:16896
ds_read_b64_tr_b16 v[212:213], v154 offset:18432
ds_read_b64_tr_b16 v[214:215], v154 offset:18944
ds_read_b64_tr_b16 v[216:217], v155 offset:16384
ds_read_b64_tr_b16 v[218:219], v155 offset:16896
ds_read_b64_tr_b16 v[220:221], v155 offset:18432
ds_read_b64_tr_b16 v[222:223], v155 offset:18944
s_waitcnt lgkmcnt(0)
ds_write_b128 v248, v[160:163] offset:16384
ds_write_b128 v248, v[164:167] offset:17408
ds_write_b128 v248, v[168:171] offset:18432
ds_write_b128 v248, v[172:175] offset:19456
ds_write_b128 v248, v[176:179] offset:20480
ds_write_b128 v248, v[180:183] offset:21504
ds_write_b128 v248, v[184:187] offset:22528
ds_write_b128 v248, v[188:191] offset:23552
ds_write_b128 v248, v[192:195] offset:24576
ds_write_b128 v248, v[196:199] offset:25600
ds_write_b128 v248, v[200:203] offset:26624
ds_write_b128 v248, v[204:207] offset:27648
ds_write_b128 v248, v[208:211] offset:28672
ds_write_b128 v248, v[212:215] offset:29696
ds_write_b128 v248, v[216:219] offset:30720
ds_write_b128 v248, v[220:223] offset:31744
s_waitcnt lgkmcnt(0)
v_mov_b64 v[160:161], 0
v_mov_b64 v[162:163], 0
v_mov_b64 v[164:165], 0
v_mov_b64 v[166:167], 0
v_mov_b64 v[168:169], 0
v_mov_b64 v[170:171], 0
v_mov_b64 v[172:173], 0
v_mov_b64 v[174:175], 0
v_mov_b64 v[176:177], 0
v_mov_b64 v[178:179], 0
v_mov_b64 v[180:181], 0
v_mov_b64 v[182:183], 0
v_mov_b64 v[224:225], -1
v_mov_b64 v[226:227], -1
s_mov_b32 s41, 0x106000
v_mov_b64 v[244:245], 0
v_mov_b64 v[240:241], 0
v_mov_b64 v[242:243], 0
v_add_u32 v245, 151552, v247
s_mov_b32 s36, 200000
s_waitcnt vmcnt(0)
s_branch L_arq_104
L_arr_103:
buffer_load_dword v233, v232, s[16:19], 0 offen sc1
s_sub_u32 s36, s36, 1
s_cmp_eq_u32 s36, 0
s_cbranch_scc1 L_abort
s_waitcnt vmcnt(0)
L_arq_104:
v_cmp_ne_u32 vcc, 32, v233
s_cbranch_vccnz L_arr_103
s_waitcnt vmcnt(0)
s_barrier
s_cmp_lg_u32 s32, 0
s_cbranch_scc1 L_cslow3
L_step_w3f:
s_waitcnt vmcnt(0)
s_mov_b32 s36, 200000
buffer_load_dwordx4 v[184:187], v247, s[8:11], s24 offen offset:2048 sc1
buffer_load_dwordx4 v[188:191], v247, s[8:11], s24 offen offset:3072 sc1
v_mov_b64 v[160:161], 0
v_mov_b64 v[162:163], 0
v_mov_b64 v[164:165], 0
v_mov_b64 v[166:167], 0
v_mov_b64 v[168:169], 0
v_mov_b64 v[170:171], 0
v_mov_b64 v[172:173], 0
v_mov_b64 v[174:175], 0
v_mov_b64 v[176:177], 0
v_mov_b64 v[178:179], 0
v_mov_b64 v[180:181], 0
v_mov_b64 v[182:183], 0
L_pl_108:
buffer_load_dwordx4 v[192:195], v247, s[8:11], s24 offen offset:2048 sc1
buffer_load_dwordx4 v[196:199], v247, s[8:11], s24 offen offset:3072 sc1
s_waitcnt vmcnt(2)
ds_write_b128 v245, v[184:187] offset:6144
ds_write_b128 v245, v[188:191] offset:7168
v_max3_u32 v255, v184, v185, v186
v_max3_u32 v255, v255, v187, v188
v_max3_u32 v255, v255, v189, v190
v_max_u32 v255, v255, v191
v_cmp_eq_u32 vcc, -1, v255
s_cbranch_vccz L_mok0_105
buffer_load_dwordx4 v[184:187], v247, s[8:11], s24 offen offset:2048 sc1
buffer_load_dwordx4 v[188:191], v247, s[8:11], s24 offen offset:3072 sc1
s_waitcnt vmcnt(2)
ds_write_b128 v245, v[192:195] offset:6144
ds_write_b128 v245, v[196:199] offset:7168
v_max3_u32 v255, v192, v193, v194
v_max3_u32 v255, v255, v195, v196
v_max3_u32 v255, v255, v197, v198
v_max_u32 v255, v255, v199
v_cmp_eq_u32 vcc, -1, v255
s_cbranch_vccz L_mok1_106
s_sub_u32 s36, s36, 1
s_cmp_lg_u32 s36, 0
s_cbranch_scc1 L_pl_108
s_branch L_abort
L_mok1_106:
v_smfmac_f32_16x16x64_bf16 v[160:163], v[192:195], a[48:55], v246
v_smfmac_f32_16x16x64_bf16 v[164:167], v[192:195], a[176:183], v246
v_smfmac_f32_16x16x64_bf16 v[168:171], v[192:195], a[112:119], v246
s_waitcnt lgkmcnt(0)
s_barrier
ds_read_b128 v[128:131], v245 offset:0
ds_read_b128 v[132:135], v245 offset:1024
v_smfmac_f32_16x16x64_bf16 v[172:175], v[192:195], a[240:247], v246
ds_read_b128 v[136:139], v245 offset:2048
v_smfmac_f32_16x16x64_bf16 v[160:163], v[196:199], a[56:63], v246
ds_read_b128 v[140:143], v245 offset:3072
v_smfmac_f32_16x16x64_bf16 v[164:167], v[196:199], a[184:191], v246
ds_read_b128 v[144:147], v245 offset:4096
v_smfmac_f32_16x16x64_bf16 v[168:171], v[196:199], a[120:127], v246
ds_read_b128 v[148:151], v245 offset:5120
v_smfmac_f32_16x16x64_bf16 v[172:175], v[196:199], a[248:255], v246
ds_read_b128 v[152:155], v245 offset:6144
ds_read_b128 v[156:159], v245 offset:7168
s_branch L_mjoin_107
L_mok0_105:
v_smfmac_f32_16x16x64_bf16 v[160:163], v[184:187], a[48:55], v246
v_smfmac_f32_16x16x64_bf16 v[164:167], v[184:187], a[176:183], v246
v_smfmac_f32_16x16x64_bf16 v[168:171], v[184:187], a[112:119], v246
s_waitcnt lgkmcnt(0)
s_barrier
ds_read_b128 v[128:131], v245 offset:0
ds_read_b128 v[132:135], v245 offset:1024
v_smfmac_f32_16x16x64_bf16 v[172:175], v[184:187], a[240:247], v246
ds_read_b128 v[136:139], v245 offset:2048
v_smfmac_f32_16x16x64_bf16 v[160:163], v[188:191], a[56:63], v246
ds_read_b128 v[140:143], v245 offset:3072
v_smfmac_f32_16x16x64_bf16 v[164:167], v[188:191], a[184:191], v246
ds_read_b128 v[144:147], v245 offset:4096
v_smfmac_f32_16x16x64_bf16 v[168:171], v[188:191], a[120:127], v246
ds_read_b128 v[148:151], v245 offset:5120
v_smfmac_f32_16x16x64_bf16 v[172:175], v[188:191], a[248:255], v246
ds_read_b128 v[152:155], v245 offset:6144
ds_read_b128 v[156:159], v245 offset:7168
L_mjoin_107:
buffer_store_dword v224, v251, s[8:11], s41 offen
v_mov_b32 v216, s22
v_mov_b32 v217, s46
buffer_store_dwordx2 v[216:217], v244, s[8:11], s47 offen sc1
s_waitcnt lgkmcnt(7)
v_smfmac_f32_16x16x64_bf16 v[160:163], v[128:131], a[0:7], v246
ds_read_b128 v[200:203], v249 offset:4096
v_smfmac_f32_16x16x64_bf16 v[164:167], v[128:131], a[128:135], v246
buffer_load_dwordx4 v[228:231], v247, s[8:11], s30 offen offset:0 sc1 nt
v_smfmac_f32_16x16x64_bf16 v[168:171], v[128:131], a[64:71], v246
ds_read_b128 v[204:207], v249 offset:5120
v_smfmac_f32_16x16x64_bf16 v[172:175], v[128:131], a[192:199], v246
s_waitcnt lgkmcnt(8)
v_smfmac_f32_16x16x64_bf16 v[160:163], v[132:135], a[8:15], v246
ds_read_b128 v[208:211], v249 offset:6144
v_smfmac_f32_16x16x64_bf16 v[164:167], v[132:135], a[136:143], v246
buffer_load_dwordx4 v[232:235], v247, s[8:11], s30 offen offset:1024 sc1 nt
v_smfmac_f32_16x16x64_bf16 v[168:171], v[132:135], a[72:79], v246
ds_read_b128 v[212:215], v249 offset:7168
v_smfmac_f32_16x16x64_bf16 v[172:175], v[132:135], a[200:207], v246
s_waitcnt lgkmcnt(9)
v_smfmac_f32_16x16x64_bf16 v[160:163], v[136:139], a[16:23], v246
s_waitcnt vmcnt(4)
s_add_u32 s43, s22, 3
s_cmp_ge_u32 s43, s97
s_cbranch_scc1 L_hz_109
L_hzb_110:
ds_read_b128 v[184:187], v249 offset:0
v_smfmac_f32_16x16x64_bf16 v[164:167], v[136:139], a[144:151], v246
s_mov_b32 m0, s44
s_nop 0
buffer_load_dwordx4 v247, s[8:11], s29 offen sc1 nt lds
v_smfmac_f32_16x16x64_bf16 v[168:171], v[136:139], a[80:87], v246
ds_read_b128 v[188:191], v249 offset:1024
v_smfmac_f32_16x16x64_bf16 v[172:175], v[136:139], a[208:215], v246
s_waitcnt lgkmcnt(10)
v_smfmac_f32_16x16x64_bf16 v[160:163], v[140:143], a[24:31], v246
ds_read_b128 v[192:195], v249 offset:2048
v_smfmac_f32_16x16x64_bf16 v[164:167], v[140:143], a[152:159], v246
buffer_load_dwordx4 v247, s[8:11], s29 offen offset:1024 sc1 nt lds
v_smfmac_f32_16x16x64_bf16 v[168:171], v[140:143], a[88:95], v246
ds_read_b128 v[196:199], v249 offset:3072
v_smfmac_f32_16x16x64_bf16 v[172:175], v[140:143], a[216:223], v246
s_waitcnt lgkmcnt(8)
v_smfmac_f32_16x16x64_bf16 v[160:163], v[144:147], a[32:39], v246
v_smfmac_f32_16x16x64_bf16 v[164:167], v[144:147], a[160:167], v246
v_smfmac_f32_16x16x64_bf16 v[160:163], v[148:151], a[40:47], v246
v_smfmac_f32_16x16x64_bf16 v[164:167], v[148:151], a[168:175], v246
v_smfmac_f32_16x16x64_bf16 v[168:171], v[144:147], a[96:103], v246
v_smfmac_f32_16x16x64_bf16 v[172:175], v[144:147], a[224:231], v246
v_smfmac_f32_16x16x64_bf16 v[168:171], v[148:151], a[104:111], v246
v_smfmac_f32_16x16x64_bf16 v[172:175], v[148:151], a[232:239], v246
v_smfmac_f32_16x16x64_bf16 v[176:179], v[128:131], v[0:7], v246
s_nop 1
v_add_f32 v160, v160, v162
v_add_f32 v161, v161, v163
v_smfmac_f32_16x16x64_bf16 v[180:183], v[128:131], v[64:71], v246
v_add_f32 v164, v164, v166
v_add_f32 v165, v165, v167
v_smfmac_f32_16x16x64_bf16 v[176:179], v[132:135], v[8:15], v246
v_cvt_pk_bf16_f32 v163, v160, v161
v_cvt_pk_bf16_f32 v162, v164, v165
ds_write_b64 v252, v[162:163] offset:0
v_add_f32 v168, v168, v170
v_add_f32 v169, v169, v171
v_add_f32 v172, v172, v174
v_add_f32 v173, v173, v175
v_cvt_pk_bf16_f32 v171, v168, v169
v_cvt_pk_bf16_f32 v170, v172, v173
ds_write_b64 v252, v[170:171] offset:512
v_smfmac_f32_16x16x64_bf16 v[180:183], v[132:135], v[72:79], v246
v_smfmac_f32_16x16x64_bf16 v[176:179], v[136:139], v[16:23], v246
v_smfmac_f32_16x16x64_bf16 v[180:183], v[136:139], v[80:87], v246
v_smfmac_f32_16x16x64_bf16 v[176:179], v[140:143], v[24:31], v246
s_waitcnt lgkmcnt(0)
s_barrier
ds_read_b64_tr_b16 v[160:161], v253 offset:0
ds_read_b64_tr_b16 v[162:163], v253 offset:512
ds_read_b64_tr_b16 v[164:165], v253 offset:1024
v_smfmac_f32_16x16x64_bf16 v[180:183], v[140:143], v[88:95], v246
ds_read_b64_tr_b16 v[166:167], v253 offset:1536
v_smfmac_f32_16x16x64_bf16 v[176:179], v[144:147], v[32:39], v246
ds_read_b64_tr_b16 v[168:169], v253 offset:2048
v_smfmac_f32_16x16x64_bf16 v[180:183], v[144:147], v[96:103], v246
ds_read_b64_tr_b16 v[170:171], v253 offset:2560
v_smfmac_f32_16x16x64_bf16 v[176:179], v[148:151], v[40:47], v246
ds_read_b64_tr_b16 v[172:173], v253 offset:3072
v_smfmac_f32_16x16x64_bf16 v[180:183], v[148:151], v[104:111], v246
ds_read_b64_tr_b16 v[174:175], v253 offset:3584
s_waitcnt lgkmcnt(6)
v_mfma_f32_16x16x32_bf16 v[216:219], v[184:187], v[160:163], 0
v_mfma_f32_16x16x32_bf16 v[220:223], v[200:203], v[160:163], 0
ds_read_b128 v[128:131], v248 offset:4096
v_mfma_f32_16x16x32_bf16 v[224:227], v[160:163], v[160:163], 0
ds_read_b128 v[132:135], v248 offset:5120
s_waitcnt lgkmcnt(6)
v_mfma_f32_16x16x32_bf16 v[216:219], v[188:191], v[164:167], v[216:219]
ds_read_b128 v[136:139], v248 offset:20480
v_mfma_f32_16x16x32_bf16 v[220:223], v[204:207], v[164:167], v[220:223]
ds_read_b128 v[140:143], v248 offset:21504
v_mfma_f32_16x16x32_bf16 v[224:227], v[164:167], v[164:167], v[224:227]
ds_read_b128 v[144:147], v248 offset:6144
s_waitcnt lgkmcnt(7)
v_mfma_f32_16x16x32_bf16 v[216:219], v[192:195], v[168:171], v[216:219]
ds_read_b128 v[148:151], v248 offset:7168
v_mfma_f32_16x16x32_bf16 v[220:223], v[208:211], v[168:171], v[220:223]
v_mfma_f32_16x16x32_bf16 v[224:227], v[168:171], v[168:171], v[224:227]
s_waitcnt lgkmcnt(6)
v_mfma_f32_16x16x32_bf16 v[216:219], v[196:199], v[172:175], v[216:219]
v_mfma_f32_16x16x32_bf16 v[220:223], v[212:215], v[172:175], v[220:223]
v_mfma_f32_16x16x32_bf16 v[224:227], v[172:175], v[172:175], v[224:227]
buffer_store_dwordx4 v[172:175], v254, s[8:11], s31 offen offset:1536 sc1
v_smfmac_f32_16x16x64_bf16 v[176:179], v[152:155], v[48:55], v246
v_smfmac_f32_16x16x64_bf16 v[180:183], v[152:155], v[112:119], v246
v_smfmac_f32_16x16x64_bf16 v[176:179], v[156:159], v[56:63], v246
v_smfmac_f32_16x16x64_bf16 v[180:183], v[156:159], v[120:127], v246
ds_read_b128 v[152:155], v248 offset:22528
ds_read_b128 v[156:159], v248 offset:23552
v_max3_f32 v168, v216, v217, v218
v_max3_f32 v169, v219, v220, v221
v_max3_f32 v168, v168, v222, v223
v_max3_f32 v169, v169, v224, v225
v_max_f32 v168, v168, v169
v_mov_b32 v169, v168
ds_read_b128 v[184:187], v248 offset:0
v_mov_b64 v[164:165], s[100:101]
v_permlane32_swap_b32 v168, v169
v_max_f32 v168, v168, v169
v_mov_b32 v169, v168
ds_read_b128 v[188:191], v248 offset:1024
v_mov_b64 v[166:167], s[100:101]
v_permlane16_swap_b32 v168, v169
v_max_f32 v168, v168, v169
v_mul_f32 v170, s35, v168
v_pk_fma_f32 v[216:217], v[216:217], s[34:35], v[170:171] op_sel_hi:[1,0,0]
v_pk_fma_f32 v[218:219], v[218:219], s[34:35], v[170:171] op_sel_hi:[1,0,0]
ds_read_b128 v[192:195], v248 offset:16384
v_pk_fma_f32 v[220:221], v[220:221], s[34:35], v[170:171] op_sel_hi:[1,0,0]
v_pk_fma_f32 v[222:223], v[222:223], s[34:35], v[170:171] op_sel_hi:[1,0,0]
v_pk_fma_f32 v[224:225], v[224:225], s[34:35], v[170:171] op_sel_hi:[1,0,0]
ds_read_b128 v[196:199], v248 offset:17408
v_exp_f32 v216, v216
v_exp_f32 v217, v217
v_exp_f32 v218, v218
ds_read_b128 v[200:203], v248 offset:2048
v_exp_f32 v219, v219
v_exp_f32 v220, v220
v_exp_f32 v221, v221
ds_read_b128 v[204:207], v248 offset:3072
v_exp_f32 v222, v222
v_exp_f32 v223, v223
v_exp_f32 v224, v224
ds_read_b128 v[208:211], v248 offset:18432
v_exp_f32 v225, v225
ds_read_b128 v[212:215], v248 offset:19456
v_mov_b32 v161, 0
v_mov_b64 v[162:163], 0
s_cmp_lg_u32 s42, 0
s_cbranch_scc1 L_hze_111
L_hzf_112:
v_cvt_pk_bf16_f32 v236, v216, v217
v_cvt_pk_bf16_f32 v237, v218, v219
v_cvt_pk_bf16_f32 v238, v220, v221
v_cvt_pk_bf16_f32 v239, v222, v223
v_cvt_pk_bf16_f32 v160, v224, v225
v_add_f32 v176, v176, v178
v_mfma_f32_16x16x32_bf16 v[224:227], v[236:239], v[164:167], 0
s_waitcnt vmcnt(3)
v_add_f32 v177, v177, v179
v_mfma_f32_16x16x32_bf16 v[216:219], v[236:239], v[228:231], 0
v_add_f32 v180, v180, v182
v_mfma_f32_16x16x32_bf16 v[220:223], v[236:239], v[232:235], 0
v_add_f32 v181, v181, v183
v_mfma_f32_16x16x32_bf16 v[224:227], v[160:163], v[164:167], v[224:227]
v_cvt_pk_bf16_f32 v240, v176, v177
v_cvt_pk_bf16_f32 v242, v180, v181
v_lshrrev_b32 v255, 2, v247
s_nop 0
v_mfma_f32_16x16x32_bf16 v[216:219], v[160:163], v[240:243], v[216:219]
v_mfma_f32_16x16x32_bf16 v[220:223], v[160:163], v[242:245], v[220:223]
buffer_store_dword v240, v255, s[8:11], s37 offen sc1
buffer_store_dword v242, v255, s[8:11], s37 offen offset:256 sc1
v_rcp_f32 v172, v226
v_rcp_f32 v173, v227
s_nop 2
v_pk_mul_f32 v[218:219], v[218:219], v[172:173]
v_pk_mul_f32 v[222:223], v[222:223], v[172:173]
v_cvt_pk_bf16_f32 v216, v218, v219
v_cvt_pk_bf16_f32 v217, v222, v223
ds_write_b64 v252, v[216:217] offset:12288
v_mov_b64 v[168:169], 0
v_mov_b64 v[170:171], 0
v_mov_b64 v[172:173], 0
v_mov_b64 v[174:175], 0
v_mov_b64 v[176:177], 0
v_mov_b64 v[178:179], 0
v_mov_b64 v[180:181], 0
v_mov_b64 v[182:183], 0
s_waitcnt lgkmcnt(0)
s_barrier
ds_read_b64_tr_b16 v[236:237], v253 offset:12288
ds_read_b64_tr_b16 v[238:239], v253 offset:13312
ds_read_b64_tr_b16 v[240:241], v253 offset:14336
ds_read_b64_tr_b16 v[242:243], v253 offset:15360
v_mov_b64 v[160:161], 0
v_mov_b64 v[162:163], 0
v_mov_b64 v[164:165], 0
v_mov_b64 v[166:167], 0
v_mov_b64 v[228:229], 0
v_mov_b64 v[230:231], 0
v_mov_b64 v[232:233], 0
v_mov_b64 v[234:235], 0
s_waitcnt lgkmcnt(0)
v_smfmac_f32_16x16x64_bf16 v[160:163], v[236:239], v[184:191], v246
ds_read_b128 v[184:187], v248 offset:8192
ds_read_b128 v[188:191], v248 offset:9216
v_smfmac_f32_16x16x64_bf16 v[160:163], v[240:243], v[192:199], v246
ds_read_b128 v[192:195], v248 offset:24576
v_smfmac_f32_16x16x64_bf16 v[164:167], v[236:239], v[200:207], v246
ds_read_b128 v[196:199], v248 offset:25600
ds_read_b128 v[200:203], v248 offset:10240
v_smfmac_f32_16x16x64_bf16 v[164:167], v[240:243], v[208:215], v246
ds_read_b128 v[204:207], v248 offset:11264
s_nop 1
v_add_f32 v160, v160, v162
v_smfmac_f32_16x16x64_bf16 v[168:171], v[236:239], v[128:135], v246
ds_read_b128 v[208:211], v248 offset:26624
ds_read_b128 v[212:215], v248 offset:27648
v_add_f32 v161, v161, v163
v_smfmac_f32_16x16x64_bf16 v[168:171], v[240:243], v[136:143], v246
ds_read_b128 v[128:131], v248 offset:12288
v_cvt_pk_bf16_f32 v160, v160, v161
v_smfmac_f32_16x16x64_bf16 v[172:175], v[236:239], v[144:151], v246
ds_read_b128 v[132:135], v248 offset:13312
ds_read_b128 v[136:139], v248 offset:28672
v_add_f32 v164, v164, v166
v_smfmac_f32_16x16x64_bf16 v[172:175], v[240:243], v[152:159], v246
ds_read_b128 v[140:143], v248 offset:29696
v_add_f32 v165, v165, v167
s_waitcnt lgkmcnt(10)
v_smfmac_f32_16x16x64_bf16 v[176:179], v[236:239], v[184:191], v246
ds_read_b128 v[144:147], v248 offset:14336
ds_read_b128 v[148:151], v248 offset:15360
v_cvt_pk_bf16_f32 v161, v164, v165
v_add_f32 v168, v168, v170
s_waitcnt lgkmcnt(10)
v_smfmac_f32_16x16x64_bf16 v[176:179], v[240:243], v[192:199], v246
ds_read_b128 v[152:155], v248 offset:30720
v_add_f32 v169, v169, v171
v_cvt_pk_bf16_f32 v162, v168, v169
s_waitcnt lgkmcnt(9)
v_smfmac_f32_16x16x64_bf16 v[180:183], v[236:239], v[200:207], v246
ds_read_b128 v[156:159], v248 offset:31744
v_add_f32 v172, v172, v174
v_add_f32 v173, v173, v175
s_waitcnt lgkmcnt(8)
v_smfmac_f32_16x16x64_bf16 v[180:183], v[240:243], v[208:215], v246
v_cvt_pk_bf16_f32 v163, v172, v173
v_bfi_b32 v160, 1, s96, v160
s_waitcnt lgkmcnt(6)
v_smfmac_f32_16x16x64_bf16 v[228:231], v[236:239], v[128:135], v246
buffer_store_dwordx4 v[160:163], v250, s[8:11], s25 offen
v_add_f32 v176, v176, v178
s_waitcnt lgkmcnt(4)
v_smfmac_f32_16x16x64_bf16 v[228:231], v[240:243], v[136:143], v246
v_add_f32 v177, v177, v179
v_cvt_pk_bf16_f32 v176, v176, v177
s_waitcnt lgkmcnt(2)
v_smfmac_f32_16x16x64_bf16 v[232:235], v[236:239], v[144:151], v246
v_add_f32 v180, v180, v182
v_add_f32 v181, v181, v183
s_waitcnt lgkmcnt(0)
v_smfmac_f32_16x16x64_bf16 v[232:235], v[240:243], v[152:159], v246
v_cvt_pk_bf16_f32 v177, v180, v181
v_add_f32 v228, v228, v230
v_add_f32 v229, v229, v231
v_cvt_pk_bf16_f32 v178, v228, v229
s_nop 3
v_pk_add_f32 v[232:233], v[232:233], v[234:235]
v_cvt_pk_bf16_f32 v179, v232, v233
v_bfi_b32 v176, 1, s96, v176
buffer_store_dwordx4 v[176:179], v250, s[8:11], s26 offen
v_lshrrev_b32 v216, 9, v247
v_mul_u32_u24 v216, 512, v216
v_add3_u32 v255, v247, v216, s99
ds_read_b128 v[216:219], v255
s_add_u32 s29, s29, 262144
s_add_u32 s30, s30, 262144
s_add_u32 s37, s37, 65536
s_add_u32 s31, s31, 65536
s_add_u32 s22, s22, 1
s_xor_b32 s44, s44, 8192
v_xor_b32 v249, 8192, v249
s_waitcnt vmcnt(0)
s_waitcnt lgkmcnt(0)
s_mov_b32 s36, 200000
buffer_load_dwordx4 v[184:187], v247, s[8:11], s27 offen offset:0 sc1
buffer_load_dwordx4 v[188:191], v247, s[8:11], s27 offen offset:1024 sc1
s_waitcnt vmcnt(0)
v_bitop3_b32 v255, v184, v188, s96 bitop3:0x7e
v_and_b32 v255, 1, v255
v_cmp_ne_u32 vcc, 0, v255
s_cbranch_vccz L_rok0_113
buffer_load_dwordx4 v[184:187], v247, s[8:11], s27 offen offset:0 sc1
buffer_load_dwordx4 v[188:191], v247, s[8:11], s27 offen offset:1024 sc1
L_pl_116:
buffer_load_dwordx4 v[192:195], v247, s[8:11], s27 offen offset:0 sc1
buffer_load_dwordx4 v[196:199], v247, s[8:11], s27 offen offset:1024 sc1
s_waitcnt vmcnt(2)
v_bitop3_b32 v255, v184, v188, s96 bitop3:0x7e
v_and_b32 v255, 1, v255
v_cmp_ne_u32 vcc, 0, v255
s_cbranch_vccz L_rok0_113
buffer_load_dwordx4 v[184:187], v247, s[8:11], s27 offen offset:0 sc1
buffer_load_dwordx4 v[188:191], v247, s[8:11], s27 offen offset:1024 sc1
s_waitcnt vmcnt(2)
v_bitop3_b32 v255, v192, v196, s96 bitop3:0x7e
v_and_b32 v255, 1, v255
v_cmp_ne_u32 vcc, 0, v255
s_cbranch_vccz L_rok1_114
s_sub_u32 s36, s36, 1
s_cmp_lg_u32 s36, 0
s_cbranch_scc1 L_pl_116
s_branch L_abort
L_rok1_114:
v_mfma_f32_16x16x32_bf16 v[220:223], v[192:195], v[216:219], 0
v_mfma_f32_16x16x32_bf16 v[220:223], v[196:199], v[216:219], v[220:223]
s_branch L_rjoin_115
L_rok0_113:
v_mfma_f32_16x16x32_bf16 v[220:223], v[184:187], v[216:219], 0
v_mfma_f32_16x16x32_bf16 v[220:223], v[188:191], v[216:219], v[220:223]
L_rjoin_115:
s_add_u32 s23, s23, 8192
s_and_b32 s23, s23, 0x107fff
s_add_u32 s24, s23, 4096
s_add_u32 s41, s23, 2 * 8192
s_and_b32 s41, s41, 0x107fff
v_mov_b32 v224, -1
s_nop 2
v_permlane32_swap_b32 v220, v222
v_permlane32_swap_b32 v221, v223
v_add_f32 v220, v220, v222
v_add_f32 v221, v221, v223
s_nop 1
v_permlane16_swap_b32 v220, v221
v_add_f32 v220, v220, v221
v_mov_b32 v221, v220
s_nop 1
v_permlane16_swap_b32 v220, v221
v_cvt_pk_bf16_f32 v220, v220, v221
v_min_u32 v220, 0xfffffffe, v220
buffer_store_dword v220, v251, s[8:11], s23 offen
s_xor_b32 s25, s25, 262144
s_xor_b32 s26, s26, 262144
s_xor_b32 s27, s27, 262144
s_bfe_u32 s96, s22, 0x10001
s_cmp_lg_u32 s22, 63
s_cbranch_scc1 L_step_w3f
v_mov_b64 v[160:161], 0
v_mov_b64 v[162:163], 0
v_mov_b64 v[164:165], 0
v_mov_b64 v[166:167], 0
v_mov_b64 v[168:169], 0
v_mov_b64 v[170:171], 0
v_mov_b64 v[172:173], 0
v_mov_b64 v[174:175], 0
v_mov_b64 v[176:177], 0
v_mov_b64 v[178:179], 0
v_mov_b64 v[180:181], 0
v_mov_b64 v[182:183], 0
s_mov_b32 s36, 200000
L_lpoll_117:
buffer_load_dwordx4 v[128:131], v247, s[8:11], s23 offen offset:0 sc1
buffer_load_dwordx4 v[132:135], v247, s[8:11], s23 offen offset:1024 sc1
buffer_load_dwordx4 v[136:139], v247, s[8:11], s23 offen offset:2048 sc1
buffer_load_dwordx4 v[140:143], v247, s[8:11], s23 offen offset:3072 sc1
buffer_load_dwordx4 v[144:147], v247, s[8:11], s24 offen offset:0 sc1
buffer_load_dwordx4 v[148:151], v247, s[8:11], s24 offen offset:1024 sc1
buffer_load_dwordx4 v[152:155], v247, s[8:11], s24 offen offset:2048 sc1
buffer_load_dwordx4 v[156:159], v247, s[8:11], s24 offen offset:3072 sc1
s_waitcnt vmcnt(0)
v_max3_u32 v255, v128, v129, v130
v_max3_u32 v255, v255, v131, v132
v_max3_u32 v255, v255, v133, v134
v_max3_u32 v255, v255, v135, v136
v_max3_u32 v255, v255, v137, v138
v_max3_u32 v255, v255, v139, v140
v_max3_u32 v255, v255, v141, v142
v_max3_u32 v255, v255, v143, v144
v_max3_u32 v255, v255, v145, v146
v_max3_u32 v255, v255, v147, v148
v_max3_u32 v255, v255, v149, v150
v_max3_u32 v255, v255, v151, v152
v_max3_u32 v255, v255, v153, v154
v_max3_u32 v255, v255, v155, v156
v_max3_u32 v255, v255, v157, v158
v_max_u32 v255, v255, v159
v_cmp_eq_u32 vcc, -1, v255
s_cbranch_vccnz L_lretry_118
v_smfmac_f32_16x16x64_bf16 v[164:167], v[128:131], a[128:135], v246
v_smfmac_f32_16x16x64_bf16 v[172:175], v[128:131], a[192:199], v246
v_smfmac_f32_16x16x64_bf16 v[176:179], v[128:131], v[0:7], v246
v_smfmac_f32_16x16x64_bf16 v[180:183], v[128:131], v[64:71], v246
v_smfmac_f32_16x16x64_bf16 v[164:167], v[132:135], a[136:143], v246
v_smfmac_f32_16x16x64_bf16 v[172:175], v[132:135], a[200:207], v246
v_smfmac_f32_16x16x64_bf16 v[176:179], v[132:135], v[8:15], v246
v_smfmac_f32_16x16x64_bf16 v[180:183], v[132:135], v[72:79], v246
v_smfmac_f32_16x16x64_bf16 v[164:167], v[136:139], a[144:151], v246
v_smfmac_f32_16x16x64_bf16 v[172:175], v[136:139], a[208:215], v246
v_smfmac_f32_16x16x64_bf16 v[176:179], v[136:139], v[16:23], v246
v_smfmac_f32_16x16x64_bf16 v[180:183], v[136:139], v[80:87], v246
v_smfmac_f32_16x16x64_bf16 v[164:167], v[140:143], a[152:159], v246
v_smfmac_f32_16x16x64_bf16 v[172:175], v[140:143], a[216:223], v246
v_smfmac_f32_16x16x64_bf16 v[176:179], v[140:143], v[24:31], v246
v_smfmac_f32_16x16x64_bf16 v[180:183], v[140:143], v[88:95], v246
v_smfmac_f32_16x16x64_bf16 v[164:167], v[144:147], a[160:167], v246
v_smfmac_f32_16x16x64_bf16 v[172:175], v[144:147], a[224:231], v246
v_smfmac_f32_16x16x64_bf16 v[176:179], v[144:147], v[32:39], v246
v_smfmac_f32_16x16x64_bf16 v[180:183], v[144:147], v[96:103], v246
v_smfmac_f32_16x16x64_bf16 v[164:167], v[148:151], a[168:175], v246
v_smfmac_f32_16x16x64_bf16 v[172:175], v[148:151], a[232:239], v246
v_smfmac_f32_16x16x64_bf16 v[176:179], v[148:151], v[40:47], v246
v_smfmac_f32_16x16x64_bf16 v[180:183], v[148:151], v[104:111], v246
v_smfmac_f32_16x16x64_bf16 v[164:167], v[152:155], a[176:183], v246
v_smfmac_f32_16x16x64_bf16 v[172:175], v[152:155], a[240:247], v246
v_smfmac_f32_16x16x64_bf16 v[176:179], v[152:155], v[48:55], v246
v_smfmac_f32_16x16x64_bf16 v[180:183], v[152:155], v[112:119], v246
v_smfmac_f32_16x16x64_bf16 v[164:167], v[156:159], a[184:191], v246
v_smfmac_f32_16x16x64_bf16 v[172:175], v[156:159], a[248:255], v246
v_smfmac_f32_16x16x64_bf16 v[176:179], v[156:159], v[56:63], v246
v_smfmac_f32_16x16x64_bf16 v[180:183], v[156:159], v[120:127], v246
v_add_f32 v160, v160, v162
v_add_f32 v161, v161, v163
s_nop 2
v_add_f32 v164, v164, v166
v_add_f32 v165, v165, v167
v_cvt_pk_bf16_f32 v163, v160, v161
v_cvt_pk_bf16_f32 v162, v164, v165
ds_write_b64 v252, v[162:163] offset:0
v_add_f32 v168, v168, v170
v_add_f32 v169, v169, v171
v_add_f32 v172, v172, v174
v_add_f32 v173, v173, v175
v_cvt_pk_bf16_f32 v171, v168, v169
v_cvt_pk_bf16_f32 v170, v172, v173
ds_write_b64 v252, v[170:171] offset:512
v_add_f32 v176, v176, v178
v_add_f32 v177, v177, v179
v_add_f32 v180, v180, v182
v_add_f32 v181, v181, v183
v_cvt_pk_bf16_f32 v240, v176, v177
v_cvt_pk_bf16_f32 v242, v180, v181
v_lshrrev_b32 v255, 2, v247
buffer_store_dword v240, v255, s[8:11], s37 offen sc1
buffer_store_dword v242, v255, s[8:11], s37 offen offset:256 sc1
s_waitcnt lgkmcnt(0)
s_barrier
v_mov_b32 v216, 63
v_mov_b32 v217, s46
buffer_store_dwordx2 v[216:217], v244, s[8:11], s47 offen sc1
ds_read_b64_tr_b16 v[184:185], v253 offset:3072
ds_read_b64_tr_b16 v[186:187], v253 offset:3584
s_waitcnt lgkmcnt(0)
buffer_store_dwordx4 v[184:187], v254, s[8:11], s31 offen offset:1536 sc1
s_waitcnt vmcnt(0)
s_barrier
v_mov_b32 v216, 64
v_mov_b32 v217, s46
buffer_store_dwordx2 v[216:217], v244, s[8:11], s47 offen sc1
L_done_w3f:
s_waitcnt vmcnt(0) lgkmcnt(0)
s_branch L_end_119
L_lretry_118:
s_sub_u32 s36, s36, 1
s_cmp_lg_u32 s36, 0
s_cbranch_scc1 L_lpoll_117
s_branch L_abort
L_hz_109:
s_cmp_ge_u32 s97, 64
s_cbranch_scc1 L_hzb_110
s_add_u32 s43, s22, 1
s_cmp_ge_u32 s43, s97
s_cbranch_scc1 L_hzblk_120
buffer_load_dwordx4 v[236:239], v244, s[8:11], s98 offen offset:16 sc1
buffer_load_dwordx4 v[240:243], v244, s[8:11], s98 offen offset:32 sc1
s_mov_b32 s42, 1
s_branch L_hzb_110
L_hzblk_120:
s_cmp_ge_u32 s43, 64
s_cbranch_scc1 L_hx_122
s_mov_b32 s36, 200000
L_hq_121:
buffer_load_dwordx4 v[216:219], v244, s[8:11], s98 offen offset:16 sc1
buffer_load_dwordx4 v[220:223], v244, s[8:11], s98 offen offset:32 sc1
s_sub_u32 s36, s36, 1
s_cmp_eq_u32 s36, 0
s_cbranch_scc1 L_abort
s_waitcnt vmcnt(0)
L_he_123:
v_cmp_eq_u32 vcc, s46, v217
s_nop 1
v_cndmask_b32 v216, 0, v216, vcc
v_cmp_eq_u32 vcc, s46, v219
s_nop 1
v_cndmask_b32 v218, 0, v218, vcc
v_cmp_eq_u32 vcc, s46, v221
s_nop 1
v_cndmask_b32 v220, 0, v220, vcc
v_cmp_eq_u32 vcc, s46, v223
s_nop 1
v_cndmask_b32 v222, 0, v222, vcc
v_min_u32 v216, v216, v220
v_min_u32 v217, v218, v222
v_lshlrev_b32 v216, 1, v216
v_lshl_add_u32 v217, v217, 1, 1
v_min_u32 v216, v216, v217
s_nop 0
v_readfirstlane_b32 s97, v216
s_cmp_ge_u32 s97, 64
s_cselect_b32 s97, 1000, s97
s_cmp_lt_u32 s43, s97
s_cbranch_scc0 L_hq_121
L_hx_122:
s_branch L_hzb_110
L_hze_111:
s_mov_b32 s42, 0
s_waitcnt vmcnt(3)
v_cmp_eq_u32 vcc, s46, v237
s_nop 1
v_cndmask_b32 v236, 0, v236, vcc
v_cmp_eq_u32 vcc, s46, v239
s_nop 1
v_cndmask_b32 v238, 0, v238, vcc
v_cmp_eq_u32 vcc, s46, v241
s_nop 1
v_cndmask_b32 v240, 0, v240, vcc
v_cmp_eq_u32 vcc, s46, v243
s_nop 1
v_cndmask_b32 v242, 0, v242, vcc
v_min_u32 v236, v236, v240
v_min_u32 v237, v238, v242
v_lshlrev_b32 v236, 1, v236
v_lshl_add_u32 v237, v237, 1, 1
v_min_u32 v236, v236, v237
s_nop 0
v_readfirstlane_b32 s97, v236
s_cmp_ge_u32 s97, 64
s_cselect_b32 s97, 1000, s97
v_mov_b32 v241, 0
v_mov_b32 v243, 0
s_branch L_hzf_112
L_end_119:
s_endpgm
L_cslow0:
L_step_w0s:
s_waitcnt vmcnt(0)
s_mov_b32 s36, 200000
buffer_load_dwordx4 v[184:187], v247, s[8:11], s23 offen offset:0 sc1
buffer_load_dwordx4 v[188:191], v247, s[8:11], s23 offen offset:1024 sc1
v_mov_b64 v[160:161], 0
v_mov_b64 v[162:163], 0
v_mov_b64 v[164:165], 0
v_mov_b64 v[166:167], 0
v_mov_b64 v[168:169], 0
v_mov_b64 v[170:171], 0
v_mov_b64 v[172:173], 0
v_mov_b64 v[174:175], 0
v_mov_b64 v[176:177], 0
v_mov_b64 v[178:179], 0
v_mov_b64 v[180:181], 0
v_mov_b64 v[182:183], 0
L_pl_127:
buffer_load_dwordx4 v[192:195], v247, s[8:11], s23 offen offset:0 sc1
buffer_load_dwordx4 v[196:199], v247, s[8:11], s23 offen offset:1024 sc1
s_waitcnt vmcnt(2)
ds_write_b128 v245, v[184:187] offset:0
ds_write_b128 v245, v[188:191] offset:1024
v_max3_u32 v255, v184, v185, v186
v_max3_u32 v255, v255, v187, v188
v_max3_u32 v255, v255, v189, v190
v_max_u32 v255, v255, v191
v_cmp_eq_u32 vcc, -1, v255
s_cbranch_vccz L_mok0_124
buffer_load_dwordx4 v[184:187], v247, s[8:11], s23 offen offset:0 sc1
buffer_load_dwordx4 v[188:191], v247, s[8:11], s23 offen offset:1024 sc1
s_waitcnt vmcnt(2)
ds_write_b128 v245, v[192:195] offset:0
ds_write_b128 v245, v[196:199] offset:1024
v_max3_u32 v255, v192, v193, v194
v_max3_u32 v255, v255, v195, v196
v_max3_u32 v255, v255, v197, v198
v_max_u32 v255, v255, v199
v_cmp_eq_u32 vcc, -1, v255
s_cbranch_vccz L_mok1_125
s_sub_u32 s36, s36, 1
s_cmp_lg_u32 s36, 0
s_cbranch_scc1 L_pl_127
s_branch L_abort
L_mok1_125:
v_smfmac_f32_16x16x64_bf16 v[160:163], v[192:195], a[0:7], v246
v_smfmac_f32_16x16x64_bf16 v[164:167], v[192:195], a[128:135], v246
v_smfmac_f32_16x16x64_bf16 v[168:171], v[192:195], a[64:71], v246
s_waitcnt lgkmcnt(0)
s_barrier
ds_read_b128 v[136:139], v245 offset:2048
ds_read_b128 v[140:143], v245 offset:3072
v_smfmac_f32_16x16x64_bf16 v[172:175], v[192:195], a[192:199], v246
ds_read_b128 v[144:147], v245 offset:4096
v_smfmac_f32_16x16x64_bf16 v[160:163], v[196:199], a[8:15], v246
ds_read_b128 v[148:151], v245 offset:5120
v_smfmac_f32_16x16x64_bf16 v[164:167], v[196:199], a[136:143], v246
ds_read_b128 v[152:155], v245 offset:6144
v_smfmac_f32_16x16x64_bf16 v[168:171], v[196:199], a[72:79], v246
ds_read_b128 v[156:159], v245 offset:7168
v_smfmac_f32_16x16x64_bf16 v[172:175], v[196:199], a[200:207], v246
ds_read_b128 v[128:131], v245 offset:0
ds_read_b128 v[132:135], v245 offset:1024
s_branch L_mjoin_126
L_mok0_124:
v_smfmac_f32_16x16x64_bf16 v[160:163], v[184:187], a[0:7], v246
v_smfmac_f32_16x16x64_bf16 v[164:167], v[184:187], a[128:135], v246
v_smfmac_f32_16x16x64_bf16 v[168:171], v[184:187], a[64:71], v246
s_waitcnt lgkmcnt(0)
s_barrier
ds_read_b128 v[136:139], v245 offset:2048
ds_read_b128 v[140:143], v245 offset:3072
v_smfmac_f32_16x16x64_bf16 v[172:175], v[184:187], a[192:199], v246
ds_read_b128 v[144:147], v245 offset:4096
v_smfmac_f32_16x16x64_bf16 v[160:163], v[188:191], a[8:15], v246
ds_read_b128 v[148:151], v245 offset:5120
v_smfmac_f32_16x16x64_bf16 v[164:167], v[188:191], a[136:143], v246
ds_read_b128 v[152:155], v245 offset:6144
v_smfmac_f32_16x16x64_bf16 v[168:171], v[188:191], a[72:79], v246
ds_read_b128 v[156:159], v245 offset:7168
v_smfmac_f32_16x16x64_bf16 v[172:175], v[188:191], a[200:207], v246
ds_read_b128 v[128:131], v245 offset:0
ds_read_b128 v[132:135], v245 offset:1024
L_mjoin_126:
buffer_store_dword v224, v251, s[8:11], s41 offen sc1
s_waitcnt lgkmcnt(7)
v_smfmac_f32_16x16x64_bf16 v[160:163], v[136:139], a[16:23], v246
ds_read_b128 v[200:203], v249 offset:4096
v_smfmac_f32_16x16x64_bf16 v[164:167], v[136:139], a[144:151], v246
buffer_load_dwordx4 v[228:231], v247, s[8:11], s30 offen offset:0 sc1 nt
v_smfmac_f32_16x16x64_bf16 v[168:171], v[136:139], a[80:87], v246
ds_read_b128 v[204:207], v249 offset:5120
v_smfmac_f32_16x16x64_bf16 v[172:175], v[136:139], a[208:215], v246
s_waitcnt lgkmcnt(8)
v_smfmac_f32_16x16x64_bf16 v[160:163], v[140:143], a[24:31], v246
ds_read_b128 v[208:211], v249 offset:6144
v_smfmac_f32_16x16x64_bf16 v[164:167], v[140:143], a[152:159], v246
buffer_load_dwordx4 v[232:235], v247, s[8:11], s30 offen offset:1024 sc1 nt
v_smfmac_f32_16x16x64_bf16 v[168:171], v[140:143], a[88:95], v246
ds_read_b128 v[212:215], v249 offset:7168
v_smfmac_f32_16x16x64_bf16 v[172:175], v[140:143], a[216:223], v246
s_waitcnt lgkmcnt(9)
v_smfmac_f32_16x16x64_bf16 v[160:163], v[144:147], a[32:39], v246
s_waitcnt vmcnt(3)
s_add_u32 s43, s22, 3
s_cmp_ge_u32 s43, s97
s_cbranch_scc1 L_hz_128
L_hzb_129:
ds_read_b128 v[184:187], v249 offset:0
v_smfmac_f32_16x16x64_bf16 v[164:167], v[144:147], a[160:167], v246
s_mov_b32 m0, s44
s_nop 0
buffer_load_dwordx4 v247, s[8:11], s29 offen sc1 nt lds
v_smfmac_f32_16x16x64_bf16 v[168:171], v[144:147], a[96:103], v246
ds_read_b128 v[188:191], v249 offset:1024
v_smfmac_f32_16x16x64_bf16 v[172:175], v[144:147], a[224:231], v246
s_waitcnt lgkmcnt(10)
v_smfmac_f32_16x16x64_bf16 v[160:163], v[148:151], a[40:47], v246
ds_read_b128 v[192:195], v249 offset:2048
v_smfmac_f32_16x16x64_bf16 v[164:167], v[148:151], a[168:175], v246
buffer_load_dwordx4 v247, s[8:11], s29 offen offset:1024 sc1 nt lds
v_smfmac_f32_16x16x64_bf16 v[168:171], v[148:151], a[104:111], v246
ds_read_b128 v[196:199], v249 offset:3072
v_smfmac_f32_16x16x64_bf16 v[172:175], v[148:151], a[232:239], v246
s_waitcnt lgkmcnt(8)
v_smfmac_f32_16x16x64_bf16 v[160:163], v[152:155], a[48:55], v246
v_smfmac_f32_16x16x64_bf16 v[164:167], v[152:155], a[176:183], v246
v_smfmac_f32_16x16x64_bf16 v[160:163], v[156:159], a[56:63], v246
v_smfmac_f32_16x16x64_bf16 v[164:167], v[156:159], a[184:191], v246
v_smfmac_f32_16x16x64_bf16 v[168:171], v[152:155], a[112:119], v246
v_smfmac_f32_16x16x64_bf16 v[172:175], v[152:155], a[240:247], v246
v_smfmac_f32_16x16x64_bf16 v[168:171], v[156:159], a[120:127], v246
v_smfmac_f32_16x16x64_bf16 v[172:175], v[156:159], a[248:255], v246
v_smfmac_f32_16x16x64_bf16 v[176:179], v[128:131], v[0:7], v246
s_nop 1
v_add_f32 v160, v160, v162
v_add_f32 v161, v161, v163
v_smfmac_f32_16x16x64_bf16 v[180:183], v[128:131], v[64:71], v246
v_add_f32 v164, v164, v166
v_add_f32 v165, v165, v167
v_smfmac_f32_16x16x64_bf16 v[176:179], v[132:135], v[8:15], v246
v_cvt_pk_bf16_f32 v163, v160, v161
v_cvt_pk_bf16_f32 v162, v164, v165
ds_write_b64 v252, v[162:163] offset:0
v_add_f32 v168, v168, v170
v_add_f32 v169, v169, v171
v_add_f32 v172, v172, v174
v_add_f32 v173, v173, v175
v_cvt_pk_bf16_f32 v171, v168, v169
v_cvt_pk_bf16_f32 v170, v172, v173
ds_write_b64 v252, v[170:171] offset:512
v_smfmac_f32_16x16x64_bf16 v[180:183], v[132:135], v[72:79], v246
v_smfmac_f32_16x16x64_bf16 v[176:179], v[136:139], v[16:23], v246
v_smfmac_f32_16x16x64_bf16 v[180:183], v[136:139], v[80:87], v246
v_smfmac_f32_16x16x64_bf16 v[176:179], v[140:143], v[24:31], v246
s_waitcnt lgkmcnt(0)
s_barrier
ds_read_b64_tr_b16 v[160:161], v253 offset:0
ds_read_b64_tr_b16 v[162:163], v253 offset:512
ds_read_b64_tr_b16 v[164:165], v253 offset:1024
v_smfmac_f32_16x16x64_bf16 v[180:183], v[140:143], v[88:95], v246
ds_read_b64_tr_b16 v[166:167], v253 offset:1536
v_smfmac_f32_16x16x64_bf16 v[176:179], v[144:147], v[32:39], v246
ds_read_b64_tr_b16 v[168:169], v253 offset:2048
v_smfmac_f32_16x16x64_bf16 v[180:183], v[144:147], v[96:103], v246
ds_read_b64_tr_b16 v[170:171], v253 offset:2560
v_smfmac_f32_16x16x64_bf16 v[176:179], v[148:151], v[40:47], v246
ds_read_b64_tr_b16 v[172:173], v253 offset:3072
v_smfmac_f32_16x16x64_bf16 v[180:183], v[148:151], v[104:111], v246
ds_read_b64_tr_b16 v[174:175], v253 offset:3584
s_waitcnt lgkmcnt(6)
v_mfma_f32_16x16x32_bf16 v[216:219], v[184:187], v[160:163], 0
v_mfma_f32_16x16x32_bf16 v[220:223], v[200:203], v[160:163], 0
ds_read_b128 v[128:131], v248 offset:4096
v_mfma_f32_16x16x32_bf16 v[224:227], v[160:163], v[160:163], 0
ds_read_b128 v[132:135], v248 offset:5120
s_waitcnt lgkmcnt(6)
v_mfma_f32_16x16x32_bf16 v[216:219], v[188:191], v[164:167], v[216:219]
ds_read_b128 v[136:139], v248 offset:20480
v_mfma_f32_16x16x32_bf16 v[220:223], v[204:207], v[164:167], v[220:223]
ds_read_b128 v[140:143], v248 offset:21504
v_mfma_f32_16x16x32_bf16 v[224:227], v[164:167], v[164:167], v[224:227]
ds_read_b128 v[144:147], v248 offset:6144
s_waitcnt lgkmcnt(7)
v_mfma_f32_16x16x32_bf16 v[216:219], v[192:195], v[168:171], v[216:219]
ds_read_b128 v[148:151], v248 offset:7168
v_mfma_f32_16x16x32_bf16 v[220:223], v[208:211], v[168:171], v[220:223]
v_mfma_f32_16x16x32_bf16 v[224:227], v[168:171], v[168:171], v[224:227]
s_waitcnt lgkmcnt(6)
v_mfma_f32_16x16x32_bf16 v[216:219], v[196:199], v[172:175], v[216:219]
v_mfma_f32_16x16x32_bf16 v[220:223], v[212:215], v[172:175], v[220:223]
v_mfma_f32_16x16x32_bf16 v[224:227], v[172:175], v[172:175], v[224:227]
buffer_store_dwordx4 v[160:163], v254, s[8:11], s31 offen offset:0 sc1
v_smfmac_f32_16x16x64_bf16 v[176:179], v[152:155], v[48:55], v246
v_smfmac_f32_16x16x64_bf16 v[180:183], v[152:155], v[112:119], v246
v_smfmac_f32_16x16x64_bf16 v[176:179], v[156:159], v[56:63], v246
v_smfmac_f32_16x16x64_bf16 v[180:183], v[156:159], v[120:127], v246
ds_read_b128 v[152:155], v248 offset:22528
ds_read_b128 v[156:159], v248 offset:23552
v_max3_f32 v168, v216, v217, v218
v_max3_f32 v169, v219, v220, v221
v_max3_f32 v168, v168, v222, v223
v_max3_f32 v169, v169, v224, v225
v_max_f32 v168, v168, v169
v_mov_b32 v169, v168
ds_read_b128 v[184:187], v248 offset:0
v_mov_b64 v[164:165], s[100:101]
v_permlane32_swap_b32 v168, v169
v_max_f32 v168, v168, v169
v_mov_b32 v169, v168
ds_read_b128 v[188:191], v248 offset:1024
v_mov_b64 v[166:167], s[100:101]
v_permlane16_swap_b32 v168, v169
v_max_f32 v168, v168, v169
v_mul_f32 v170, s35, v168
v_pk_fma_f32 v[216:217], v[216:217], s[34:35], v[170:171] op_sel_hi:[1,0,0]
v_pk_fma_f32 v[218:219], v[218:219], s[34:35], v[170:171] op_sel_hi:[1,0,0]
ds_read_b128 v[192:195], v248 offset:16384
v_pk_fma_f32 v[220:221], v[220:221], s[34:35], v[170:171] op_sel_hi:[1,0,0]
v_pk_fma_f32 v[222:223], v[222:223], s[34:35], v[170:171] op_sel_hi:[1,0,0]
v_pk_fma_f32 v[224:225], v[224:225], s[34:35], v[170:171] op_sel_hi:[1,0,0]
ds_read_b128 v[196:199], v248 offset:17408
v_exp_f32 v216, v216
v_exp_f32 v217, v217
v_exp_f32 v218, v218
ds_read_b128 v[200:203], v248 offset:2048
v_exp_f32 v219, v219
v_exp_f32 v220, v220
v_exp_f32 v221, v221
ds_read_b128 v[204:207], v248 offset:3072
v_exp_f32 v222, v222
v_exp_f32 v223, v223
v_exp_f32 v224, v224
ds_read_b128 v[208:211], v248 offset:18432
v_exp_f32 v225, v225
ds_read_b128 v[212:215], v248 offset:19456
v_mov_b32 v161, 0
v_mov_b64 v[162:163], 0
s_cmp_lg_u32 s42, 0
s_cbranch_scc1 L_hze_130
L_hzf_131:
v_cvt_pk_bf16_f32 v236, v216, v217
v_cvt_pk_bf16_f32 v237, v218, v219
v_cvt_pk_bf16_f32 v238, v220, v221
v_cvt_pk_bf16_f32 v239, v222, v223
v_cvt_pk_bf16_f32 v160, v224, v225
v_add_f32 v176, v176, v178
v_mfma_f32_16x16x32_bf16 v[224:227], v[236:239], v[164:167], 0
s_waitcnt vmcnt(3)
v_add_f32 v177, v177, v179
v_mfma_f32_16x16x32_bf16 v[216:219], v[236:239], v[228:231], 0
v_add_f32 v180, v180, v182
v_mfma_f32_16x16x32_bf16 v[220:223], v[236:239], v[232:235], 0
v_add_f32 v181, v181, v183
v_mfma_f32_16x16x32_bf16 v[224:227], v[160:163], v[164:167], v[224:227]
v_cvt_pk_bf16_f32 v240, v176, v177
v_cvt_pk_bf16_f32 v242, v180, v181
v_lshrrev_b32 v255, 2, v247
s_nop 0
v_mfma_f32_16x16x32_bf16 v[216:219], v[160:163], v[240:243], v[216:219]
v_mfma_f32_16x16x32_bf16 v[220:223], v[160:163], v[242:245], v[220:223]
buffer_store_dword v240, v255, s[8:11], s37 offen sc1
buffer_store_dword v242, v255, s[8:11], s37 offen offset:256 sc1
v_rcp_f32 v172, v226
v_rcp_f32 v173, v227
s_nop 2
v_pk_mul_f32 v[218:219], v[218:219], v[172:173]
v_pk_mul_f32 v[222:223], v[222:223], v[172:173]
v_cvt_pk_bf16_f32 v216, v218, v219
v_cvt_pk_bf16_f32 v217, v222, v223
ds_write_b64 v252, v[216:217] offset:12288
v_mov_b64 v[168:169], 0
v_mov_b64 v[170:171], 0
v_mov_b64 v[172:173], 0
v_mov_b64 v[174:175], 0
v_mov_b64 v[176:177], 0
v_mov_b64 v[178:179], 0
v_mov_b64 v[180:181], 0
v_mov_b64 v[182:183], 0
s_waitcnt lgkmcnt(0)
s_barrier
ds_read_b64_tr_b16 v[236:237], v253 offset:12288
ds_read_b64_tr_b16 v[238:239], v253 offset:13312
ds_read_b64_tr_b16 v[240:241], v253 offset:14336
ds_read_b64_tr_b16 v[242:243], v253 offset:15360
v_mov_b64 v[160:161], 0
v_mov_b64 v[162:163], 0
v_mov_b64 v[164:165], 0
v_mov_b64 v[166:167], 0
v_mov_b64 v[228:229], 0
v_mov_b64 v[230:231], 0
v_mov_b64 v[232:233], 0
v_mov_b64 v[234:235], 0
s_waitcnt lgkmcnt(0)
v_smfmac_f32_16x16x64_bf16 v[160:163], v[236:239], v[184:191], v246
ds_read_b128 v[184:187], v248 offset:8192
ds_read_b128 v[188:191], v248 offset:9216
v_smfmac_f32_16x16x64_bf16 v[160:163], v[240:243], v[192:199], v246
ds_read_b128 v[192:195], v248 offset:24576
v_smfmac_f32_16x16x64_bf16 v[164:167], v[236:239], v[200:207], v246
ds_read_b128 v[196:199], v248 offset:25600
ds_read_b128 v[200:203], v248 offset:10240
v_smfmac_f32_16x16x64_bf16 v[164:167], v[240:243], v[208:215], v246
ds_read_b128 v[204:207], v248 offset:11264
s_nop 1
v_add_f32 v160, v160, v162
v_smfmac_f32_16x16x64_bf16 v[168:171], v[236:239], v[128:135], v246
ds_read_b128 v[208:211], v248 offset:26624
ds_read_b128 v[212:215], v248 offset:27648
v_add_f32 v161, v161, v163
v_smfmac_f32_16x16x64_bf16 v[168:171], v[240:243], v[136:143], v246
ds_read_b128 v[128:131], v248 offset:12288
v_cvt_pk_bf16_f32 v160, v160, v161
v_smfmac_f32_16x16x64_bf16 v[172:175], v[236:239], v[144:151], v246
ds_read_b128 v[132:135], v248 offset:13312
ds_read_b128 v[136:139], v248 offset:28672
v_add_f32 v164, v164, v166
v_smfmac_f32_16x16x64_bf16 v[172:175], v[240:243], v[152:159], v246
ds_read_b128 v[140:143], v248 offset:29696
v_add_f32 v165, v165, v167
s_waitcnt lgkmcnt(10)
v_smfmac_f32_16x16x64_bf16 v[176:179], v[236:239], v[184:191], v246
ds_read_b128 v[144:147], v248 offset:14336
ds_read_b128 v[148:151], v248 offset:15360
v_cvt_pk_bf16_f32 v161, v164, v165
v_add_f32 v168, v168, v170
s_waitcnt lgkmcnt(10)
v_smfmac_f32_16x16x64_bf16 v[176:179], v[240:243], v[192:199], v246
ds_read_b128 v[152:155], v248 offset:30720
v_add_f32 v169, v169, v171
v_cvt_pk_bf16_f32 v162, v168, v169
s_waitcnt lgkmcnt(9)
v_smfmac_f32_16x16x64_bf16 v[180:183], v[236:239], v[200:207], v246
ds_read_b128 v[156:159], v248 offset:31744
v_add_f32 v172, v172, v174
v_add_f32 v173, v173, v175
s_waitcnt lgkmcnt(8)
v_smfmac_f32_16x16x64_bf16 v[180:183], v[240:243], v[208:215], v246
v_cvt_pk_bf16_f32 v163, v172, v173
v_bfi_b32 v160, 1, s96, v160
s_waitcnt lgkmcnt(6)
v_smfmac_f32_16x16x64_bf16 v[228:231], v[236:239], v[128:135], v246
buffer_store_dwordx4 v[160:163], v250, s[8:11], s25 offen sc1
v_add_f32 v176, v176, v178
s_waitcnt lgkmcnt(4)
v_smfmac_f32_16x16x64_bf16 v[228:231], v[240:243], v[136:143], v246
v_add_f32 v177, v177, v179
v_cvt_pk_bf16_f32 v176, v176, v177
s_waitcnt lgkmcnt(2)
v_smfmac_f32_16x16x64_bf16 v[232:235], v[236:239], v[144:151], v246
v_add_f32 v180, v180, v182
v_add_f32 v181, v181, v183
s_waitcnt lgkmcnt(0)
v_smfmac_f32_16x16x64_bf16 v[232:235], v[240:243], v[152:159], v246
v_cvt_pk_bf16_f32 v177, v180, v181
v_add_f32 v228, v228, v230
v_add_f32 v229, v229, v231
v_cvt_pk_bf16_f32 v178, v228, v229
s_nop 3
v_pk_add_f32 v[232:233], v[232:233], v[234:235]
v_cvt_pk_bf16_f32 v179, v232, v233
v_bfi_b32 v176, 1, s96, v176
buffer_store_dwordx4 v[176:179], v250, s[8:11], s26 offen sc1
v_lshrrev_b32 v216, 9, v247
v_mul_u32_u24 v216, 512, v216
v_add3_u32 v255, v247, v216, s99
ds_read_b128 v[216:219], v255
s_add_u32 s29, s29, 262144
s_add_u32 s30, s30, 262144
s_add_u32 s37, s37, 65536
s_add_u32 s31, s31, 65536
s_add_u32 s22, s22, 1
s_xor_b32 s44, s44, 8192
v_xor_b32 v249, 8192, v249
s_waitcnt vmcnt(0)
s_waitcnt lgkmcnt(0)
s_mov_b32 s36, 200000
buffer_load_dwordx4 v[184:187], v247, s[8:11], s27 offen offset:0 sc1
buffer_load_dwordx4 v[188:191], v247, s[8:11], s27 offen offset:1024 sc1
s_waitcnt vmcnt(0)
v_bitop3_b32 v255, v184, v188, s96 bitop3:0x7e
v_and_b32 v255, 1, v255
v_cmp_ne_u32 vcc, 0, v255
s_cbranch_vccz L_rok0_132
buffer_load_dwordx4 v[184:187], v247, s[8:11], s27 offen offset:0 sc1
buffer_load_dwordx4 v[188:191], v247, s[8:11], s27 offen offset:1024 sc1
L_pl_135:
buffer_load_dwordx4 v[192:195], v247, s[8:11], s27 offen offset:0 sc1
buffer_load_dwordx4 v[196:199], v247, s[8:11], s27 offen offset:1024 sc1
s_waitcnt vmcnt(2)
v_bitop3_b32 v255, v184, v188, s96 bitop3:0x7e
v_and_b32 v255, 1, v255
v_cmp_ne_u32 vcc, 0, v255
s_cbranch_vccz L_rok0_132
buffer_load_dwordx4 v[184:187], v247, s[8:11], s27 offen offset:0 sc1
buffer_load_dwordx4 v[188:191], v247, s[8:11], s27 offen offset:1024 sc1
s_waitcnt vmcnt(2)
v_bitop3_b32 v255, v192, v196, s96 bitop3:0x7e
v_and_b32 v255, 1, v255
v_cmp_ne_u32 vcc, 0, v255
s_cbranch_vccz L_rok1_133
s_sub_u32 s36, s36, 1
s_cmp_lg_u32 s36, 0
s_cbranch_scc1 L_pl_135
s_branch L_abort
L_rok1_133:
v_mfma_f32_16x16x32_bf16 v[220:223], v[192:195], v[216:219], 0
v_mfma_f32_16x16x32_bf16 v[220:223], v[196:199], v[216:219], v[220:223]
s_branch L_rjoin_134
L_rok0_132:
v_mfma_f32_16x16x32_bf16 v[220:223], v[184:187], v[216:219], 0
v_mfma_f32_16x16x32_bf16 v[220:223], v[188:191], v[216:219], v[220:223]
L_rjoin_134:
s_add_u32 s23, s23, 8192
s_and_b32 s23, s23, 0x107fff
s_add_u32 s24, s23, 4096
s_add_u32 s41, s23, 2 * 8192
s_and_b32 s41, s41, 0x107fff
v_mov_b32 v224, -1
s_nop 2
v_permlane32_swap_b32 v220, v222
v_permlane32_swap_b32 v221, v223
v_add_f32 v220, v220, v222
v_add_f32 v221, v221, v223
s_nop 1
v_permlane16_swap_b32 v220, v221
v_add_f32 v220, v220, v221
v_mov_b32 v221, v220
s_nop 1
v_permlane16_swap_b32 v220, v221
v_cvt_pk_bf16_f32 v220, v220, v221
v_min_u32 v220, 0xfffffffe, v220
buffer_store_dword v220, v251, s[8:11], s23 offen sc1
s_xor_b32 s25, s25, 262144
s_xor_b32 s26, s26, 262144
s_xor_b32 s27, s27, 262144
s_bfe_u32 s96, s22, 0x10001
s_cmp_lg_u32 s22, 63
s_cbranch_scc1 L_step_w0s
v_mov_b64 v[160:161], 0
v_mov_b64 v[162:163], 0
v_mov_b64 v[164:165], 0
v_mov_b64 v[166:167], 0
v_mov_b64 v[168:169], 0
v_mov_b64 v[170:171], 0
v_mov_b64 v[172:173], 0
v_mov_b64 v[174:175], 0
v_mov_b64 v[176:177], 0
v_mov_b64 v[178:179], 0
v_mov_b64 v[180:181], 0
v_mov_b64 v[182:183], 0
s_mov_b32 s36, 200000
L_lpoll_136:
buffer_load_dwordx4 v[128:131], v247, s[8:11], s23 offen offset:0 sc1
buffer_load_dwordx4 v[132:135], v247, s[8:11], s23 offen offset:1024 sc1
buffer_load_dwordx4 v[136:139], v247, s[8:11], s23 offen offset:2048 sc1
buffer_load_dwordx4 v[140:143], v247, s[8:11], s23 offen offset:3072 sc1
buffer_load_dwordx4 v[144:147], v247, s[8:11], s24 offen offset:0 sc1
buffer_load_dwordx4 v[148:151], v247, s[8:11], s24 offen offset:1024 sc1
buffer_load_dwordx4 v[152:155], v247, s[8:11], s24 offen offset:2048 sc1
buffer_load_dwordx4 v[156:159], v247, s[8:11], s24 offen offset:3072 sc1
s_waitcnt vmcnt(0)
v_max3_u32 v255, v128, v129, v130
v_max3_u32 v255, v255, v131, v132
v_max3_u32 v255, v255, v133, v134
v_max3_u32 v255, v255, v135, v136
v_max3_u32 v255, v255, v137, v138
v_max3_u32 v255, v255, v139, v140
v_max3_u32 v255, v255, v141, v142
v_max3_u32 v255, v255, v143, v144
v_max3_u32 v255, v255, v145, v146
v_max3_u32 v255, v255, v147, v148
v_max3_u32 v255, v255, v149, v150
v_max3_u32 v255, v255, v151, v152
v_max3_u32 v255, v255, v153, v154
v_max3_u32 v255, v255, v155, v156
v_max3_u32 v255, v255, v157, v158
v_max_u32 v255, v255, v159
v_cmp_eq_u32 vcc, -1, v255
s_cbranch_vccnz L_lretry_137
v_smfmac_f32_16x16x64_bf16 v[164:167], v[128:131], a[128:135], v246
v_smfmac_f32_16x16x64_bf16 v[172:175], v[128:131], a[192:199], v246
v_smfmac_f32_16x16x64_bf16 v[176:179], v[128:131], v[0:7], v246
v_smfmac_f32_16x16x64_bf16 v[180:183], v[128:131], v[64:71], v246
v_smfmac_f32_16x16x64_bf16 v[164:167], v[132:135], a[136:143], v246
v_smfmac_f32_16x16x64_bf16 v[172:175], v[132:135], a[200:207], v246
v_smfmac_f32_16x16x64_bf16 v[176:179], v[132:135], v[8:15], v246
v_smfmac_f32_16x16x64_bf16 v[180:183], v[132:135], v[72:79], v246
v_smfmac_f32_16x16x64_bf16 v[164:167], v[136:139], a[144:151], v246
v_smfmac_f32_16x16x64_bf16 v[172:175], v[136:139], a[208:215], v246
v_smfmac_f32_16x16x64_bf16 v[176:179], v[136:139], v[16:23], v246
v_smfmac_f32_16x16x64_bf16 v[180:183], v[136:139], v[80:87], v246
v_smfmac_f32_16x16x64_bf16 v[164:167], v[140:143], a[152:159], v246
v_smfmac_f32_16x16x64_bf16 v[172:175], v[140:143], a[216:223], v246
v_smfmac_f32_16x16x64_bf16 v[176:179], v[140:143], v[24:31], v246
v_smfmac_f32_16x16x64_bf16 v[180:183], v[140:143], v[88:95], v246
v_smfmac_f32_16x16x64_bf16 v[164:167], v[144:147], a[160:167], v246
v_smfmac_f32_16x16x64_bf16 v[172:175], v[144:147], a[224:231], v246
v_smfmac_f32_16x16x64_bf16 v[176:179], v[144:147], v[32:39], v246
v_smfmac_f32_16x16x64_bf16 v[180:183], v[144:147], v[96:103], v246
v_smfmac_f32_16x16x64_bf16 v[164:167], v[148:151], a[168:175], v246
v_smfmac_f32_16x16x64_bf16 v[172:175], v[148:151], a[232:239], v246
v_smfmac_f32_16x16x64_bf16 v[176:179], v[148:151], v[40:47], v246
v_smfmac_f32_16x16x64_bf16 v[180:183], v[148:151], v[104:111], v246
v_smfmac_f32_16x16x64_bf16 v[164:167], v[152:155], a[176:183], v246
v_smfmac_f32_16x16x64_bf16 v[172:175], v[152:155], a[240:247], v246
v_smfmac_f32_16x16x64_bf16 v[176:179], v[152:155], v[48:55], v246
v_smfmac_f32_16x16x64_bf16 v[180:183], v[152:155], v[112:119], v246
v_smfmac_f32_16x16x64_bf16 v[164:167], v[156:159], a[184:191], v246
v_smfmac_f32_16x16x64_bf16 v[172:175], v[156:159], a[248:255], v246
v_smfmac_f32_16x16x64_bf16 v[176:179], v[156:159], v[56:63], v246
v_smfmac_f32_16x16x64_bf16 v[180:183], v[156:159], v[120:127], v246
v_add_f32 v160, v160, v162
v_add_f32 v161, v161, v163
s_nop 2
v_add_f32 v164, v164, v166
v_add_f32 v165, v165, v167
v_cvt_pk_bf16_f32 v163, v160, v161
v_cvt_pk_bf16_f32 v162, v164, v165
ds_write_b64 v252, v[162:163] offset:0
v_add_f32 v168, v168, v170
v_add_f32 v169, v169, v171
v_add_f32 v172, v172, v174
v_add_f32 v173, v173, v175
v_cvt_pk_bf16_f32 v171, v168, v169
v_cvt_pk_bf16_f32 v170, v172, v173
ds_write_b64 v252, v[170:171] offset:512
v_add_f32 v176, v176, v178
v_add_f32 v177, v177, v179
v_add_f32 v180, v180, v182
v_add_f32 v181, v181, v183
v_cvt_pk_bf16_f32 v240, v176, v177
v_cvt_pk_bf16_f32 v242, v180, v181
v_lshrrev_b32 v255, 2, v247
buffer_store_dword v240, v255, s[8:11], s37 offen sc1
buffer_store_dword v242, v255, s[8:11], s37 offen offset:256 sc1
s_waitcnt lgkmcnt(0)
s_barrier
ds_read_b64_tr_b16 v[184:185], v253 offset:0
ds_read_b64_tr_b16 v[186:187], v253 offset:512
s_waitcnt lgkmcnt(0)
buffer_store_dwordx4 v[184:187], v254, s[8:11], s31 offen offset:0 sc1
s_waitcnt vmcnt(0)
s_barrier
L_done_w0s:
s_waitcnt vmcnt(0) lgkmcnt(0)
s_branch L_end_138
L_lretry_137:
s_sub_u32 s36, s36, 1
s_cmp_lg_u32 s36, 0
s_cbranch_scc1 L_lpoll_136
s_branch L_abort
L_hz_128:
s_cmp_ge_u32 s97, 64
s_cbranch_scc1 L_hzb_129
s_add_u32 s43, s22, 1
s_cmp_ge_u32 s43, s97
s_cbranch_scc1 L_hzblk_139
buffer_load_dwordx4 v[236:239], v244, s[8:11], s98 offen offset:16 sc1
buffer_load_dwordx4 v[240:243], v244, s[8:11], s98 offen offset:32 sc1
s_mov_b32 s42, 1
s_branch L_hzb_129
L_hzblk_139:
s_cmp_ge_u32 s43, 64
s_cbranch_scc1 L_hx_141
s_mov_b32 s36, 200000
L_hq_140:
buffer_load_dwordx4 v[216:219], v244, s[8:11], s98 offen offset:16 sc1
buffer_load_dwordx4 v[220:223], v244, s[8:11], s98 offen offset:32 sc1
s_sub_u32 s36, s36, 1
s_cmp_eq_u32 s36, 0
s_cbranch_scc1 L_abort
s_waitcnt vmcnt(0)
L_he_142:
v_cmp_eq_u32 vcc, s46, v217
s_nop 1
v_cndmask_b32 v216, 0, v216, vcc
v_cmp_eq_u32 vcc, s46, v219
s_nop 1
v_cndmask_b32 v218, 0, v218, vcc
v_cmp_eq_u32 vcc, s46, v221
s_nop 1
v_cndmask_b32 v220, 0, v220, vcc
v_cmp_eq_u32 vcc, s46, v223
s_nop 1
v_cndmask_b32 v222, 0, v222, vcc
v_min_u32 v216, v216, v220
v_min_u32 v217, v218, v222
v_lshlrev_b32 v216, 1, v216
v_lshl_add_u32 v217, v217, 1, 1
v_min_u32 v216, v216, v217
s_nop 0
v_readfirstlane_b32 s97, v216
s_cmp_ge_u32 s97, 64
s_cselect_b32 s97, 1000, s97
s_cmp_lt_u32 s43, s97
s_cbranch_scc0 L_hq_140
L_hx_141:
s_branch L_hzb_129
L_hze_130:
s_mov_b32 s42, 0
s_waitcnt vmcnt(3)
v_cmp_eq_u32 vcc, s46, v237
s_nop 1
v_cndmask_b32 v236, 0, v236, vcc
v_cmp_eq_u32 vcc, s46, v239
s_nop 1
v_cndmask_b32 v238, 0, v238, vcc
v_cmp_eq_u32 vcc, s46, v241
s_nop 1
v_cndmask_b32 v240, 0, v240, vcc
v_cmp_eq_u32 vcc, s46, v243
s_nop 1
v_cndmask_b32 v242, 0, v242, vcc
v_min_u32 v236, v236, v240
v_min_u32 v237, v238, v242
v_lshlrev_b32 v236, 1, v236
v_lshl_add_u32 v237, v237, 1, 1
v_min_u32 v236, v236, v237
s_nop 0
v_readfirstlane_b32 s97, v236
s_cmp_ge_u32 s97, 64
s_cselect_b32 s97, 1000, s97
v_mov_b32 v241, 0
v_mov_b32 v243, 0
s_branch L_hzf_131
L_end_138:
s_endpgm
L_cslow1:
L_step_w1s:
s_waitcnt vmcnt(0)
s_mov_b32 s36, 200000
buffer_load_dwordx4 v[184:187], v247, s[8:11], s23 offen offset:2048 sc1
buffer_load_dwordx4 v[188:191], v247, s[8:11], s23 offen offset:3072 sc1
v_mov_b64 v[160:161], 0
v_mov_b64 v[162:163], 0
v_mov_b64 v[164:165], 0
v_mov_b64 v[166:167], 0
v_mov_b64 v[168:169], 0
v_mov_b64 v[170:171], 0
v_mov_b64 v[172:173], 0
v_mov_b64 v[174:175], 0
v_mov_b64 v[176:177], 0
v_mov_b64 v[178:179], 0
v_mov_b64 v[180:181], 0
v_mov_b64 v[182:183], 0
L_pl_146:
buffer_load_dwordx4 v[192:195], v247, s[8:11], s23 offen offset:2048 sc1
buffer_load_dwordx4 v[196:199], v247, s[8:11], s23 offen offset:3072 sc1
s_waitcnt vmcnt(2)
ds_write_b128 v245, v[184:187] offset:2048
ds_write_b128 v245, v[188:191] offset:3072
v_max3_u32 v255, v184, v185, v186
v_max3_u32 v255, v255, v187, v188
v_max3_u32 v255, v255, v189, v190
v_max_u32 v255, v255, v191
v_cmp_eq_u32 vcc, -1, v255
s_cbranch_vccz L_mok0_143
buffer_load_dwordx4 v[184:187], v247, s[8:11], s23 offen offset:2048 sc1
buffer_load_dwordx4 v[188:191], v247, s[8:11], s23 offen offset:3072 sc1
s_waitcnt vmcnt(2)
ds_write_b128 v245, v[192:195] offset:2048
ds_write_b128 v245, v[196:199] offset:3072
v_max3_u32 v255, v192, v193, v194
v_max3_u32 v255, v255, v195, v196
v_max3_u32 v255, v255, v197, v198
v_max_u32 v255, v255, v199
v_cmp_eq_u32 vcc, -1, v255
s_cbranch_vccz L_mok1_144
s_sub_u32 s36, s36, 1
s_cmp_lg_u32 s36, 0
s_cbranch_scc1 L_pl_146
s_branch L_abort
L_mok1_144:
v_smfmac_f32_16x16x64_bf16 v[160:163], v[192:195], a[16:23], v246
v_smfmac_f32_16x16x64_bf16 v[164:167], v[192:195], a[144:151], v246
v_smfmac_f32_16x16x64_bf16 v[168:171], v[192:195], a[80:87], v246
s_waitcnt lgkmcnt(0)
s_barrier
ds_read_b128 v[128:131], v245 offset:0
ds_read_b128 v[132:135], v245 offset:1024
v_smfmac_f32_16x16x64_bf16 v[172:175], v[192:195], a[208:215], v246
ds_read_b128 v[144:147], v245 offset:4096
v_smfmac_f32_16x16x64_bf16 v[160:163], v[196:199], a[24:31], v246
ds_read_b128 v[148:151], v245 offset:5120
v_smfmac_f32_16x16x64_bf16 v[164:167], v[196:199], a[152:159], v246
ds_read_b128 v[152:155], v245 offset:6144
v_smfmac_f32_16x16x64_bf16 v[168:171], v[196:199], a[88:95], v246
ds_read_b128 v[156:159], v245 offset:7168
v_smfmac_f32_16x16x64_bf16 v[172:175], v[196:199], a[216:223], v246
ds_read_b128 v[136:139], v245 offset:2048
ds_read_b128 v[140:143], v245 offset:3072
s_branch L_mjoin_145
L_mok0_143:
v_smfmac_f32_16x16x64_bf16 v[160:163], v[184:187], a[16:23], v246
v_smfmac_f32_16x16x64_bf16 v[164:167], v[184:187], a[144:151], v246
v_smfmac_f32_16x16x64_bf16 v[168:171], v[184:187], a[80:87], v246
s_waitcnt lgkmcnt(0)
s_barrier
ds_read_b128 v[128:131], v245 offset:0
ds_read_b128 v[132:135], v245 offset:1024
v_smfmac_f32_16x16x64_bf16 v[172:175], v[184:187], a[208:215], v246
ds_read_b128 v[144:147], v245 offset:4096
v_smfmac_f32_16x16x64_bf16 v[160:163], v[188:191], a[24:31], v246
ds_read_b128 v[148:151], v245 offset:5120
v_smfmac_f32_16x16x64_bf16 v[164:167], v[188:191], a[152:159], v246
ds_read_b128 v[152:155], v245 offset:6144
v_smfmac_f32_16x16x64_bf16 v[168:171], v[188:191], a[88:95], v246
ds_read_b128 v[156:159], v245 offset:7168
v_smfmac_f32_16x16x64_bf16 v[172:175], v[188:191], a[216:223], v246
ds_read_b128 v[136:139], v245 offset:2048
ds_read_b128 v[140:143], v245 offset:3072
L_mjoin_145:
buffer_store_dword v224, v251, s[8:11], s41 offen sc1
s_waitcnt lgkmcnt(7)
v_smfmac_f32_16x16x64_bf16 v[160:163], v[128:131], a[0:7], v246
ds_read_b128 v[200:203], v249 offset:4096
v_smfmac_f32_16x16x64_bf16 v[164:167], v[128:131], a[128:135], v246
buffer_load_dwordx4 v[228:231], v247, s[8:11], s30 offen offset:0 sc1 nt
v_smfmac_f32_16x16x64_bf16 v[168:171], v[128:131], a[64:71], v246
ds_read_b128 v[204:207], v249 offset:5120
v_smfmac_f32_16x16x64_bf16 v[172:175], v[128:131], a[192:199], v246
s_waitcnt lgkmcnt(8)
v_smfmac_f32_16x16x64_bf16 v[160:163], v[132:135], a[8:15], v246
ds_read_b128 v[208:211], v249 offset:6144
v_smfmac_f32_16x16x64_bf16 v[164:167], v[132:135], a[136:143], v246
buffer_load_dwordx4 v[232:235], v247, s[8:11], s30 offen offset:1024 sc1 nt
v_smfmac_f32_16x16x64_bf16 v[168:171], v[132:135], a[72:79], v246
ds_read_b128 v[212:215], v249 offset:7168
v_smfmac_f32_16x16x64_bf16 v[172:175], v[132:135], a[200:207], v246
s_waitcnt lgkmcnt(9)
v_smfmac_f32_16x16x64_bf16 v[160:163], v[144:147], a[32:39], v246
s_waitcnt vmcnt(3)
s_add_u32 s43, s22, 3
s_cmp_ge_u32 s43, s97
s_cbranch_scc1 L_hz_147
L_hzb_148:
ds_read_b128 v[184:187], v249 offset:0
v_smfmac_f32_16x16x64_bf16 v[164:167], v[144:147], a[160:167], v246
s_mov_b32 m0, s44
s_nop 0
buffer_load_dwordx4 v247, s[8:11], s29 offen sc1 nt lds
v_smfmac_f32_16x16x64_bf16 v[168:171], v[144:147], a[96:103], v246
ds_read_b128 v[188:191], v249 offset:1024
v_smfmac_f32_16x16x64_bf16 v[172:175], v[144:147], a[224:231], v246
s_waitcnt lgkmcnt(10)
v_smfmac_f32_16x16x64_bf16 v[160:163], v[148:151], a[40:47], v246
ds_read_b128 v[192:195], v249 offset:2048
v_smfmac_f32_16x16x64_bf16 v[164:167], v[148:151], a[168:175], v246
buffer_load_dwordx4 v247, s[8:11], s29 offen offset:1024 sc1 nt lds
v_smfmac_f32_16x16x64_bf16 v[168:171], v[148:151], a[104:111], v246
ds_read_b128 v[196:199], v249 offset:3072
v_smfmac_f32_16x16x64_bf16 v[172:175], v[148:151], a[232:239], v246
s_waitcnt lgkmcnt(8)
v_smfmac_f32_16x16x64_bf16 v[160:163], v[152:155], a[48:55], v246
v_smfmac_f32_16x16x64_bf16 v[164:167], v[152:155], a[176:183], v246
v_smfmac_f32_16x16x64_bf16 v[160:163], v[156:159], a[56:63], v246
v_smfmac_f32_16x16x64_bf16 v[164:167], v[156:159], a[184:191], v246
v_smfmac_f32_16x16x64_bf16 v[168:171], v[152:155], a[112:119], v246
v_smfmac_f32_16x16x64_bf16 v[172:175], v[152:155], a[240:247], v246
v_smfmac_f32_16x16x64_bf16 v[168:171], v[156:159], a[120:127], v246
v_smfmac_f32_16x16x64_bf16 v[172:175], v[156:159], a[248:255], v246
v_smfmac_f32_16x16x64_bf16 v[176:179], v[128:131], v[0:7], v246
s_nop 1
v_add_f32 v160, v160, v162
v_add_f32 v161, v161, v163
v_smfmac_f32_16x16x64_bf16 v[180:183], v[128:131], v[64:71], v246
v_add_f32 v164, v164, v166
v_add_f32 v165, v165, v167
v_smfmac_f32_16x16x64_bf16 v[176:179], v[132:135], v[8:15], v246
v_cvt_pk_bf16_f32 v163, v160, v161
v_cvt_pk_bf16_f32 v162, v164, v165
ds_write_b64 v252, v[162:163] offset:0
v_add_f32 v168, v168, v170
v_add_f32 v169, v169, v171
v_add_f32 v172, v172, v174
v_add_f32 v173, v173, v175
v_cvt_pk_bf16_f32 v171, v168, v169
v_cvt_pk_bf16_f32 v170, v172, v173
ds_write_b64 v252, v[170:171] offset:512
v_smfmac_f32_16x16x64_bf16 v[180:183], v[132:135], v[72:79], v246
v_smfmac_f32_16x16x64_bf16 v[176:179], v[136:139], v[16:23], v246
v_smfmac_f32_16x16x64_bf16 v[180:183], v[136:139], v[80:87], v246
v_smfmac_f32_16x16x64_bf16 v[176:179], v[140:143], v[24:31], v246
s_waitcnt lgkmcnt(0)
s_barrier
ds_read_b64_tr_b16 v[160:161], v253 offset:0
ds_read_b64_tr_b16 v[162:163], v253 offset:512
ds_read_b64_tr_b16 v[164:165], v253 offset:1024
v_smfmac_f32_16x16x64_bf16 v[180:183], v[140:143], v[88:95], v246
ds_read_b64_tr_b16 v[166:167], v253 offset:1536
v_smfmac_f32_16x16x64_bf16 v[176:179], v[144:147], v[32:39], v246
ds_read_b64_tr_b16 v[168:169], v253 offset:2048
v_smfmac_f32_16x16x64_bf16 v[180:183], v[144:147], v[96:103], v246
ds_read_b64_tr_b16 v[170:171], v253 offset:2560
v_smfmac_f32_16x16x64_bf16 v[176:179], v[148:151], v[40:47], v246
ds_read_b64_tr_b16 v[172:173], v253 offset:3072
v_smfmac_f32_16x16x64_bf16 v[180:183], v[148:151], v[104:111], v246
ds_read_b64_tr_b16 v[174:175], v253 offset:3584
s_waitcnt lgkmcnt(6)
v_mfma_f32_16x16x32_bf16 v[216:219], v[184:187], v[160:163], 0
v_mfma_f32_16x16x32_bf16 v[220:223], v[200:203], v[160:163], 0
ds_read_b128 v[128:131], v248 offset:4096
v_mfma_f32_16x16x32_bf16 v[224:227], v[160:163], v[160:163], 0
ds_read_b128 v[132:135], v248 offset:5120
s_waitcnt lgkmcnt(6)
v_mfma_f32_16x16x32_bf16 v[216:219], v[188:191], v[164:167], v[216:219]
ds_read_b128 v[136:139], v248 offset:20480
v_mfma_f32_16x16x32_bf16 v[220:223], v[204:207], v[164:167], v[220:223]
ds_read_b128 v[140:143], v248 offset:21504
v_mfma_f32_16x16x32_bf16 v[224:227], v[164:167], v[164:167], v[224:227]
ds_read_b128 v[144:147], v248 offset:6144
s_waitcnt lgkmcnt(7)
v_mfma_f32_16x16x32_bf16 v[216:219], v[192:195], v[168:171], v[216:219]
ds_read_b128 v[148:151], v248 offset:7168
v_mfma_f32_16x16x32_bf16 v[220:223], v[208:211], v[168:171], v[220:223]
v_mfma_f32_16x16x32_bf16 v[224:227], v[168:171], v[168:171], v[224:227]
s_waitcnt lgkmcnt(6)
v_mfma_f32_16x16x32_bf16 v[216:219], v[196:199], v[172:175], v[216:219]
v_mfma_f32_16x16x32_bf16 v[220:223], v[212:215], v[172:175], v[220:223]
v_mfma_f32_16x16x32_bf16 v[224:227], v[172:175], v[172:175], v[224:227]
buffer_store_dwordx4 v[164:167], v254, s[8:11], s31 offen offset:512 sc1
v_smfmac_f32_16x16x64_bf16 v[176:179], v[152:155], v[48:55], v246
v_smfmac_f32_16x16x64_bf16 v[180:183], v[152:155], v[112:119], v246
v_smfmac_f32_16x16x64_bf16 v[176:179], v[156:159], v[56:63], v246
v_smfmac_f32_16x16x64_bf16 v[180:183], v[156:159], v[120:127], v246
ds_read_b128 v[152:155], v248 offset:22528
ds_read_b128 v[156:159], v248 offset:23552
v_max3_f32 v168, v216, v217, v218
v_max3_f32 v169, v219, v220, v221
v_max3_f32 v168, v168, v222, v223
v_max3_f32 v169, v169, v224, v225
v_max_f32 v168, v168, v169
v_mov_b32 v169, v168
ds_read_b128 v[184:187], v248 offset:0
v_mov_b64 v[164:165], s[100:101]
v_permlane32_swap_b32 v168, v169
v_max_f32 v168, v168, v169
v_mov_b32 v169, v168
ds_read_b128 v[188:191], v248 offset:1024
v_mov_b64 v[166:167], s[100:101]
v_permlane16_swap_b32 v168, v169
v_max_f32 v168, v168, v169
v_mul_f32 v170, s35, v168
v_pk_fma_f32 v[216:217], v[216:217], s[34:35], v[170:171] op_sel_hi:[1,0,0]
v_pk_fma_f32 v[218:219], v[218:219], s[34:35], v[170:171] op_sel_hi:[1,0,0]
ds_read_b128 v[192:195], v248 offset:16384
v_pk_fma_f32 v[220:221], v[220:221], s[34:35], v[170:171] op_sel_hi:[1,0,0]
v_pk_fma_f32 v[222:223], v[222:223], s[34:35], v[170:171] op_sel_hi:[1,0,0]
v_pk_fma_f32 v[224:225], v[224:225], s[34:35], v[170:171] op_sel_hi:[1,0,0]
ds_read_b128 v[196:199], v248 offset:17408
v_exp_f32 v216, v216
v_exp_f32 v217, v217
v_exp_f32 v218, v218
ds_read_b128 v[200:203], v248 offset:2048
v_exp_f32 v219, v219
v_exp_f32 v220, v220
v_exp_f32 v221, v221
ds_read_b128 v[204:207], v248 offset:3072
v_exp_f32 v222, v222
v_exp_f32 v223, v223
v_exp_f32 v224, v224
ds_read_b128 v[208:211], v248 offset:18432
v_exp_f32 v225, v225
ds_read_b128 v[212:215], v248 offset:19456
v_mov_b32 v161, 0
v_mov_b64 v[162:163], 0
s_cmp_lg_u32 s42, 0
s_cbranch_scc1 L_hze_149
L_hzf_150:
v_cvt_pk_bf16_f32 v236, v216, v217
v_cvt_pk_bf16_f32 v237, v218, v219
v_cvt_pk_bf16_f32 v238, v220, v221
v_cvt_pk_bf16_f32 v239, v222, v223
v_cvt_pk_bf16_f32 v160, v224, v225
v_add_f32 v176, v176, v178
v_mfma_f32_16x16x32_bf16 v[224:227], v[236:239], v[164:167], 0
s_waitcnt vmcnt(3)
v_add_f32 v177, v177, v179
v_mfma_f32_16x16x32_bf16 v[216:219], v[236:239], v[228:231], 0
v_add_f32 v180, v180, v182
v_mfma_f32_16x16x32_bf16 v[220:223], v[236:239], v[232:235], 0
v_add_f32 v181, v181, v183
v_mfma_f32_16x16x32_bf16 v[224:227], v[160:163], v[164:167], v[224:227]
v_cvt_pk_bf16_f32 v240, v176, v177
v_cvt_pk_bf16_f32 v242, v180, v181
v_lshrrev_b32 v255, 2, v247
s_nop 0
v_mfma_f32_16x16x32_bf16 v[216:219], v[160:163], v[240:243], v[216:219]
v_mfma_f32_16x16x32_bf16 v[220:223], v[160:163], v[242:245], v[220:223]
buffer_store_dword v240, v255, s[8:11], s37 offen sc1
buffer_store_dword v242, v255, s[8:11], s37 offen offset:256 sc1
v_rcp_f32 v172, v226
v_rcp_f32 v173, v227
s_nop 2
v_pk_mul_f32 v[218:219], v[218:219], v[172:173]
v_pk_mul_f32 v[222:223], v[222:223], v[172:173]
v_cvt_pk_bf16_f32 v216, v218, v219
v_cvt_pk_bf16_f32 v217, v222, v223
ds_write_b64 v252, v[216:217] offset:12288
v_mov_b64 v[168:169], 0
v_mov_b64 v[170:171], 0
v_mov_b64 v[172:173], 0
v_mov_b64 v[174:175], 0
v_mov_b64 v[176:177], 0
v_mov_b64 v[178:179], 0
v_mov_b64 v[180:181], 0
v_mov_b64 v[182:183], 0
s_waitcnt lgkmcnt(0)
s_barrier
ds_read_b64_tr_b16 v[236:237], v253 offset:12288
ds_read_b64_tr_b16 v[238:239], v253 offset:13312
ds_read_b64_tr_b16 v[240:241], v253 offset:14336
ds_read_b64_tr_b16 v[242:243], v253 offset:15360
v_mov_b64 v[160:161], 0
v_mov_b64 v[162:163], 0
v_mov_b64 v[164:165], 0
v_mov_b64 v[166:167], 0
v_mov_b64 v[228:229], 0
v_mov_b64 v[230:231], 0
v_mov_b64 v[232:233], 0
v_mov_b64 v[234:235], 0
s_waitcnt lgkmcnt(0)
v_smfmac_f32_16x16x64_bf16 v[160:163], v[236:239], v[184:191], v246
ds_read_b128 v[184:187], v248 offset:8192
ds_read_b128 v[188:191], v248 offset:9216
v_smfmac_f32_16x16x64_bf16 v[160:163], v[240:243], v[192:199], v246
ds_read_b128 v[192:195], v248 offset:24576
v_smfmac_f32_16x16x64_bf16 v[164:167], v[236:239], v[200:207], v246
ds_read_b128 v[196:199], v248 offset:25600
ds_read_b128 v[200:203], v248 offset:10240
v_smfmac_f32_16x16x64_bf16 v[164:167], v[240:243], v[208:215], v246
ds_read_b128 v[204:207], v248 offset:11264
s_nop 1
v_add_f32 v160, v160, v162
v_smfmac_f32_16x16x64_bf16 v[168:171], v[236:239], v[128:135], v246
ds_read_b128 v[208:211], v248 offset:26624
ds_read_b128 v[212:215], v248 offset:27648
v_add_f32 v161, v161, v163
v_smfmac_f32_16x16x64_bf16 v[168:171], v[240:243], v[136:143], v246
ds_read_b128 v[128:131], v248 offset:12288
v_cvt_pk_bf16_f32 v160, v160, v161
v_smfmac_f32_16x16x64_bf16 v[172:175], v[236:239], v[144:151], v246
ds_read_b128 v[132:135], v248 offset:13312
ds_read_b128 v[136:139], v248 offset:28672
v_add_f32 v164, v164, v166
v_smfmac_f32_16x16x64_bf16 v[172:175], v[240:243], v[152:159], v246
ds_read_b128 v[140:143], v248 offset:29696
v_add_f32 v165, v165, v167
s_waitcnt lgkmcnt(10)
v_smfmac_f32_16x16x64_bf16 v[176:179], v[236:239], v[184:191], v246
ds_read_b128 v[144:147], v248 offset:14336
ds_read_b128 v[148:151], v248 offset:15360
v_cvt_pk_bf16_f32 v161, v164, v165
v_add_f32 v168, v168, v170
s_waitcnt lgkmcnt(10)
v_smfmac_f32_16x16x64_bf16 v[176:179], v[240:243], v[192:199], v246
ds_read_b128 v[152:155], v248 offset:30720
v_add_f32 v169, v169, v171
v_cvt_pk_bf16_f32 v162, v168, v169
s_waitcnt lgkmcnt(9)
v_smfmac_f32_16x16x64_bf16 v[180:183], v[236:239], v[200:207], v246
ds_read_b128 v[156:159], v248 offset:31744
v_add_f32 v172, v172, v174
v_add_f32 v173, v173, v175
s_waitcnt lgkmcnt(8)
v_smfmac_f32_16x16x64_bf16 v[180:183], v[240:243], v[208:215], v246
v_cvt_pk_bf16_f32 v163, v172, v173
v_bfi_b32 v160, 1, s96, v160
s_waitcnt lgkmcnt(6)
v_smfmac_f32_16x16x64_bf16 v[228:231], v[236:239], v[128:135], v246
buffer_store_dwordx4 v[160:163], v250, s[8:11], s25 offen sc1
v_add_f32 v176, v176, v178
s_waitcnt lgkmcnt(4)
v_smfmac_f32_16x16x64_bf16 v[228:231], v[240:243], v[136:143], v246
v_add_f32 v177, v177, v179
v_cvt_pk_bf16_f32 v176, v176, v177
s_waitcnt lgkmcnt(2)
v_smfmac_f32_16x16x64_bf16 v[232:235], v[236:239], v[144:151], v246
v_add_f32 v180, v180, v182
v_add_f32 v181, v181, v183
s_waitcnt lgkmcnt(0)
v_smfmac_f32_16x16x64_bf16 v[232:235], v[240:243], v[152:159], v246
v_cvt_pk_bf16_f32 v177, v180, v181
v_add_f32 v228, v228, v230
v_add_f32 v229, v229, v231
v_cvt_pk_bf16_f32 v178, v228, v229
s_nop 3
v_pk_add_f32 v[232:233], v[232:233], v[234:235]
v_cvt_pk_bf16_f32 v179, v232, v233
v_bfi_b32 v176, 1, s96, v176
buffer_store_dwordx4 v[176:179], v250, s[8:11], s26 offen sc1
v_lshrrev_b32 v216, 9, v247
v_mul_u32_u24 v216, 512, v216
v_add3_u32 v255, v247, v216, s99
ds_read_b128 v[216:219], v255
s_add_u32 s29, s29, 262144
s_add_u32 s30, s30, 262144
s_add_u32 s37, s37, 65536
s_add_u32 s31, s31, 65536
s_add_u32 s22, s22, 1
s_xor_b32 s44, s44, 8192
v_xor_b32 v249, 8192, v249
s_waitcnt vmcnt(0)
s_waitcnt lgkmcnt(0)
s_mov_b32 s36, 200000
buffer_load_dwordx4 v[184:187], v247, s[8:11], s27 offen offset:0 sc1
buffer_load_dwordx4 v[188:191], v247, s[8:11], s27 offen offset:1024 sc1
s_waitcnt vmcnt(0)
v_bitop3_b32 v255, v184, v188, s96 bitop3:0x7e
v_and_b32 v255, 1, v255
v_cmp_ne_u32 vcc, 0, v255
s_cbranch_vccz L_rok0_151
buffer_load_dwordx4 v[184:187], v247, s[8:11], s27 offen offset:0 sc1
buffer_load_dwordx4 v[188:191], v247, s[8:11], s27 offen offset:1024 sc1
L_pl_154:
buffer_load_dwordx4 v[192:195], v247, s[8:11], s27 offen offset:0 sc1
buffer_load_dwordx4 v[196:199], v247, s[8:11], s27 offen offset:1024 sc1
s_waitcnt vmcnt(2)
v_bitop3_b32 v255, v184, v188, s96 bitop3:0x7e
v_and_b32 v255, 1, v255
v_cmp_ne_u32 vcc, 0, v255
s_cbranch_vccz L_rok0_151
buffer_load_dwordx4 v[184:187], v247, s[8:11], s27 offen offset:0 sc1
buffer_load_dwordx4 v[188:191], v247, s[8:11], s27 offen offset:1024 sc1
s_waitcnt vmcnt(2)
v_bitop3_b32 v255, v192, v196, s96 bitop3:0x7e
v_and_b32 v255, 1, v255
v_cmp_ne_u32 vcc, 0, v255
s_cbranch_vccz L_rok1_152
s_sub_u32 s36, s36, 1
s_cmp_lg_u32 s36, 0
s_cbranch_scc1 L_pl_154
s_branch L_abort
L_rok1_152:
v_mfma_f32_16x16x32_bf16 v[220:223], v[192:195], v[216:219], 0
v_mfma_f32_16x16x32_bf16 v[220:223], v[196:199], v[216:219], v[220:223]
s_branch L_rjoin_153
L_rok0_151:
v_mfma_f32_16x16x32_bf16 v[220:223], v[184:187], v[216:219], 0
v_mfma_f32_16x16x32_bf16 v[220:223], v[188:191], v[216:219], v[220:223]
L_rjoin_153:
s_add_u32 s23, s23, 8192
s_and_b32 s23, s23, 0x107fff
s_add_u32 s24, s23, 4096
s_add_u32 s41, s23, 2 * 8192
s_and_b32 s41, s41, 0x107fff
v_mov_b32 v224, -1
s_nop 2
v_permlane32_swap_b32 v220, v222
v_permlane32_swap_b32 v221, v223
v_add_f32 v220, v220, v222
v_add_f32 v221, v221, v223
s_nop 1
v_permlane16_swap_b32 v220, v221
v_add_f32 v220, v220, v221
v_mov_b32 v221, v220
s_nop 1
v_permlane16_swap_b32 v220, v221
v_cvt_pk_bf16_f32 v220, v220, v221
v_min_u32 v220, 0xfffffffe, v220
buffer_store_dword v220, v251, s[8:11], s23 offen sc1
s_xor_b32 s25, s25, 262144
s_xor_b32 s26, s26, 262144
s_xor_b32 s27, s27, 262144
s_bfe_u32 s96, s22, 0x10001
s_cmp_lg_u32 s22, 63
s_cbranch_scc1 L_step_w1s
v_mov_b64 v[160:161], 0
v_mov_b64 v[162:163], 0
v_mov_b64 v[164:165], 0
v_mov_b64 v[166:167], 0
v_mov_b64 v[168:169], 0
v_mov_b64 v[170:171], 0
v_mov_b64 v[172:173], 0
v_mov_b64 v[174:175], 0
v_mov_b64 v[176:177], 0
v_mov_b64 v[178:179], 0
v_mov_b64 v[180:181], 0
v_mov_b64 v[182:183], 0
s_mov_b32 s36, 200000
L_lpoll_155:
buffer_load_dwordx4 v[128:131], v247, s[8:11], s23 offen offset:0 sc1
buffer_load_dwordx4 v[132:135], v247, s[8:11], s23 offen offset:1024 sc1
buffer_load_dwordx4 v[136:139], v247, s[8:11], s23 offen offset:2048 sc1
buffer_load_dwordx4 v[140:143], v247, s[8:11], s23 offen offset:3072 sc1
buffer_load_dwordx4 v[144:147], v247, s[8:11], s24 offen offset:0 sc1
buffer_load_dwordx4 v[148:151], v247, s[8:11], s24 offen offset:1024 sc1
buffer_load_dwordx4 v[152:155], v247, s[8:11], s24 offen offset:2048 sc1
buffer_load_dwordx4 v[156:159], v247, s[8:11], s24 offen offset:3072 sc1
s_waitcnt vmcnt(0)
v_max3_u32 v255, v128, v129, v130
v_max3_u32 v255, v255, v131, v132
v_max3_u32 v255, v255, v133, v134
v_max3_u32 v255, v255, v135, v136
v_max3_u32 v255, v255, v137, v138
v_max3_u32 v255, v255, v139, v140
v_max3_u32 v255, v255, v141, v142
v_max3_u32 v255, v255, v143, v144
v_max3_u32 v255, v255, v145, v146
v_max3_u32 v255, v255, v147, v148
v_max3_u32 v255, v255, v149, v150
v_max3_u32 v255, v255, v151, v152
v_max3_u32 v255, v255, v153, v154
v_max3_u32 v255, v255, v155, v156
v_max3_u32 v255, v255, v157, v158
v_max_u32 v255, v255, v159
v_cmp_eq_u32 vcc, -1, v255
s_cbranch_vccnz L_lretry_156
v_smfmac_f32_16x16x64_bf16 v[164:167], v[128:131], a[128:135], v246
v_smfmac_f32_16x16x64_bf16 v[172:175], v[128:131], a[192:199], v246
v_smfmac_f32_16x16x64_bf16 v[176:179], v[128:131], v[0:7], v246
v_smfmac_f32_16x16x64_bf16 v[180:183], v[128:131], v[64:71], v246
v_smfmac_f32_16x16x64_bf16 v[164:167], v[132:135], a[136:143], v246
v_smfmac_f32_16x16x64_bf16 v[172:175], v[132:135], a[200:207], v246
v_smfmac_f32_16x16x64_bf16 v[176:179], v[132:135], v[8:15], v246
v_smfmac_f32_16x16x64_bf16 v[180:183], v[132:135], v[72:79], v246
v_smfmac_f32_16x16x64_bf16 v[164:167], v[136:139], a[144:151], v246
v_smfmac_f32_16x16x64_bf16 v[172:175], v[136:139], a[208:215], v246
v_smfmac_f32_16x16x64_bf16 v[176:179], v[136:139], v[16:23], v246
v_smfmac_f32_16x16x64_bf16 v[180:183], v[136:139], v[80:87], v246
v_smfmac_f32_16x16x64_bf16 v[164:167], v[140:143], a[152:159], v246
v_smfmac_f32_16x16x64_bf16 v[172:175], v[140:143], a[216:223], v246
v_smfmac_f32_16x16x64_bf16 v[176:179], v[140:143], v[24:31], v246
v_smfmac_f32_16x16x64_bf16 v[180:183], v[140:143], v[88:95], v246
v_smfmac_f32_16x16x64_bf16 v[164:167], v[144:147], a[160:167], v246
v_smfmac_f32_16x16x64_bf16 v[172:175], v[144:147], a[224:231], v246
v_smfmac_f32_16x16x64_bf16 v[176:179], v[144:147], v[32:39], v246
v_smfmac_f32_16x16x64_bf16 v[180:183], v[144:147], v[96:103], v246
v_smfmac_f32_16x16x64_bf16 v[164:167], v[148:151], a[168:175], v246
v_smfmac_f32_16x16x64_bf16 v[172:175], v[148:151], a[232:239], v246
v_smfmac_f32_16x16x64_bf16 v[176:179], v[148:151], v[40:47], v246
v_smfmac_f32_16x16x64_bf16 v[180:183], v[148:151], v[104:111], v246
v_smfmac_f32_16x16x64_bf16 v[164:167], v[152:155], a[176:183], v246
v_smfmac_f32_16x16x64_bf16 v[172:175], v[152:155], a[240:247], v246
v_smfmac_f32_16x16x64_bf16 v[176:179], v[152:155], v[48:55], v246
v_smfmac_f32_16x16x64_bf16 v[180:183], v[152:155], v[112:119], v246
v_smfmac_f32_16x16x64_bf16 v[164:167], v[156:159], a[184:191], v246
v_smfmac_f32_16x16x64_bf16 v[172:175], v[156:159], a[248:255], v246
v_smfmac_f32_16x16x64_bf16 v[176:179], v[156:159], v[56:63], v246
v_smfmac_f32_16x16x64_bf16 v[180:183], v[156:159], v[120:127], v246
v_add_f32 v160, v160, v162
v_add_f32 v161, v161, v163
s_nop 2
v_add_f32 v164, v164, v166
v_add_f32 v165, v165, v167
v_cvt_pk_bf16_f32 v163, v160, v161
v_cvt_pk_bf16_f32 v162, v164, v165
ds_write_b64 v252, v[162:163] offset:0
v_add_f32 v168, v168, v170
v_add_f32 v169, v169, v171
v_add_f32 v172, v172, v174
v_add_f32 v173, v173, v175
v_cvt_pk_bf16_f32 v171, v168, v169
v_cvt_pk_bf16_f32 v170, v172, v173
ds_write_b64 v252, v[170:171] offset:512
v_add_f32 v176, v176, v178
v_add_f32 v177, v177, v179
v_add_f32 v180, v180, v182
v_add_f32 v181, v181, v183
v_cvt_pk_bf16_f32 v240, v176, v177
v_cvt_pk_bf16_f32 v242, v180, v181
v_lshrrev_b32 v255, 2, v247
buffer_store_dword v240, v255, s[8:11], s37 offen sc1
buffer_store_dword v242, v255, s[8:11], s37 offen offset:256 sc1
s_waitcnt lgkmcnt(0)
s_barrier
ds_read_b64_tr_b16 v[184:185], v253 offset:1024
ds_read_b64_tr_b16 v[186:187], v253 offset:1536
s_waitcnt lgkmcnt(0)
buffer_store_dwordx4 v[184:187], v254, s[8:11], s31 offen offset:512 sc1
s_waitcnt vmcnt(0)
s_barrier
L_done_w1s:
s_waitcnt vmcnt(0) lgkmcnt(0)
s_branch L_end_157
L_lretry_156:
s_sub_u32 s36, s36, 1
s_cmp_lg_u32 s36, 0
s_cbranch_scc1 L_lpoll_155
s_branch L_abort
L_hz_147:
s_cmp_ge_u32 s97, 64
s_cbranch_scc1 L_hzb_148
s_add_u32 s43, s22, 1
s_cmp_ge_u32 s43, s97
s_cbranch_scc1 L_hzblk_158
buffer_load_dwordx4 v[236:239], v244, s[8:11], s98 offen offset:16 sc1
buffer_load_dwordx4 v[240:243], v244, s[8:11], s98 offen offset:32 sc1
s_mov_b32 s42, 1
s_branch L_hzb_148
L_hzblk_158:
s_cmp_ge_u32 s43, 64
s_cbranch_scc1 L_hx_160
s_mov_b32 s36, 200000
L_hq_159:
buffer_load_dwordx4 v[216:219], v244, s[8:11], s98 offen offset:16 sc1
buffer_load_dwordx4 v[220:223], v244, s[8:11], s98 offen offset:32 sc1
s_sub_u32 s36, s36, 1
s_cmp_eq_u32 s36, 0
s_cbranch_scc1 L_abort
s_waitcnt vmcnt(0)
L_he_161:
v_cmp_eq_u32 vcc, s46, v217
s_nop 1
v_cndmask_b32 v216, 0, v216, vcc
v_cmp_eq_u32 vcc, s46, v219
s_nop 1
v_cndmask_b32 v218, 0, v218, vcc
v_cmp_eq_u32 vcc, s46, v221
s_nop 1
v_cndmask_b32 v220, 0, v220, vcc
v_cmp_eq_u32 vcc, s46, v223
s_nop 1
v_cndmask_b32 v222, 0, v222, vcc
v_min_u32 v216, v216, v220
v_min_u32 v217, v218, v222
v_lshlrev_b32 v216, 1, v216
v_lshl_add_u32 v217, v217, 1, 1
v_min_u32 v216, v216, v217
s_nop 0
v_readfirstlane_b32 s97, v216
s_cmp_ge_u32 s97, 64
s_cselect_b32 s97, 1000, s97
s_cmp_lt_u32 s43, s97
s_cbranch_scc0 L_hq_159
L_hx_160:
s_branch L_hzb_148
L_hze_149:
s_mov_b32 s42, 0
s_waitcnt vmcnt(3)
v_cmp_eq_u32 vcc, s46, v237
s_nop 1
v_cndmask_b32 v236, 0, v236, vcc
v_cmp_eq_u32 vcc, s46, v239
s_nop 1
v_cndmask_b32 v238, 0, v238, vcc
v_cmp_eq_u32 vcc, s46, v241
s_nop 1
v_cndmask_b32 v240, 0, v240, vcc
v_cmp_eq_u32 vcc, s46, v243
s_nop 1
v_cndmask_b32 v242, 0, v242, vcc
v_min_u32 v236, v236, v240
v_min_u32 v237, v238, v242
v_lshlrev_b32 v236, 1, v236
v_lshl_add_u32 v237, v237, 1, 1
v_min_u32 v236, v236, v237
s_nop 0
v_readfirstlane_b32 s97, v236
s_cmp_ge_u32 s97, 64
s_cselect_b32 s97, 1000, s97
v_mov_b32 v241, 0
v_mov_b32 v243, 0
s_branch L_hzf_150
L_end_157:
s_endpgm
L_cslow2:
L_step_w2s:
s_waitcnt vmcnt(0)
s_mov_b32 s36, 200000
buffer_load_dwordx4 v[184:187], v247, s[8:11], s24 offen offset:0 sc1
buffer_load_dwordx4 v[188:191], v247, s[8:11], s24 offen offset:1024 sc1
v_mov_b64 v[160:161], 0
v_mov_b64 v[162:163], 0
v_mov_b64 v[164:165], 0
v_mov_b64 v[166:167], 0
v_mov_b64 v[168:169], 0
v_mov_b64 v[170:171], 0
v_mov_b64 v[172:173], 0
v_mov_b64 v[174:175], 0
v_mov_b64 v[176:177], 0
v_mov_b64 v[178:179], 0
v_mov_b64 v[180:181], 0
v_mov_b64 v[182:183], 0
L_pl_165:
buffer_load_dwordx4 v[192:195], v247, s[8:11], s24 offen offset:0 sc1
buffer_load_dwordx4 v[196:199], v247, s[8:11], s24 offen offset:1024 sc1
s_waitcnt vmcnt(2)
ds_write_b128 v245, v[184:187] offset:4096
ds_write_b128 v245, v[188:191] offset:5120
v_max3_u32 v255, v184, v185, v186
v_max3_u32 v255, v255, v187, v188
v_max3_u32 v255, v255, v189, v190
v_max_u32 v255, v255, v191
v_cmp_eq_u32 vcc, -1, v255
s_cbranch_vccz L_mok0_162
buffer_load_dwordx4 v[184:187], v247, s[8:11], s24 offen offset:0 sc1
buffer_load_dwordx4 v[188:191], v247, s[8:11], s24 offen offset:1024 sc1
s_waitcnt vmcnt(2)
ds_write_b128 v245, v[192:195] offset:4096
ds_write_b128 v245, v[196:199] offset:5120
v_max3_u32 v255, v192, v193, v194
v_max3_u32 v255, v255, v195, v196
v_max3_u32 v255, v255, v197, v198
v_max_u32 v255, v255, v199
v_cmp_eq_u32 vcc, -1, v255
s_cbranch_vccz L_mok1_163
s_sub_u32 s36, s36, 1
s_cmp_lg_u32 s36, 0
s_cbranch_scc1 L_pl_165
s_branch L_abort
L_mok1_163:
v_smfmac_f32_16x16x64_bf16 v[160:163], v[192:195], a[32:39], v246
v_smfmac_f32_16x16x64_bf16 v[164:167], v[192:195], a[160:167], v246
v_smfmac_f32_16x16x64_bf16 v[168:171], v[192:195], a[96:103], v246
s_waitcnt lgkmcnt(0)
s_barrier
ds_read_b128 v[128:131], v245 offset:0
ds_read_b128 v[132:135], v245 offset:1024
v_smfmac_f32_16x16x64_bf16 v[172:175], v[192:195], a[224:231], v246
ds_read_b128 v[136:139], v245 offset:2048
v_smfmac_f32_16x16x64_bf16 v[160:163], v[196:199], a[40:47], v246
ds_read_b128 v[140:143], v245 offset:3072
v_smfmac_f32_16x16x64_bf16 v[164:167], v[196:199], a[168:175], v246
ds_read_b128 v[152:155], v245 offset:6144
v_smfmac_f32_16x16x64_bf16 v[168:171], v[196:199], a[104:111], v246
ds_read_b128 v[156:159], v245 offset:7168
v_smfmac_f32_16x16x64_bf16 v[172:175], v[196:199], a[232:239], v246
ds_read_b128 v[144:147], v245 offset:4096
ds_read_b128 v[148:151], v245 offset:5120
s_branch L_mjoin_164
L_mok0_162:
v_smfmac_f32_16x16x64_bf16 v[160:163], v[184:187], a[32:39], v246
v_smfmac_f32_16x16x64_bf16 v[164:167], v[184:187], a[160:167], v246
v_smfmac_f32_16x16x64_bf16 v[168:171], v[184:187], a[96:103], v246
s_waitcnt lgkmcnt(0)
s_barrier
ds_read_b128 v[128:131], v245 offset:0
ds_read_b128 v[132:135], v245 offset:1024
v_smfmac_f32_16x16x64_bf16 v[172:175], v[184:187], a[224:231], v246
ds_read_b128 v[136:139], v245 offset:2048
v_smfmac_f32_16x16x64_bf16 v[160:163], v[188:191], a[40:47], v246
ds_read_b128 v[140:143], v245 offset:3072
v_smfmac_f32_16x16x64_bf16 v[164:167], v[188:191], a[168:175], v246
ds_read_b128 v[152:155], v245 offset:6144
v_smfmac_f32_16x16x64_bf16 v[168:171], v[188:191], a[104:111], v246
ds_read_b128 v[156:159], v245 offset:7168
v_smfmac_f32_16x16x64_bf16 v[172:175], v[188:191], a[232:239], v246
ds_read_b128 v[144:147], v245 offset:4096
ds_read_b128 v[148:151], v245 offset:5120
L_mjoin_164:
buffer_store_dword v224, v251, s[8:11], s41 offen sc1
s_waitcnt lgkmcnt(7)
v_smfmac_f32_16x16x64_bf16 v[160:163], v[128:131], a[0:7], v246
ds_read_b128 v[200:203], v249 offset:4096
v_smfmac_f32_16x16x64_bf16 v[164:167], v[128:131], a[128:135], v246
buffer_load_dwordx4 v[228:231], v247, s[8:11], s30 offen offset:0 sc1 nt
v_smfmac_f32_16x16x64_bf16 v[168:171], v[128:131], a[64:71], v246
ds_read_b128 v[204:207], v249 offset:5120
v_smfmac_f32_16x16x64_bf16 v[172:175], v[128:131], a[192:199], v246
s_waitcnt lgkmcnt(8)
v_smfmac_f32_16x16x64_bf16 v[160:163], v[132:135], a[8:15], v246
ds_read_b128 v[208:211], v249 offset:6144
v_smfmac_f32_16x16x64_bf16 v[164:167], v[132:135], a[136:143], v246
buffer_load_dwordx4 v[232:235], v247, s[8:11], s30 offen offset:1024 sc1 nt
v_smfmac_f32_16x16x64_bf16 v[168:171], v[132:135], a[72:79], v246
ds_read_b128 v[212:215], v249 offset:7168
v_smfmac_f32_16x16x64_bf16 v[172:175], v[132:135], a[200:207], v246
s_waitcnt lgkmcnt(9)
v_smfmac_f32_16x16x64_bf16 v[160:163], v[136:139], a[16:23], v246
s_waitcnt vmcnt(3)
s_add_u32 s43, s22, 3
s_cmp_ge_u32 s43, s97
s_cbranch_scc1 L_hz_166
L_hzb_167:
ds_read_b128 v[184:187], v249 offset:0
v_smfmac_f32_16x16x64_bf16 v[164:167], v[136:139], a[144:151], v246
s_mov_b32 m0, s44
s_nop 0
buffer_load_dwordx4 v247, s[8:11], s29 offen sc1 nt lds
v_smfmac_f32_16x16x64_bf16 v[168:171], v[136:139], a[80:87], v246
ds_read_b128 v[188:191], v249 offset:1024
v_smfmac_f32_16x16x64_bf16 v[172:175], v[136:139], a[208:215], v246
s_waitcnt lgkmcnt(10)
v_smfmac_f32_16x16x64_bf16 v[160:163], v[140:143], a[24:31], v246
ds_read_b128 v[192:195], v249 offset:2048
v_smfmac_f32_16x16x64_bf16 v[164:167], v[140:143], a[152:159], v246
buffer_load_dwordx4 v247, s[8:11], s29 offen offset:1024 sc1 nt lds
v_smfmac_f32_16x16x64_bf16 v[168:171], v[140:143], a[88:95], v246
ds_read_b128 v[196:199], v249 offset:3072
v_smfmac_f32_16x16x64_bf16 v[172:175], v[140:143], a[216:223], v246
s_waitcnt lgkmcnt(8)
v_smfmac_f32_16x16x64_bf16 v[160:163], v[152:155], a[48:55], v246
v_smfmac_f32_16x16x64_bf16 v[164:167], v[152:155], a[176:183], v246
v_smfmac_f32_16x16x64_bf16 v[160:163], v[156:159], a[56:63], v246
v_smfmac_f32_16x16x64_bf16 v[164:167], v[156:159], a[184:191], v246
v_smfmac_f32_16x16x64_bf16 v[168:171], v[152:155], a[112:119], v246
v_smfmac_f32_16x16x64_bf16 v[172:175], v[152:155], a[240:247], v246
v_smfmac_f32_16x16x64_bf16 v[168:171], v[156:159], a[120:127], v246
v_smfmac_f32_16x16x64_bf16 v[172:175], v[156:159], a[248:255], v246
v_smfmac_f32_16x16x64_bf16 v[176:179], v[128:131], v[0:7], v246
s_nop 1
v_add_f32 v160, v160, v162
v_add_f32 v161, v161, v163
v_smfmac_f32_16x16x64_bf16 v[180:183], v[128:131], v[64:71], v246
v_add_f32 v164, v164, v166
v_add_f32 v165, v165, v167
v_smfmac_f32_16x16x64_bf16 v[176:179], v[132:135], v[8:15], v246
v_cvt_pk_bf16_f32 v163, v160, v161
v_cvt_pk_bf16_f32 v162, v164, v165
ds_write_b64 v252, v[162:163] offset:0
v_add_f32 v168, v168, v170
v_add_f32 v169, v169, v171
v_add_f32 v172, v172, v174
v_add_f32 v173, v173, v175
v_cvt_pk_bf16_f32 v171, v168, v169
v_cvt_pk_bf16_f32 v170, v172, v173
ds_write_b64 v252, v[170:171] offset:512
v_smfmac_f32_16x16x64_bf16 v[180:183], v[132:135], v[72:79], v246
v_smfmac_f32_16x16x64_bf16 v[176:179], v[136:139], v[16:23], v246
v_smfmac_f32_16x16x64_bf16 v[180:183], v[136:139], v[80:87], v246
v_smfmac_f32_16x16x64_bf16 v[176:179], v[140:143], v[24:31], v246
s_waitcnt lgkmcnt(0)
s_barrier
ds_read_b64_tr_b16 v[160:161], v253 offset:0
ds_read_b64_tr_b16 v[162:163], v253 offset:512
ds_read_b64_tr_b16 v[164:165], v253 offset:1024
v_smfmac_f32_16x16x64_bf16 v[180:183], v[140:143], v[88:95], v246
ds_read_b64_tr_b16 v[166:167], v253 offset:1536
v_smfmac_f32_16x16x64_bf16 v[176:179], v[144:147], v[32:39], v246
ds_read_b64_tr_b16 v[168:169], v253 offset:2048
v_smfmac_f32_16x16x64_bf16 v[180:183], v[144:147], v[96:103], v246
ds_read_b64_tr_b16 v[170:171], v253 offset:2560
v_smfmac_f32_16x16x64_bf16 v[176:179], v[148:151], v[40:47], v246
ds_read_b64_tr_b16 v[172:173], v253 offset:3072
v_smfmac_f32_16x16x64_bf16 v[180:183], v[148:151], v[104:111], v246
ds_read_b64_tr_b16 v[174:175], v253 offset:3584
s_waitcnt lgkmcnt(6)
v_mfma_f32_16x16x32_bf16 v[216:219], v[184:187], v[160:163], 0
v_mfma_f32_16x16x32_bf16 v[220:223], v[200:203], v[160:163], 0
ds_read_b128 v[128:131], v248 offset:4096
v_mfma_f32_16x16x32_bf16 v[224:227], v[160:163], v[160:163], 0
ds_read_b128 v[132:135], v248 offset:5120
s_waitcnt lgkmcnt(6)
v_mfma_f32_16x16x32_bf16 v[216:219], v[188:191], v[164:167], v[216:219]
ds_read_b128 v[136:139], v248 offset:20480
v_mfma_f32_16x16x32_bf16 v[220:223], v[204:207], v[164:167], v[220:223]
ds_read_b128 v[140:143], v248 offset:21504
v_mfma_f32_16x16x32_bf16 v[224:227], v[164:167], v[164:167], v[224:227]
ds_read_b128 v[144:147], v248 offset:6144
s_waitcnt lgkmcnt(7)
v_mfma_f32_16x16x32_bf16 v[216:219], v[192:195], v[168:171], v[216:219]
ds_read_b128 v[148:151], v248 offset:7168
v_mfma_f32_16x16x32_bf16 v[220:223], v[208:211], v[168:171], v[220:223]
v_mfma_f32_16x16x32_bf16 v[224:227], v[168:171], v[168:171], v[224:227]
s_waitcnt lgkmcnt(6)
v_mfma_f32_16x16x32_bf16 v[216:219], v[196:199], v[172:175], v[216:219]
v_mfma_f32_16x16x32_bf16 v[220:223], v[212:215], v[172:175], v[220:223]
v_mfma_f32_16x16x32_bf16 v[224:227], v[172:175], v[172:175], v[224:227]
buffer_store_dwordx4 v[168:171], v254, s[8:11], s31 offen offset:1024 sc1
v_smfmac_f32_16x16x64_bf16 v[176:179], v[152:155], v[48:55], v246
v_smfmac_f32_16x16x64_bf16 v[180:183], v[152:155], v[112:119], v246
v_smfmac_f32_16x16x64_bf16 v[176:179], v[156:159], v[56:63], v246
v_smfmac_f32_16x16x64_bf16 v[180:183], v[156:159], v[120:127], v246
ds_read_b128 v[152:155], v248 offset:22528
ds_read_b128 v[156:159], v248 offset:23552
v_max3_f32 v168, v216, v217, v218
v_max3_f32 v169, v219, v220, v221
v_max3_f32 v168, v168, v222, v223
v_max3_f32 v169, v169, v224, v225
v_max_f32 v168, v168, v169
v_mov_b32 v169, v168
ds_read_b128 v[184:187], v248 offset:0
v_mov_b64 v[164:165], s[100:101]
v_permlane32_swap_b32 v168, v169
v_max_f32 v168, v168, v169
v_mov_b32 v169, v168
ds_read_b128 v[188:191], v248 offset:1024
v_mov_b64 v[166:167], s[100:101]
v_permlane16_swap_b32 v168, v169
v_max_f32 v168, v168, v169
v_mul_f32 v170, s35, v168
v_pk_fma_f32 v[216:217], v[216:217], s[34:35], v[170:171] op_sel_hi:[1,0,0]
v_pk_fma_f32 v[218:219], v[218:219], s[34:35], v[170:171] op_sel_hi:[1,0,0]
ds_read_b128 v[192:195], v248 offset:16384
v_pk_fma_f32 v[220:221], v[220:221], s[34:35], v[170:171] op_sel_hi:[1,0,0]
v_pk_fma_f32 v[222:223], v[222:223], s[34:35], v[170:171] op_sel_hi:[1,0,0]
v_pk_fma_f32 v[224:225], v[224:225], s[34:35], v[170:171] op_sel_hi:[1,0,0]
ds_read_b128 v[196:199], v248 offset:17408
v_exp_f32 v216, v216
v_exp_f32 v217, v217
v_exp_f32 v218, v218
ds_read_b128 v[200:203], v248 offset:2048
v_exp_f32 v219, v219
v_exp_f32 v220, v220
v_exp_f32 v221, v221
ds_read_b128 v[204:207], v248 offset:3072
v_exp_f32 v222, v222
v_exp_f32 v223, v223
v_exp_f32 v224, v224
ds_read_b128 v[208:211], v248 offset:18432
v_exp_f32 v225, v225
ds_read_b128 v[212:215], v248 offset:19456
v_mov_b32 v161, 0
v_mov_b64 v[162:163], 0
s_cmp_lg_u32 s42, 0
s_cbranch_scc1 L_hze_168
L_hzf_169:
v_cvt_pk_bf16_f32 v236, v216, v217
v_cvt_pk_bf16_f32 v237, v218, v219
v_cvt_pk_bf16_f32 v238, v220, v221
v_cvt_pk_bf16_f32 v239, v222, v223
v_cvt_pk_bf16_f32 v160, v224, v225
v_add_f32 v176, v176, v178
v_mfma_f32_16x16x32_bf16 v[224:227], v[236:239], v[164:167], 0
s_waitcnt vmcnt(3)
v_add_f32 v177, v177, v179
v_mfma_f32_16x16x32_bf16 v[216:219], v[236:239], v[228:231], 0
v_add_f32 v180, v180, v182
v_mfma_f32_16x16x32_bf16 v[220:223], v[236:239], v[232:235], 0
v_add_f32 v181, v181, v183
v_mfma_f32_16x16x32_bf16 v[224:227], v[160:163], v[164:167], v[224:227]
v_cvt_pk_bf16_f32 v240, v176, v177
v_cvt_pk_bf16_f32 v242, v180, v181
v_lshrrev_b32 v255, 2, v247
s_nop 0
v_mfma_f32_16x16x32_bf16 v[216:219], v[160:163], v[240:243], v[216:219]
v_mfma_f32_16x16x32_bf16 v[220:223], v[160:163], v[242:245], v[220:223]
buffer_store_dword v240, v255, s[8:11], s37 offen sc1
buffer_store_dword v242, v255, s[8:11], s37 offen offset:256 sc1
v_rcp_f32 v172, v226
v_rcp_f32 v173, v227
s_nop 2
v_pk_mul_f32 v[218:219], v[218:219], v[172:173]
v_pk_mul_f32 v[222:223], v[222:223], v[172:173]
v_cvt_pk_bf16_f32 v216, v218, v219
v_cvt_pk_bf16_f32 v217, v222, v223
ds_write_b64 v252, v[216:217] offset:12288
v_mov_b64 v[168:169], 0
v_mov_b64 v[170:171], 0
v_mov_b64 v[172:173], 0
v_mov_b64 v[174:175], 0
v_mov_b64 v[176:177], 0
v_mov_b64 v[178:179], 0
v_mov_b64 v[180:181], 0
v_mov_b64 v[182:183], 0
s_waitcnt lgkmcnt(0)
s_barrier
ds_read_b64_tr_b16 v[236:237], v253 offset:12288
ds_read_b64_tr_b16 v[238:239], v253 offset:13312
ds_read_b64_tr_b16 v[240:241], v253 offset:14336
ds_read_b64_tr_b16 v[242:243], v253 offset:15360
v_mov_b64 v[160:161], 0
v_mov_b64 v[162:163], 0
v_mov_b64 v[164:165], 0
v_mov_b64 v[166:167], 0
v_mov_b64 v[228:229], 0
v_mov_b64 v[230:231], 0
v_mov_b64 v[232:233], 0
v_mov_b64 v[234:235], 0
s_waitcnt lgkmcnt(0)
v_smfmac_f32_16x16x64_bf16 v[160:163], v[236:239], v[184:191], v246
ds_read_b128 v[184:187], v248 offset:8192
ds_read_b128 v[188:191], v248 offset:9216
v_smfmac_f32_16x16x64_bf16 v[160:163], v[240:243], v[192:199], v246
ds_read_b128 v[192:195], v248 offset:24576
v_smfmac_f32_16x16x64_bf16 v[164:167], v[236:239], v[200:207], v246
ds_read_b128 v[196:199], v248 offset:25600
ds_read_b128 v[200:203], v248 offset:10240
v_smfmac_f32_16x16x64_bf16 v[164:167], v[240:243], v[208:215], v246
ds_read_b128 v[204:207], v248 offset:11264
s_nop 1
v_add_f32 v160, v160, v162
v_smfmac_f32_16x16x64_bf16 v[168:171], v[236:239], v[128:135], v246
ds_read_b128 v[208:211], v248 offset:26624
ds_read_b128 v[212:215], v248 offset:27648
v_add_f32 v161, v161, v163
v_smfmac_f32_16x16x64_bf16 v[168:171], v[240:243], v[136:143], v246
ds_read_b128 v[128:131], v248 offset:12288
v_cvt_pk_bf16_f32 v160, v160, v161
v_smfmac_f32_16x16x64_bf16 v[172:175], v[236:239], v[144:151], v246
ds_read_b128 v[132:135], v248 offset:13312
ds_read_b128 v[136:139], v248 offset:28672
v_add_f32 v164, v164, v166
v_smfmac_f32_16x16x64_bf16 v[172:175], v[240:243], v[152:159], v246
ds_read_b128 v[140:143], v248 offset:29696
v_add_f32 v165, v165, v167
s_waitcnt lgkmcnt(10)
v_smfmac_f32_16x16x64_bf16 v[176:179], v[236:239], v[184:191], v246
ds_read_b128 v[144:147], v248 offset:14336
ds_read_b128 v[148:151], v248 offset:15360
v_cvt_pk_bf16_f32 v161, v164, v165
v_add_f32 v168, v168, v170
s_waitcnt lgkmcnt(10)
v_smfmac_f32_16x16x64_bf16 v[176:179], v[240:243], v[192:199], v246
ds_read_b128 v[152:155], v248 offset:30720
v_add_f32 v169, v169, v171
v_cvt_pk_bf16_f32 v162, v168, v169
s_waitcnt lgkmcnt(9)
v_smfmac_f32_16x16x64_bf16 v[180:183], v[236:239], v[200:207], v246
ds_read_b128 v[156:159], v248 offset:31744
v_add_f32 v172, v172, v174
v_add_f32 v173, v173, v175
s_waitcnt lgkmcnt(8)
v_smfmac_f32_16x16x64_bf16 v[180:183], v[240:243], v[208:215], v246
v_cvt_pk_bf16_f32 v163, v172, v173
v_bfi_b32 v160, 1, s96, v160
s_waitcnt lgkmcnt(6)
v_smfmac_f32_16x16x64_bf16 v[228:231], v[236:239], v[128:135], v246
buffer_store_dwordx4 v[160:163], v250, s[8:11], s25 offen sc1
v_add_f32 v176, v176, v178
s_waitcnt lgkmcnt(4)
v_smfmac_f32_16x16x64_bf16 v[228:231], v[240:243], v[136:143], v246
v_add_f32 v177, v177, v179
v_cvt_pk_bf16_f32 v176, v176, v177
s_waitcnt lgkmcnt(2)
v_smfmac_f32_16x16x64_bf16 v[232:235], v[236:239], v[144:151], v246
v_add_f32 v180, v180, v182
v_add_f32 v181, v181, v183
s_waitcnt lgkmcnt(0)
v_smfmac_f32_16x16x64_bf16 v[232:235], v[240:243], v[152:159], v246
v_cvt_pk_bf16_f32 v177, v180, v181
v_add_f32 v228, v228, v230
v_add_f32 v229, v229, v231
v_cvt_pk_bf16_f32 v178, v228, v229
s_nop 3
v_pk_add_f32 v[232:233], v[232:233], v[234:235]
v_cvt_pk_bf16_f32 v179, v232, v233
v_bfi_b32 v176, 1, s96, v176
buffer_store_dwordx4 v[176:179], v250, s[8:11], s26 offen sc1
v_lshrrev_b32 v216, 9, v247
v_mul_u32_u24 v216, 512, v216
v_add3_u32 v255, v247, v216, s99
ds_read_b128 v[216:219], v255
s_add_u32 s29, s29, 262144
s_add_u32 s30, s30, 262144
s_add_u32 s37, s37, 65536
s_add_u32 s31, s31, 65536
s_add_u32 s22, s22, 1
s_xor_b32 s44, s44, 8192
v_xor_b32 v249, 8192, v249
s_waitcnt vmcnt(0)
s_waitcnt lgkmcnt(0)
s_mov_b32 s36, 200000
buffer_load_dwordx4 v[184:187], v247, s[8:11], s27 offen offset:0 sc1
buffer_load_dwordx4 v[188:191], v247, s[8:11], s27 offen offset:1024 sc1
s_waitcnt vmcnt(0)
v_bitop3_b32 v255, v184, v188, s96 bitop3:0x7e
v_and_b32 v255, 1, v255
v_cmp_ne_u32 vcc, 0, v255
s_cbranch_vccz L_rok0_170
buffer_load_dwordx4 v[184:187], v247, s[8:11], s27 offen offset:0 sc1
buffer_load_dwordx4 v[188:191], v247, s[8:11], s27 offen offset:1024 sc1
L_pl_173:
buffer_load_dwordx4 v[192:195], v247, s[8:11], s27 offen offset:0 sc1
buffer_load_dwordx4 v[196:199], v247, s[8:11], s27 offen offset:1024 sc1
s_waitcnt vmcnt(2)
v_bitop3_b32 v255, v184, v188, s96 bitop3:0x7e
v_and_b32 v255, 1, v255
v_cmp_ne_u32 vcc, 0, v255
s_cbranch_vccz L_rok0_170
buffer_load_dwordx4 v[184:187], v247, s[8:11], s27 offen offset:0 sc1
buffer_load_dwordx4 v[188:191], v247, s[8:11], s27 offen offset:1024 sc1
s_waitcnt vmcnt(2)
v_bitop3_b32 v255, v192, v196, s96 bitop3:0x7e
v_and_b32 v255, 1, v255
v_cmp_ne_u32 vcc, 0, v255
s_cbranch_vccz L_rok1_171
s_sub_u32 s36, s36, 1
s_cmp_lg_u32 s36, 0
s_cbranch_scc1 L_pl_173
s_branch L_abort
L_rok1_171:
v_mfma_f32_16x16x32_bf16 v[220:223], v[192:195], v[216:219], 0
v_mfma_f32_16x16x32_bf16 v[220:223], v[196:199], v[216:219], v[220:223]
s_branch L_rjoin_172
L_rok0_170:
v_mfma_f32_16x16x32_bf16 v[220:223], v[184:187], v[216:219], 0
v_mfma_f32_16x16x32_bf16 v[220:223], v[188:191], v[216:219], v[220:223]
L_rjoin_172:
s_add_u32 s23, s23, 8192
s_and_b32 s23, s23, 0x107fff
s_add_u32 s24, s23, 4096
s_add_u32 s41, s23, 2 * 8192
s_and_b32 s41, s41, 0x107fff
v_mov_b32 v224, -1
s_nop 2
v_permlane32_swap_b32 v220, v222
v_permlane32_swap_b32 v221, v223
v_add_f32 v220, v220, v222
v_add_f32 v221, v221, v223
s_nop 1
v_permlane16_swap_b32 v220, v221
v_add_f32 v220, v220, v221
v_mov_b32 v221, v220
s_nop 1
v_permlane16_swap_b32 v220, v221
v_cvt_pk_bf16_f32 v220, v220, v221
v_min_u32 v220, 0xfffffffe, v220
buffer_store_dword v220, v251, s[8:11], s23 offen sc1
s_xor_b32 s25, s25, 262144
s_xor_b32 s26, s26, 262144
s_xor_b32 s27, s27, 262144
s_bfe_u32 s96, s22, 0x10001
s_cmp_lg_u32 s22, 63
s_cbranch_scc1 L_step_w2s
v_mov_b64 v[160:161], 0
v_mov_b64 v[162:163], 0
v_mov_b64 v[164:165], 0
v_mov_b64 v[166:167], 0
v_mov_b64 v[168:169], 0
v_mov_b64 v[170:171], 0
v_mov_b64 v[172:173], 0
v_mov_b64 v[174:175], 0
v_mov_b64 v[176:177], 0
v_mov_b64 v[178:179], 0
v_mov_b64 v[180:181], 0
v_mov_b64 v[182:183], 0
s_mov_b32 s36, 200000
L_lpoll_174:
buffer_load_dwordx4 v[128:131], v247, s[8:11], s23 offen offset:0 sc1
buffer_load_dwordx4 v[132:135], v247, s[8:11], s23 offen offset:1024 sc1
buffer_load_dwordx4 v[136:139], v247, s[8:11], s23 offen offset:2048 sc1
buffer_load_dwordx4 v[140:143], v247, s[8:11], s23 offen offset:3072 sc1
buffer_load_dwordx4 v[144:147], v247, s[8:11], s24 offen offset:0 sc1
buffer_load_dwordx4 v[148:151], v247, s[8:11], s24 offen offset:1024 sc1
buffer_load_dwordx4 v[152:155], v247, s[8:11], s24 offen offset:2048 sc1
buffer_load_dwordx4 v[156:159], v247, s[8:11], s24 offen offset:3072 sc1
s_waitcnt vmcnt(0)
v_max3_u32 v255, v128, v129, v130
v_max3_u32 v255, v255, v131, v132
v_max3_u32 v255, v255, v133, v134
v_max3_u32 v255, v255, v135, v136
v_max3_u32 v255, v255, v137, v138
v_max3_u32 v255, v255, v139, v140
v_max3_u32 v255, v255, v141, v142
v_max3_u32 v255, v255, v143, v144
v_max3_u32 v255, v255, v145, v146
v_max3_u32 v255, v255, v147, v148
v_max3_u32 v255, v255, v149, v150
v_max3_u32 v255, v255, v151, v152
v_max3_u32 v255, v255, v153, v154
v_max3_u32 v255, v255, v155, v156
v_max3_u32 v255, v255, v157, v158
v_max_u32 v255, v255, v159
v_cmp_eq_u32 vcc, -1, v255
s_cbranch_vccnz L_lretry_175
v_smfmac_f32_16x16x64_bf16 v[164:167], v[128:131], a[128:135], v246
v_smfmac_f32_16x16x64_bf16 v[172:175], v[128:131], a[192:199], v246
v_smfmac_f32_16x16x64_bf16 v[176:179], v[128:131], v[0:7], v246
v_smfmac_f32_16x16x64_bf16 v[180:183], v[128:131], v[64:71], v246
v_smfmac_f32_16x16x64_bf16 v[164:167], v[132:135], a[136:143], v246
v_smfmac_f32_16x16x64_bf16 v[172:175], v[132:135], a[200:207], v246
v_smfmac_f32_16x16x64_bf16 v[176:179], v[132:135], v[8:15], v246
v_smfmac_f32_16x16x64_bf16 v[180:183], v[132:135], v[72:79], v246
v_smfmac_f32_16x16x64_bf16 v[164:167], v[136:139], a[144:151], v246
v_smfmac_f32_16x16x64_bf16 v[172:175], v[136:139], a[208:215], v246
v_smfmac_f32_16x16x64_bf16 v[176:179], v[136:139], v[16:23], v246
v_smfmac_f32_16x16x64_bf16 v[180:183], v[136:139], v[80:87], v246
v_smfmac_f32_16x16x64_bf16 v[164:167], v[140:143], a[152:159], v246
v_smfmac_f32_16x16x64_bf16 v[172:175], v[140:143], a[216:223], v246
v_smfmac_f32_16x16x64_bf16 v[176:179], v[140:143], v[24:31], v246
v_smfmac_f32_16x16x64_bf16 v[180:183], v[140:143], v[88:95], v246
v_smfmac_f32_16x16x64_bf16 v[164:167], v[144:147], a[160:167], v246
v_smfmac_f32_16x16x64_bf16 v[172:175], v[144:147], a[224:231], v246
v_smfmac_f32_16x16x64_bf16 v[176:179], v[144:147], v[32:39], v246
v_smfmac_f32_16x16x64_bf16 v[180:183], v[144:147], v[96:103], v246
v_smfmac_f32_16x16x64_bf16 v[164:167], v[148:151], a[168:175], v246
v_smfmac_f32_16x16x64_bf16 v[172:175], v[148:151], a[232:239], v246
v_smfmac_f32_16x16x64_bf16 v[176:179], v[148:151], v[40:47], v246
v_smfmac_f32_16x16x64_bf16 v[180:183], v[148:151], v[104:111], v246
v_smfmac_f32_16x16x64_bf16 v[164:167], v[152:155], a[176:183], v246
v_smfmac_f32_16x16x64_bf16 v[172:175], v[152:155], a[240:247], v246
v_smfmac_f32_16x16x64_bf16 v[176:179], v[152:155], v[48:55], v246
v_smfmac_f32_16x16x64_bf16 v[180:183], v[152:155], v[112:119], v246
v_smfmac_f32_16x16x64_bf16 v[164:167], v[156:159], a[184:191], v246
v_smfmac_f32_16x16x64_bf16 v[172:175], v[156:159], a[248:255], v246
v_smfmac_f32_16x16x64_bf16 v[176:179], v[156:159], v[56:63], v246
v_smfmac_f32_16x16x64_bf16 v[180:183], v[156:159], v[120:127], v246
v_add_f32 v160, v160, v162
v_add_f32 v161, v161, v163
s_nop 2
v_add_f32 v164, v164, v166
v_add_f32 v165, v165, v167
v_cvt_pk_bf16_f32 v163, v160, v161
v_cvt_pk_bf16_f32 v162, v164, v165
ds_write_b64 v252, v[162:163] offset:0
v_add_f32 v168, v168, v170
v_add_f32 v169, v169, v171
v_add_f32 v172, v172, v174
v_add_f32 v173, v173, v175
v_cvt_pk_bf16_f32 v171, v168, v169
v_cvt_pk_bf16_f32 v170, v172, v173
ds_write_b64 v252, v[170:171] offset:512
v_add_f32 v176, v176, v178
v_add_f32 v177, v177, v179
v_add_f32 v180, v180, v182
v_add_f32 v181, v181, v183
v_cvt_pk_bf16_f32 v240, v176, v177
v_cvt_pk_bf16_f32 v242, v180, v181
v_lshrrev_b32 v255, 2, v247
buffer_store_dword v240, v255, s[8:11], s37 offen sc1
buffer_store_dword v242, v255, s[8:11], s37 offen offset:256 sc1
s_waitcnt lgkmcnt(0)
s_barrier
ds_read_b64_tr_b16 v[184:185], v253 offset:2048
ds_read_b64_tr_b16 v[186:187], v253 offset:2560
s_waitcnt lgkmcnt(0)
buffer_store_dwordx4 v[184:187], v254, s[8:11], s31 offen offset:1024 sc1
s_waitcnt vmcnt(0)
s_barrier
L_done_w2s:
s_waitcnt vmcnt(0) lgkmcnt(0)
s_branch L_end_176
L_lretry_175:
s_sub_u32 s36, s36, 1
s_cmp_lg_u32 s36, 0
s_cbranch_scc1 L_lpoll_174
s_branch L_abort
L_hz_166:
s_cmp_ge_u32 s97, 64
s_cbranch_scc1 L_hzb_167
s_add_u32 s43, s22, 1
s_cmp_ge_u32 s43, s97
s_cbranch_scc1 L_hzblk_177
buffer_load_dwordx4 v[236:239], v244, s[8:11], s98 offen offset:16 sc1
buffer_load_dwordx4 v[240:243], v244, s[8:11], s98 offen offset:32 sc1
s_mov_b32 s42, 1
s_branch L_hzb_167
L_hzblk_177:
s_cmp_ge_u32 s43, 64
s_cbranch_scc1 L_hx_179
s_mov_b32 s36, 200000
L_hq_178:
buffer_load_dwordx4 v[216:219], v244, s[8:11], s98 offen offset:16 sc1
buffer_load_dwordx4 v[220:223], v244, s[8:11], s98 offen offset:32 sc1
s_sub_u32 s36, s36, 1
s_cmp_eq_u32 s36, 0
s_cbranch_scc1 L_abort
s_waitcnt vmcnt(0)
L_he_180:
v_cmp_eq_u32 vcc, s46, v217
s_nop 1
v_cndmask_b32 v216, 0, v216, vcc
v_cmp_eq_u32 vcc, s46, v219
s_nop 1
v_cndmask_b32 v218, 0, v218, vcc
v_cmp_eq_u32 vcc, s46, v221
s_nop 1
v_cndmask_b32 v220, 0, v220, vcc
v_cmp_eq_u32 vcc, s46, v223
s_nop 1
v_cndmask_b32 v222, 0, v222, vcc
v_min_u32 v216, v216, v220
v_min_u32 v217, v218, v222
v_lshlrev_b32 v216, 1, v216
v_lshl_add_u32 v217, v217, 1, 1
v_min_u32 v216, v216, v217
s_nop 0
v_readfirstlane_b32 s97, v216
s_cmp_ge_u32 s97, 64
s_cselect_b32 s97, 1000, s97
s_cmp_lt_u32 s43, s97
s_cbranch_scc0 L_hq_178
L_hx_179:
s_branch L_hzb_167
L_hze_168:
s_mov_b32 s42, 0
s_waitcnt vmcnt(3)
v_cmp_eq_u32 vcc, s46, v237
s_nop 1
v_cndmask_b32 v236, 0, v236, vcc
v_cmp_eq_u32 vcc, s46, v239
s_nop 1
v_cndmask_b32 v238, 0, v238, vcc
v_cmp_eq_u32 vcc, s46, v241
s_nop 1
v_cndmask_b32 v240, 0, v240, vcc
v_cmp_eq_u32 vcc, s46, v243
s_nop 1
v_cndmask_b32 v242, 0, v242, vcc
v_min_u32 v236, v236, v240
v_min_u32 v237, v238, v242
v_lshlrev_b32 v236, 1, v236
v_lshl_add_u32 v237, v237, 1, 1
v_min_u32 v236, v236, v237
s_nop 0
v_readfirstlane_b32 s97, v236
s_cmp_ge_u32 s97, 64
s_cselect_b32 s97, 1000, s97
v_mov_b32 v241, 0
v_mov_b32 v243, 0
s_branch L_hzf_169
L_end_176:
s_endpgm
L_cslow3:
L_step_w3s:
s_waitcnt vmcnt(0)
s_mov_b32 s36, 200000
buffer_load_dwordx4 v[184:187], v247, s[8:11], s24 offen offset:2048 sc1
buffer_load_dwordx4 v[188:191], v247, s[8:11], s24 offen offset:3072 sc1
v_mov_b64 v[160:161], 0
v_mov_b64 v[162:163], 0
v_mov_b64 v[164:165], 0
v_mov_b64 v[166:167], 0
v_mov_b64 v[168:169], 0
v_mov_b64 v[170:171], 0
v_mov_b64 v[172:173], 0
v_mov_b64 v[174:175], 0
v_mov_b64 v[176:177], 0
v_mov_b64 v[178:179], 0
v_mov_b64 v[180:181], 0
v_mov_b64 v[182:183], 0
L_pl_184:
buffer_load_dwordx4 v[192:195], v247, s[8:11], s24 offen offset:2048 sc1
buffer_load_dwordx4 v[196:199], v247, s[8:11], s24 offen offset:3072 sc1
s_waitcnt vmcnt(2)
ds_write_b128 v245, v[184:187] offset:6144
ds_write_b128 v245, v[188:191] offset:7168
v_max3_u32 v255, v184, v185, v186
v_max3_u32 v255, v255, v187, v188
v_max3_u32 v255, v255, v189, v190
v_max_u32 v255, v255, v191
v_cmp_eq_u32 vcc, -1, v255
s_cbranch_vccz L_mok0_181
buffer_load_dwordx4 v[184:187], v247, s[8:11], s24 offen offset:2048 sc1
buffer_load_dwordx4 v[188:191], v247, s[8:11], s24 offen offset:3072 sc1
s_waitcnt vmcnt(2)
ds_write_b128 v245, v[192:195] offset:6144
ds_write_b128 v245, v[196:199] offset:7168
v_max3_u32 v255, v192, v193, v194
v_max3_u32 v255, v255, v195, v196
v_max3_u32 v255, v255, v197, v198
v_max_u32 v255, v255, v199
v_cmp_eq_u32 vcc, -1, v255
s_cbranch_vccz L_mok1_182
s_sub_u32 s36, s36, 1
s_cmp_lg_u32 s36, 0
s_cbranch_scc1 L_pl_184
s_branch L_abort
L_mok1_182:
v_smfmac_f32_16x16x64_bf16 v[160:163], v[192:195], a[48:55], v246
v_smfmac_f32_16x16x64_bf16 v[164:167], v[192:195], a[176:183], v246
v_smfmac_f32_16x16x64_bf16 v[168:171], v[192:195], a[112:119], v246
s_waitcnt lgkmcnt(0)
s_barrier
ds_read_b128 v[128:131], v245 offset:0
ds_read_b128 v[132:135], v245 offset:1024
v_smfmac_f32_16x16x64_bf16 v[172:175], v[192:195], a[240:247], v246
ds_read_b128 v[136:139], v245 offset:2048
v_smfmac_f32_16x16x64_bf16 v[160:163], v[196:199], a[56:63], v246
ds_read_b128 v[140:143], v245 offset:3072
v_smfmac_f32_16x16x64_bf16 v[164:167], v[196:199], a[184:191], v246
ds_read_b128 v[144:147], v245 offset:4096
v_smfmac_f32_16x16x64_bf16 v[168:171], v[196:199], a[120:127], v246
ds_read_b128 v[148:151], v245 offset:5120
v_smfmac_f32_16x16x64_bf16 v[172:175], v[196:199], a[248:255], v246
ds_read_b128 v[152:155], v245 offset:6144
ds_read_b128 v[156:159], v245 offset:7168
s_branch L_mjoin_183
L_mok0_181:
v_smfmac_f32_16x16x64_bf16 v[160:163], v[184:187], a[48:55], v246
v_smfmac_f32_16x16x64_bf16 v[164:167], v[184:187], a[176:183], v246
v_smfmac_f32_16x16x64_bf16 v[168:171], v[184:187], a[112:119], v246
s_waitcnt lgkmcnt(0)
s_barrier
ds_read_b128 v[128:131], v245 offset:0
ds_read_b128 v[132:135], v245 offset:1024
v_smfmac_f32_16x16x64_bf16 v[172:175], v[184:187], a[240:247], v246
ds_read_b128 v[136:139], v245 offset:2048
v_smfmac_f32_16x16x64_bf16 v[160:163], v[188:191], a[56:63], v246
ds_read_b128 v[140:143], v245 offset:3072
v_smfmac_f32_16x16x64_bf16 v[164:167], v[188:191], a[184:191], v246
ds_read_b128 v[144:147], v245 offset:4096
v_smfmac_f32_16x16x64_bf16 v[168:171], v[188:191], a[120:127], v246
ds_read_b128 v[148:151], v245 offset:5120
v_smfmac_f32_16x16x64_bf16 v[172:175], v[188:191], a[248:255], v246
ds_read_b128 v[152:155], v245 offset:6144
ds_read_b128 v[156:159], v245 offset:7168
L_mjoin_183:
buffer_store_dword v224, v251, s[8:11], s41 offen sc1
v_mov_b32 v216, s22
v_mov_b32 v217, s46
buffer_store_dwordx2 v[216:217], v244, s[8:11], s47 offen sc1
s_waitcnt lgkmcnt(7)
v_smfmac_f32_16x16x64_bf16 v[160:163], v[128:131], a[0:7], v246
ds_read_b128 v[200:203], v249 offset:4096
v_smfmac_f32_16x16x64_bf16 v[164:167], v[128:131], a[128:135], v246
buffer_load_dwordx4 v[228:231], v247, s[8:11], s30 offen offset:0 sc1 nt
v_smfmac_f32_16x16x64_bf16 v[168:171], v[128:131], a[64:71], v246
ds_read_b128 v[204:207], v249 offset:5120
v_smfmac_f32_16x16x64_bf16 v[172:175], v[128:131], a[192:199], v246
s_waitcnt lgkmcnt(8)
v_smfmac_f32_16x16x64_bf16 v[160:163], v[132:135], a[8:15], v246
ds_read_b128 v[208:211], v249 offset:6144
v_smfmac_f32_16x16x64_bf16 v[164:167], v[132:135], a[136:143], v246
buffer_load_dwordx4 v[232:235], v247, s[8:11], s30 offen offset:1024 sc1 nt
v_smfmac_f32_16x16x64_bf16 v[168:171], v[132:135], a[72:79], v246
ds_read_b128 v[212:215], v249 offset:7168
v_smfmac_f32_16x16x64_bf16 v[172:175], v[132:135], a[200:207], v246
s_waitcnt lgkmcnt(9)
v_smfmac_f32_16x16x64_bf16 v[160:163], v[136:139], a[16:23], v246
s_waitcnt vmcnt(4)
s_add_u32 s43, s22, 3
s_cmp_ge_u32 s43, s97
s_cbranch_scc1 L_hz_185
L_hzb_186:
ds_read_b128 v[184:187], v249 offset:0
v_smfmac_f32_16x16x64_bf16 v[164:167], v[136:139], a[144:151], v246
s_mov_b32 m0, s44
s_nop 0
buffer_load_dwordx4 v247, s[8:11], s29 offen sc1 nt lds
v_smfmac_f32_16x16x64_bf16 v[168:171], v[136:139], a[80:87], v246
ds_read_b128 v[188:191], v249 offset:1024
v_smfmac_f32_16x16x64_bf16 v[172:175], v[136:139], a[208:215], v246
s_waitcnt lgkmcnt(10)
v_smfmac_f32_16x16x64_bf16 v[160:163], v[140:143], a[24:31], v246
ds_read_b128 v[192:195], v249 offset:2048
v_smfmac_f32_16x16x64_bf16 v[164:167], v[140:143], a[152:159], v246
buffer_load_dwordx4 v247, s[8:11], s29 offen offset:1024 sc1 nt lds
v_smfmac_f32_16x16x64_bf16 v[168:171], v[140:143], a[88:95], v246
ds_read_b128 v[196:199], v249 offset:3072
v_smfmac_f32_16x16x64_bf16 v[172:175], v[140:143], a[216:223], v246
s_waitcnt lgkmcnt(8)
v_smfmac_f32_16x16x64_bf16 v[160:163], v[144:147], a[32:39], v246
v_smfmac_f32_16x16x64_bf16 v[164:167], v[144:147], a[160:167], v246
v_smfmac_f32_16x16x64_bf16 v[160:163], v[148:151], a[40:47], v246
v_smfmac_f32_16x16x64_bf16 v[164:167], v[148:151], a[168:175], v246
v_smfmac_f32_16x16x64_bf16 v[168:171], v[144:147], a[96:103], v246
v_smfmac_f32_16x16x64_bf16 v[172:175], v[144:147], a[224:231], v246
v_smfmac_f32_16x16x64_bf16 v[168:171], v[148:151], a[104:111], v246
v_smfmac_f32_16x16x64_bf16 v[172:175], v[148:151], a[232:239], v246
v_smfmac_f32_16x16x64_bf16 v[176:179], v[128:131], v[0:7], v246
s_nop 1
v_add_f32 v160, v160, v162
v_add_f32 v161, v161, v163
v_smfmac_f32_16x16x64_bf16 v[180:183], v[128:131], v[64:71], v246
v_add_f32 v164, v164, v166
v_add_f32 v165, v165, v167
v_smfmac_f32_16x16x64_bf16 v[176:179], v[132:135], v[8:15], v246
v_cvt_pk_bf16_f32 v163, v160, v161
v_cvt_pk_bf16_f32 v162, v164, v165
ds_write_b64 v252, v[162:163] offset:0
v_add_f32 v168, v168, v170
v_add_f32 v169, v169, v171
v_add_f32 v172, v172, v174
v_add_f32 v173, v173, v175
v_cvt_pk_bf16_f32 v171, v168, v169
v_cvt_pk_bf16_f32 v170, v172, v173
ds_write_b64 v252, v[170:171] offset:512
v_smfmac_f32_16x16x64_bf16 v[180:183], v[132:135], v[72:79], v246
v_smfmac_f32_16x16x64_bf16 v[176:179], v[136:139], v[16:23], v246
v_smfmac_f32_16x16x64_bf16 v[180:183], v[136:139], v[80:87], v246
v_smfmac_f32_16x16x64_bf16 v[176:179], v[140:143], v[24:31], v246
s_waitcnt lgkmcnt(0)
s_barrier
ds_read_b64_tr_b16 v[160:161], v253 offset:0
ds_read_b64_tr_b16 v[162:163], v253 offset:512
ds_read_b64_tr_b16 v[164:165], v253 offset:1024
v_smfmac_f32_16x16x64_bf16 v[180:183], v[140:143], v[88:95], v246
ds_read_b64_tr_b16 v[166:167], v253 offset:1536
v_smfmac_f32_16x16x64_bf16 v[176:179], v[144:147], v[32:39], v246
ds_read_b64_tr_b16 v[168:169], v253 offset:2048
v_smfmac_f32_16x16x64_bf16 v[180:183], v[144:147], v[96:103], v246
ds_read_b64_tr_b16 v[170:171], v253 offset:2560
v_smfmac_f32_16x16x64_bf16 v[176:179], v[148:151], v[40:47], v246
ds_read_b64_tr_b16 v[172:173], v253 offset:3072
v_smfmac_f32_16x16x64_bf16 v[180:183], v[148:151], v[104:111], v246
ds_read_b64_tr_b16 v[174:175], v253 offset:3584
s_waitcnt lgkmcnt(6)
v_mfma_f32_16x16x32_bf16 v[216:219], v[184:187], v[160:163], 0
v_mfma_f32_16x16x32_bf16 v[220:223], v[200:203], v[160:163], 0
ds_read_b128 v[128:131], v248 offset:4096
v_mfma_f32_16x16x32_bf16 v[224:227], v[160:163], v[160:163], 0
ds_read_b128 v[132:135], v248 offset:5120
s_waitcnt lgkmcnt(6)
v_mfma_f32_16x16x32_bf16 v[216:219], v[188:191], v[164:167], v[216:219]
ds_read_b128 v[136:139], v248 offset:20480
v_mfma_f32_16x16x32_bf16 v[220:223], v[204:207], v[164:167], v[220:223]
ds_read_b128 v[140:143], v248 offset:21504
v_mfma_f32_16x16x32_bf16 v[224:227], v[164:167], v[164:167], v[224:227]
ds_read_b128 v[144:147], v248 offset:6144
s_waitcnt lgkmcnt(7)
v_mfma_f32_16x16x32_bf16 v[216:219], v[192:195], v[168:171], v[216:219]
ds_read_b128 v[148:151], v248 offset:7168
v_mfma_f32_16x16x32_bf16 v[220:223], v[208:211], v[168:171], v[220:223]
v_mfma_f32_16x16x32_bf16 v[224:227], v[168:171], v[168:171], v[224:227]
s_waitcnt lgkmcnt(6)
v_mfma_f32_16x16x32_bf16 v[216:219], v[196:199], v[172:175], v[216:219]
v_mfma_f32_16x16x32_bf16 v[220:223], v[212:215], v[172:175], v[220:223]
v_mfma_f32_16x16x32_bf16 v[224:227], v[172:175], v[172:175], v[224:227]
buffer_store_dwordx4 v[172:175], v254, s[8:11], s31 offen offset:1536 sc1
v_smfmac_f32_16x16x64_bf16 v[176:179], v[152:155], v[48:55], v246
v_smfmac_f32_16x16x64_bf16 v[180:183], v[152:155], v[112:119], v246
v_smfmac_f32_16x16x64_bf16 v[176:179], v[156:159], v[56:63], v246
v_smfmac_f32_16x16x64_bf16 v[180:183], v[156:159], v[120:127], v246
ds_read_b128 v[152:155], v248 offset:22528
ds_read_b128 v[156:159], v248 offset:23552
v_max3_f32 v168, v216, v217, v218
v_max3_f32 v169, v219, v220, v221
v_max3_f32 v168, v168, v222, v223
v_max3_f32 v169, v169, v224, v225
v_max_f32 v168, v168, v169
v_mov_b32 v169, v168
ds_read_b128 v[184:187], v248 offset:0
v_mov_b64 v[164:165], s[100:101]
v_permlane32_swap_b32 v168, v169
v_max_f32 v168, v168, v169
v_mov_b32 v169, v168
ds_read_b128 v[188:191], v248 offset:1024
v_mov_b64 v[166:167], s[100:101]
v_permlane16_swap_b32 v168, v169
v_max_f32 v168, v168, v169
v_mul_f32 v170, s35, v168
v_pk_fma_f32 v[216:217], v[216:217], s[34:35], v[170:171] op_sel_hi:[1,0,0]
v_pk_fma_f32 v[218:219], v[218:219], s[34:35], v[170:171] op_sel_hi:[1,0,0]
ds_read_b128 v[192:195], v248 offset:16384
v_pk_fma_f32 v[220:221], v[220:221], s[34:35], v[170:171] op_sel_hi:[1,0,0]
v_pk_fma_f32 v[222:223], v[222:223], s[34:35], v[170:171] op_sel_hi:[1,0,0]
v_pk_fma_f32 v[224:225], v[224:225], s[34:35], v[170:171] op_sel_hi:[1,0,0]
ds_read_b128 v[196:199], v248 offset:17408
v_exp_f32 v216, v216
v_exp_f32 v217, v217
v_exp_f32 v218, v218
ds_read_b128 v[200:203], v248 offset:2048
v_exp_f32 v219, v219
v_exp_f32 v220, v220
v_exp_f32 v221, v221
ds_read_b128 v[204:207], v248 offset:3072
v_exp_f32 v222, v222
v_exp_f32 v223, v223
v_exp_f32 v224, v224
ds_read_b128 v[208:211], v248 offset:18432
v_exp_f32 v225, v225
ds_read_b128 v[212:215], v248 offset:19456
v_mov_b32 v161, 0
v_mov_b64 v[162:163], 0
s_cmp_lg_u32 s42, 0
s_cbranch_scc1 L_hze_187
L_hzf_188:
v_cvt_pk_bf16_f32 v236, v216, v217
v_cvt_pk_bf16_f32 v237, v218, v219
v_cvt_pk_bf16_f32 v238, v220, v221
v_cvt_pk_bf16_f32 v239, v222, v223
v_cvt_pk_bf16_f32 v160, v224, v225
v_add_f32 v176, v176, v178
v_mfma_f32_16x16x32_bf16 v[224:227], v[236:239], v[164:167], 0
s_waitcnt vmcnt(3)
v_add_f32 v177, v177, v179
v_mfma_f32_16x16x32_bf16 v[216:219], v[236:239], v[228:231], 0
v_add_f32 v180, v180, v182
v_mfma_f32_16x16x32_bf16 v[220:223], v[236:239], v[232:235], 0
v_add_f32 v181, v181, v183
v_mfma_f32_16x16x32_bf16 v[224:227], v[160:163], v[164:167], v[224:227]
v_cvt_pk_bf16_f32 v240, v176, v177
v_cvt_pk_bf16_f32 v242, v180, v181
v_lshrrev_b32 v255, 2, v247
s_nop 0
v_mfma_f32_16x16x32_bf16 v[216:219], v[160:163], v[240:243], v[216:219]
v_mfma_f32_16x16x32_bf16 v[220:223], v[160:163], v[242:245], v[220:223]
buffer_store_dword v240, v255, s[8:11], s37 offen sc1
buffer_store_dword v242, v255, s[8:11], s37 offen offset:256 sc1
v_rcp_f32 v172, v226
v_rcp_f32 v173, v227
s_nop 2
v_pk_mul_f32 v[218:219], v[218:219], v[172:173]
v_pk_mul_f32 v[222:223], v[222:223], v[172:173]
v_cvt_pk_bf16_f32 v216, v218, v219
v_cvt_pk_bf16_f32 v217, v222, v223
ds_write_b64 v252, v[216:217] offset:12288
v_mov_b64 v[168:169], 0
v_mov_b64 v[170:171], 0
v_mov_b64 v[172:173], 0
v_mov_b64 v[174:175], 0
v_mov_b64 v[176:177], 0
v_mov_b64 v[178:179], 0
v_mov_b64 v[180:181], 0
v_mov_b64 v[182:183], 0
s_waitcnt lgkmcnt(0)
s_barrier
ds_read_b64_tr_b16 v[236:237], v253 offset:12288
ds_read_b64_tr_b16 v[238:239], v253 offset:13312
ds_read_b64_tr_b16 v[240:241], v253 offset:14336
ds_read_b64_tr_b16 v[242:243], v253 offset:15360
v_mov_b64 v[160:161], 0
v_mov_b64 v[162:163], 0
v_mov_b64 v[164:165], 0
v_mov_b64 v[166:167], 0
v_mov_b64 v[228:229], 0
v_mov_b64 v[230:231], 0
v_mov_b64 v[232:233], 0
v_mov_b64 v[234:235], 0
s_waitcnt lgkmcnt(0)
v_smfmac_f32_16x16x64_bf16 v[160:163], v[236:239], v[184:191], v246
ds_read_b128 v[184:187], v248 offset:8192
ds_read_b128 v[188:191], v248 offset:9216
v_smfmac_f32_16x16x64_bf16 v[160:163], v[240:243], v[192:199], v246
ds_read_b128 v[192:195], v248 offset:24576
v_smfmac_f32_16x16x64_bf16 v[164:167], v[236:239], v[200:207], v246
ds_read_b128 v[196:199], v248 offset:25600
ds_read_b128 v[200:203], v248 offset:10240
v_smfmac_f32_16x16x64_bf16 v[164:167], v[240:243], v[208:215], v246
ds_read_b128 v[204:207], v248 offset:11264
s_nop 1
v_add_f32 v160, v160, v162
v_smfmac_f32_16x16x64_bf16 v[168:171], v[236:239], v[128:135], v246
ds_read_b128 v[208:211], v248 offset:26624
ds_read_b128 v[212:215], v248 offset:27648
v_add_f32 v161, v161, v163
v_smfmac_f32_16x16x64_bf16 v[168:171], v[240:243], v[136:143], v246
ds_read_b128 v[128:131], v248 offset:12288
v_cvt_pk_bf16_f32 v160, v160, v161
v_smfmac_f32_16x16x64_bf16 v[172:175], v[236:239], v[144:151], v246
ds_read_b128 v[132:135], v248 offset:13312
ds_read_b128 v[136:139], v248 offset:28672
v_add_f32 v164, v164, v166
v_smfmac_f32_16x16x64_bf16 v[172:175], v[240:243], v[152:159], v246
ds_read_b128 v[140:143], v248 offset:29696
v_add_f32 v165, v165, v167
s_waitcnt lgkmcnt(10)
v_smfmac_f32_16x16x64_bf16 v[176:179], v[236:239], v[184:191], v246
ds_read_b128 v[144:147], v248 offset:14336
ds_read_b128 v[148:151], v248 offset:15360
v_cvt_pk_bf16_f32 v161, v164, v165
v_add_f32 v168, v168, v170
s_waitcnt lgkmcnt(10)
v_smfmac_f32_16x16x64_bf16 v[176:179], v[240:243], v[192:199], v246
ds_read_b128 v[152:155], v248 offset:30720
v_add_f32 v169, v169, v171
v_cvt_pk_bf16_f32 v162, v168, v169
s_waitcnt lgkmcnt(9)
v_smfmac_f32_16x16x64_bf16 v[180:183], v[236:239], v[200:207], v246
ds_read_b128 v[156:159], v248 offset:31744
v_add_f32 v172, v172, v174
v_add_f32 v173, v173, v175
s_waitcnt lgkmcnt(8)
v_smfmac_f32_16x16x64_bf16 v[180:183], v[240:243], v[208:215], v246
v_cvt_pk_bf16_f32 v163, v172, v173
v_bfi_b32 v160, 1, s96, v160
s_waitcnt lgkmcnt(6)
v_smfmac_f32_16x16x64_bf16 v[228:231], v[236:239], v[128:135], v246
buffer_store_dwordx4 v[160:163], v250, s[8:11], s25 offen sc1
v_add_f32 v176, v176, v178
s_waitcnt lgkmcnt(4)
v_smfmac_f32_16x16x64_bf16 v[228:231], v[240:243], v[136:143], v246
v_add_f32 v177, v177, v179
v_cvt_pk_bf16_f32 v176, v176, v177
s_waitcnt lgkmcnt(2)
v_smfmac_f32_16x16x64_bf16 v[232:235], v[236:239], v[144:151], v246
v_add_f32 v180, v180, v182
v_add_f32 v181, v181, v183
s_waitcnt lgkmcnt(0)
v_smfmac_f32_16x16x64_bf16 v[232:235], v[240:243], v[152:159], v246
v_cvt_pk_bf16_f32 v177, v180, v181
v_add_f32 v228, v228, v230
v_add_f32 v229, v229, v231
v_cvt_pk_bf16_f32 v178, v228, v229
s_nop 3
v_pk_add_f32 v[232:233], v[232:233], v[234:235]
v_cvt_pk_bf16_f32 v179, v232, v233
v_bfi_b32 v176, 1, s96, v176
buffer_store_dwordx4 v[176:179], v250, s[8:11], s26 offen sc1
v_lshrrev_b32 v216, 9, v247
v_mul_u32_u24 v216, 512, v216
v_add3_u32 v255, v247, v216, s99
ds_read_b128 v[216:219], v255
s_add_u32 s29, s29, 262144
s_add_u32 s30, s30, 262144
s_add_u32 s37, s37, 65536
s_add_u32 s31, s31, 65536
s_add_u32 s22, s22, 1
s_xor_b32 s44, s44, 8192
v_xor_b32 v249, 8192, v249
s_waitcnt vmcnt(0)
s_waitcnt lgkmcnt(0)
s_mov_b32 s36, 200000
buffer_load_dwordx4 v[184:187], v247, s[8:11], s27 offen offset:0 sc1
buffer_load_dwordx4 v[188:191], v247, s[8:11], s27 offen offset:1024 sc1
s_waitcnt vmcnt(0)
v_bitop3_b32 v255, v184, v188, s96 bitop3:0x7e
v_and_b32 v255, 1, v255
v_cmp_ne_u32 vcc, 0, v255
s_cbranch_vccz L_rok0_189
buffer_load_dwordx4 v[184:187], v247, s[8:11], s27 offen offset:0 sc1
buffer_load_dwordx4 v[188:191], v247, s[8:11], s27 offen offset:1024 sc1
L_pl_192:
buffer_load_dwordx4 v[192:195], v247, s[8:11], s27 offen offset:0 sc1
buffer_load_dwordx4 v[196:199], v247, s[8:11], s27 offen offset:1024 sc1
s_waitcnt vmcnt(2)
v_bitop3_b32 v255, v184, v188, s96 bitop3:0x7e
v_and_b32 v255, 1, v255
v_cmp_ne_u32 vcc, 0, v255
s_cbranch_vccz L_rok0_189
buffer_load_dwordx4 v[184:187], v247, s[8:11], s27 offen offset:0 sc1
buffer_load_dwordx4 v[188:191], v247, s[8:11], s27 offen offset:1024 sc1
s_waitcnt vmcnt(2)
v_bitop3_b32 v255, v192, v196, s96 bitop3:0x7e
v_and_b32 v255, 1, v255
v_cmp_ne_u32 vcc, 0, v255
s_cbranch_vccz L_rok1_190
s_sub_u32 s36, s36, 1
s_cmp_lg_u32 s36, 0
s_cbranch_scc1 L_pl_192
s_branch L_abort
L_rok1_190:
v_mfma_f32_16x16x32_bf16 v[220:223], v[192:195], v[216:219], 0
v_mfma_f32_16x16x32_bf16 v[220:223], v[196:199], v[216:219], v[220:223]
s_branch L_rjoin_191
L_rok0_189:
v_mfma_f32_16x16x32_bf16 v[220:223], v[184:187], v[216:219], 0
v_mfma_f32_16x16x32_bf16 v[220:223], v[188:191], v[216:219], v[220:223]
L_rjoin_191:
s_add_u32 s23, s23, 8192
s_and_b32 s23, s23, 0x107fff
s_add_u32 s24, s23, 4096
s_add_u32 s41, s23, 2 * 8192
s_and_b32 s41, s41, 0x107fff
v_mov_b32 v224, -1
s_nop 2
v_permlane32_swap_b32 v220, v222
v_permlane32_swap_b32 v221, v223
v_add_f32 v220, v220, v222
v_add_f32 v221, v221, v223
s_nop 1
v_permlane16_swap_b32 v220, v221
v_add_f32 v220, v220, v221
v_mov_b32 v221, v220
s_nop 1
v_permlane16_swap_b32 v220, v221
v_cvt_pk_bf16_f32 v220, v220, v221
v_min_u32 v220, 0xfffffffe, v220
buffer_store_dword v220, v251, s[8:11], s23 offen sc1
s_xor_b32 s25, s25, 262144
s_xor_b32 s26, s26, 262144
s_xor_b32 s27, s27, 262144
s_bfe_u32 s96, s22, 0x10001
s_cmp_lg_u32 s22, 63
s_cbranch_scc1 L_step_w3s
v_mov_b64 v[160:161], 0
v_mov_b64 v[162:163], 0
v_mov_b64 v[164:165], 0
v_mov_b64 v[166:167], 0
v_mov_b64 v[168:169], 0
v_mov_b64 v[170:171], 0
v_mov_b64 v[172:173], 0
v_mov_b64 v[174:175], 0
v_mov_b64 v[176:177], 0
v_mov_b64 v[178:179], 0
v_mov_b64 v[180:181], 0
v_mov_b64 v[182:183], 0
s_mov_b32 s36, 200000
L_lpoll_193:
buffer_load_dwordx4 v[128:131], v247, s[8:11], s23 offen offset:0 sc1
buffer_load_dwordx4 v[132:135], v247, s[8:11], s23 offen offset:1024 sc1
buffer_load_dwordx4 v[136:139], v247, s[8:11], s23 offen offset:2048 sc1
buffer_load_dwordx4 v[140:143], v247, s[8:11], s23 offen offset:3072 sc1
buffer_load_dwordx4 v[144:147], v247, s[8:11], s24 offen offset:0 sc1
buffer_load_dwordx4 v[148:151], v247, s[8:11], s24 offen offset:1024 sc1
buffer_load_dwordx4 v[152:155], v247, s[8:11], s24 offen offset:2048 sc1
buffer_load_dwordx4 v[156:159], v247, s[8:11], s24 offen offset:3072 sc1
s_waitcnt vmcnt(0)
v_max3_u32 v255, v128, v129, v130
v_max3_u32 v255, v255, v131, v132
v_max3_u32 v255, v255, v133, v134
v_max3_u32 v255, v255, v135, v136
v_max3_u32 v255, v255, v137, v138
v_max3_u32 v255, v255, v139, v140
v_max3_u32 v255, v255, v141, v142
v_max3_u32 v255, v255, v143, v144
v_max3_u32 v255, v255, v145, v146
v_max3_u32 v255, v255, v147, v148
v_max3_u32 v255, v255, v149, v150
v_max3_u32 v255, v255, v151, v152
v_max3_u32 v255, v255, v153, v154
v_max3_u32 v255, v255, v155, v156
v_max3_u32 v255, v255, v157, v158
v_max_u32 v255, v255, v159
v_cmp_eq_u32 vcc, -1, v255
s_cbranch_vccnz L_lretry_194
v_smfmac_f32_16x16x64_bf16 v[164:167], v[128:131], a[128:135], v246
v_smfmac_f32_16x16x64_bf16 v[172:175], v[128:131], a[192:199], v246
v_smfmac_f32_16x16x64_bf16 v[176:179], v[128:131], v[0:7], v246
v_smfmac_f32_16x16x64_bf16 v[180:183], v[128:131], v[64:71], v246
v_smfmac_f32_16x16x64_bf16 v[164:167], v[132:135], a[136:143], v246
v_smfmac_f32_16x16x64_bf16 v[172:175], v[132:135], a[200:207], v246
v_smfmac_f32_16x16x64_bf16 v[176:179], v[132:135], v[8:15], v246
v_smfmac_f32_16x16x64_bf16 v[180:183], v[132:135], v[72:79], v246
v_smfmac_f32_16x16x64_bf16 v[164:167], v[136:139], a[144:151], v246
v_smfmac_f32_16x16x64_bf16 v[172:175], v[136:139], a[208:215], v246
v_smfmac_f32_16x16x64_bf16 v[176:179], v[136:139], v[16:23], v246
v_smfmac_f32_16x16x64_bf16 v[180:183], v[136:139], v[80:87], v246
v_smfmac_f32_16x16x64_bf16 v[164:167], v[140:143], a[152:159], v246
v_smfmac_f32_16x16x64_bf16 v[172:175], v[140:143], a[216:223], v246
v_smfmac_f32_16x16x64_bf16 v[176:179], v[140:143], v[24:31], v246
v_smfmac_f32_16x16x64_bf16 v[180:183], v[140:143], v[88:95], v246
v_smfmac_f32_16x16x64_bf16 v[164:167], v[144:147], a[160:167], v246
v_smfmac_f32_16x16x64_bf16 v[172:175], v[144:147], a[224:231], v246
v_smfmac_f32_16x16x64_bf16 v[176:179], v[144:147], v[32:39], v246
v_smfmac_f32_16x16x64_bf16 v[180:183], v[144:147], v[96:103], v246
v_smfmac_f32_16x16x64_bf16 v[164:167], v[148:151], a[168:175], v246
v_smfmac_f32_16x16x64_bf16 v[172:175], v[148:151], a[232:239], v246
v_smfmac_f32_16x16x64_bf16 v[176:179], v[148:151], v[40:47], v246
v_smfmac_f32_16x16x64_bf16 v[180:183], v[148:151], v[104:111], v246
v_smfmac_f32_16x16x64_bf16 v[164:167], v[152:155], a[176:183], v246
v_smfmac_f32_16x16x64_bf16 v[172:175], v[152:155], a[240:247], v246
v_smfmac_f32_16x16x64_bf16 v[176:179], v[152:155], v[48:55], v246
v_smfmac_f32_16x16x64_bf16 v[180:183], v[152:155], v[112:119], v246
v_smfmac_f32_16x16x64_bf16 v[164:167], v[156:159], a[184:191], v246
v_smfmac_f32_16x16x64_bf16 v[172:175], v[156:159], a[248:255], v246
v_smfmac_f32_16x16x64_bf16 v[176:179], v[156:159], v[56:63], v246
v_smfmac_f32_16x16x64_bf16 v[180:183], v[156:159], v[120:127], v246
v_add_f32 v160, v160, v162
v_add_f32 v161, v161, v163
s_nop 2
v_add_f32 v164, v164, v166
v_add_f32 v165, v165, v167
v_cvt_pk_bf16_f32 v163, v160, v161
v_cvt_pk_bf16_f32 v162, v164, v165
ds_write_b64 v252, v[162:163] offset:0
v_add_f32 v168, v168, v170
v_add_f32 v169, v169, v171
v_add_f32 v172, v172, v174
v_add_f32 v173, v173, v175
v_cvt_pk_bf16_f32 v171, v168, v169
v_cvt_pk_bf16_f32 v170, v172, v173
ds_write_b64 v252, v[170:171] offset:512
v_add_f32 v176, v176, v178
v_add_f32 v177, v177, v179
v_add_f32 v180, v180, v182
v_add_f32 v181, v181, v183
v_cvt_pk_bf16_f32 v240, v176, v177
v_cvt_pk_bf16_f32 v242, v180, v181
v_lshrrev_b32 v255, 2, v247
buffer_store_dword v240, v255, s[8:11], s37 offen sc1
buffer_store_dword v242, v255, s[8:11], s37 offen offset:256 sc1
s_waitcnt lgkmcnt(0)
s_barrier
v_mov_b32 v216, 63
v_mov_b32 v217, s46
buffer_store_dwordx2 v[216:217], v244, s[8:11], s47 offen sc1
ds_read_b64_tr_b16 v[184:185], v253 offset:3072
ds_read_b64_tr_b16 v[186:187], v253 offset:3584
s_waitcnt lgkmcnt(0)
buffer_store_dwordx4 v[184:187], v254, s[8:11], s31 offen offset:1536 sc1
s_waitcnt vmcnt(0)
s_barrier
v_mov_b32 v216, 64
v_mov_b32 v217, s46
buffer_store_dwordx2 v[216:217], v244, s[8:11], s47 offen sc1
L_done_w3s:
s_waitcnt vmcnt(0) lgkmcnt(0)
s_branch L_end_195
L_lretry_194:
s_sub_u32 s36, s36, 1
s_cmp_lg_u32 s36, 0
s_cbranch_scc1 L_lpoll_193
s_branch L_abort
L_hz_185:
s_cmp_ge_u32 s97, 64
s_cbranch_scc1 L_hzb_186
s_add_u32 s43, s22, 1
s_cmp_ge_u32 s43, s97
s_cbranch_scc1 L_hzblk_196
buffer_load_dwordx4 v[236:239], v244, s[8:11], s98 offen offset:16 sc1
buffer_load_dwordx4 v[240:243], v244, s[8:11], s98 offen offset:32 sc1
s_mov_b32 s42, 1
s_branch L_hzb_186
L_hzblk_196:
s_cmp_ge_u32 s43, 64
s_cbranch_scc1 L_hx_198
s_mov_b32 s36, 200000
L_hq_197:
buffer_load_dwordx4 v[216:219], v244, s[8:11], s98 offen offset:16 sc1
buffer_load_dwordx4 v[220:223], v244, s[8:11], s98 offen offset:32 sc1
s_sub_u32 s36, s36, 1
s_cmp_eq_u32 s36, 0
s_cbranch_scc1 L_abort
s_waitcnt vmcnt(0)
L_he_199:
v_cmp_eq_u32 vcc, s46, v217
s_nop 1
v_cndmask_b32 v216, 0, v216, vcc
v_cmp_eq_u32 vcc, s46, v219
s_nop 1
v_cndmask_b32 v218, 0, v218, vcc
v_cmp_eq_u32 vcc, s46, v221
s_nop 1
v_cndmask_b32 v220, 0, v220, vcc
v_cmp_eq_u32 vcc, s46, v223
s_nop 1
v_cndmask_b32 v222, 0, v222, vcc
v_min_u32 v216, v216, v220
v_min_u32 v217, v218, v222
v_lshlrev_b32 v216, 1, v216
v_lshl_add_u32 v217, v217, 1, 1
v_min_u32 v216, v216, v217
s_nop 0
v_readfirstlane_b32 s97, v216
s_cmp_ge_u32 s97, 64
s_cselect_b32 s97, 1000, s97
s_cmp_lt_u32 s43, s97
s_cbranch_scc0 L_hq_197
L_hx_198:
s_branch L_hzb_186
L_hze_187:
s_mov_b32 s42, 0
s_waitcnt vmcnt(3)
v_cmp_eq_u32 vcc, s46, v237
s_nop 1
v_cndmask_b32 v236, 0, v236, vcc
v_cmp_eq_u32 vcc, s46, v239
s_nop 1
v_cndmask_b32 v238, 0, v238, vcc
v_cmp_eq_u32 vcc, s46, v241
s_nop 1
v_cndmask_b32 v240, 0, v240, vcc
v_cmp_eq_u32 vcc, s46, v243
s_nop 1
v_cndmask_b32 v242, 0, v242, vcc
v_min_u32 v236, v236, v240
v_min_u32 v237, v238, v242
v_lshlrev_b32 v236, 1, v236
v_lshl_add_u32 v237, v237, 1, 1
v_min_u32 v236, v236, v237
s_nop 0
v_readfirstlane_b32 s97, v236
s_cmp_ge_u32 s97, 64
s_cselect_b32 s97, 1000, s97
v_mov_b32 v241, 0
v_mov_b32 v243, 0
s_branch L_hzf_188
L_end_195:
s_endpgm
L_abort:
s_mov_b64 exec, 1
v_mov_b32 v2, 0x7777
v_mov_b32 v3, 252
buffer_store_dword v2, v3, s[16:19], 0 offen
s_waitcnt vmcnt(0)
s_endpgm
L_hop_worker:
s_branch L_worker
L_worker:
s_sub_u32 s35, s33, 1
s_lshl_b32 s35, s35, 5
s_add_u32 s35, s35, s21
v_and_b32 v1, 63, v0
s_load_dwordx2 s[22:23], s[0:1], 0
s_load_dwordx4 s[24:27], s[0:1], 80
s_load_dwordx4 s[28:31], s[0:1], 16
s_load_dwordx2 s[36:37], s[0:1], 32
s_waitcnt lgkmcnt(0)
s_cmp_lt_u32 s35, 192
s_cbranch_scc1 L_front
s_sub_u32 s38, s35, 192
s_mov_b32 s4, s22
s_mov_b32 s5, s23
s_mov_b32 s6, 0x200000
s_mov_b32 s7, 0x00020000
s_lshl_b32 s39, s38, 5
v_lshrrev_b32 v112, 3, v1
v_and_b32 v113, 7, v1
s_lshl_b32 s90, s20, 3
s_add_u32 s90, s90, s39
v_add_u32 v114, s90, v112
v_lshlrev_b32 v115, 10, v114
v_lshl_add_u32 v115, v113, 4, v115
buffer_load_dwordx4 v[128:131], v115, s[4:7], 0 offen offset:0
buffer_load_dwordx4 v[132:135], v115, s[4:7], 0 offen offset:128
buffer_load_dwordx4 v[136:139], v115, s[4:7], 0 offen offset:256
buffer_load_dwordx4 v[140:143], v115, s[4:7], 0 offen offset:384
buffer_load_dwordx4 v[144:147], v115, s[4:7], 0 offen offset:512
buffer_load_dwordx4 v[148:151], v115, s[4:7], 0 offen offset:640
buffer_load_dwordx4 v[152:155], v115, s[4:7], 0 offen offset:768
buffer_load_dwordx4 v[156:159], v115, s[4:7], 0 offen offset:896
v_lshrrev_b32 v116, 5, v114
v_lshlrev_b32 v116, 15, v116
v_and_b32 v117, 31, v114
v_lshl_add_u32 v116, v117, 4, v116
v_lshrrev_b32 v117, 1, v113
v_lshl_add_u32 v116, v117, 10, v116
v_and_b32 v117, 1, v113
v_lshl_add_u32 v116, v117, 9, v116
v_lshlrev_b32 v117, 5, v113
s_add_u32 s39, s39, 1024
s_mov_b32 s12, s26
s_mov_b32 s13, s27
s_mov_b32 s14, 0x300000
s_mov_b32 s15, 0x00020000
s_mov_b32 s40, s24
s_mov_b32 s41, s25
s_mov_b32 s42, 0x400
s_mov_b32 s43, 0x00020000
v_lshrrev_b32 v16, 3, v1
v_and_b32 v17, 7, v1
s_lshl_b32 s90, s20, 7
v_add_u32 v16, s90, v16
v_mul_u32_u24 v18, 6144, v16
v_lshl_add_u32 v18, v17, 4, v18
s_lshl_b32 s91, s38, 7
v_lshlrev_b32 v19, 1, v16
s_add_u32 s92, s91, 0
buffer_load_dwordx4 v[32:35], v18, s[12:15], s92 offen
s_add_u32 s92, s91, 49152
buffer_load_dwordx4 v[36:39], v18, s[12:15], s92 offen
s_add_u32 s92, s91, 98304
buffer_load_dwordx4 v[40:43], v18, s[12:15], s92 offen
s_add_u32 s92, s91, 147456
buffer_load_dwordx4 v[44:47], v18, s[12:15], s92 offen
s_add_u32 s92, s91, 196608
buffer_load_dwordx4 v[48:51], v18, s[12:15], s92 offen
s_add_u32 s92, s91, 245760
buffer_load_dwordx4 v[52:55], v18, s[12:15], s92 offen
s_add_u32 s92, s91, 294912
buffer_load_dwordx4 v[56:59], v18, s[12:15], s92 offen
s_add_u32 s92, s91, 344064
buffer_load_dwordx4 v[60:63], v18, s[12:15], s92 offen
s_add_u32 s92, s91, 393216
buffer_load_dwordx4 v[64:67], v18, s[12:15], s92 offen
s_add_u32 s92, s91, 442368
buffer_load_dwordx4 v[68:71], v18, s[12:15], s92 offen
s_add_u32 s92, s91, 491520
buffer_load_dwordx4 v[72:75], v18, s[12:15], s92 offen
s_add_u32 s92, s91, 540672
buffer_load_dwordx4 v[76:79], v18, s[12:15], s92 offen
s_add_u32 s92, s91, 589824
buffer_load_dwordx4 v[80:83], v18, s[12:15], s92 offen
s_add_u32 s92, s91, 638976
buffer_load_dwordx4 v[84:87], v18, s[12:15], s92 offen
s_add_u32 s92, s91, 688128
buffer_load_dwordx4 v[88:91], v18, s[12:15], s92 offen
s_add_u32 s92, s91, 737280
buffer_load_dwordx4 v[92:95], v18, s[12:15], s92 offen
buffer_load_ushort v96, v19, s[40:43], 0 offen offset:0
buffer_load_ushort v97, v19, s[40:43], 0 offen offset:16
buffer_load_ushort v98, v19, s[40:43], 0 offen offset:32
buffer_load_ushort v99, v19, s[40:43], 0 offen offset:48
buffer_load_ushort v100, v19, s[40:43], 0 offen offset:64
buffer_load_ushort v101, v19, s[40:43], 0 offen offset:80
buffer_load_ushort v102, v19, s[40:43], 0 offen offset:96
buffer_load_ushort v103, v19, s[40:43], 0 offen offset:112
buffer_load_ushort v104, v19, s[40:43], 0 offen offset:128
buffer_load_ushort v105, v19, s[40:43], 0 offen offset:144
buffer_load_ushort v106, v19, s[40:43], 0 offen offset:160
buffer_load_ushort v107, v19, s[40:43], 0 offen offset:176
buffer_load_ushort v108, v19, s[40:43], 0 offen offset:192
buffer_load_ushort v109, v19, s[40:43], 0 offen offset:208
buffer_load_ushort v110, v19, s[40:43], 0 offen offset:224
buffer_load_ushort v111, v19, s[40:43], 0 offen offset:240
v_mov_b32 v24, 0
v_mov_b32 v25, 0
v_mov_b32 v26, 0
v_mov_b32 v27, 0
v_mov_b32 v28, 0
v_mov_b32 v29, 0
v_mov_b32 v30, 0
v_mov_b32 v31, 0
s_waitcnt vmcnt(0)
v_lshlrev_b32 v96, 16, v96
v_mul_f32 v20, 0xbfb8aa3b, v96
v_exp_f32 v20, v20
s_nop 0
v_add_f32 v20, 1.0, v20
v_rcp_f32 v20, v20
s_nop 0
v_mul_f32 v96, v96, v20
v_cvt_pk_bf16_f32 v96, v96, v96
v_and_b32 v96, 0xffff0000, v96
v_lshlrev_b32 v97, 16, v97
v_mul_f32 v20, 0xbfb8aa3b, v97
v_exp_f32 v20, v20
s_nop 0
v_add_f32 v20, 1.0, v20
v_rcp_f32 v20, v20
s_nop 0
v_mul_f32 v97, v97, v20
v_cvt_pk_bf16_f32 v97, v97, v97
v_and_b32 v97, 0xffff0000, v97
v_lshlrev_b32 v98, 16, v98
v_mul_f32 v20, 0xbfb8aa3b, v98
v_exp_f32 v20, v20
s_nop 0
v_add_f32 v20, 1.0, v20
v_rcp_f32 v20, v20
s_nop 0
v_mul_f32 v98, v98, v20
v_cvt_pk_bf16_f32 v98, v98, v98
v_and_b32 v98, 0xffff0000, v98
v_lshlrev_b32 v99, 16, v99
v_mul_f32 v20, 0xbfb8aa3b, v99
v_exp_f32 v20, v20
s_nop 0
v_add_f32 v20, 1.0, v20
v_rcp_f32 v20, v20
s_nop 0
v_mul_f32 v99, v99, v20
v_cvt_pk_bf16_f32 v99, v99, v99
v_and_b32 v99, 0xffff0000, v99
v_lshlrev_b32 v100, 16, v100
v_mul_f32 v20, 0xbfb8aa3b, v100
v_exp_f32 v20, v20
s_nop 0
v_add_f32 v20, 1.0, v20
v_rcp_f32 v20, v20
s_nop 0
v_mul_f32 v100, v100, v20
v_cvt_pk_bf16_f32 v100, v100, v100
v_and_b32 v100, 0xffff0000, v100
v_lshlrev_b32 v101, 16, v101
v_mul_f32 v20, 0xbfb8aa3b, v101
v_exp_f32 v20, v20
s_nop 0
v_add_f32 v20, 1.0, v20
v_rcp_f32 v20, v20
s_nop 0
v_mul_f32 v101, v101, v20
v_cvt_pk_bf16_f32 v101, v101, v101
v_and_b32 v101, 0xffff0000, v101
v_lshlrev_b32 v102, 16, v102
v_mul_f32 v20, 0xbfb8aa3b, v102
v_exp_f32 v20, v20
s_nop 0
v_add_f32 v20, 1.0, v20
v_rcp_f32 v20, v20
s_nop 0
v_mul_f32 v102, v102, v20
v_cvt_pk_bf16_f32 v102, v102, v102
v_and_b32 v102, 0xffff0000, v102
v_lshlrev_b32 v103, 16, v103
v_mul_f32 v20, 0xbfb8aa3b, v103
v_exp_f32 v20, v20
s_nop 0
v_add_f32 v20, 1.0, v20
v_rcp_f32 v20, v20
s_nop 0
v_mul_f32 v103, v103, v20
v_cvt_pk_bf16_f32 v103, v103, v103
v_and_b32 v103, 0xffff0000, v103
v_lshlrev_b32 v104, 16, v104
v_mul_f32 v20, 0xbfb8aa3b, v104
v_exp_f32 v20, v20
s_nop 0
v_add_f32 v20, 1.0, v20
v_rcp_f32 v20, v20
s_nop 0
v_mul_f32 v104, v104, v20
v_cvt_pk_bf16_f32 v104, v104, v104
v_and_b32 v104, 0xffff0000, v104
v_lshlrev_b32 v105, 16, v105
v_mul_f32 v20, 0xbfb8aa3b, v105
v_exp_f32 v20, v20
s_nop 0
v_add_f32 v20, 1.0, v20
v_rcp_f32 v20, v20
s_nop 0
v_mul_f32 v105, v105, v20
v_cvt_pk_bf16_f32 v105, v105, v105
v_and_b32 v105, 0xffff0000, v105
v_lshlrev_b32 v106, 16, v106
v_mul_f32 v20, 0xbfb8aa3b, v106
v_exp_f32 v20, v20
s_nop 0
v_add_f32 v20, 1.0, v20
v_rcp_f32 v20, v20
s_nop 0
v_mul_f32 v106, v106, v20
v_cvt_pk_bf16_f32 v106, v106, v106
v_and_b32 v106, 0xffff0000, v106
v_lshlrev_b32 v107, 16, v107
v_mul_f32 v20, 0xbfb8aa3b, v107
v_exp_f32 v20, v20
s_nop 0
v_add_f32 v20, 1.0, v20
v_rcp_f32 v20, v20
s_nop 0
v_mul_f32 v107, v107, v20
v_cvt_pk_bf16_f32 v107, v107, v107
v_and_b32 v107, 0xffff0000, v107
v_lshlrev_b32 v108, 16, v108
v_mul_f32 v20, 0xbfb8aa3b, v108
v_exp_f32 v20, v20
s_nop 0
v_add_f32 v20, 1.0, v20
v_rcp_f32 v20, v20
s_nop 0
v_mul_f32 v108, v108, v20
v_cvt_pk_bf16_f32 v108, v108, v108
v_and_b32 v108, 0xffff0000, v108
v_lshlrev_b32 v109, 16, v109
v_mul_f32 v20, 0xbfb8aa3b, v109
v_exp_f32 v20, v20
s_nop 0
v_add_f32 v20, 1.0, v20
v_rcp_f32 v20, v20
s_nop 0
v_mul_f32 v109, v109, v20
v_cvt_pk_bf16_f32 v109, v109, v109
v_and_b32 v109, 0xffff0000, v109
v_lshlrev_b32 v110, 16, v110
v_mul_f32 v20, 0xbfb8aa3b, v110
v_exp_f32 v20, v20
s_nop 0
v_add_f32 v20, 1.0, v20
v_rcp_f32 v20, v20
s_nop 0
v_mul_f32 v110, v110, v20
v_cvt_pk_bf16_f32 v110, v110, v110
v_and_b32 v110, 0xffff0000, v110
v_lshlrev_b32 v111, 16, v111
v_mul_f32 v20, 0xbfb8aa3b, v111
v_exp_f32 v20, v20
s_nop 0
v_add_f32 v20, 1.0, v20
v_rcp_f32 v20, v20
s_nop 0
v_mul_f32 v111, v111, v20
v_cvt_pk_bf16_f32 v111, v111, v111
v_and_b32 v111, 0xffff0000, v111
v_lshlrev_b32 v20, 16, v32
v_and_b32 v21, 0xffff0000, v32
v_fmac_f32 v24, v20, v96
v_fmac_f32 v25, v21, v96
v_lshlrev_b32 v20, 16, v33
v_and_b32 v21, 0xffff0000, v33
v_fmac_f32 v26, v20, v96
v_fmac_f32 v27, v21, v96
v_lshlrev_b32 v20, 16, v34
v_and_b32 v21, 0xffff0000, v34
v_fmac_f32 v28, v20, v96
v_fmac_f32 v29, v21, v96
v_lshlrev_b32 v20, 16, v35
v_and_b32 v21, 0xffff0000, v35
v_fmac_f32 v30, v20, v96
v_fmac_f32 v31, v21, v96
v_lshlrev_b32 v20, 16, v36
v_and_b32 v21, 0xffff0000, v36
v_fmac_f32 v24, v20, v97
v_fmac_f32 v25, v21, v97
v_lshlrev_b32 v20, 16, v37
v_and_b32 v21, 0xffff0000, v37
v_fmac_f32 v26, v20, v97
v_fmac_f32 v27, v21, v97
v_lshlrev_b32 v20, 16, v38
v_and_b32 v21, 0xffff0000, v38
v_fmac_f32 v28, v20, v97
v_fmac_f32 v29, v21, v97
v_lshlrev_b32 v20, 16, v39
v_and_b32 v21, 0xffff0000, v39
v_fmac_f32 v30, v20, v97
v_fmac_f32 v31, v21, v97
v_lshlrev_b32 v20, 16, v40
v_and_b32 v21, 0xffff0000, v40
v_fmac_f32 v24, v20, v98
v_fmac_f32 v25, v21, v98
v_lshlrev_b32 v20, 16, v41
v_and_b32 v21, 0xffff0000, v41
v_fmac_f32 v26, v20, v98
v_fmac_f32 v27, v21, v98
v_lshlrev_b32 v20, 16, v42
v_and_b32 v21, 0xffff0000, v42
v_fmac_f32 v28, v20, v98
v_fmac_f32 v29, v21, v98
v_lshlrev_b32 v20, 16, v43
v_and_b32 v21, 0xffff0000, v43
v_fmac_f32 v30, v20, v98
v_fmac_f32 v31, v21, v98
v_lshlrev_b32 v20, 16, v44
v_and_b32 v21, 0xffff0000, v44
v_fmac_f32 v24, v20, v99
v_fmac_f32 v25, v21, v99
v_lshlrev_b32 v20, 16, v45
v_and_b32 v21, 0xffff0000, v45
v_fmac_f32 v26, v20, v99
v_fmac_f32 v27, v21, v99
v_lshlrev_b32 v20, 16, v46
v_and_b32 v21, 0xffff0000, v46
v_fmac_f32 v28, v20, v99
v_fmac_f32 v29, v21, v99
v_lshlrev_b32 v20, 16, v47
v_and_b32 v21, 0xffff0000, v47
v_fmac_f32 v30, v20, v99
v_fmac_f32 v31, v21, v99
v_lshlrev_b32 v20, 16, v48
v_and_b32 v21, 0xffff0000, v48
v_fmac_f32 v24, v20, v100
v_fmac_f32 v25, v21, v100
v_lshlrev_b32 v20, 16, v49
v_and_b32 v21, 0xffff0000, v49
v_fmac_f32 v26, v20, v100
v_fmac_f32 v27, v21, v100
v_lshlrev_b32 v20, 16, v50
v_and_b32 v21, 0xffff0000, v50
v_fmac_f32 v28, v20, v100
v_fmac_f32 v29, v21, v100
v_lshlrev_b32 v20, 16, v51
v_and_b32 v21, 0xffff0000, v51
v_fmac_f32 v30, v20, v100
v_fmac_f32 v31, v21, v100
v_lshlrev_b32 v20, 16, v52
v_and_b32 v21, 0xffff0000, v52
v_fmac_f32 v24, v20, v101
v_fmac_f32 v25, v21, v101
v_lshlrev_b32 v20, 16, v53
v_and_b32 v21, 0xffff0000, v53
v_fmac_f32 v26, v20, v101
v_fmac_f32 v27, v21, v101
v_lshlrev_b32 v20, 16, v54
v_and_b32 v21, 0xffff0000, v54
v_fmac_f32 v28, v20, v101
v_fmac_f32 v29, v21, v101
v_lshlrev_b32 v20, 16, v55
v_and_b32 v21, 0xffff0000, v55
v_fmac_f32 v30, v20, v101
v_fmac_f32 v31, v21, v101
v_lshlrev_b32 v20, 16, v56
v_and_b32 v21, 0xffff0000, v56
v_fmac_f32 v24, v20, v102
v_fmac_f32 v25, v21, v102
v_lshlrev_b32 v20, 16, v57
v_and_b32 v21, 0xffff0000, v57
v_fmac_f32 v26, v20, v102
v_fmac_f32 v27, v21, v102
v_lshlrev_b32 v20, 16, v58
v_and_b32 v21, 0xffff0000, v58
v_fmac_f32 v28, v20, v102
v_fmac_f32 v29, v21, v102
v_lshlrev_b32 v20, 16, v59
v_and_b32 v21, 0xffff0000, v59
v_fmac_f32 v30, v20, v102
v_fmac_f32 v31, v21, v102
v_lshlrev_b32 v20, 16, v60
v_and_b32 v21, 0xffff0000, v60
v_fmac_f32 v24, v20, v103
v_fmac_f32 v25, v21, v103
v_lshlrev_b32 v20, 16, v61
v_and_b32 v21, 0xffff0000, v61
v_fmac_f32 v26, v20, v103
v_fmac_f32 v27, v21, v103
v_lshlrev_b32 v20, 16, v62
v_and_b32 v21, 0xffff0000, v62
v_fmac_f32 v28, v20, v103
v_fmac_f32 v29, v21, v103
v_lshlrev_b32 v20, 16, v63
v_and_b32 v21, 0xffff0000, v63
v_fmac_f32 v30, v20, v103
v_fmac_f32 v31, v21, v103
v_lshlrev_b32 v20, 16, v64
v_and_b32 v21, 0xffff0000, v64
v_fmac_f32 v24, v20, v104
v_fmac_f32 v25, v21, v104
v_lshlrev_b32 v20, 16, v65
v_and_b32 v21, 0xffff0000, v65
v_fmac_f32 v26, v20, v104
v_fmac_f32 v27, v21, v104
v_lshlrev_b32 v20, 16, v66
v_and_b32 v21, 0xffff0000, v66
v_fmac_f32 v28, v20, v104
v_fmac_f32 v29, v21, v104
v_lshlrev_b32 v20, 16, v67
v_and_b32 v21, 0xffff0000, v67
v_fmac_f32 v30, v20, v104
v_fmac_f32 v31, v21, v104
v_lshlrev_b32 v20, 16, v68
v_and_b32 v21, 0xffff0000, v68
v_fmac_f32 v24, v20, v105
v_fmac_f32 v25, v21, v105
v_lshlrev_b32 v20, 16, v69
v_and_b32 v21, 0xffff0000, v69
v_fmac_f32 v26, v20, v105
v_fmac_f32 v27, v21, v105
v_lshlrev_b32 v20, 16, v70
v_and_b32 v21, 0xffff0000, v70
v_fmac_f32 v28, v20, v105
v_fmac_f32 v29, v21, v105
v_lshlrev_b32 v20, 16, v71
v_and_b32 v21, 0xffff0000, v71
v_fmac_f32 v30, v20, v105
v_fmac_f32 v31, v21, v105
v_lshlrev_b32 v20, 16, v72
v_and_b32 v21, 0xffff0000, v72
v_fmac_f32 v24, v20, v106
v_fmac_f32 v25, v21, v106
v_lshlrev_b32 v20, 16, v73
v_and_b32 v21, 0xffff0000, v73
v_fmac_f32 v26, v20, v106
v_fmac_f32 v27, v21, v106
v_lshlrev_b32 v20, 16, v74
v_and_b32 v21, 0xffff0000, v74
v_fmac_f32 v28, v20, v106
v_fmac_f32 v29, v21, v106
v_lshlrev_b32 v20, 16, v75
v_and_b32 v21, 0xffff0000, v75
v_fmac_f32 v30, v20, v106
v_fmac_f32 v31, v21, v106
v_lshlrev_b32 v20, 16, v76
v_and_b32 v21, 0xffff0000, v76
v_fmac_f32 v24, v20, v107
v_fmac_f32 v25, v21, v107
v_lshlrev_b32 v20, 16, v77
v_and_b32 v21, 0xffff0000, v77
v_fmac_f32 v26, v20, v107
v_fmac_f32 v27, v21, v107
v_lshlrev_b32 v20, 16, v78
v_and_b32 v21, 0xffff0000, v78
v_fmac_f32 v28, v20, v107
v_fmac_f32 v29, v21, v107
v_lshlrev_b32 v20, 16, v79
v_and_b32 v21, 0xffff0000, v79
v_fmac_f32 v30, v20, v107
v_fmac_f32 v31, v21, v107
v_lshlrev_b32 v20, 16, v80
v_and_b32 v21, 0xffff0000, v80
v_fmac_f32 v24, v20, v108
v_fmac_f32 v25, v21, v108
v_lshlrev_b32 v20, 16, v81
v_and_b32 v21, 0xffff0000, v81
v_fmac_f32 v26, v20, v108
v_fmac_f32 v27, v21, v108
v_lshlrev_b32 v20, 16, v82
v_and_b32 v21, 0xffff0000, v82
v_fmac_f32 v28, v20, v108
v_fmac_f32 v29, v21, v108
v_lshlrev_b32 v20, 16, v83
v_and_b32 v21, 0xffff0000, v83
v_fmac_f32 v30, v20, v108
v_fmac_f32 v31, v21, v108
v_lshlrev_b32 v20, 16, v84
v_and_b32 v21, 0xffff0000, v84
v_fmac_f32 v24, v20, v109
v_fmac_f32 v25, v21, v109
v_lshlrev_b32 v20, 16, v85
v_and_b32 v21, 0xffff0000, v85
v_fmac_f32 v26, v20, v109
v_fmac_f32 v27, v21, v109
v_lshlrev_b32 v20, 16, v86
v_and_b32 v21, 0xffff0000, v86
v_fmac_f32 v28, v20, v109
v_fmac_f32 v29, v21, v109
v_lshlrev_b32 v20, 16, v87
v_and_b32 v21, 0xffff0000, v87
v_fmac_f32 v30, v20, v109
v_fmac_f32 v31, v21, v109
v_lshlrev_b32 v20, 16, v88
v_and_b32 v21, 0xffff0000, v88
v_fmac_f32 v24, v20, v110
v_fmac_f32 v25, v21, v110
v_lshlrev_b32 v20, 16, v89
v_and_b32 v21, 0xffff0000, v89
v_fmac_f32 v26, v20, v110
v_fmac_f32 v27, v21, v110
v_lshlrev_b32 v20, 16, v90
v_and_b32 v21, 0xffff0000, v90
v_fmac_f32 v28, v20, v110
v_fmac_f32 v29, v21, v110
v_lshlrev_b32 v20, 16, v91
v_and_b32 v21, 0xffff0000, v91
v_fmac_f32 v30, v20, v110
v_fmac_f32 v31, v21, v110
v_lshlrev_b32 v20, 16, v92
v_and_b32 v21, 0xffff0000, v92
v_fmac_f32 v24, v20, v111
v_fmac_f32 v25, v21, v111
v_lshlrev_b32 v20, 16, v93
v_and_b32 v21, 0xffff0000, v93
v_fmac_f32 v26, v20, v111
v_fmac_f32 v27, v21, v111
v_lshlrev_b32 v20, 16, v94
v_and_b32 v21, 0xffff0000, v94
v_fmac_f32 v28, v20, v111
v_fmac_f32 v29, v21, v111
v_lshlrev_b32 v20, 16, v95
v_and_b32 v21, 0xffff0000, v95
v_fmac_f32 v30, v20, v111
v_fmac_f32 v31, v21, v111
v_add_f32_dpp v24, v24, v24 row_ror:8 row_mask:0xf bank_mask:0xf
v_add_f32_dpp v25, v25, v25 row_ror:8 row_mask:0xf bank_mask:0xf
v_add_f32_dpp v26, v26, v26 row_ror:8 row_mask:0xf bank_mask:0xf
v_add_f32_dpp v27, v27, v27 row_ror:8 row_mask:0xf bank_mask:0xf
v_add_f32_dpp v28, v28, v28 row_ror:8 row_mask:0xf bank_mask:0xf
v_add_f32_dpp v29, v29, v29 row_ror:8 row_mask:0xf bank_mask:0xf
v_add_f32_dpp v30, v30, v30 row_ror:8 row_mask:0xf bank_mask:0xf
v_add_f32_dpp v31, v31, v31 row_ror:8 row_mask:0xf bank_mask:0xf
v_mov_b32 v20, v24
s_nop 1
v_permlane16_swap_b32 v24, v20
v_add_f32 v24, v24, v20
v_mov_b32 v20, v24
s_nop 1
v_permlane32_swap_b32 v24, v20
v_add_f32 v24, v24, v20
v_mov_b32 v20, v25
s_nop 1
v_permlane16_swap_b32 v25, v20
v_add_f32 v25, v25, v20
v_mov_b32 v20, v25
s_nop 1
v_permlane32_swap_b32 v25, v20
v_add_f32 v25, v25, v20
v_mov_b32 v20, v26
s_nop 1
v_permlane16_swap_b32 v26, v20
v_add_f32 v26, v26, v20
v_mov_b32 v20, v26
s_nop 1
v_permlane32_swap_b32 v26, v20
v_add_f32 v26, v26, v20
v_mov_b32 v20, v27
s_nop 1
v_permlane16_swap_b32 v27, v20
v_add_f32 v27, v27, v20
v_mov_b32 v20, v27
s_nop 1
v_permlane32_swap_b32 v27, v20
v_add_f32 v27, v27, v20
v_mov_b32 v20, v28
s_nop 1
v_permlane16_swap_b32 v28, v20
v_add_f32 v28, v28, v20
v_mov_b32 v20, v28
s_nop 1
v_permlane32_swap_b32 v28, v20
v_add_f32 v28, v28, v20
v_mov_b32 v20, v29
s_nop 1
v_permlane16_swap_b32 v29, v20
v_add_f32 v29, v29, v20
v_mov_b32 v20, v29
s_nop 1
v_permlane32_swap_b32 v29, v20
v_add_f32 v29, v29, v20
v_mov_b32 v20, v30
s_nop 1
v_permlane16_swap_b32 v30, v20
v_add_f32 v30, v30, v20
v_mov_b32 v20, v30
s_nop 1
v_permlane32_swap_b32 v30, v20
v_add_f32 v30, v30, v20
v_mov_b32 v20, v31
s_nop 1
v_permlane16_swap_b32 v31, v20
v_add_f32 v31, v31, v20
v_mov_b32 v20, v31
s_nop 1
v_permlane32_swap_b32 v31, v20
v_add_f32 v31, v31, v20
v_lshlrev_b32 v20, 5, v17
s_lshl_b32 s90, s20, 8
s_add_u32 s90, s90, 140000
v_add_u32 v20, s90, v20
ds_write_b128 v20, v[24:27]
ds_write_b128 v20, v[28:31] offset:16
s_waitcnt lgkmcnt(0)
s_barrier
v_lshlrev_b32 v20, 2, v1
v_add_u32 v21, 140000, v20
ds_read_b32 v24, v21 offset:0
ds_read_b32 v25, v21 offset:256
ds_read_b32 v26, v21 offset:512
ds_read_b32 v27, v21 offset:768
s_waitcnt lgkmcnt(0)
v_add_f32 v24, v24, v25
v_add_f32 v26, v26, v27
v_add_f32 v24, v24, v26
v_cvt_pk_bf16_f32 v24, v24, v24
v_and_b32 v24, 0xffff0000, v24
v_add_f32 v25, 1.0, v24
v_cvt_pk_bf16_f32 v25, v25, v25
v_and_b32 v25, 0xffff0000, v25
s_lshr_b32 s90, s38, 3
s_cmp_eq_u32 s90, 1
s_cbranch_scc1 L_modp_200
s_cmp_eq_u32 s90, 4
s_cbranch_scc0 L_modq_201
L_modp_200:
v_mov_b32 v24, v25
L_modq_201:
s_lshl_b32 s90, s38, 8
s_add_u32 s90, s90, 0x0
s_cmp_lg_u32 s20, 0
s_cbranch_scc1 L_modr_202
buffer_store_dword v24, v20, s[8:11], s90 offen sc1
L_modr_202:
s_waitcnt vmcnt(0)
s_barrier
s_cmp_lg_u32 s32, 0
s_cbranch_scc1 L_vfx_205
s_mov_b32 s90, 200000
L_vf_203:
v_mov_b32 v28, 0
buffer_load_dwordx4 v[16:19], v28, s[16:19], 0 offen sc1
buffer_load_dwordx4 v[20:23], v28, s[16:19], 0 offen offset:16 sc1
buffer_load_dwordx2 v[24:25], v28, s[16:19], 0 offen offset:128 sc1
s_sub_u32 s90, s90, 1
s_cmp_eq_u32 s90, 0
s_cbranch_scc1 L_abort
s_waitcnt vmcnt(0)
L_vfe_204:
v_add3_u32 v26, v17, v18, v19
v_add3_u32 v26, v26, v20, v21
v_add3_u32 v26, v26, v22, v23
v_add_u32 v26, v26, v24
v_max3_u32 v27, v17, v18, v19
v_max3_u32 v27, v27, v20, v21
v_max3_u32 v27, v27, v22, v23
v_max_u32 v27, v27, v24
v_cmp_lt_u32 vcc, 0x100, v26
s_cbranch_vccnz L_abort
v_cmp_ne_u32 vcc, 0x100, v26
s_cbranch_vccnz L_vf_203
v_cmp_eq_u32 vcc, 0, v25
s_cbranch_vccnz L_vf_203
v_readfirstlane_b32 s46, v25
v_readfirstlane_b32 s90, v27
s_cmp_lg_u32 s90, 32
s_cbranch_scc1 L_slow
L_vfx_205:
s_lshl_b32 s90, s38, 3
s_add_u32 s90, s90, 0x10000
s_cmp_lg_u32 s20, 0
s_cbranch_scc1 L_sf_206
v_mov_b32 v16, 1
v_mov_b32 v17, s46
v_mov_b32 v18, 0
s_mov_b64 exec, 1
buffer_store_dwordx2 v[16:17], v18, s[8:11], s90 offen sc1
s_mov_b64 exec, -1
L_sf_206:
v_lshlrev_b32 v160, 16, v128
v_and_b32 v161, 0xffff0000, v128
v_lshlrev_b32 v162, 16, v129
v_and_b32 v163, 0xffff0000, v129
v_lshlrev_b32 v164, 16, v130
v_and_b32 v165, 0xffff0000, v130
v_lshlrev_b32 v166, 16, v131
v_and_b32 v167, 0xffff0000, v131
v_lshlrev_b32 v168, 16, v132
v_and_b32 v169, 0xffff0000, v132
v_lshlrev_b32 v170, 16, v133
v_and_b32 v171, 0xffff0000, v133
v_lshlrev_b32 v172, 16, v134
v_and_b32 v173, 0xffff0000, v134
v_lshlrev_b32 v174, 16, v135
v_and_b32 v175, 0xffff0000, v135
v_lshlrev_b32 v176, 16, v136
v_and_b32 v177, 0xffff0000, v136
v_lshlrev_b32 v178, 16, v137
v_and_b32 v179, 0xffff0000, v137
v_lshlrev_b32 v180, 16, v138
v_and_b32 v181, 0xffff0000, v138
v_lshlrev_b32 v182, 16, v139
v_and_b32 v183, 0xffff0000, v139
v_lshlrev_b32 v184, 16, v140
v_and_b32 v185, 0xffff0000, v140
v_lshlrev_b32 v186, 16, v141
v_and_b32 v187, 0xffff0000, v141
v_lshlrev_b32 v188, 16, v142
v_and_b32 v189, 0xffff0000, v142
v_lshlrev_b32 v190, 16, v143
v_and_b32 v191, 0xffff0000, v143
v_lshlrev_b32 v192, 16, v144
v_and_b32 v193, 0xffff0000, v144
v_lshlrev_b32 v194, 16, v145
v_and_b32 v195, 0xffff0000, v145
v_lshlrev_b32 v196, 16, v146
v_and_b32 v197, 0xffff0000, v146
v_lshlrev_b32 v198, 16, v147
v_and_b32 v199, 0xffff0000, v147
v_lshlrev_b32 v200, 16, v148
v_and_b32 v201, 0xffff0000, v148
v_lshlrev_b32 v202, 16, v149
v_and_b32 v203, 0xffff0000, v149
v_lshlrev_b32 v204, 16, v150
v_and_b32 v205, 0xffff0000, v150
v_lshlrev_b32 v206, 16, v151
v_and_b32 v207, 0xffff0000, v151
v_lshlrev_b32 v208, 16, v152
v_and_b32 v209, 0xffff0000, v152
v_lshlrev_b32 v210, 16, v153
v_and_b32 v211, 0xffff0000, v153
v_lshlrev_b32 v212, 16, v154
v_and_b32 v213, 0xffff0000, v154
v_lshlrev_b32 v214, 16, v155
v_and_b32 v215, 0xffff0000, v155
v_lshlrev_b32 v216, 16, v156
v_and_b32 v217, 0xffff0000, v156
v_lshlrev_b32 v218, 16, v157
v_and_b32 v219, 0xffff0000, v157
v_lshlrev_b32 v220, 16, v158
v_and_b32 v221, 0xffff0000, v158
v_lshlrev_b32 v222, 16, v159
v_and_b32 v223, 0xffff0000, v159
v_add_f32 v119, v160, v161
v_add_f32 v118, v162, v163
v_add_f32 v119, v119, v164
v_add_f32 v118, v118, v165
v_add_f32 v119, v119, v166
v_add_f32 v118, v118, v167
v_add_f32 v119, v119, v168
v_add_f32 v118, v118, v169
v_add_f32 v119, v119, v170
v_add_f32 v118, v118, v171
v_add_f32 v119, v119, v172
v_add_f32 v118, v118, v173
v_add_f32 v119, v119, v174
v_add_f32 v118, v118, v175
v_add_f32 v119, v119, v176
v_add_f32 v118, v118, v177
v_add_f32 v119, v119, v178
v_add_f32 v118, v118, v179
v_add_f32 v119, v119, v180
v_add_f32 v118, v118, v181
v_add_f32 v119, v119, v182
v_add_f32 v118, v118, v183
v_add_f32 v119, v119, v184
v_add_f32 v118, v118, v185
v_add_f32 v119, v119, v186
v_add_f32 v118, v118, v187
v_add_f32 v119, v119, v188
v_add_f32 v118, v118, v189
v_add_f32 v119, v119, v190
v_add_f32 v118, v118, v191
v_add_f32 v119, v119, v192
v_add_f32 v118, v118, v193
v_add_f32 v119, v119, v194
v_add_f32 v118, v118, v195
v_add_f32 v119, v119, v196
v_add_f32 v118, v118, v197
v_add_f32 v119, v119, v198
v_add_f32 v118, v118, v199
v_add_f32 v119, v119, v200
v_add_f32 v118, v118, v201
v_add_f32 v119, v119, v202
v_add_f32 v118, v118, v203
v_add_f32 v119, v119, v204
v_add_f32 v118, v118, v205
v_add_f32 v119, v119, v206
v_add_f32 v118, v118, v207
v_add_f32 v119, v119, v208
v_add_f32 v118, v118, v209
v_add_f32 v119, v119, v210
v_add_f32 v118, v118, v211
v_add_f32 v119, v119, v212
v_add_f32 v118, v118, v213
v_add_f32 v119, v119, v214
v_add_f32 v118, v118, v215
v_add_f32 v119, v119, v216
v_add_f32 v118, v118, v217
v_add_f32 v119, v119, v218
v_add_f32 v118, v118, v219
v_add_f32 v119, v119, v220
v_add_f32 v118, v118, v221
v_add_f32 v119, v119, v222
v_add_f32 v118, v118, v223
v_add_f32 v119, v119, v118
s_nop 1
v_add_f32_dpp v119, v119, v119 quad_perm:[1,0,3,2] row_mask:0xf bank_mask:0xf
s_nop 1
v_add_f32_dpp v119, v119, v119 quad_perm:[2,3,0,1] row_mask:0xf bank_mask:0xf
s_nop 1
v_add_f32_dpp v119, v119, v119 row_half_mirror row_mask:0xf bank_mask:0xf
v_mul_f32 v119, 0x3b000000, v119
v_cvt_pk_bf16_f32 v118, v119, v119
v_and_b32 v118, 0xffff0000, v118
v_sub_f32 v121, v160, v119
v_mul_f32 v120, v121, v121
v_sub_f32 v122, v161, v119
v_mul_f32 v123, v122, v122
v_sub_f32 v121, v162, v119
v_sub_f32 v122, v163, v119
v_fmac_f32 v120, v121, v121
v_fmac_f32 v123, v122, v122
v_sub_f32 v121, v164, v119
v_sub_f32 v122, v165, v119
v_fmac_f32 v120, v121, v121
v_fmac_f32 v123, v122, v122
v_sub_f32 v121, v166, v119
v_sub_f32 v122, v167, v119
v_fmac_f32 v120, v121, v121
v_fmac_f32 v123, v122, v122
v_sub_f32 v121, v168, v119
v_sub_f32 v122, v169, v119
v_fmac_f32 v120, v121, v121
v_fmac_f32 v123, v122, v122
v_sub_f32 v121, v170, v119
v_sub_f32 v122, v171, v119
v_fmac_f32 v120, v121, v121
v_fmac_f32 v123, v122, v122
v_sub_f32 v121, v172, v119
v_sub_f32 v122, v173, v119
v_fmac_f32 v120, v121, v121
v_fmac_f32 v123, v122, v122
v_sub_f32 v121, v174, v119
v_sub_f32 v122, v175, v119
v_fmac_f32 v120, v121, v121
v_fmac_f32 v123, v122, v122
v_sub_f32 v121, v176, v119
v_sub_f32 v122, v177, v119
v_fmac_f32 v120, v121, v121
v_fmac_f32 v123, v122, v122
v_sub_f32 v121, v178, v119
v_sub_f32 v122, v179, v119
v_fmac_f32 v120, v121, v121
v_fmac_f32 v123, v122, v122
v_sub_f32 v121, v180, v119
v_sub_f32 v122, v181, v119
v_fmac_f32 v120, v121, v121
v_fmac_f32 v123, v122, v122
v_sub_f32 v121, v182, v119
v_sub_f32 v122, v183, v119
v_fmac_f32 v120, v121, v121
v_fmac_f32 v123, v122, v122
v_sub_f32 v121, v184, v119
v_sub_f32 v122, v185, v119
v_fmac_f32 v120, v121, v121
v_fmac_f32 v123, v122, v122
v_sub_f32 v121, v186, v119
v_sub_f32 v122, v187, v119
v_fmac_f32 v120, v121, v121
v_fmac_f32 v123, v122, v122
v_sub_f32 v121, v188, v119
v_sub_f32 v122, v189, v119
v_fmac_f32 v120, v121, v121
v_fmac_f32 v123, v122, v122
v_sub_f32 v121, v190, v119
v_sub_f32 v122, v191, v119
v_fmac_f32 v120, v121, v121
v_fmac_f32 v123, v122, v122
v_sub_f32 v121, v192, v119
v_sub_f32 v122, v193, v119
v_fmac_f32 v120, v121, v121
v_fmac_f32 v123, v122, v122
v_sub_f32 v121, v194, v119
v_sub_f32 v122, v195, v119
v_fmac_f32 v120, v121, v121
v_fmac_f32 v123, v122, v122
v_sub_f32 v121, v196, v119
v_sub_f32 v122, v197, v119
v_fmac_f32 v120, v121, v121
v_fmac_f32 v123, v122, v122
v_sub_f32 v121, v198, v119
v_sub_f32 v122, v199, v119
v_fmac_f32 v120, v121, v121
v_fmac_f32 v123, v122, v122
v_sub_f32 v121, v200, v119
v_sub_f32 v122, v201, v119
v_fmac_f32 v120, v121, v121
v_fmac_f32 v123, v122, v122
v_sub_f32 v121, v202, v119
v_sub_f32 v122, v203, v119
v_fmac_f32 v120, v121, v121
v_fmac_f32 v123, v122, v122
v_sub_f32 v121, v204, v119
v_sub_f32 v122, v205, v119
v_fmac_f32 v120, v121, v121
v_fmac_f32 v123, v122, v122
v_sub_f32 v121, v206, v119
v_sub_f32 v122, v207, v119
v_fmac_f32 v120, v121, v121
v_fmac_f32 v123, v122, v122
v_sub_f32 v121, v208, v119
v_sub_f32 v122, v209, v119
v_fmac_f32 v120, v121, v121
v_fmac_f32 v123, v122, v122
v_sub_f32 v121, v210, v119
v_sub_f32 v122, v211, v119
v_fmac_f32 v120, v121, v121
v_fmac_f32 v123, v122, v122
v_sub_f32 v121, v212, v119
v_sub_f32 v122, v213, v119
v_fmac_f32 v120, v121, v121
v_fmac_f32 v123, v122, v122
v_sub_f32 v121, v214, v119
v_sub_f32 v122, v215, v119
v_fmac_f32 v120, v121, v121
v_fmac_f32 v123, v122, v122
v_sub_f32 v121, v216, v119
v_sub_f32 v122, v217, v119
v_fmac_f32 v120, v121, v121
v_fmac_f32 v123, v122, v122
v_sub_f32 v121, v218, v119
v_sub_f32 v122, v219, v119
v_fmac_f32 v120, v121, v121
v_fmac_f32 v123, v122, v122
v_sub_f32 v121, v220, v119
v_sub_f32 v122, v221, v119
v_fmac_f32 v120, v121, v121
v_fmac_f32 v123, v122, v122
v_sub_f32 v121, v222, v119
v_sub_f32 v122, v223, v119
v_fmac_f32 v120, v121, v121
v_fmac_f32 v123, v122, v122
v_add_f32 v120, v120, v123
s_nop 1
v_add_f32_dpp v120, v120, v120 quad_perm:[1,0,3,2] row_mask:0xf bank_mask:0xf
s_nop 1
v_add_f32_dpp v120, v120, v120 quad_perm:[2,3,0,1] row_mask:0xf bank_mask:0xf
s_nop 1
v_add_f32_dpp v120, v120, v120 row_half_mirror row_mask:0xf bank_mask:0xf
v_mul_f32 v120, 0x3b000000, v120
v_cvt_pk_bf16_f32 v120, v120, v120
v_and_b32 v120, 0xffff0000, v120
v_add_f32 v120, 0x3727c5ac, v120
v_cvt_pk_bf16_f32 v120, v120, v120
v_and_b32 v120, 0xffff0000, v120
v_sqrt_f32 v120, v120
s_nop 0
v_cvt_pk_bf16_f32 v120, v120, v120
v_and_b32 v120, 0xffff0000, v120
v_rcp_f32 v120, v120
s_cmp_lg_u32 s20, 0
s_cbranch_scc1 L_lnw_207
s_mov_b32 s90, 0x10000
v_lshlrev_b32 v16, 3, v1
v_mov_b32 v17, 1
v_cmp_gt_u32 vcc, 16, v1
s_nop 1
v_cndmask_b32 v17, 0, v17, vcc
s_mov_b32 s91, 300000
L_pl_208:
buffer_load_dwordx2 v[18:19], v16, s[8:11], s90 offen sc1
s_sub_u32 s91, s91, 1
s_cmp_eq_u32 s91, 0
s_cbranch_scc1 L_abort
s_waitcnt vmcnt(0)
v_cmp_eq_u32 vcc, s46, v19
s_nop 1
v_cndmask_b32 v18, 0, v18, vcc
v_cmp_gt_u32 vcc, v17, v18
s_cbranch_vccnz L_pl_208
L_lnw_207:
s_barrier
v_lshlrev_b32 v16, 4, v1
s_lshl_b32 s90, s20, 10
s_add_u32 m0, s90, 144000
s_add_u32 s90, s90, 0x0
buffer_load_dwordx4 v16, s[8:11], s90 offen sc1 lds
s_waitcnt vmcnt(0)
s_barrier
v_add_u32 v124, 144000, v117
s_mov_b32 s93, 0x400000
ds_read_b128 v[20:23], v124 offset:0
ds_read_b128 v[28:31], v124 offset:2048
ds_read_b128 v[24:27], v124 offset:16
ds_read_b128 v[32:35], v124 offset:2064
v_sub_f32 v160, v160, v118
v_mul_f32 v160, v160, v120
v_sub_f32 v161, v161, v118
v_mul_f32 v161, v161, v120
v_sub_f32 v162, v162, v118
v_mul_f32 v162, v162, v120
v_sub_f32 v163, v163, v118
v_mul_f32 v163, v163, v120
v_sub_f32 v164, v164, v118
v_mul_f32 v164, v164, v120
v_sub_f32 v165, v165, v118
v_mul_f32 v165, v165, v120
v_sub_f32 v166, v166, v118
v_mul_f32 v166, v166, v120
v_sub_f32 v167, v167, v118
v_mul_f32 v167, v167, v120
s_waitcnt lgkmcnt(0)
v_fma_f32 v160, v160, v28, v20
v_fma_f32 v161, v161, v29, v21
v_fma_f32 v162, v162, v30, v22
v_fma_f32 v163, v163, v31, v23
v_fma_f32 v164, v164, v32, v24
v_fma_f32 v165, v165, v33, v25
v_fma_f32 v166, v166, v34, v26
v_fma_f32 v167, v167, v35, v27
v_cvt_pk_bf16_f32 v128, v160, v161
v_cvt_pk_bf16_f32 v129, v162, v163
v_cvt_pk_bf16_f32 v130, v164, v165
v_cvt_pk_bf16_f32 v131, v166, v167
s_add_u32 s94, s93, 0
buffer_store_dwordx4 v[128:131], v116, s[8:11], s94 offen sc1
ds_read_b128 v[36:39], v124 offset:256
ds_read_b128 v[44:47], v124 offset:2304
ds_read_b128 v[40:43], v124 offset:272
ds_read_b128 v[48:51], v124 offset:2320
v_sub_f32 v168, v168, v118
v_mul_f32 v168, v168, v120
v_sub_f32 v169, v169, v118
v_mul_f32 v169, v169, v120
v_sub_f32 v170, v170, v118
v_mul_f32 v170, v170, v120
v_sub_f32 v171, v171, v118
v_mul_f32 v171, v171, v120
v_sub_f32 v172, v172, v118
v_mul_f32 v172, v172, v120
v_sub_f32 v173, v173, v118
v_mul_f32 v173, v173, v120
v_sub_f32 v174, v174, v118
v_mul_f32 v174, v174, v120
v_sub_f32 v175, v175, v118
v_mul_f32 v175, v175, v120
s_waitcnt lgkmcnt(0)
v_fma_f32 v168, v168, v44, v36
v_fma_f32 v169, v169, v45, v37
v_fma_f32 v170, v170, v46, v38
v_fma_f32 v171, v171, v47, v39
v_fma_f32 v172, v172, v48, v40
v_fma_f32 v173, v173, v49, v41
v_fma_f32 v174, v174, v50, v42
v_fma_f32 v175, v175, v51, v43
v_cvt_pk_bf16_f32 v132, v168, v169
v_cvt_pk_bf16_f32 v133, v170, v171
v_cvt_pk_bf16_f32 v134, v172, v173
v_cvt_pk_bf16_f32 v135, v174, v175
s_add_u32 s94, s93, 4096
buffer_store_dwordx4 v[132:135], v116, s[8:11], s94 offen sc1
ds_read_b128 v[20:23], v124 offset:512
ds_read_b128 v[28:31], v124 offset:2560
ds_read_b128 v[24:27], v124 offset:528
ds_read_b128 v[32:35], v124 offset:2576
v_sub_f32 v176, v176, v118
v_mul_f32 v176, v176, v120
v_sub_f32 v177, v177, v118
v_mul_f32 v177, v177, v120
v_sub_f32 v178, v178, v118
v_mul_f32 v178, v178, v120
v_sub_f32 v179, v179, v118
v_mul_f32 v179, v179, v120
v_sub_f32 v180, v180, v118
v_mul_f32 v180, v180, v120
v_sub_f32 v181, v181, v118
v_mul_f32 v181, v181, v120
v_sub_f32 v182, v182, v118
v_mul_f32 v182, v182, v120
v_sub_f32 v183, v183, v118
v_mul_f32 v183, v183, v120
s_waitcnt lgkmcnt(0)
v_fma_f32 v176, v176, v28, v20
v_fma_f32 v177, v177, v29, v21
v_fma_f32 v178, v178, v30, v22
v_fma_f32 v179, v179, v31, v23
v_fma_f32 v180, v180, v32, v24
v_fma_f32 v181, v181, v33, v25
v_fma_f32 v182, v182, v34, v26
v_fma_f32 v183, v183, v35, v27
v_cvt_pk_bf16_f32 v136, v176, v177
v_cvt_pk_bf16_f32 v137, v178, v179
v_cvt_pk_bf16_f32 v138, v180, v181
v_cvt_pk_bf16_f32 v139, v182, v183
s_add_u32 s94, s93, 8192
buffer_store_dwordx4 v[136:139], v116, s[8:11], s94 offen sc1
ds_read_b128 v[36:39], v124 offset:768
ds_read_b128 v[44:47], v124 offset:2816
ds_read_b128 v[40:43], v124 offset:784
ds_read_b128 v[48:51], v124 offset:2832
v_sub_f32 v184, v184, v118
v_mul_f32 v184, v184, v120
v_sub_f32 v185, v185, v118
v_mul_f32 v185, v185, v120
v_sub_f32 v186, v186, v118
v_mul_f32 v186, v186, v120
v_sub_f32 v187, v187, v118
v_mul_f32 v187, v187, v120
v_sub_f32 v188, v188, v118
v_mul_f32 v188, v188, v120
v_sub_f32 v189, v189, v118
v_mul_f32 v189, v189, v120
v_sub_f32 v190, v190, v118
v_mul_f32 v190, v190, v120
v_sub_f32 v191, v191, v118
v_mul_f32 v191, v191, v120
s_waitcnt lgkmcnt(0)
v_fma_f32 v184, v184, v44, v36
v_fma_f32 v185, v185, v45, v37
v_fma_f32 v186, v186, v46, v38
v_fma_f32 v187, v187, v47, v39
v_fma_f32 v188, v188, v48, v40
v_fma_f32 v189, v189, v49, v41
v_fma_f32 v190, v190, v50, v42
v_fma_f32 v191, v191, v51, v43
v_cvt_pk_bf16_f32 v140, v184, v185
v_cvt_pk_bf16_f32 v141, v186, v187
v_cvt_pk_bf16_f32 v142, v188, v189
v_cvt_pk_bf16_f32 v143, v190, v191
s_add_u32 s94, s93, 12288
buffer_store_dwordx4 v[140:143], v116, s[8:11], s94 offen sc1
ds_read_b128 v[20:23], v124 offset:1024
ds_read_b128 v[28:31], v124 offset:3072
ds_read_b128 v[24:27], v124 offset:1040
ds_read_b128 v[32:35], v124 offset:3088
v_sub_f32 v192, v192, v118
v_mul_f32 v192, v192, v120
v_sub_f32 v193, v193, v118
v_mul_f32 v193, v193, v120
v_sub_f32 v194, v194, v118
v_mul_f32 v194, v194, v120
v_sub_f32 v195, v195, v118
v_mul_f32 v195, v195, v120
v_sub_f32 v196, v196, v118
v_mul_f32 v196, v196, v120
v_sub_f32 v197, v197, v118
v_mul_f32 v197, v197, v120
v_sub_f32 v198, v198, v118
v_mul_f32 v198, v198, v120
v_sub_f32 v199, v199, v118
v_mul_f32 v199, v199, v120
s_waitcnt lgkmcnt(0)
v_fma_f32 v192, v192, v28, v20
v_fma_f32 v193, v193, v29, v21
v_fma_f32 v194, v194, v30, v22
v_fma_f32 v195, v195, v31, v23
v_fma_f32 v196, v196, v32, v24
v_fma_f32 v197, v197, v33, v25
v_fma_f32 v198, v198, v34, v26
v_fma_f32 v199, v199, v35, v27
v_cvt_pk_bf16_f32 v144, v192, v193
v_cvt_pk_bf16_f32 v145, v194, v195
v_cvt_pk_bf16_f32 v146, v196, v197
v_cvt_pk_bf16_f32 v147, v198, v199
s_add_u32 s94, s93, 16384
buffer_store_dwordx4 v[144:147], v116, s[8:11], s94 offen sc1
ds_read_b128 v[36:39], v124 offset:1280
ds_read_b128 v[44:47], v124 offset:3328
ds_read_b128 v[40:43], v124 offset:1296
ds_read_b128 v[48:51], v124 offset:3344
v_sub_f32 v200, v200, v118
v_mul_f32 v200, v200, v120
v_sub_f32 v201, v201, v118
v_mul_f32 v201, v201, v120
v_sub_f32 v202, v202, v118
v_mul_f32 v202, v202, v120
v_sub_f32 v203, v203, v118
v_mul_f32 v203, v203, v120
v_sub_f32 v204, v204, v118
v_mul_f32 v204, v204, v120
v_sub_f32 v205, v205, v118
v_mul_f32 v205, v205, v120
v_sub_f32 v206, v206, v118
v_mul_f32 v206, v206, v120
v_sub_f32 v207, v207, v118
v_mul_f32 v207, v207, v120
s_waitcnt lgkmcnt(0)
v_fma_f32 v200, v200, v44, v36
v_fma_f32 v201, v201, v45, v37
v_fma_f32 v202, v202, v46, v38
v_fma_f32 v203, v203, v47, v39
v_fma_f32 v204, v204, v48, v40
v_fma_f32 v205, v205, v49, v41
v_fma_f32 v206, v206, v50, v42
v_fma_f32 v207, v207, v51, v43
v_cvt_pk_bf16_f32 v148, v200, v201
v_cvt_pk_bf16_f32 v149, v202, v203
v_cvt_pk_bf16_f32 v150, v204, v205
v_cvt_pk_bf16_f32 v151, v206, v207
s_add_u32 s94, s93, 20480
buffer_store_dwordx4 v[148:151], v116, s[8:11], s94 offen sc1
ds_read_b128 v[20:23], v124 offset:1536
ds_read_b128 v[28:31], v124 offset:3584
ds_read_b128 v[24:27], v124 offset:1552
ds_read_b128 v[32:35], v124 offset:3600
v_sub_f32 v208, v208, v118
v_mul_f32 v208, v208, v120
v_sub_f32 v209, v209, v118
v_mul_f32 v209, v209, v120
v_sub_f32 v210, v210, v118
v_mul_f32 v210, v210, v120
v_sub_f32 v211, v211, v118
v_mul_f32 v211, v211, v120
v_sub_f32 v212, v212, v118
v_mul_f32 v212, v212, v120
v_sub_f32 v213, v213, v118
v_mul_f32 v213, v213, v120
v_sub_f32 v214, v214, v118
v_mul_f32 v214, v214, v120
v_sub_f32 v215, v215, v118
v_mul_f32 v215, v215, v120
s_waitcnt lgkmcnt(0)
v_fma_f32 v208, v208, v28, v20
v_fma_f32 v209, v209, v29, v21
v_fma_f32 v210, v210, v30, v22
v_fma_f32 v211, v211, v31, v23
v_fma_f32 v212, v212, v32, v24
v_fma_f32 v213, v213, v33, v25
v_fma_f32 v214, v214, v34, v26
v_fma_f32 v215, v215, v35, v27
v_cvt_pk_bf16_f32 v152, v208, v209
v_cvt_pk_bf16_f32 v153, v210, v211
v_cvt_pk_bf16_f32 v154, v212, v213
v_cvt_pk_bf16_f32 v155, v214, v215
s_add_u32 s94, s93, 24576
buffer_store_dwordx4 v[152:155], v116, s[8:11], s94 offen sc1
ds_read_b128 v[36:39], v124 offset:1792
ds_read_b128 v[44:47], v124 offset:3840
ds_read_b128 v[40:43], v124 offset:1808
ds_read_b128 v[48:51], v124 offset:3856
v_sub_f32 v216, v216, v118
v_mul_f32 v216, v216, v120
v_sub_f32 v217, v217, v118
v_mul_f32 v217, v217, v120
v_sub_f32 v218, v218, v118
v_mul_f32 v218, v218, v120
v_sub_f32 v219, v219, v118
v_mul_f32 v219, v219, v120
v_sub_f32 v220, v220, v118
v_mul_f32 v220, v220, v120
v_sub_f32 v221, v221, v118
v_mul_f32 v221, v221, v120
v_sub_f32 v222, v222, v118
v_mul_f32 v222, v222, v120
v_sub_f32 v223, v223, v118
v_mul_f32 v223, v223, v120
s_waitcnt lgkmcnt(0)
v_fma_f32 v216, v216, v44, v36
v_fma_f32 v217, v217, v45, v37
v_fma_f32 v218, v218, v46, v38
v_fma_f32 v219, v219, v47, v39
v_fma_f32 v220, v220, v48, v40
v_fma_f32 v221, v221, v49, v41
v_fma_f32 v222, v222, v50, v42
v_fma_f32 v223, v223, v51, v43
v_cvt_pk_bf16_f32 v156, v216, v217
v_cvt_pk_bf16_f32 v157, v218, v219
v_cvt_pk_bf16_f32 v158, v220, v221
v_cvt_pk_bf16_f32 v159, v222, v223
s_add_u32 s94, s93, 28672
buffer_store_dwordx4 v[156:159], v116, s[8:11], s94 offen sc1
s_waitcnt vmcnt(0)
s_barrier
s_lshl_b32 s90, s38, 3
s_add_u32 s90, s90, 0x10200
s_cmp_lg_u32 s20, 0
s_cbranch_scc1 L_sf_209
v_mov_b32 v16, 1
v_mov_b32 v17, s46
v_mov_b32 v18, 0
s_mov_b64 exec, 1
buffer_store_dwordx2 v[16:17], v18, s[8:11], s90 offen sc1
s_mov_b64 exec, -1
L_sf_209:
v_lshrrev_b32 v112, 3, v1
v_and_b32 v113, 7, v1
s_lshl_b32 s90, s20, 3
s_add_u32 s90, s90, s39
v_add_u32 v114, s90, v112
v_lshlrev_b32 v115, 10, v114
v_lshl_add_u32 v115, v113, 4, v115
buffer_load_dwordx4 v[128:131], v115, s[4:7], 0 offen offset:0
buffer_load_dwordx4 v[132:135], v115, s[4:7], 0 offen offset:128
buffer_load_dwordx4 v[136:139], v115, s[4:7], 0 offen offset:256
buffer_load_dwordx4 v[140:143], v115, s[4:7], 0 offen offset:384
buffer_load_dwordx4 v[144:147], v115, s[4:7], 0 offen offset:512
buffer_load_dwordx4 v[148:151], v115, s[4:7], 0 offen offset:640
buffer_load_dwordx4 v[152:155], v115, s[4:7], 0 offen offset:768
buffer_load_dwordx4 v[156:159], v115, s[4:7], 0 offen offset:896
v_lshrrev_b32 v116, 5, v114
v_lshlrev_b32 v116, 15, v116
v_and_b32 v117, 31, v114
v_lshl_add_u32 v116, v117, 4, v116
v_lshrrev_b32 v117, 1, v113
v_lshl_add_u32 v116, v117, 10, v116
v_and_b32 v117, 1, v113
v_lshl_add_u32 v116, v117, 9, v116
v_lshlrev_b32 v117, 5, v113
s_waitcnt vmcnt(0)
v_lshlrev_b32 v160, 16, v128
v_and_b32 v161, 0xffff0000, v128
v_lshlrev_b32 v162, 16, v129
v_and_b32 v163, 0xffff0000, v129
v_lshlrev_b32 v164, 16, v130
v_and_b32 v165, 0xffff0000, v130
v_lshlrev_b32 v166, 16, v131
v_and_b32 v167, 0xffff0000, v131
v_lshlrev_b32 v168, 16, v132
v_and_b32 v169, 0xffff0000, v132
v_lshlrev_b32 v170, 16, v133
v_and_b32 v171, 0xffff0000, v133
v_lshlrev_b32 v172, 16, v134
v_and_b32 v173, 0xffff0000, v134
v_lshlrev_b32 v174, 16, v135
v_and_b32 v175, 0xffff0000, v135
v_lshlrev_b32 v176, 16, v136
v_and_b32 v177, 0xffff0000, v136
v_lshlrev_b32 v178, 16, v137
v_and_b32 v179, 0xffff0000, v137
v_lshlrev_b32 v180, 16, v138
v_and_b32 v181, 0xffff0000, v138
v_lshlrev_b32 v182, 16, v139
v_and_b32 v183, 0xffff0000, v139
v_lshlrev_b32 v184, 16, v140
v_and_b32 v185, 0xffff0000, v140
v_lshlrev_b32 v186, 16, v141
v_and_b32 v187, 0xffff0000, v141
v_lshlrev_b32 v188, 16, v142
v_and_b32 v189, 0xffff0000, v142
v_lshlrev_b32 v190, 16, v143
v_and_b32 v191, 0xffff0000, v143
v_lshlrev_b32 v192, 16, v144
v_and_b32 v193, 0xffff0000, v144
v_lshlrev_b32 v194, 16, v145
v_and_b32 v195, 0xffff0000, v145
v_lshlrev_b32 v196, 16, v146
v_and_b32 v197, 0xffff0000, v146
v_lshlrev_b32 v198, 16, v147
v_and_b32 v199, 0xffff0000, v147
v_lshlrev_b32 v200, 16, v148
v_and_b32 v201, 0xffff0000, v148
v_lshlrev_b32 v202, 16, v149
v_and_b32 v203, 0xffff0000, v149
v_lshlrev_b32 v204, 16, v150
v_and_b32 v205, 0xffff0000, v150
v_lshlrev_b32 v206, 16, v151
v_and_b32 v207, 0xffff0000, v151
v_lshlrev_b32 v208, 16, v152
v_and_b32 v209, 0xffff0000, v152
v_lshlrev_b32 v210, 16, v153
v_and_b32 v211, 0xffff0000, v153
v_lshlrev_b32 v212, 16, v154
v_and_b32 v213, 0xffff0000, v154
v_lshlrev_b32 v214, 16, v155
v_and_b32 v215, 0xffff0000, v155
v_lshlrev_b32 v216, 16, v156
v_and_b32 v217, 0xffff0000, v156
v_lshlrev_b32 v218, 16, v157
v_and_b32 v219, 0xffff0000, v157
v_lshlrev_b32 v220, 16, v158
v_and_b32 v221, 0xffff0000, v158
v_lshlrev_b32 v222, 16, v159
v_and_b32 v223, 0xffff0000, v159
v_add_f32 v119, v160, v161
v_add_f32 v118, v162, v163
v_add_f32 v119, v119, v164
v_add_f32 v118, v118, v165
v_add_f32 v119, v119, v166
v_add_f32 v118, v118, v167
v_add_f32 v119, v119, v168
v_add_f32 v118, v118, v169
v_add_f32 v119, v119, v170
v_add_f32 v118, v118, v171
v_add_f32 v119, v119, v172
v_add_f32 v118, v118, v173
v_add_f32 v119, v119, v174
v_add_f32 v118, v118, v175
v_add_f32 v119, v119, v176
v_add_f32 v118, v118, v177
v_add_f32 v119, v119, v178
v_add_f32 v118, v118, v179
v_add_f32 v119, v119, v180
v_add_f32 v118, v118, v181
v_add_f32 v119, v119, v182
v_add_f32 v118, v118, v183
v_add_f32 v119, v119, v184
v_add_f32 v118, v118, v185
v_add_f32 v119, v119, v186
v_add_f32 v118, v118, v187
v_add_f32 v119, v119, v188
v_add_f32 v118, v118, v189
v_add_f32 v119, v119, v190
v_add_f32 v118, v118, v191
v_add_f32 v119, v119, v192
v_add_f32 v118, v118, v193
v_add_f32 v119, v119, v194
v_add_f32 v118, v118, v195
v_add_f32 v119, v119, v196
v_add_f32 v118, v118, v197
v_add_f32 v119, v119, v198
v_add_f32 v118, v118, v199
v_add_f32 v119, v119, v200
v_add_f32 v118, v118, v201
v_add_f32 v119, v119, v202
v_add_f32 v118, v118, v203
v_add_f32 v119, v119, v204
v_add_f32 v118, v118, v205
v_add_f32 v119, v119, v206
v_add_f32 v118, v118, v207
v_add_f32 v119, v119, v208
v_add_f32 v118, v118, v209
v_add_f32 v119, v119, v210
v_add_f32 v118, v118, v211
v_add_f32 v119, v119, v212
v_add_f32 v118, v118, v213
v_add_f32 v119, v119, v214
v_add_f32 v118, v118, v215
v_add_f32 v119, v119, v216
v_add_f32 v118, v118, v217
v_add_f32 v119, v119, v218
v_add_f32 v118, v118, v219
v_add_f32 v119, v119, v220
v_add_f32 v118, v118, v221
v_add_f32 v119, v119, v222
v_add_f32 v118, v118, v223
v_add_f32 v119, v119, v118
s_nop 1
v_add_f32_dpp v119, v119, v119 quad_perm:[1,0,3,2] row_mask:0xf bank_mask:0xf
s_nop 1
v_add_f32_dpp v119, v119, v119 quad_perm:[2,3,0,1] row_mask:0xf bank_mask:0xf
s_nop 1
v_add_f32_dpp v119, v119, v119 row_half_mirror row_mask:0xf bank_mask:0xf
v_mul_f32 v119, 0x3b000000, v119
v_cvt_pk_bf16_f32 v118, v119, v119
v_and_b32 v118, 0xffff0000, v118
v_sub_f32 v121, v160, v119
v_mul_f32 v120, v121, v121
v_sub_f32 v122, v161, v119
v_mul_f32 v123, v122, v122
v_sub_f32 v121, v162, v119
v_sub_f32 v122, v163, v119
v_fmac_f32 v120, v121, v121
v_fmac_f32 v123, v122, v122
v_sub_f32 v121, v164, v119
v_sub_f32 v122, v165, v119
v_fmac_f32 v120, v121, v121
v_fmac_f32 v123, v122, v122
v_sub_f32 v121, v166, v119
v_sub_f32 v122, v167, v119
v_fmac_f32 v120, v121, v121
v_fmac_f32 v123, v122, v122
v_sub_f32 v121, v168, v119
v_sub_f32 v122, v169, v119
v_fmac_f32 v120, v121, v121
v_fmac_f32 v123, v122, v122
v_sub_f32 v121, v170, v119
v_sub_f32 v122, v171, v119
v_fmac_f32 v120, v121, v121
v_fmac_f32 v123, v122, v122
v_sub_f32 v121, v172, v119
v_sub_f32 v122, v173, v119
v_fmac_f32 v120, v121, v121
v_fmac_f32 v123, v122, v122
v_sub_f32 v121, v174, v119
v_sub_f32 v122, v175, v119
v_fmac_f32 v120, v121, v121
v_fmac_f32 v123, v122, v122
v_sub_f32 v121, v176, v119
v_sub_f32 v122, v177, v119
v_fmac_f32 v120, v121, v121
v_fmac_f32 v123, v122, v122
v_sub_f32 v121, v178, v119
v_sub_f32 v122, v179, v119
v_fmac_f32 v120, v121, v121
v_fmac_f32 v123, v122, v122
v_sub_f32 v121, v180, v119
v_sub_f32 v122, v181, v119
v_fmac_f32 v120, v121, v121
v_fmac_f32 v123, v122, v122
v_sub_f32 v121, v182, v119
v_sub_f32 v122, v183, v119
v_fmac_f32 v120, v121, v121
v_fmac_f32 v123, v122, v122
v_sub_f32 v121, v184, v119
v_sub_f32 v122, v185, v119
v_fmac_f32 v120, v121, v121
v_fmac_f32 v123, v122, v122
v_sub_f32 v121, v186, v119
v_sub_f32 v122, v187, v119
v_fmac_f32 v120, v121, v121
v_fmac_f32 v123, v122, v122
v_sub_f32 v121, v188, v119
v_sub_f32 v122, v189, v119
v_fmac_f32 v120, v121, v121
v_fmac_f32 v123, v122, v122
v_sub_f32 v121, v190, v119
v_sub_f32 v122, v191, v119
v_fmac_f32 v120, v121, v121
v_fmac_f32 v123, v122, v122
v_sub_f32 v121, v192, v119
v_sub_f32 v122, v193, v119
v_fmac_f32 v120, v121, v121
v_fmac_f32 v123, v122, v122
v_sub_f32 v121, v194, v119
v_sub_f32 v122, v195, v119
v_fmac_f32 v120, v121, v121
v_fmac_f32 v123, v122, v122
v_sub_f32 v121, v196, v119
v_sub_f32 v122, v197, v119
v_fmac_f32 v120, v121, v121
v_fmac_f32 v123, v122, v122
v_sub_f32 v121, v198, v119
v_sub_f32 v122, v199, v119
v_fmac_f32 v120, v121, v121
v_fmac_f32 v123, v122, v122
v_sub_f32 v121, v200, v119
v_sub_f32 v122, v201, v119
v_fmac_f32 v120, v121, v121
v_fmac_f32 v123, v122, v122
v_sub_f32 v121, v202, v119
v_sub_f32 v122, v203, v119
v_fmac_f32 v120, v121, v121
v_fmac_f32 v123, v122, v122
v_sub_f32 v121, v204, v119
v_sub_f32 v122, v205, v119
v_fmac_f32 v120, v121, v121
v_fmac_f32 v123, v122, v122
v_sub_f32 v121, v206, v119
v_sub_f32 v122, v207, v119
v_fmac_f32 v120, v121, v121
v_fmac_f32 v123, v122, v122
v_sub_f32 v121, v208, v119
v_sub_f32 v122, v209, v119
v_fmac_f32 v120, v121, v121
v_fmac_f32 v123, v122, v122
v_sub_f32 v121, v210, v119
v_sub_f32 v122, v211, v119
v_fmac_f32 v120, v121, v121
v_fmac_f32 v123, v122, v122
v_sub_f32 v121, v212, v119
v_sub_f32 v122, v213, v119
v_fmac_f32 v120, v121, v121
v_fmac_f32 v123, v122, v122
v_sub_f32 v121, v214, v119
v_sub_f32 v122, v215, v119
v_fmac_f32 v120, v121, v121
v_fmac_f32 v123, v122, v122
v_sub_f32 v121, v216, v119
v_sub_f32 v122, v217, v119
v_fmac_f32 v120, v121, v121
v_fmac_f32 v123, v122, v122
v_sub_f32 v121, v218, v119
v_sub_f32 v122, v219, v119
v_fmac_f32 v120, v121, v121
v_fmac_f32 v123, v122, v122
v_sub_f32 v121, v220, v119
v_sub_f32 v122, v221, v119
v_fmac_f32 v120, v121, v121
v_fmac_f32 v123, v122, v122
v_sub_f32 v121, v222, v119
v_sub_f32 v122, v223, v119
v_fmac_f32 v120, v121, v121
v_fmac_f32 v123, v122, v122
v_add_f32 v120, v120, v123
s_nop 1
v_add_f32_dpp v120, v120, v120 quad_perm:[1,0,3,2] row_mask:0xf bank_mask:0xf
s_nop 1
v_add_f32_dpp v120, v120, v120 quad_perm:[2,3,0,1] row_mask:0xf bank_mask:0xf
s_nop 1
v_add_f32_dpp v120, v120, v120 row_half_mirror row_mask:0xf bank_mask:0xf
v_mul_f32 v120, 0x3b000000, v120
v_cvt_pk_bf16_f32 v120, v120, v120
v_and_b32 v120, 0xffff0000, v120
v_add_f32 v120, 0x3727c5ac, v120
v_cvt_pk_bf16_f32 v120, v120, v120
v_and_b32 v120, 0xffff0000, v120
v_sqrt_f32 v120, v120
s_nop 0
v_cvt_pk_bf16_f32 v120, v120, v120
v_and_b32 v120, 0xffff0000, v120
v_rcp_f32 v120, v120
v_add_u32 v124, 144000, v117
s_mov_b32 s93, 0x400000
ds_read_b128 v[20:23], v124 offset:0
ds_read_b128 v[28:31], v124 offset:2048
ds_read_b128 v[24:27], v124 offset:16
ds_read_b128 v[32:35], v124 offset:2064
v_sub_f32 v160, v160, v118
v_mul_f32 v160, v160, v120
v_sub_f32 v161, v161, v118
v_mul_f32 v161, v161, v120
v_sub_f32 v162, v162, v118
v_mul_f32 v162, v162, v120
v_sub_f32 v163, v163, v118
v_mul_f32 v163, v163, v120
v_sub_f32 v164, v164, v118
v_mul_f32 v164, v164, v120
v_sub_f32 v165, v165, v118
v_mul_f32 v165, v165, v120
v_sub_f32 v166, v166, v118
v_mul_f32 v166, v166, v120
v_sub_f32 v167, v167, v118
v_mul_f32 v167, v167, v120
s_waitcnt lgkmcnt(0)
v_fma_f32 v160, v160, v28, v20
v_fma_f32 v161, v161, v29, v21
v_fma_f32 v162, v162, v30, v22
v_fma_f32 v163, v163, v31, v23
v_fma_f32 v164, v164, v32, v24
v_fma_f32 v165, v165, v33, v25
v_fma_f32 v166, v166, v34, v26
v_fma_f32 v167, v167, v35, v27
v_cvt_pk_bf16_f32 v128, v160, v161
v_cvt_pk_bf16_f32 v129, v162, v163
v_cvt_pk_bf16_f32 v130, v164, v165
v_cvt_pk_bf16_f32 v131, v166, v167
s_add_u32 s94, s93, 0
buffer_store_dwordx4 v[128:131], v116, s[8:11], s94 offen sc1
ds_read_b128 v[36:39], v124 offset:256
ds_read_b128 v[44:47], v124 offset:2304
ds_read_b128 v[40:43], v124 offset:272
ds_read_b128 v[48:51], v124 offset:2320
v_sub_f32 v168, v168, v118
v_mul_f32 v168, v168, v120
v_sub_f32 v169, v169, v118
v_mul_f32 v169, v169, v120
v_sub_f32 v170, v170, v118
v_mul_f32 v170, v170, v120
v_sub_f32 v171, v171, v118
v_mul_f32 v171, v171, v120
v_sub_f32 v172, v172, v118
v_mul_f32 v172, v172, v120
v_sub_f32 v173, v173, v118
v_mul_f32 v173, v173, v120
v_sub_f32 v174, v174, v118
v_mul_f32 v174, v174, v120
v_sub_f32 v175, v175, v118
v_mul_f32 v175, v175, v120
s_waitcnt lgkmcnt(0)
v_fma_f32 v168, v168, v44, v36
v_fma_f32 v169, v169, v45, v37
v_fma_f32 v170, v170, v46, v38
v_fma_f32 v171, v171, v47, v39
v_fma_f32 v172, v172, v48, v40
v_fma_f32 v173, v173, v49, v41
v_fma_f32 v174, v174, v50, v42
v_fma_f32 v175, v175, v51, v43
v_cvt_pk_bf16_f32 v132, v168, v169
v_cvt_pk_bf16_f32 v133, v170, v171
v_cvt_pk_bf16_f32 v134, v172, v173
v_cvt_pk_bf16_f32 v135, v174, v175
s_add_u32 s94, s93, 4096
buffer_store_dwordx4 v[132:135], v116, s[8:11], s94 offen sc1
ds_read_b128 v[20:23], v124 offset:512
ds_read_b128 v[28:31], v124 offset:2560
ds_read_b128 v[24:27], v124 offset:528
ds_read_b128 v[32:35], v124 offset:2576
v_sub_f32 v176, v176, v118
v_mul_f32 v176, v176, v120
v_sub_f32 v177, v177, v118
v_mul_f32 v177, v177, v120
v_sub_f32 v178, v178, v118
v_mul_f32 v178, v178, v120
v_sub_f32 v179, v179, v118
v_mul_f32 v179, v179, v120
v_sub_f32 v180, v180, v118
v_mul_f32 v180, v180, v120
v_sub_f32 v181, v181, v118
v_mul_f32 v181, v181, v120
v_sub_f32 v182, v182, v118
v_mul_f32 v182, v182, v120
v_sub_f32 v183, v183, v118
v_mul_f32 v183, v183, v120
s_waitcnt lgkmcnt(0)
v_fma_f32 v176, v176, v28, v20
v_fma_f32 v177, v177, v29, v21
v_fma_f32 v178, v178, v30, v22
v_fma_f32 v179, v179, v31, v23
v_fma_f32 v180, v180, v32, v24
v_fma_f32 v181, v181, v33, v25
v_fma_f32 v182, v182, v34, v26
v_fma_f32 v183, v183, v35, v27
v_cvt_pk_bf16_f32 v136, v176, v177
v_cvt_pk_bf16_f32 v137, v178, v179
v_cvt_pk_bf16_f32 v138, v180, v181
v_cvt_pk_bf16_f32 v139, v182, v183
s_add_u32 s94, s93, 8192
buffer_store_dwordx4 v[136:139], v116, s[8:11], s94 offen sc1
ds_read_b128 v[36:39], v124 offset:768
ds_read_b128 v[44:47], v124 offset:2816
ds_read_b128 v[40:43], v124 offset:784
ds_read_b128 v[48:51], v124 offset:2832
v_sub_f32 v184, v184, v118
v_mul_f32 v184, v184, v120
v_sub_f32 v185, v185, v118
v_mul_f32 v185, v185, v120
v_sub_f32 v186, v186, v118
v_mul_f32 v186, v186, v120
v_sub_f32 v187, v187, v118
v_mul_f32 v187, v187, v120
v_sub_f32 v188, v188, v118
v_mul_f32 v188, v188, v120
v_sub_f32 v189, v189, v118
v_mul_f32 v189, v189, v120
v_sub_f32 v190, v190, v118
v_mul_f32 v190, v190, v120
v_sub_f32 v191, v191, v118
v_mul_f32 v191, v191, v120
s_waitcnt lgkmcnt(0)
v_fma_f32 v184, v184, v44, v36
v_fma_f32 v185, v185, v45, v37
v_fma_f32 v186, v186, v46, v38
v_fma_f32 v187, v187, v47, v39
v_fma_f32 v188, v188, v48, v40
v_fma_f32 v189, v189, v49, v41
v_fma_f32 v190, v190, v50, v42
v_fma_f32 v191, v191, v51, v43
v_cvt_pk_bf16_f32 v140, v184, v185
v_cvt_pk_bf16_f32 v141, v186, v187
v_cvt_pk_bf16_f32 v142, v188, v189
v_cvt_pk_bf16_f32 v143, v190, v191
s_add_u32 s94, s93, 12288
buffer_store_dwordx4 v[140:143], v116, s[8:11], s94 offen sc1
ds_read_b128 v[20:23], v124 offset:1024
ds_read_b128 v[28:31], v124 offset:3072
ds_read_b128 v[24:27], v124 offset:1040
ds_read_b128 v[32:35], v124 offset:3088
v_sub_f32 v192, v192, v118
v_mul_f32 v192, v192, v120
v_sub_f32 v193, v193, v118
v_mul_f32 v193, v193, v120
v_sub_f32 v194, v194, v118
v_mul_f32 v194, v194, v120
v_sub_f32 v195, v195, v118
v_mul_f32 v195, v195, v120
v_sub_f32 v196, v196, v118
v_mul_f32 v196, v196, v120
v_sub_f32 v197, v197, v118
v_mul_f32 v197, v197, v120
v_sub_f32 v198, v198, v118
v_mul_f32 v198, v198, v120
v_sub_f32 v199, v199, v118
v_mul_f32 v199, v199, v120
s_waitcnt lgkmcnt(0)
v_fma_f32 v192, v192, v28, v20
v_fma_f32 v193, v193, v29, v21
v_fma_f32 v194, v194, v30, v22
v_fma_f32 v195, v195, v31, v23
v_fma_f32 v196, v196, v32, v24
v_fma_f32 v197, v197, v33, v25
v_fma_f32 v198, v198, v34, v26
v_fma_f32 v199, v199, v35, v27
v_cvt_pk_bf16_f32 v144, v192, v193
v_cvt_pk_bf16_f32 v145, v194, v195
v_cvt_pk_bf16_f32 v146, v196, v197
v_cvt_pk_bf16_f32 v147, v198, v199
s_add_u32 s94, s93, 16384
buffer_store_dwordx4 v[144:147], v116, s[8:11], s94 offen sc1
ds_read_b128 v[36:39], v124 offset:1280
ds_read_b128 v[44:47], v124 offset:3328
ds_read_b128 v[40:43], v124 offset:1296
ds_read_b128 v[48:51], v124 offset:3344
v_sub_f32 v200, v200, v118
v_mul_f32 v200, v200, v120
v_sub_f32 v201, v201, v118
v_mul_f32 v201, v201, v120
v_sub_f32 v202, v202, v118
v_mul_f32 v202, v202, v120
v_sub_f32 v203, v203, v118
v_mul_f32 v203, v203, v120
v_sub_f32 v204, v204, v118
v_mul_f32 v204, v204, v120
v_sub_f32 v205, v205, v118
v_mul_f32 v205, v205, v120
v_sub_f32 v206, v206, v118
v_mul_f32 v206, v206, v120
v_sub_f32 v207, v207, v118
v_mul_f32 v207, v207, v120
s_waitcnt lgkmcnt(0)
v_fma_f32 v200, v200, v44, v36
v_fma_f32 v201, v201, v45, v37
v_fma_f32 v202, v202, v46, v38
v_fma_f32 v203, v203, v47, v39
v_fma_f32 v204, v204, v48, v40
v_fma_f32 v205, v205, v49, v41
v_fma_f32 v206, v206, v50, v42
v_fma_f32 v207, v207, v51, v43
v_cvt_pk_bf16_f32 v148, v200, v201
v_cvt_pk_bf16_f32 v149, v202, v203
v_cvt_pk_bf16_f32 v150, v204, v205
v_cvt_pk_bf16_f32 v151, v206, v207
s_add_u32 s94, s93, 20480
buffer_store_dwordx4 v[148:151], v116, s[8:11], s94 offen sc1
ds_read_b128 v[20:23], v124 offset:1536
ds_read_b128 v[28:31], v124 offset:3584
ds_read_b128 v[24:27], v124 offset:1552
ds_read_b128 v[32:35], v124 offset:3600
v_sub_f32 v208, v208, v118
v_mul_f32 v208, v208, v120
v_sub_f32 v209, v209, v118
v_mul_f32 v209, v209, v120
v_sub_f32 v210, v210, v118
v_mul_f32 v210, v210, v120
v_sub_f32 v211, v211, v118
v_mul_f32 v211, v211, v120
v_sub_f32 v212, v212, v118
v_mul_f32 v212, v212, v120
v_sub_f32 v213, v213, v118
v_mul_f32 v213, v213, v120
v_sub_f32 v214, v214, v118
v_mul_f32 v214, v214, v120
v_sub_f32 v215, v215, v118
v_mul_f32 v215, v215, v120
s_waitcnt lgkmcnt(0)
v_fma_f32 v208, v208, v28, v20
v_fma_f32 v209, v209, v29, v21
v_fma_f32 v210, v210, v30, v22
v_fma_f32 v211, v211, v31, v23
v_fma_f32 v212, v212, v32, v24
v_fma_f32 v213, v213, v33, v25
v_fma_f32 v214, v214, v34, v26
v_fma_f32 v215, v215, v35, v27
v_cvt_pk_bf16_f32 v152, v208, v209
v_cvt_pk_bf16_f32 v153, v210, v211
v_cvt_pk_bf16_f32 v154, v212, v213
v_cvt_pk_bf16_f32 v155, v214, v215
s_add_u32 s94, s93, 24576
buffer_store_dwordx4 v[152:155], v116, s[8:11], s94 offen sc1
ds_read_b128 v[36:39], v124 offset:1792
ds_read_b128 v[44:47], v124 offset:3840
ds_read_b128 v[40:43], v124 offset:1808
ds_read_b128 v[48:51], v124 offset:3856
v_sub_f32 v216, v216, v118
v_mul_f32 v216, v216, v120
v_sub_f32 v217, v217, v118
v_mul_f32 v217, v217, v120
v_sub_f32 v218, v218, v118
v_mul_f32 v218, v218, v120
v_sub_f32 v219, v219, v118
v_mul_f32 v219, v219, v120
v_sub_f32 v220, v220, v118
v_mul_f32 v220, v220, v120
v_sub_f32 v221, v221, v118
v_mul_f32 v221, v221, v120
v_sub_f32 v222, v222, v118
v_mul_f32 v222, v222, v120
v_sub_f32 v223, v223, v118
v_mul_f32 v223, v223, v120
s_waitcnt lgkmcnt(0)
v_fma_f32 v216, v216, v44, v36
v_fma_f32 v217, v217, v45, v37
v_fma_f32 v218, v218, v46, v38
v_fma_f32 v219, v219, v47, v39
v_fma_f32 v220, v220, v48, v40
v_fma_f32 v221, v221, v49, v41
v_fma_f32 v222, v222, v50, v42
v_fma_f32 v223, v223, v51, v43
v_cvt_pk_bf16_f32 v156, v216, v217
v_cvt_pk_bf16_f32 v157, v218, v219
v_cvt_pk_bf16_f32 v158, v220, v221
v_cvt_pk_bf16_f32 v159, v222, v223
s_add_u32 s94, s93, 28672
buffer_store_dwordx4 v[156:159], v116, s[8:11], s94 offen sc1
s_waitcnt vmcnt(0)
s_barrier
s_lshl_b32 s90, s38, 3
s_add_u32 s90, s90, 0x10300
s_cmp_lg_u32 s20, 0
s_cbranch_scc1 L_sf_210
v_mov_b32 v16, 1
v_mov_b32 v17, s46
v_mov_b32 v18, 0
s_mov_b64 exec, 1
buffer_store_dwordx2 v[16:17], v18, s[8:11], s90 offen sc1
s_mov_b64 exec, -1
L_sf_210:
s_cmp_ge_u32 s38, 16
s_cbranch_scc1 L_tail
s_add_u32 s38, s38, 32
s_mov_b32 s12, s26
s_mov_b32 s13, s27
s_mov_b32 s14, 0x300000
s_mov_b32 s15, 0x00020000
s_mov_b32 s40, s24
s_mov_b32 s41, s25
s_mov_b32 s42, 0x400
s_mov_b32 s43, 0x00020000
v_lshrrev_b32 v16, 3, v1
v_and_b32 v17, 7, v1
s_lshl_b32 s90, s20, 7
v_add_u32 v16, s90, v16
v_mul_u32_u24 v18, 6144, v16
v_lshl_add_u32 v18, v17, 4, v18
s_lshl_b32 s91, s38, 7
v_lshlrev_b32 v19, 1, v16
s_add_u32 s92, s91, 0
buffer_load_dwordx4 v[32:35], v18, s[12:15], s92 offen
s_add_u32 s92, s91, 49152
buffer_load_dwordx4 v[36:39], v18, s[12:15], s92 offen
s_add_u32 s92, s91, 98304
buffer_load_dwordx4 v[40:43], v18, s[12:15], s92 offen
s_add_u32 s92, s91, 147456
buffer_load_dwordx4 v[44:47], v18, s[12:15], s92 offen
s_add_u32 s92, s91, 196608
buffer_load_dwordx4 v[48:51], v18, s[12:15], s92 offen
s_add_u32 s92, s91, 245760
buffer_load_dwordx4 v[52:55], v18, s[12:15], s92 offen
s_add_u32 s92, s91, 294912
buffer_load_dwordx4 v[56:59], v18, s[12:15], s92 offen
s_add_u32 s92, s91, 344064
buffer_load_dwordx4 v[60:63], v18, s[12:15], s92 offen
s_add_u32 s92, s91, 393216
buffer_load_dwordx4 v[64:67], v18, s[12:15], s92 offen
s_add_u32 s92, s91, 442368
buffer_load_dwordx4 v[68:71], v18, s[12:15], s92 offen
s_add_u32 s92, s91, 491520
buffer_load_dwordx4 v[72:75], v18, s[12:15], s92 offen
s_add_u32 s92, s91, 540672
buffer_load_dwordx4 v[76:79], v18, s[12:15], s92 offen
s_add_u32 s92, s91, 589824
buffer_load_dwordx4 v[80:83], v18, s[12:15], s92 offen
s_add_u32 s92, s91, 638976
buffer_load_dwordx4 v[84:87], v18, s[12:15], s92 offen
s_add_u32 s92, s91, 688128
buffer_load_dwordx4 v[88:91], v18, s[12:15], s92 offen
s_add_u32 s92, s91, 737280
buffer_load_dwordx4 v[92:95], v18, s[12:15], s92 offen
buffer_load_ushort v96, v19, s[40:43], 0 offen offset:0
buffer_load_ushort v97, v19, s[40:43], 0 offen offset:16
buffer_load_ushort v98, v19, s[40:43], 0 offen offset:32
buffer_load_ushort v99, v19, s[40:43], 0 offen offset:48
buffer_load_ushort v100, v19, s[40:43], 0 offen offset:64
buffer_load_ushort v101, v19, s[40:43], 0 offen offset:80
buffer_load_ushort v102, v19, s[40:43], 0 offen offset:96
buffer_load_ushort v103, v19, s[40:43], 0 offen offset:112
buffer_load_ushort v104, v19, s[40:43], 0 offen offset:128
buffer_load_ushort v105, v19, s[40:43], 0 offen offset:144
buffer_load_ushort v106, v19, s[40:43], 0 offen offset:160
buffer_load_ushort v107, v19, s[40:43], 0 offen offset:176
buffer_load_ushort v108, v19, s[40:43], 0 offen offset:192
buffer_load_ushort v109, v19, s[40:43], 0 offen offset:208
buffer_load_ushort v110, v19, s[40:43], 0 offen offset:224
buffer_load_ushort v111, v19, s[40:43], 0 offen offset:240
v_mov_b32 v24, 0
v_mov_b32 v25, 0
v_mov_b32 v26, 0
v_mov_b32 v27, 0
v_mov_b32 v28, 0
v_mov_b32 v29, 0
v_mov_b32 v30, 0
v_mov_b32 v31, 0
s_waitcnt vmcnt(0)
v_lshlrev_b32 v96, 16, v96
v_mul_f32 v20, 0xbfb8aa3b, v96
v_exp_f32 v20, v20
s_nop 0
v_add_f32 v20, 1.0, v20
v_rcp_f32 v20, v20
s_nop 0
v_mul_f32 v96, v96, v20
v_cvt_pk_bf16_f32 v96, v96, v96
v_and_b32 v96, 0xffff0000, v96
v_lshlrev_b32 v97, 16, v97
v_mul_f32 v20, 0xbfb8aa3b, v97
v_exp_f32 v20, v20
s_nop 0
v_add_f32 v20, 1.0, v20
v_rcp_f32 v20, v20
s_nop 0
v_mul_f32 v97, v97, v20
v_cvt_pk_bf16_f32 v97, v97, v97
v_and_b32 v97, 0xffff0000, v97
v_lshlrev_b32 v98, 16, v98
v_mul_f32 v20, 0xbfb8aa3b, v98
v_exp_f32 v20, v20
s_nop 0
v_add_f32 v20, 1.0, v20
v_rcp_f32 v20, v20
s_nop 0
v_mul_f32 v98, v98, v20
v_cvt_pk_bf16_f32 v98, v98, v98
v_and_b32 v98, 0xffff0000, v98
v_lshlrev_b32 v99, 16, v99
v_mul_f32 v20, 0xbfb8aa3b, v99
v_exp_f32 v20, v20
s_nop 0
v_add_f32 v20, 1.0, v20
v_rcp_f32 v20, v20
s_nop 0
v_mul_f32 v99, v99, v20
v_cvt_pk_bf16_f32 v99, v99, v99
v_and_b32 v99, 0xffff0000, v99
v_lshlrev_b32 v100, 16, v100
v_mul_f32 v20, 0xbfb8aa3b, v100
v_exp_f32 v20, v20
s_nop 0
v_add_f32 v20, 1.0, v20
v_rcp_f32 v20, v20
s_nop 0
v_mul_f32 v100, v100, v20
v_cvt_pk_bf16_f32 v100, v100, v100
v_and_b32 v100, 0xffff0000, v100
v_lshlrev_b32 v101, 16, v101
v_mul_f32 v20, 0xbfb8aa3b, v101
v_exp_f32 v20, v20
s_nop 0
v_add_f32 v20, 1.0, v20
v_rcp_f32 v20, v20
s_nop 0
v_mul_f32 v101, v101, v20
v_cvt_pk_bf16_f32 v101, v101, v101
v_and_b32 v101, 0xffff0000, v101
v_lshlrev_b32 v102, 16, v102
v_mul_f32 v20, 0xbfb8aa3b, v102
v_exp_f32 v20, v20
s_nop 0
v_add_f32 v20, 1.0, v20
v_rcp_f32 v20, v20
s_nop 0
v_mul_f32 v102, v102, v20
v_cvt_pk_bf16_f32 v102, v102, v102
v_and_b32 v102, 0xffff0000, v102
v_lshlrev_b32 v103, 16, v103
v_mul_f32 v20, 0xbfb8aa3b, v103
v_exp_f32 v20, v20
s_nop 0
v_add_f32 v20, 1.0, v20
v_rcp_f32 v20, v20
s_nop 0
v_mul_f32 v103, v103, v20
v_cvt_pk_bf16_f32 v103, v103, v103
v_and_b32 v103, 0xffff0000, v103
v_lshlrev_b32 v104, 16, v104
v_mul_f32 v20, 0xbfb8aa3b, v104
v_exp_f32 v20, v20
s_nop 0
v_add_f32 v20, 1.0, v20
v_rcp_f32 v20, v20
s_nop 0
v_mul_f32 v104, v104, v20
v_cvt_pk_bf16_f32 v104, v104, v104
v_and_b32 v104, 0xffff0000, v104
v_lshlrev_b32 v105, 16, v105
v_mul_f32 v20, 0xbfb8aa3b, v105
v_exp_f32 v20, v20
s_nop 0
v_add_f32 v20, 1.0, v20
v_rcp_f32 v20, v20
s_nop 0
v_mul_f32 v105, v105, v20
v_cvt_pk_bf16_f32 v105, v105, v105
v_and_b32 v105, 0xffff0000, v105
v_lshlrev_b32 v106, 16, v106
v_mul_f32 v20, 0xbfb8aa3b, v106
v_exp_f32 v20, v20
s_nop 0
v_add_f32 v20, 1.0, v20
v_rcp_f32 v20, v20
s_nop 0
v_mul_f32 v106, v106, v20
v_cvt_pk_bf16_f32 v106, v106, v106
v_and_b32 v106, 0xffff0000, v106
v_lshlrev_b32 v107, 16, v107
v_mul_f32 v20, 0xbfb8aa3b, v107
v_exp_f32 v20, v20
s_nop 0
v_add_f32 v20, 1.0, v20
v_rcp_f32 v20, v20
s_nop 0
v_mul_f32 v107, v107, v20
v_cvt_pk_bf16_f32 v107, v107, v107
v_and_b32 v107, 0xffff0000, v107
v_lshlrev_b32 v108, 16, v108
v_mul_f32 v20, 0xbfb8aa3b, v108
v_exp_f32 v20, v20
s_nop 0
v_add_f32 v20, 1.0, v20
v_rcp_f32 v20, v20
s_nop 0
v_mul_f32 v108, v108, v20
v_cvt_pk_bf16_f32 v108, v108, v108
v_and_b32 v108, 0xffff0000, v108
v_lshlrev_b32 v109, 16, v109
v_mul_f32 v20, 0xbfb8aa3b, v109
v_exp_f32 v20, v20
s_nop 0
v_add_f32 v20, 1.0, v20
v_rcp_f32 v20, v20
s_nop 0
v_mul_f32 v109, v109, v20
v_cvt_pk_bf16_f32 v109, v109, v109
v_and_b32 v109, 0xffff0000, v109
v_lshlrev_b32 v110, 16, v110
v_mul_f32 v20, 0xbfb8aa3b, v110
v_exp_f32 v20, v20
s_nop 0
v_add_f32 v20, 1.0, v20
v_rcp_f32 v20, v20
s_nop 0
v_mul_f32 v110, v110, v20
v_cvt_pk_bf16_f32 v110, v110, v110
v_and_b32 v110, 0xffff0000, v110
v_lshlrev_b32 v111, 16, v111
v_mul_f32 v20, 0xbfb8aa3b, v111
v_exp_f32 v20, v20
s_nop 0
v_add_f32 v20, 1.0, v20
v_rcp_f32 v20, v20
s_nop 0
v_mul_f32 v111, v111, v20
v_cvt_pk_bf16_f32 v111, v111, v111
v_and_b32 v111, 0xffff0000, v111
v_lshlrev_b32 v20, 16, v32
v_and_b32 v21, 0xffff0000, v32
v_fmac_f32 v24, v20, v96
v_fmac_f32 v25, v21, v96
v_lshlrev_b32 v20, 16, v33
v_and_b32 v21, 0xffff0000, v33
v_fmac_f32 v26, v20, v96
v_fmac_f32 v27, v21, v96
v_lshlrev_b32 v20, 16, v34
v_and_b32 v21, 0xffff0000, v34
v_fmac_f32 v28, v20, v96
v_fmac_f32 v29, v21, v96
v_lshlrev_b32 v20, 16, v35
v_and_b32 v21, 0xffff0000, v35
v_fmac_f32 v30, v20, v96
v_fmac_f32 v31, v21, v96
v_lshlrev_b32 v20, 16, v36
v_and_b32 v21, 0xffff0000, v36
v_fmac_f32 v24, v20, v97
v_fmac_f32 v25, v21, v97
v_lshlrev_b32 v20, 16, v37
v_and_b32 v21, 0xffff0000, v37
v_fmac_f32 v26, v20, v97
v_fmac_f32 v27, v21, v97
v_lshlrev_b32 v20, 16, v38
v_and_b32 v21, 0xffff0000, v38
v_fmac_f32 v28, v20, v97
v_fmac_f32 v29, v21, v97
v_lshlrev_b32 v20, 16, v39
v_and_b32 v21, 0xffff0000, v39
v_fmac_f32 v30, v20, v97
v_fmac_f32 v31, v21, v97
v_lshlrev_b32 v20, 16, v40
v_and_b32 v21, 0xffff0000, v40
v_fmac_f32 v24, v20, v98
v_fmac_f32 v25, v21, v98
v_lshlrev_b32 v20, 16, v41
v_and_b32 v21, 0xffff0000, v41
v_fmac_f32 v26, v20, v98
v_fmac_f32 v27, v21, v98
v_lshlrev_b32 v20, 16, v42
v_and_b32 v21, 0xffff0000, v42
v_fmac_f32 v28, v20, v98
v_fmac_f32 v29, v21, v98
v_lshlrev_b32 v20, 16, v43
v_and_b32 v21, 0xffff0000, v43
v_fmac_f32 v30, v20, v98
v_fmac_f32 v31, v21, v98
v_lshlrev_b32 v20, 16, v44
v_and_b32 v21, 0xffff0000, v44
v_fmac_f32 v24, v20, v99
v_fmac_f32 v25, v21, v99
v_lshlrev_b32 v20, 16, v45
v_and_b32 v21, 0xffff0000, v45
v_fmac_f32 v26, v20, v99
v_fmac_f32 v27, v21, v99
v_lshlrev_b32 v20, 16, v46
v_and_b32 v21, 0xffff0000, v46
v_fmac_f32 v28, v20, v99
v_fmac_f32 v29, v21, v99
v_lshlrev_b32 v20, 16, v47
v_and_b32 v21, 0xffff0000, v47
v_fmac_f32 v30, v20, v99
v_fmac_f32 v31, v21, v99
v_lshlrev_b32 v20, 16, v48
v_and_b32 v21, 0xffff0000, v48
v_fmac_f32 v24, v20, v100
v_fmac_f32 v25, v21, v100
v_lshlrev_b32 v20, 16, v49
v_and_b32 v21, 0xffff0000, v49
v_fmac_f32 v26, v20, v100
v_fmac_f32 v27, v21, v100
v_lshlrev_b32 v20, 16, v50
v_and_b32 v21, 0xffff0000, v50
v_fmac_f32 v28, v20, v100
v_fmac_f32 v29, v21, v100
v_lshlrev_b32 v20, 16, v51
v_and_b32 v21, 0xffff0000, v51
v_fmac_f32 v30, v20, v100
v_fmac_f32 v31, v21, v100
v_lshlrev_b32 v20, 16, v52
v_and_b32 v21, 0xffff0000, v52
v_fmac_f32 v24, v20, v101
v_fmac_f32 v25, v21, v101
v_lshlrev_b32 v20, 16, v53
v_and_b32 v21, 0xffff0000, v53
v_fmac_f32 v26, v20, v101
v_fmac_f32 v27, v21, v101
v_lshlrev_b32 v20, 16, v54
v_and_b32 v21, 0xffff0000, v54
v_fmac_f32 v28, v20, v101
v_fmac_f32 v29, v21, v101
v_lshlrev_b32 v20, 16, v55
v_and_b32 v21, 0xffff0000, v55
v_fmac_f32 v30, v20, v101
v_fmac_f32 v31, v21, v101
v_lshlrev_b32 v20, 16, v56
v_and_b32 v21, 0xffff0000, v56
v_fmac_f32 v24, v20, v102
v_fmac_f32 v25, v21, v102
v_lshlrev_b32 v20, 16, v57
v_and_b32 v21, 0xffff0000, v57
v_fmac_f32 v26, v20, v102
v_fmac_f32 v27, v21, v102
v_lshlrev_b32 v20, 16, v58
v_and_b32 v21, 0xffff0000, v58
v_fmac_f32 v28, v20, v102
v_fmac_f32 v29, v21, v102
v_lshlrev_b32 v20, 16, v59
v_and_b32 v21, 0xffff0000, v59
v_fmac_f32 v30, v20, v102
v_fmac_f32 v31, v21, v102
v_lshlrev_b32 v20, 16, v60
v_and_b32 v21, 0xffff0000, v60
v_fmac_f32 v24, v20, v103
v_fmac_f32 v25, v21, v103
v_lshlrev_b32 v20, 16, v61
v_and_b32 v21, 0xffff0000, v61
v_fmac_f32 v26, v20, v103
v_fmac_f32 v27, v21, v103
v_lshlrev_b32 v20, 16, v62
v_and_b32 v21, 0xffff0000, v62
v_fmac_f32 v28, v20, v103
v_fmac_f32 v29, v21, v103
v_lshlrev_b32 v20, 16, v63
v_and_b32 v21, 0xffff0000, v63
v_fmac_f32 v30, v20, v103
v_fmac_f32 v31, v21, v103
v_lshlrev_b32 v20, 16, v64
v_and_b32 v21, 0xffff0000, v64
v_fmac_f32 v24, v20, v104
v_fmac_f32 v25, v21, v104
v_lshlrev_b32 v20, 16, v65
v_and_b32 v21, 0xffff0000, v65
v_fmac_f32 v26, v20, v104
v_fmac_f32 v27, v21, v104
v_lshlrev_b32 v20, 16, v66
v_and_b32 v21, 0xffff0000, v66
v_fmac_f32 v28, v20, v104
v_fmac_f32 v29, v21, v104
v_lshlrev_b32 v20, 16, v67
v_and_b32 v21, 0xffff0000, v67
v_fmac_f32 v30, v20, v104
v_fmac_f32 v31, v21, v104
v_lshlrev_b32 v20, 16, v68
v_and_b32 v21, 0xffff0000, v68
v_fmac_f32 v24, v20, v105
v_fmac_f32 v25, v21, v105
v_lshlrev_b32 v20, 16, v69
v_and_b32 v21, 0xffff0000, v69
v_fmac_f32 v26, v20, v105
v_fmac_f32 v27, v21, v105
v_lshlrev_b32 v20, 16, v70
v_and_b32 v21, 0xffff0000, v70
v_fmac_f32 v28, v20, v105
v_fmac_f32 v29, v21, v105
v_lshlrev_b32 v20, 16, v71
v_and_b32 v21, 0xffff0000, v71
v_fmac_f32 v30, v20, v105
v_fmac_f32 v31, v21, v105
v_lshlrev_b32 v20, 16, v72
v_and_b32 v21, 0xffff0000, v72
v_fmac_f32 v24, v20, v106
v_fmac_f32 v25, v21, v106
v_lshlrev_b32 v20, 16, v73
v_and_b32 v21, 0xffff0000, v73
v_fmac_f32 v26, v20, v106
v_fmac_f32 v27, v21, v106
v_lshlrev_b32 v20, 16, v74
v_and_b32 v21, 0xffff0000, v74
v_fmac_f32 v28, v20, v106
v_fmac_f32 v29, v21, v106
v_lshlrev_b32 v20, 16, v75
v_and_b32 v21, 0xffff0000, v75
v_fmac_f32 v30, v20, v106
v_fmac_f32 v31, v21, v106
v_lshlrev_b32 v20, 16, v76
v_and_b32 v21, 0xffff0000, v76
v_fmac_f32 v24, v20, v107
v_fmac_f32 v25, v21, v107
v_lshlrev_b32 v20, 16, v77
v_and_b32 v21, 0xffff0000, v77
v_fmac_f32 v26, v20, v107
v_fmac_f32 v27, v21, v107
v_lshlrev_b32 v20, 16, v78
v_and_b32 v21, 0xffff0000, v78
v_fmac_f32 v28, v20, v107
v_fmac_f32 v29, v21, v107
v_lshlrev_b32 v20, 16, v79
v_and_b32 v21, 0xffff0000, v79
v_fmac_f32 v30, v20, v107
v_fmac_f32 v31, v21, v107
v_lshlrev_b32 v20, 16, v80
v_and_b32 v21, 0xffff0000, v80
v_fmac_f32 v24, v20, v108
v_fmac_f32 v25, v21, v108
v_lshlrev_b32 v20, 16, v81
v_and_b32 v21, 0xffff0000, v81
v_fmac_f32 v26, v20, v108
v_fmac_f32 v27, v21, v108
v_lshlrev_b32 v20, 16, v82
v_and_b32 v21, 0xffff0000, v82
v_fmac_f32 v28, v20, v108
v_fmac_f32 v29, v21, v108
v_lshlrev_b32 v20, 16, v83
v_and_b32 v21, 0xffff0000, v83
v_fmac_f32 v30, v20, v108
v_fmac_f32 v31, v21, v108
v_lshlrev_b32 v20, 16, v84
v_and_b32 v21, 0xffff0000, v84
v_fmac_f32 v24, v20, v109
v_fmac_f32 v25, v21, v109
v_lshlrev_b32 v20, 16, v85
v_and_b32 v21, 0xffff0000, v85
v_fmac_f32 v26, v20, v109
v_fmac_f32 v27, v21, v109
v_lshlrev_b32 v20, 16, v86
v_and_b32 v21, 0xffff0000, v86
v_fmac_f32 v28, v20, v109
v_fmac_f32 v29, v21, v109
v_lshlrev_b32 v20, 16, v87
v_and_b32 v21, 0xffff0000, v87
v_fmac_f32 v30, v20, v109
v_fmac_f32 v31, v21, v109
v_lshlrev_b32 v20, 16, v88
v_and_b32 v21, 0xffff0000, v88
v_fmac_f32 v24, v20, v110
v_fmac_f32 v25, v21, v110
v_lshlrev_b32 v20, 16, v89
v_and_b32 v21, 0xffff0000, v89
v_fmac_f32 v26, v20, v110
v_fmac_f32 v27, v21, v110
v_lshlrev_b32 v20, 16, v90
v_and_b32 v21, 0xffff0000, v90
v_fmac_f32 v28, v20, v110
v_fmac_f32 v29, v21, v110
v_lshlrev_b32 v20, 16, v91
v_and_b32 v21, 0xffff0000, v91
v_fmac_f32 v30, v20, v110
v_fmac_f32 v31, v21, v110
v_lshlrev_b32 v20, 16, v92
v_and_b32 v21, 0xffff0000, v92
v_fmac_f32 v24, v20, v111
v_fmac_f32 v25, v21, v111
v_lshlrev_b32 v20, 16, v93
v_and_b32 v21, 0xffff0000, v93
v_fmac_f32 v26, v20, v111
v_fmac_f32 v27, v21, v111
v_lshlrev_b32 v20, 16, v94
v_and_b32 v21, 0xffff0000, v94
v_fmac_f32 v28, v20, v111
v_fmac_f32 v29, v21, v111
v_lshlrev_b32 v20, 16, v95
v_and_b32 v21, 0xffff0000, v95
v_fmac_f32 v30, v20, v111
v_fmac_f32 v31, v21, v111
v_add_f32_dpp v24, v24, v24 row_ror:8 row_mask:0xf bank_mask:0xf
v_add_f32_dpp v25, v25, v25 row_ror:8 row_mask:0xf bank_mask:0xf
v_add_f32_dpp v26, v26, v26 row_ror:8 row_mask:0xf bank_mask:0xf
v_add_f32_dpp v27, v27, v27 row_ror:8 row_mask:0xf bank_mask:0xf
v_add_f32_dpp v28, v28, v28 row_ror:8 row_mask:0xf bank_mask:0xf
v_add_f32_dpp v29, v29, v29 row_ror:8 row_mask:0xf bank_mask:0xf
v_add_f32_dpp v30, v30, v30 row_ror:8 row_mask:0xf bank_mask:0xf
v_add_f32_dpp v31, v31, v31 row_ror:8 row_mask:0xf bank_mask:0xf
v_mov_b32 v20, v24
s_nop 1
v_permlane16_swap_b32 v24, v20
v_add_f32 v24, v24, v20
v_mov_b32 v20, v24
s_nop 1
v_permlane32_swap_b32 v24, v20
v_add_f32 v24, v24, v20
v_mov_b32 v20, v25
s_nop 1
v_permlane16_swap_b32 v25, v20
v_add_f32 v25, v25, v20
v_mov_b32 v20, v25
s_nop 1
v_permlane32_swap_b32 v25, v20
v_add_f32 v25, v25, v20
v_mov_b32 v20, v26
s_nop 1
v_permlane16_swap_b32 v26, v20
v_add_f32 v26, v26, v20
v_mov_b32 v20, v26
s_nop 1
v_permlane32_swap_b32 v26, v20
v_add_f32 v26, v26, v20
v_mov_b32 v20, v27
s_nop 1
v_permlane16_swap_b32 v27, v20
v_add_f32 v27, v27, v20
v_mov_b32 v20, v27
s_nop 1
v_permlane32_swap_b32 v27, v20
v_add_f32 v27, v27, v20
v_mov_b32 v20, v28
s_nop 1
v_permlane16_swap_b32 v28, v20
v_add_f32 v28, v28, v20
v_mov_b32 v20, v28
s_nop 1
v_permlane32_swap_b32 v28, v20
v_add_f32 v28, v28, v20
v_mov_b32 v20, v29
s_nop 1
v_permlane16_swap_b32 v29, v20
v_add_f32 v29, v29, v20
v_mov_b32 v20, v29
s_nop 1
v_permlane32_swap_b32 v29, v20
v_add_f32 v29, v29, v20
v_mov_b32 v20, v30
s_nop 1
v_permlane16_swap_b32 v30, v20
v_add_f32 v30, v30, v20
v_mov_b32 v20, v30
s_nop 1
v_permlane32_swap_b32 v30, v20
v_add_f32 v30, v30, v20
v_mov_b32 v20, v31
s_nop 1
v_permlane16_swap_b32 v31, v20
v_add_f32 v31, v31, v20
v_mov_b32 v20, v31
s_nop 1
v_permlane32_swap_b32 v31, v20
v_add_f32 v31, v31, v20
v_lshlrev_b32 v20, 5, v17
s_lshl_b32 s90, s20, 8
s_add_u32 s90, s90, 140000
v_add_u32 v20, s90, v20
ds_write_b128 v20, v[24:27]
ds_write_b128 v20, v[28:31] offset:16
s_waitcnt lgkmcnt(0)
s_barrier
v_lshlrev_b32 v20, 2, v1
v_add_u32 v21, 140000, v20
ds_read_b32 v24, v21 offset:0
ds_read_b32 v25, v21 offset:256
ds_read_b32 v26, v21 offset:512
ds_read_b32 v27, v21 offset:768
s_waitcnt lgkmcnt(0)
v_add_f32 v24, v24, v25
v_add_f32 v26, v26, v27
v_add_f32 v24, v24, v26
v_cvt_pk_bf16_f32 v24, v24, v24
v_and_b32 v24, 0xffff0000, v24
v_add_f32 v25, 1.0, v24
v_cvt_pk_bf16_f32 v25, v25, v25
v_and_b32 v25, 0xffff0000, v25
s_lshr_b32 s90, s38, 3
s_cmp_eq_u32 s90, 1
s_cbranch_scc1 L_modp_211
s_cmp_eq_u32 s90, 4
s_cbranch_scc0 L_modq_212
L_modp_211:
v_mov_b32 v24, v25
L_modq_212:
s_lshl_b32 s90, s38, 8
s_add_u32 s90, s90, 0x0
s_cmp_lg_u32 s20, 0
s_cbranch_scc1 L_modr_213
buffer_store_dword v24, v20, s[8:11], s90 offen sc1
L_modr_213:
s_waitcnt vmcnt(0)
s_barrier
s_lshl_b32 s90, s38, 3
s_add_u32 s90, s90, 0x10000
s_cmp_lg_u32 s20, 0
s_cbranch_scc1 L_sf_214
v_mov_b32 v16, 1
v_mov_b32 v17, s46
v_mov_b32 v18, 0
s_mov_b64 exec, 1
buffer_store_dwordx2 v[16:17], v18, s[8:11], s90 offen sc1
s_mov_b64 exec, -1
L_sf_214:
s_branch L_tail
L_front:
s_and_b32 s38, s35, 1
s_lshr_b32 s39, s35, 1
s_and_b32 s40, s39, 31
s_lshr_b32 s41, s39, 5
s_add_u32 s41, s41, 1
s_cmp_eq_u32 s41, 3
s_cselect_b32 s41, 0, s41
s_cmp_eq_u32 s41, 1
s_cselect_b32 s28, s30, s28
s_cselect_b32 s29, s31, s29
s_cmp_eq_u32 s41, 2
s_cselect_b32 s28, s36, s28
s_cselect_b32 s29, s37, s29
s_lshl_b32 s42, s40, 6
s_lshl_b32 s43, s41, 1
s_add_u32 s43, s43, s38
s_lshl_b32 s43, s43, 3
s_add_u32 s42, s42, s43
s_add_u32 s42, s42, 0x10400
s_mov_b32 s12, s28
s_mov_b32 s13, s29
s_mov_b32 s14, 0x400000
s_mov_b32 s15, 0x00020000
v_lshlrev_b32 v104, 4, v1
v_lshrrev_b32 v2, 2, v1
v_lshlrev_b32 v2, 13, v2
v_and_b32 v3, 3, v1
v_lshl_add_u32 v2, v3, 4, v2
s_lshl_b32 s70, s40, 8
s_lshl_b32 s71, s20, 6
s_add_u32 s70, s70, s71
v_add_u32 v107, s70, v2
s_lshl_b32 s72, s20, 15
s_add_u32 m0, s72, 0
s_mov_b32 s71, 0x0
buffer_load_dwordx4 v107, s[12:15], s71 offen lds
s_add_u32 m0, s72, 1024
s_mov_b32 s71, 0x20000
buffer_load_dwordx4 v107, s[12:15], s71 offen lds
s_add_u32 m0, s72, 2048
s_mov_b32 s71, 0x40000
buffer_load_dwordx4 v107, s[12:15], s71 offen lds
s_add_u32 m0, s72, 3072
s_mov_b32 s71, 0x60000
buffer_load_dwordx4 v107, s[12:15], s71 offen lds
s_add_u32 m0, s72, 4096
s_mov_b32 s71, 0x80000
buffer_load_dwordx4 v107, s[12:15], s71 offen lds
s_add_u32 m0, s72, 5120
s_mov_b32 s71, 0xa0000
buffer_load_dwordx4 v107, s[12:15], s71 offen lds
s_add_u32 m0, s72, 6144
s_mov_b32 s71, 0xc0000
buffer_load_dwordx4 v107, s[12:15], s71 offen lds
s_add_u32 m0, s72, 7168
s_mov_b32 s71, 0xe0000
buffer_load_dwordx4 v107, s[12:15], s71 offen lds
s_add_u32 m0, s72, 8192
s_mov_b32 s71, 0x100000
buffer_load_dwordx4 v107, s[12:15], s71 offen lds
s_add_u32 m0, s72, 9216
s_mov_b32 s71, 0x120000
buffer_load_dwordx4 v107, s[12:15], s71 offen lds
s_add_u32 m0, s72, 10240
s_mov_b32 s71, 0x140000
buffer_load_dwordx4 v107, s[12:15], s71 offen lds
s_add_u32 m0, s72, 11264
s_mov_b32 s71, 0x160000
buffer_load_dwordx4 v107, s[12:15], s71 offen lds
s_add_u32 m0, s72, 12288
s_mov_b32 s71, 0x180000
buffer_load_dwordx4 v107, s[12:15], s71 offen lds
s_add_u32 m0, s72, 13312
s_mov_b32 s71, 0x1a0000
buffer_load_dwordx4 v107, s[12:15], s71 offen lds
s_add_u32 m0, s72, 14336
s_mov_b32 s71, 0x1c0000
buffer_load_dwordx4 v107, s[12:15], s71 offen lds
s_add_u32 m0, s72, 15360
s_mov_b32 s71, 0x1e0000
buffer_load_dwordx4 v107, s[12:15], s71 offen lds
s_add_u32 m0, s72, 16384
s_mov_b32 s71, 0x200000
buffer_load_dwordx4 v107, s[12:15], s71 offen lds
s_add_u32 m0, s72, 17408
s_mov_b32 s71, 0x220000
buffer_load_dwordx4 v107, s[12:15], s71 offen lds
s_add_u32 m0, s72, 18432
s_mov_b32 s71, 0x240000
buffer_load_dwordx4 v107, s[12:15], s71 offen lds
s_add_u32 m0, s72, 19456
s_mov_b32 s71, 0x260000
buffer_load_dwordx4 v107, s[12:15], s71 offen lds
s_add_u32 m0, s72, 20480
s_mov_b32 s71, 0x280000
buffer_load_dwordx4 v107, s[12:15], s71 offen lds
s_add_u32 m0, s72, 21504
s_mov_b32 s71, 0x2a0000
buffer_load_dwordx4 v107, s[12:15], s71 offen lds
s_add_u32 m0, s72, 22528
s_mov_b32 s71, 0x2c0000
buffer_load_dwordx4 v107, s[12:15], s71 offen lds
s_add_u32 m0, s72, 23552
s_mov_b32 s71, 0x2e0000
buffer_load_dwordx4 v107, s[12:15], s71 offen lds
s_add_u32 m0, s72, 24576
s_mov_b32 s71, 0x300000
buffer_load_dwordx4 v107, s[12:15], s71 offen lds
s_add_u32 m0, s72, 25600
s_mov_b32 s71, 0x320000
buffer_load_dwordx4 v107, s[12:15], s71 offen lds
s_add_u32 m0, s72, 26624
s_mov_b32 s71, 0x340000
buffer_load_dwordx4 v107, s[12:15], s71 offen lds
s_add_u32 m0, s72, 27648
s_mov_b32 s71, 0x360000
buffer_load_dwordx4 v107, s[12:15], s71 offen lds
s_add_u32 m0, s72, 28672
s_mov_b32 s71, 0x380000
buffer_load_dwordx4 v107, s[12:15], s71 offen lds
s_add_u32 m0, s72, 29696
s_mov_b32 s71, 0x3a0000
buffer_load_dwordx4 v107, s[12:15], s71 offen lds
s_add_u32 m0, s72, 30720
s_mov_b32 s71, 0x3c0000
buffer_load_dwordx4 v107, s[12:15], s71 offen lds
s_add_u32 m0, s72, 31744
s_mov_b32 s71, 0x3e0000
buffer_load_dwordx4 v107, s[12:15], s71 offen lds
v_lshrrev_b32 v2, 5, v1
v_bfe_u32 v3, v1, 2, 2
v_lshl_add_u32 v2, v2, 3, v3
v_lshlrev_b32 v2, 6, v2
v_and_b32 v3, 3, v1
v_bfe_u32 v4, v1, 4, 1
v_lshl_add_u32 v3, v4, 2, v3
v_and_b32 v4, 1, v3
v_bfe_u32 v5, v3, 1, 1
v_lshl_or_b32 v4, v5, 2, v4
v_bfe_u32 v5, v3, 2, 1
v_lshl_or_b32 v4, v5, 1, v4
s_cmp_eq_u32 s41, 2
s_cselect_b64 vcc, -1, 0
v_cndmask_b32 v3, v4, v3, vcc
v_lshl_add_u32 v2, v3, 3, v2
v_add_u32 v105, s72, v2
v_bfe_u32 v2, v1, 4, 1
v_and_b32 v3, 15, v1
v_lshrrev_b32 v4, 5, v1
v_lshlrev_b32 v3, 4, v3
v_lshl_add_u32 v3, v4, 8, v3
v_lshlrev_b32 v4, 12, v2
v_lshlrev_b32 v5, 10, v2
v_cndmask_b32 v4, v4, v5, vcc
s_lshl_b32 s70, s20, 10
s_lshl_b32 s71, s20, 11
s_cmp_eq_u32 s41, 2
s_cselect_b32 s70, s71, s70
v_add3_u32 v106, v3, v4, s70
s_mov_b32 s75, 0x2800000
s_cmp_eq_u32 s41, 1
s_cselect_b32 s75, 0x800000, s75
s_cmp_eq_u32 s41, 2
s_cselect_b32 s75, 0x1800000, s75
s_lshl_b32 s70, s40, 13
s_add_u32 s75, s75, s70
s_lshl_b32 s70, s38, 18
s_add_u32 s75, s75, s70
s_waitcnt vmcnt(0)
ds_read_b64_tr_b16 a[0:1], v105 offset:0
ds_read_b64_tr_b16 a[2:3], v105 offset:256
ds_read_b64_tr_b16 a[4:5], v105 offset:1024
ds_read_b64_tr_b16 a[6:7], v105 offset:1280
ds_read_b64_tr_b16 a[8:9], v105 offset:2048
ds_read_b64_tr_b16 a[10:11], v105 offset:2304
ds_read_b64_tr_b16 a[12:13], v105 offset:3072
ds_read_b64_tr_b16 a[14:15], v105 offset:3328
ds_read_b64_tr_b16 a[16:17], v105 offset:4096
ds_read_b64_tr_b16 a[18:19], v105 offset:4352
ds_read_b64_tr_b16 a[20:21], v105 offset:5120
ds_read_b64_tr_b16 a[22:23], v105 offset:5376
ds_read_b64_tr_b16 a[24:25], v105 offset:6144
ds_read_b64_tr_b16 a[26:27], v105 offset:6400
ds_read_b64_tr_b16 a[28:29], v105 offset:7168
ds_read_b64_tr_b16 a[30:31], v105 offset:7424
ds_read_b64_tr_b16 a[32:33], v105 offset:8192
ds_read_b64_tr_b16 a[34:35], v105 offset:8448
ds_read_b64_tr_b16 a[36:37], v105 offset:9216
ds_read_b64_tr_b16 a[38:39], v105 offset:9472
ds_read_b64_tr_b16 a[40:41], v105 offset:10240
ds_read_b64_tr_b16 a[42:43], v105 offset:10496
ds_read_b64_tr_b16 a[44:45], v105 offset:11264
ds_read_b64_tr_b16 a[46:47], v105 offset:11520
ds_read_b64_tr_b16 a[48:49], v105 offset:12288
ds_read_b64_tr_b16 a[50:51], v105 offset:12544
ds_read_b64_tr_b16 a[52:53], v105 offset:13312
ds_read_b64_tr_b16 a[54:55], v105 offset:13568
ds_read_b64_tr_b16 a[56:57], v105 offset:14336
ds_read_b64_tr_b16 a[58:59], v105 offset:14592
ds_read_b64_tr_b16 a[60:61], v105 offset:15360
ds_read_b64_tr_b16 a[62:63], v105 offset:15616
ds_read_b64_tr_b16 a[64:65], v105 offset:16384
ds_read_b64_tr_b16 a[66:67], v105 offset:16640
ds_read_b64_tr_b16 a[68:69], v105 offset:17408
ds_read_b64_tr_b16 a[70:71], v105 offset:17664
ds_read_b64_tr_b16 a[72:73], v105 offset:18432
ds_read_b64_tr_b16 a[74:75], v105 offset:18688
ds_read_b64_tr_b16 a[76:77], v105 offset:19456
ds_read_b64_tr_b16 a[78:79], v105 offset:19712
ds_read_b64_tr_b16 a[80:81], v105 offset:20480
ds_read_b64_tr_b16 a[82:83], v105 offset:20736
ds_read_b64_tr_b16 a[84:85], v105 offset:21504
ds_read_b64_tr_b16 a[86:87], v105 offset:21760
ds_read_b64_tr_b16 a[88:89], v105 offset:22528
ds_read_b64_tr_b16 a[90:91], v105 offset:22784
ds_read_b64_tr_b16 a[92:93], v105 offset:23552
ds_read_b64_tr_b16 a[94:95], v105 offset:23808
ds_read_b64_tr_b16 a[96:97], v105 offset:24576
ds_read_b64_tr_b16 a[98:99], v105 offset:24832
ds_read_b64_tr_b16 a[100:101], v105 offset:25600
ds_read_b64_tr_b16 a[102:103], v105 offset:25856
ds_read_b64_tr_b16 a[104:105], v105 offset:26624
ds_read_b64_tr_b16 a[106:107], v105 offset:26880
ds_read_b64_tr_b16 a[108:109], v105 offset:27648
ds_read_b64_tr_b16 a[110:111], v105 offset:27904
ds_read_b64_tr_b16 a[112:113], v105 offset:28672
ds_read_b64_tr_b16 a[114:115], v105 offset:28928
ds_read_b64_tr_b16 a[116:117], v105 offset:29696
ds_read_b64_tr_b16 a[118:119], v105 offset:29952
ds_read_b64_tr_b16 a[120:121], v105 offset:30720
ds_read_b64_tr_b16 a[122:123], v105 offset:30976
ds_read_b64_tr_b16 a[124:125], v105 offset:31744
ds_read_b64_tr_b16 a[126:127], v105 offset:32000
s_waitcnt lgkmcnt(0)
s_cmp_lg_u32 s32, 0
s_cbranch_scc1 L_vfx_217
s_mov_b32 s90, 200000
L_vf_215:
v_mov_b32 v28, 0
buffer_load_dwordx4 v[16:19], v28, s[16:19], 0 offen sc1
buffer_load_dwordx4 v[20:23], v28, s[16:19], 0 offen offset:16 sc1
buffer_load_dwordx2 v[24:25], v28, s[16:19], 0 offen offset:128 sc1
s_sub_u32 s90, s90, 1
s_cmp_eq_u32 s90, 0
s_cbranch_scc1 L_abort
s_waitcnt vmcnt(0)
L_vfe_216:
v_add3_u32 v26, v17, v18, v19
v_add3_u32 v26, v26, v20, v21
v_add3_u32 v26, v26, v22, v23
v_add_u32 v26, v26, v24
v_max3_u32 v27, v17, v18, v19
v_max3_u32 v27, v27, v20, v21
v_max3_u32 v27, v27, v22, v23
v_max_u32 v27, v27, v24
v_cmp_lt_u32 vcc, 0x100, v26
s_cbranch_vccnz L_abort
v_cmp_ne_u32 vcc, 0x100, v26
s_cbranch_vccnz L_vf_215
v_cmp_eq_u32 vcc, 0, v25
s_cbranch_vccnz L_vf_215
v_readfirstlane_b32 s46, v25
v_readfirstlane_b32 s90, v27
s_cmp_lg_u32 s90, 32
s_cbranch_scc1 L_slow
L_vfx_217:
s_cmp_lg_u32 s20, 0
s_cbranch_scc1 L_bh_218
s_mov_b32 s90, 0x10200
v_lshlrev_b32 v2, 3, v1
v_mov_b32 v3, 1
v_cmp_gt_u32 vcc, 32, v1
s_nop 1
v_cndmask_b32 v3, 0, v3, vcc
s_mov_b32 s91, 300000
L_pl_219:
buffer_load_dwordx2 v[4:5], v2, s[8:11], s90 offen sc1
s_sub_u32 s91, s91, 1
s_cmp_eq_u32 s91, 0
s_cbranch_scc1 L_abort
s_waitcnt vmcnt(0)
v_cmp_eq_u32 vcc, s46, v5
s_nop 1
v_cndmask_b32 v4, 0, v4, vcc
v_cmp_gt_u32 vcc, v3, v4
s_cbranch_vccz L_plx_220
s_sleep 1
s_branch L_pl_219
L_plx_220:
L_bh_218:
s_barrier
s_lshl_b32 s76, s38, 15
s_lshl_b32 s70, s20, 13
s_add_u32 s76, s76, s70
s_add_u32 s76, s76, 0x400000
s_mov_b32 s77, s70
s_add_u32 s72, s70, 98304
s_add_u32 m0, s77, 0
s_add_u32 s71, s76, 0
buffer_load_dwordx4 v104, s[8:11], s71 offen sc1 lds
s_add_u32 m0, s77, 1024
s_add_u32 s71, s76, 1024
buffer_load_dwordx4 v104, s[8:11], s71 offen sc1 lds
s_add_u32 m0, s77, 2048
s_add_u32 s71, s76, 2048
buffer_load_dwordx4 v104, s[8:11], s71 offen sc1 lds
s_add_u32 m0, s77, 3072
s_add_u32 s71, s76, 3072
buffer_load_dwordx4 v104, s[8:11], s71 offen sc1 lds
s_add_u32 m0, s77, 4096
s_add_u32 s71, s76, 4096
buffer_load_dwordx4 v104, s[8:11], s71 offen sc1 lds
s_add_u32 m0, s77, 5120
s_add_u32 s71, s76, 5120
buffer_load_dwordx4 v104, s[8:11], s71 offen sc1 lds
s_add_u32 m0, s77, 6144
s_add_u32 s71, s76, 6144
buffer_load_dwordx4 v104, s[8:11], s71 offen sc1 lds
s_add_u32 m0, s77, 7168
s_add_u32 s71, s76, 7168
buffer_load_dwordx4 v104, s[8:11], s71 offen sc1 lds
s_add_u32 s76, s76, 65536
s_add_u32 s77, s77, 32768
s_cmp_eq_u32 s77, s72
s_cselect_b32 s77, s70, s77
s_add_u32 m0, s77, 0
s_add_u32 s71, s76, 0
buffer_load_dwordx4 v104, s[8:11], s71 offen sc1 lds
s_add_u32 m0, s77, 1024
s_add_u32 s71, s76, 1024
buffer_load_dwordx4 v104, s[8:11], s71 offen sc1 lds
s_add_u32 m0, s77, 2048
s_add_u32 s71, s76, 2048
buffer_load_dwordx4 v104, s[8:11], s71 offen sc1 lds
s_add_u32 m0, s77, 3072
s_add_u32 s71, s76, 3072
buffer_load_dwordx4 v104, s[8:11], s71 offen sc1 lds
s_add_u32 m0, s77, 4096
s_add_u32 s71, s76, 4096
buffer_load_dwordx4 v104, s[8:11], s71 offen sc1 lds
s_add_u32 m0, s77, 5120
s_add_u32 s71, s76, 5120
buffer_load_dwordx4 v104, s[8:11], s71 offen sc1 lds
s_add_u32 m0, s77, 6144
s_add_u32 s71, s76, 6144
buffer_load_dwordx4 v104, s[8:11], s71 offen sc1 lds
s_add_u32 m0, s77, 7168
s_add_u32 s71, s76, 7168
buffer_load_dwordx4 v104, s[8:11], s71 offen sc1 lds
s_add_u32 s76, s76, 65536
s_add_u32 s77, s77, 32768
s_cmp_eq_u32 s77, s72
s_cselect_b32 s77, s70, s77
s_mov_b32 s74, 0
v_mov_b32 v6, v104
s_mov_b32 s73, 0
s_waitcnt vmcnt(8)
s_branch L_ffirst_222
L_floop_221:
s_waitcnt vmcnt(10)
L_ffirst_222:
s_barrier
s_max_u32 s71, s74, 1
s_sub_u32 s71, s71, 1
s_cmp_lg_u32 s20, 0
s_cbranch_scc1 L_sf_223
v_mov_b32 v2, s71
v_mov_b32 v3, s46
v_mov_b32 v4, 0
s_mov_b64 exec, 1
buffer_store_dwordx2 v[2:3], v4, s[8:11], s42 offen sc1
s_mov_b64 exec, -1
L_sf_223:
s_cmp_lg_u32 s74, 13
s_cbranch_scc1 L_mid_224
s_cmp_lg_u32 s20, 0
s_cbranch_scc1 L_bh_225
s_mov_b32 s90, 0x10200
v_lshlrev_b32 v2, 3, v1
v_mov_b32 v3, 1
s_mov_b32 s91, 300000
L_pl_226:
buffer_load_dwordx2 v[4:5], v2, s[8:11], s90 offen sc1
s_sub_u32 s91, s91, 1
s_cmp_eq_u32 s91, 0
s_cbranch_scc1 L_abort
s_waitcnt vmcnt(0)
v_cmp_eq_u32 vcc, s46, v5
s_nop 1
v_cndmask_b32 v4, 0, v4, vcc
v_cmp_gt_u32 vcc, v3, v4
s_cbranch_vccz L_plx_227
s_sleep 1
s_branch L_pl_226
L_plx_227:
L_bh_225:
s_barrier
L_mid_224:
s_cmp_ge_u32 s74, 30
s_cbranch_scc1 L_fnodma_228
s_add_u32 m0, s77, 0
s_add_u32 s71, s76, 0
buffer_load_dwordx4 v104, s[8:11], s71 offen sc1 lds
s_add_u32 m0, s77, 1024
s_add_u32 s71, s76, 1024
buffer_load_dwordx4 v104, s[8:11], s71 offen sc1 lds
s_add_u32 m0, s77, 2048
s_add_u32 s71, s76, 2048
buffer_load_dwordx4 v104, s[8:11], s71 offen sc1 lds
s_add_u32 m0, s77, 3072
s_add_u32 s71, s76, 3072
buffer_load_dwordx4 v104, s[8:11], s71 offen sc1 lds
s_add_u32 m0, s77, 4096
s_add_u32 s71, s76, 4096
buffer_load_dwordx4 v104, s[8:11], s71 offen sc1 lds
s_add_u32 m0, s77, 5120
s_add_u32 s71, s76, 5120
buffer_load_dwordx4 v104, s[8:11], s71 offen sc1 lds
s_add_u32 m0, s77, 6144
s_add_u32 s71, s76, 6144
buffer_load_dwordx4 v104, s[8:11], s71 offen sc1 lds
s_add_u32 m0, s77, 7168
s_add_u32 s71, s76, 7168
buffer_load_dwordx4 v104, s[8:11], s71 offen sc1 lds
s_add_u32 s76, s76, 65536
s_add_u32 s77, s77, 32768
s_cmp_eq_u32 s77, s72
s_cselect_b32 s77, s70, s77
s_branch L_fdmad_229
L_fnodma_228:
s_waitcnt vmcnt(0)
s_barrier
L_fdmad_229:
s_cmp_eq_u32 s41, 2
s_cbranch_scc1 L_fv_230
ds_read_b128 v[16:19], v6 offset:0
ds_read_b128 v[20:23], v6 offset:1024
ds_read_b128 v[24:27], v6 offset:2048
ds_read_b128 v[28:31], v6 offset:3072
ds_read_b128 v[32:35], v6 offset:4096
ds_read_b128 v[36:39], v6 offset:5120
ds_read_b128 v[40:43], v6 offset:6144
ds_read_b128 v[44:47], v6 offset:7168
ds_read_b128 v[48:51], v6 offset:8192
ds_read_b128 v[52:55], v6 offset:9216
ds_read_b128 v[56:59], v6 offset:10240
ds_read_b128 v[60:63], v6 offset:11264
ds_read_b128 v[64:67], v6 offset:12288
ds_read_b128 v[68:71], v6 offset:13312
ds_read_b128 v[72:75], v6 offset:14336
ds_read_b128 v[76:79], v6 offset:15360
s_waitcnt lgkmcnt(15)
v_mfma_f32_32x32x16_bf16 v[80:95], a[0:3], v[16:19], 0
ds_read_b128 v[16:19], v6 offset:16384
s_waitcnt lgkmcnt(15)
v_mfma_f32_32x32x16_bf16 v[80:95], a[4:7], v[20:23], v[80:95]
ds_read_b128 v[20:23], v6 offset:17408
s_waitcnt lgkmcnt(15)
v_mfma_f32_32x32x16_bf16 v[80:95], a[8:11], v[24:27], v[80:95]
ds_read_b128 v[24:27], v6 offset:18432
s_waitcnt lgkmcnt(15)
v_mfma_f32_32x32x16_bf16 v[80:95], a[12:15], v[28:31], v[80:95]
ds_read_b128 v[28:31], v6 offset:19456
s_waitcnt lgkmcnt(15)
v_mfma_f32_32x32x16_bf16 v[80:95], a[16:19], v[32:35], v[80:95]
ds_read_b128 v[32:35], v6 offset:20480
s_waitcnt lgkmcnt(15)
v_mfma_f32_32x32x16_bf16 v[80:95], a[20:23], v[36:39], v[80:95]
ds_read_b128 v[36:39], v6 offset:21504
s_waitcnt lgkmcnt(15)
v_mfma_f32_32x32x16_bf16 v[80:95], a[24:27], v[40:43], v[80:95]
ds_read_b128 v[40:43], v6 offset:22528
s_waitcnt lgkmcnt(15)
v_mfma_f32_32x32x16_bf16 v[80:95], a[28:31], v[44:47], v[80:95]
ds_read_b128 v[44:47], v6 offset:23552
s_waitcnt lgkmcnt(15)
v_mfma_f32_32x32x16_bf16 v[80:95], a[32:35], v[48:51], v[80:95]
ds_read_b128 v[48:51], v6 offset:24576
s_waitcnt lgkmcnt(15)
v_mfma_f32_32x32x16_bf16 v[80:95], a[36:39], v[52:55], v[80:95]
ds_read_b128 v[52:55], v6 offset:25600
s_waitcnt lgkmcnt(15)
v_mfma_f32_32x32x16_bf16 v[80:95], a[40:43], v[56:59], v[80:95]
ds_read_b128 v[56:59], v6 offset:26624
s_waitcnt lgkmcnt(15)
v_mfma_f32_32x32x16_bf16 v[80:95], a[44:47], v[60:63], v[80:95]
ds_read_b128 v[60:63], v6 offset:27648
s_waitcnt lgkmcnt(15)
v_mfma_f32_32x32x16_bf16 v[80:95], a[48:51], v[64:67], v[80:95]
ds_read_b128 v[64:67], v6 offset:28672
s_waitcnt lgkmcnt(15)
v_mfma_f32_32x32x16_bf16 v[80:95], a[52:55], v[68:71], v[80:95]
ds_read_b128 v[68:71], v6 offset:29696
s_waitcnt lgkmcnt(15)
v_mfma_f32_32x32x16_bf16 v[80:95], a[56:59], v[72:75], v[80:95]
ds_read_b128 v[72:75], v6 offset:30720
s_waitcnt lgkmcnt(15)
v_mfma_f32_32x32x16_bf16 v[80:95], a[60:63], v[76:79], v[80:95]
ds_read_b128 v[76:79], v6 offset:31744
s_waitcnt lgkmcnt(15)
v_mfma_f32_32x32x16_bf16 v[80:95], a[64:67], v[16:19], v[80:95]
s_waitcnt lgkmcnt(14)
v_mfma_f32_32x32x16_bf16 v[80:95], a[68:71], v[20:23], v[80:95]
s_waitcnt lgkmcnt(13)
v_mfma_f32_32x32x16_bf16 v[80:95], a[72:75], v[24:27], v[80:95]
s_waitcnt lgkmcnt(12)
v_mfma_f32_32x32x16_bf16 v[80:95], a[76:79], v[28:31], v[80:95]
s_waitcnt lgkmcnt(11)
v_mfma_f32_32x32x16_bf16 v[80:95], a[80:83], v[32:35], v[80:95]
s_waitcnt lgkmcnt(10)
v_mfma_f32_32x32x16_bf16 v[80:95], a[84:87], v[36:39], v[80:95]
s_waitcnt lgkmcnt(9)
v_mfma_f32_32x32x16_bf16 v[80:95], a[88:91], v[40:43], v[80:95]
s_waitcnt lgkmcnt(8)
v_mfma_f32_32x32x16_bf16 v[80:95], a[92:95], v[44:47], v[80:95]
s_waitcnt lgkmcnt(7)
v_mfma_f32_32x32x16_bf16 v[80:95], a[96:99], v[48:51], v[80:95]
s_waitcnt lgkmcnt(6)
v_mfma_f32_32x32x16_bf16 v[80:95], a[100:103], v[52:55], v[80:95]
s_waitcnt lgkmcnt(5)
v_mfma_f32_32x32x16_bf16 v[80:95], a[104:107], v[56:59], v[80:95]
s_waitcnt lgkmcnt(4)
v_mfma_f32_32x32x16_bf16 v[80:95], a[108:111], v[60:63], v[80:95]
s_waitcnt lgkmcnt(3)
v_mfma_f32_32x32x16_bf16 v[80:95], a[112:115], v[64:67], v[80:95]
s_waitcnt lgkmcnt(2)
v_mfma_f32_32x32x16_bf16 v[80:95], a[116:119], v[68:71], v[80:95]
s_waitcnt lgkmcnt(1)
v_mfma_f32_32x32x16_bf16 v[80:95], a[120:123], v[72:75], v[80:95]
s_waitcnt lgkmcnt(0)
v_mfma_f32_32x32x16_bf16 v[80:95], a[124:127], v[76:79], v[80:95]
s_nop 11
v_cvt_pk_bf16_f32 v96, v80, v81
v_cvt_pk_bf16_f32 v97, v82, v83
v_cvt_pk_bf16_f32 v98, v84, v85
v_cvt_pk_bf16_f32 v99, v86, v87
v_cvt_pk_bf16_f32 v100, v88, v89
v_cvt_pk_bf16_f32 v101, v90, v91
v_cvt_pk_bf16_f32 v102, v92, v93
v_cvt_pk_bf16_f32 v103, v94, v95
s_branch L_fe_231
L_fv_230:
ds_read_b128 v[16:19], v6 offset:0
ds_read_b128 v[20:23], v6 offset:1024
ds_read_b128 v[24:27], v6 offset:2048
ds_read_b128 v[28:31], v6 offset:3072
ds_read_b128 v[32:35], v6 offset:4096
ds_read_b128 v[36:39], v6 offset:5120
ds_read_b128 v[40:43], v6 offset:6144
ds_read_b128 v[44:47], v6 offset:7168
ds_read_b128 v[48:51], v6 offset:8192
ds_read_b128 v[52:55], v6 offset:9216
ds_read_b128 v[56:59], v6 offset:10240
ds_read_b128 v[60:63], v6 offset:11264
ds_read_b128 v[64:67], v6 offset:12288
ds_read_b128 v[68:71], v6 offset:13312
ds_read_b128 v[72:75], v6 offset:14336
ds_read_b128 v[76:79], v6 offset:15360
s_waitcnt lgkmcnt(15)
v_mfma_f32_32x32x16_bf16 v[80:95], v[16:19], a[0:3], 0
ds_read_b128 v[16:19], v6 offset:16384
s_waitcnt lgkmcnt(15)
v_mfma_f32_32x32x16_bf16 v[80:95], v[20:23], a[4:7], v[80:95]
ds_read_b128 v[20:23], v6 offset:17408
s_waitcnt lgkmcnt(15)
v_mfma_f32_32x32x16_bf16 v[80:95], v[24:27], a[8:11], v[80:95]
ds_read_b128 v[24:27], v6 offset:18432
s_waitcnt lgkmcnt(15)
v_mfma_f32_32x32x16_bf16 v[80:95], v[28:31], a[12:15], v[80:95]
ds_read_b128 v[28:31], v6 offset:19456
s_waitcnt lgkmcnt(15)
v_mfma_f32_32x32x16_bf16 v[80:95], v[32:35], a[16:19], v[80:95]
ds_read_b128 v[32:35], v6 offset:20480
s_waitcnt lgkmcnt(15)
v_mfma_f32_32x32x16_bf16 v[80:95], v[36:39], a[20:23], v[80:95]
ds_read_b128 v[36:39], v6 offset:21504
s_waitcnt lgkmcnt(15)
v_mfma_f32_32x32x16_bf16 v[80:95], v[40:43], a[24:27], v[80:95]
ds_read_b128 v[40:43], v6 offset:22528
s_waitcnt lgkmcnt(15)
v_mfma_f32_32x32x16_bf16 v[80:95], v[44:47], a[28:31], v[80:95]
ds_read_b128 v[44:47], v6 offset:23552
s_waitcnt lgkmcnt(15)
v_mfma_f32_32x32x16_bf16 v[80:95], v[48:51], a[32:35], v[80:95]
ds_read_b128 v[48:51], v6 offset:24576
s_waitcnt lgkmcnt(15)
v_mfma_f32_32x32x16_bf16 v[80:95], v[52:55], a[36:39], v[80:95]
ds_read_b128 v[52:55], v6 offset:25600
s_waitcnt lgkmcnt(15)
v_mfma_f32_32x32x16_bf16 v[80:95], v[56:59], a[40:43], v[80:95]
ds_read_b128 v[56:59], v6 offset:26624
s_waitcnt lgkmcnt(15)
v_mfma_f32_32x32x16_bf16 v[80:95], v[60:63], a[44:47], v[80:95]
ds_read_b128 v[60:63], v6 offset:27648
s_waitcnt lgkmcnt(15)
v_mfma_f32_32x32x16_bf16 v[80:95], v[64:67], a[48:51], v[80:95]
ds_read_b128 v[64:67], v6 offset:28672
s_waitcnt lgkmcnt(15)
v_mfma_f32_32x32x16_bf16 v[80:95], v[68:71], a[52:55], v[80:95]
ds_read_b128 v[68:71], v6 offset:29696
s_waitcnt lgkmcnt(15)
v_mfma_f32_32x32x16_bf16 v[80:95], v[72:75], a[56:59], v[80:95]
ds_read_b128 v[72:75], v6 offset:30720
s_waitcnt lgkmcnt(15)
v_mfma_f32_32x32x16_bf16 v[80:95], v[76:79], a[60:63], v[80:95]
ds_read_b128 v[76:79], v6 offset:31744
s_waitcnt lgkmcnt(15)
v_mfma_f32_32x32x16_bf16 v[80:95], v[16:19], a[64:67], v[80:95]
s_waitcnt lgkmcnt(14)
v_mfma_f32_32x32x16_bf16 v[80:95], v[20:23], a[68:71], v[80:95]
s_waitcnt lgkmcnt(13)
v_mfma_f32_32x32x16_bf16 v[80:95], v[24:27], a[72:75], v[80:95]
s_waitcnt lgkmcnt(12)
v_mfma_f32_32x32x16_bf16 v[80:95], v[28:31], a[76:79], v[80:95]
s_waitcnt lgkmcnt(11)
v_mfma_f32_32x32x16_bf16 v[80:95], v[32:35], a[80:83], v[80:95]
s_waitcnt lgkmcnt(10)
v_mfma_f32_32x32x16_bf16 v[80:95], v[36:39], a[84:87], v[80:95]
s_waitcnt lgkmcnt(9)
v_mfma_f32_32x32x16_bf16 v[80:95], v[40:43], a[88:91], v[80:95]
s_waitcnt lgkmcnt(8)
v_mfma_f32_32x32x16_bf16 v[80:95], v[44:47], a[92:95], v[80:95]
s_waitcnt lgkmcnt(7)
v_mfma_f32_32x32x16_bf16 v[80:95], v[48:51], a[96:99], v[80:95]
s_waitcnt lgkmcnt(6)
v_mfma_f32_32x32x16_bf16 v[80:95], v[52:55], a[100:103], v[80:95]
s_waitcnt lgkmcnt(5)
v_mfma_f32_32x32x16_bf16 v[80:95], v[56:59], a[104:107], v[80:95]
s_waitcnt lgkmcnt(4)
v_mfma_f32_32x32x16_bf16 v[80:95], v[60:63], a[108:111], v[80:95]
s_waitcnt lgkmcnt(3)
v_mfma_f32_32x32x16_bf16 v[80:95], v[64:67], a[112:115], v[80:95]
s_waitcnt lgkmcnt(2)
v_mfma_f32_32x32x16_bf16 v[80:95], v[68:71], a[116:119], v[80:95]
s_waitcnt lgkmcnt(1)
v_mfma_f32_32x32x16_bf16 v[80:95], v[72:75], a[120:123], v[80:95]
s_waitcnt lgkmcnt(0)
v_mfma_f32_32x32x16_bf16 v[80:95], v[76:79], a[124:127], v[80:95]
s_nop 11
v_cvt_pk_bf16_f32 v96, v80, v81
v_cvt_pk_bf16_f32 v97, v82, v83
v_cvt_pk_bf16_f32 v98, v88, v89
v_cvt_pk_bf16_f32 v99, v90, v91
v_cvt_pk_bf16_f32 v100, v84, v85
v_cvt_pk_bf16_f32 v101, v86, v87
v_cvt_pk_bf16_f32 v102, v92, v93
v_cvt_pk_bf16_f32 v103, v94, v95
L_fe_231:
buffer_store_dwordx4 v[96:99], v106, s[8:11], s75 offen sc1
buffer_store_dwordx4 v[100:103], v106, s[8:11], s75 offen offset:512 sc1
s_add_u32 s75, s75, 524288
s_add_u32 s73, s73, 32768
s_cmp_eq_u32 s73, 98304
s_cselect_b32 s73, 0, s73
v_add_u32 v6, s73, v104
s_add_u32 s74, s74, 1
s_cmp_lt_u32 s74, 32
s_cbranch_scc1 L_floop_221
s_waitcnt vmcnt(0)
s_barrier
s_cmp_lg_u32 s20, 0
s_cbranch_scc1 L_sf_232
v_mov_b32 v2, s74
v_mov_b32 v3, s46
v_mov_b32 v4, 0
s_mov_b64 exec, 1
buffer_store_dwordx2 v[2:3], v4, s[8:11], s42 offen sc1
s_mov_b64 exec, -1
L_sf_232:
L_tail:
s_barrier
s_load_dwordx2 s[22:23], s[0:1], 0
s_load_dwordx2 s[24:25], s[0:1], 40
s_load_dwordx4 s[28:31], s[0:1], 64
s_load_dwordx2 s[26:27], s[0:1], 96
v_and_b32 v3, 63, v0
s_mov_b32 s68, s21
s_waitcnt lgkmcnt(0)
s_cmp_eq_u32 s20, 1
s_cbranch_scc1 L_tw1
s_cmp_eq_u32 s20, 2
s_cbranch_scc1 L_tw2
s_cmp_eq_u32 s20, 3
s_cbranch_scc1 L_tw3
L_tw0:
v_lshlrev_b32 v2, 4, v3
v_lshlrev_b32 v13, 2, v3
v_and_b32 v140, 15, v3
v_lshrrev_b32 v141, 4, v3
v_lshrrev_b32 v142, 2, v140
v_and_b32 v143, 1, v140
v_lshl_add_u32 v142, v142, 1, v143
v_lshl_add_u32 v142, v141, 3, v142
v_lshlrev_b32 v4, 4, v142
v_lshlrev_b32 v142, 2, v141
v_sub_u32 v5, v140, v142
v_lshrrev_b32 v142, 1, v141
v_lshlrev_b32 v142, 6, v142
v_and_b32 v143, 1, v141
v_lshl_add_u32 v142, v143, 5, v142
v_add3_u32 v142, v142, v140, 0
v_lshlrev_b32 v142, 4, v142
v_add_u32 v6, 0, v142
v_lshrrev_b32 v142, 5, v3
v_lshlrev_b32 v142, 17, v142
v_and_b32 v143, 31, v3
v_lshl_add_u32 v7, v143, 2, v142
v_lshlrev_b32 v142, 10, v141
v_lshl_add_u32 v8, v140, 4, v142
v_lshrrev_b32 v142, 1, v141
v_lshlrev_b32 v142, 6, v142
v_and_b32 v143, 1, v140
v_lshl_add_u32 v142, v143, 5, v142
v_and_b32 v143, 1, v141
v_lshl_add_u32 v142, v143, 4, v142
v_lshrrev_b32 v143, 1, v140
v_add3_u32 v142, v142, v143, 0
v_add_u32 v142, 0, v142
v_lshlrev_b32 v142, 2, v142
v_add_u32 v142, 8192, v142
v_mov_b32 v9, 10240
v_cmp_gt_u32 vcc, 8, v140
s_nop 1
v_cndmask_b32 v9, v9, v142, vcc
v_add_u32 v142, 0, v3
v_lshlrev_b32 v10, 2, v142
v_lshrrev_b32 v143, 4, v142
v_lshlrev_b32 v143, 10, v143
v_bfe_u32 v144, v142, 2, 2
v_lshl_add_u32 v143, v144, 8, v143
v_and_b32 v144, 3, v142
v_lshl_add_u32 v143, v144, 2, v143
s_lshr_b32 s40, s68, 4
s_lshl_b32 s40, s40, 14
s_and_b32 s41, s68, 15
s_lshl_b32 s41, s41, 4
s_add_u32 s40, s40, s41
v_add_u32 v11, s40, v143
v_lshrrev_b32 v142, 1, v141
v_lshlrev_b32 v142, 5, v142
v_add_u32 v142, v142, v140
v_lshlrev_b32 v142, 4, v142
v_and_b32 v143, 1, v141
v_lshl_add_u32 v142, v143, 3, v142
v_add_u32 v12, 12288, v142
v_and_b32 v142, 1, v140
v_lshlrev_b32 v142, 4, v142
v_mov_b32 v143, 0x3f80
v_lshlrev_b32 v143, v142, v143
v_lshrrev_b32 v142, 1, v140
v_cmp_eq_u32 vcc, 0, v142
s_nop 1
v_cndmask_b32 v16, 0, v143, vcc
v_cmp_eq_u32 vcc, 1, v142
s_nop 1
v_cndmask_b32 v17, 0, v143, vcc
v_cmp_eq_u32 vcc, 2, v142
s_nop 1
v_cndmask_b32 v18, 0, v143, vcc
v_cmp_eq_u32 vcc, 3, v142
s_nop 1
v_cndmask_b32 v19, 0, v143, vcc
v_mov_b32 v20, 0
v_mov_b32 v21, 0
v_mov_b32 v22, 0
v_mov_b32 v23, 0
v_mov_b32 v24, 0
v_mov_b32 v25, 0
v_mov_b32 v26, 0
v_mov_b32 v27, 0
v_mov_b32 v28, 0
v_mov_b32 v29, 0
v_mov_b32 v30, 0
v_mov_b32 v31, 0
v_mov_b32 v32, 0
v_mov_b32 v33, 0
v_mov_b32 v34, 0
v_mov_b32 v35, 0
v_mov_b32 v36, 0x3f803f80
v_mov_b32 v37, 0x3f803f80
v_mov_b32 v38, 0x3f803f80
v_mov_b32 v39, 0x3f803f80
v_mov_b32 v132, 0
v_mov_b32 v133, 0
v_mov_b32 v134, 0
v_mov_b32 v135, 0
v_mov_b32 v136, 0
v_mov_b32 v137, 0
v_mov_b32 v138, 0
v_mov_b32 v139, 0
s_mov_b32 s48, 0
s_mov_b32 s49, 32768
s_mov_b32 s50, 65536
s_mov_b32 s51, 98304
s_mov_b32 s52, 262144
s_mov_b32 s53, 294912
s_mov_b32 s54, 327680
s_mov_b32 s55, 360448
s_mov_b32 s56, 524288
s_mov_b32 s57, 557056
s_mov_b32 s58, 589824
s_mov_b32 s59, 622592
s_mov_b32 s60, 786432
s_mov_b32 s61, 819200
s_mov_b32 s62, 851968
s_mov_b32 s63, 884736
s_mov_b32 s64, 0x3e0293ee
s_mov_b32 s65, 0xbe0293ee
s_mul_i32 s38, s33, 0x400000
s_add_u32 s38, s38, 0x4000000
s_lshl_b32 s39, s33, 10
s_add_u32 s39, s39, 0x11000
v_lshlrev_b32 v142, 10, v141
v_lshl_add_u32 v142, v140, 4, v142
s_mov_b32 s12, s24
s_mov_b32 s13, s25
s_mov_b32 s14, 0x400000
s_mov_b32 s15, 0x00020000
s_lshl_b32 s40, s68, 17
s_add_u32 s40, s40, 0
v_add_u32 v146, s40, v142
s_mov_b32 m0, 0
s_mov_b32 s41, 0
buffer_load_dwordx4 v146, s[12:15], s41 offen lds
s_mov_b32 m0, 1024
s_mov_b32 s41, 4096
buffer_load_dwordx4 v146, s[12:15], s41 offen lds
s_mov_b32 m0, 2048
s_mov_b32 s41, 8192
buffer_load_dwordx4 v146, s[12:15], s41 offen lds
s_mov_b32 m0, 3072
s_mov_b32 s41, 12288
buffer_load_dwordx4 v146, s[12:15], s41 offen lds
s_mov_b32 m0, 4096
s_mov_b32 s41, 16384
buffer_load_dwordx4 v146, s[12:15], s41 offen lds
s_mov_b32 m0, 5120
s_mov_b32 s41, 20480
buffer_load_dwordx4 v146, s[12:15], s41 offen lds
s_mov_b32 m0, 6144
s_mov_b32 s41, 24576
buffer_load_dwordx4 v146, s[12:15], s41 offen lds
s_mov_b32 m0, 7168
s_mov_b32 s41, 28672
buffer_load_dwordx4 v146, s[12:15], s41 offen lds
s_mov_b32 m0, 8192
s_mov_b32 s41, 32768
buffer_load_dwordx4 v146, s[12:15], s41 offen lds
s_mov_b32 m0, 9216
s_mov_b32 s41, 36864
buffer_load_dwordx4 v146, s[12:15], s41 offen lds
s_mov_b32 m0, 10240
s_mov_b32 s41, 40960
buffer_load_dwordx4 v146, s[12:15], s41 offen lds
s_mov_b32 m0, 11264
s_mov_b32 s41, 45056
buffer_load_dwordx4 v146, s[12:15], s41 offen lds
s_mov_b32 m0, 12288
s_mov_b32 s41, 49152
buffer_load_dwordx4 v146, s[12:15], s41 offen lds
s_mov_b32 m0, 13312
s_mov_b32 s41, 53248
buffer_load_dwordx4 v146, s[12:15], s41 offen lds
s_mov_b32 m0, 14336
s_mov_b32 s41, 57344
buffer_load_dwordx4 v146, s[12:15], s41 offen lds
s_mov_b32 m0, 15360
s_mov_b32 s41, 61440
buffer_load_dwordx4 v146, s[12:15], s41 offen lds
s_mov_b32 m0, 16384
s_mov_b32 s41, 65536
buffer_load_dwordx4 v146, s[12:15], s41 offen lds
s_mov_b32 m0, 17408
s_mov_b32 s41, 69632
buffer_load_dwordx4 v146, s[12:15], s41 offen lds
s_mov_b32 m0, 18432
s_mov_b32 s41, 73728
buffer_load_dwordx4 v146, s[12:15], s41 offen lds
s_mov_b32 m0, 19456
s_mov_b32 s41, 77824
buffer_load_dwordx4 v146, s[12:15], s41 offen lds
s_mov_b32 m0, 20480
s_mov_b32 s41, 81920
buffer_load_dwordx4 v146, s[12:15], s41 offen lds
s_mov_b32 m0, 21504
s_mov_b32 s41, 86016
buffer_load_dwordx4 v146, s[12:15], s41 offen lds
s_mov_b32 m0, 22528
s_mov_b32 s41, 90112
buffer_load_dwordx4 v146, s[12:15], s41 offen lds
s_mov_b32 m0, 23552
s_mov_b32 s41, 94208
buffer_load_dwordx4 v146, s[12:15], s41 offen lds
s_mov_b32 m0, 24576
s_mov_b32 s41, 98304
buffer_load_dwordx4 v146, s[12:15], s41 offen lds
s_mov_b32 m0, 25600
s_mov_b32 s41, 102400
buffer_load_dwordx4 v146, s[12:15], s41 offen lds
s_mov_b32 m0, 26624
s_mov_b32 s41, 106496
buffer_load_dwordx4 v146, s[12:15], s41 offen lds
s_mov_b32 m0, 27648
s_mov_b32 s41, 110592
buffer_load_dwordx4 v146, s[12:15], s41 offen lds
s_mov_b32 m0, 28672
s_mov_b32 s41, 114688
buffer_load_dwordx4 v146, s[12:15], s41 offen lds
s_mov_b32 m0, 29696
s_mov_b32 s41, 118784
buffer_load_dwordx4 v146, s[12:15], s41 offen lds
s_mov_b32 m0, 30720
s_mov_b32 s41, 122880
buffer_load_dwordx4 v146, s[12:15], s41 offen lds
s_mov_b32 m0, 31744
s_mov_b32 s41, 126976
buffer_load_dwordx4 v146, s[12:15], s41 offen lds
v_bfe_u32 v143, v3, 2, 2
v_lshrrev_b32 v144, 5, v3
v_bfe_u32 v145, v3, 4, 1
v_lshlrev_b32 v145, 5, v145
v_and_b32 v148, 3, v3
v_lshl_add_u32 v145, v148, 3, v145
v_lshl_add_u32 v148, v144, 2, v143
v_lshl_add_u32 v148, v148, 8, v145
v_add_u32 v147, 0, v148
v_lshl_add_u32 v148, v144, 3, v143
v_lshl_add_u32 v148, v148, 8, v145
v_add_u32 v149, 0, v148
s_waitcnt vmcnt(0)
ds_read_b64_tr_b16 a[0:1], v147 offset:0
ds_read_b64_tr_b16 a[2:3], v147 offset:4096
ds_read_b64_tr_b16 a[4:5], v147 offset:2048
ds_read_b64_tr_b16 a[6:7], v147 offset:6144
ds_read_b64_tr_b16 a[8:9], v147 offset:8192
ds_read_b64_tr_b16 a[10:11], v147 offset:12288
ds_read_b64_tr_b16 a[12:13], v147 offset:10240
ds_read_b64_tr_b16 a[14:15], v147 offset:14336
ds_read_b64_tr_b16 a[16:17], v147 offset:16384
ds_read_b64_tr_b16 a[18:19], v147 offset:20480
ds_read_b64_tr_b16 a[20:21], v147 offset:18432
ds_read_b64_tr_b16 a[22:23], v147 offset:22528
ds_read_b64_tr_b16 a[24:25], v147 offset:24576
ds_read_b64_tr_b16 a[26:27], v147 offset:28672
ds_read_b64_tr_b16 a[28:29], v147 offset:26624
ds_read_b64_tr_b16 a[30:31], v147 offset:30720
ds_read_b64_tr_b16 a[32:33], v147 offset:64
ds_read_b64_tr_b16 a[34:35], v147 offset:4160
ds_read_b64_tr_b16 a[36:37], v147 offset:2112
ds_read_b64_tr_b16 a[38:39], v147 offset:6208
ds_read_b64_tr_b16 a[40:41], v147 offset:8256
ds_read_b64_tr_b16 a[42:43], v147 offset:12352
ds_read_b64_tr_b16 a[44:45], v147 offset:10304
ds_read_b64_tr_b16 a[46:47], v147 offset:14400
ds_read_b64_tr_b16 a[48:49], v147 offset:16448
ds_read_b64_tr_b16 a[50:51], v147 offset:20544
ds_read_b64_tr_b16 a[52:53], v147 offset:18496
ds_read_b64_tr_b16 a[54:55], v147 offset:22592
ds_read_b64_tr_b16 a[56:57], v147 offset:24640
ds_read_b64_tr_b16 a[58:59], v147 offset:28736
ds_read_b64_tr_b16 a[60:61], v147 offset:26688
ds_read_b64_tr_b16 a[62:63], v147 offset:30784
ds_read_b64_tr_b16 a[64:65], v147 offset:128
ds_read_b64_tr_b16 a[66:67], v147 offset:4224
ds_read_b64_tr_b16 a[68:69], v147 offset:2176
ds_read_b64_tr_b16 a[70:71], v147 offset:6272
ds_read_b64_tr_b16 a[72:73], v147 offset:8320
ds_read_b64_tr_b16 a[74:75], v147 offset:12416
ds_read_b64_tr_b16 a[76:77], v147 offset:10368
ds_read_b64_tr_b16 a[78:79], v147 offset:14464
ds_read_b64_tr_b16 a[80:81], v147 offset:16512
ds_read_b64_tr_b16 a[82:83], v147 offset:20608
ds_read_b64_tr_b16 a[84:85], v147 offset:18560
ds_read_b64_tr_b16 a[86:87], v147 offset:22656
ds_read_b64_tr_b16 a[88:89], v147 offset:24704
ds_read_b64_tr_b16 a[90:91], v147 offset:28800
ds_read_b64_tr_b16 a[92:93], v147 offset:26752
ds_read_b64_tr_b16 a[94:95], v147 offset:30848
ds_read_b64_tr_b16 a[96:97], v147 offset:192
ds_read_b64_tr_b16 a[98:99], v147 offset:4288
ds_read_b64_tr_b16 a[100:101], v147 offset:2240
ds_read_b64_tr_b16 a[102:103], v147 offset:6336
ds_read_b64_tr_b16 a[104:105], v147 offset:8384
ds_read_b64_tr_b16 a[106:107], v147 offset:12480
ds_read_b64_tr_b16 a[108:109], v147 offset:10432
ds_read_b64_tr_b16 a[110:111], v147 offset:14528
ds_read_b64_tr_b16 a[112:113], v147 offset:16576
ds_read_b64_tr_b16 a[114:115], v147 offset:20672
ds_read_b64_tr_b16 a[116:117], v147 offset:18624
ds_read_b64_tr_b16 a[118:119], v147 offset:22720
ds_read_b64_tr_b16 a[120:121], v147 offset:24768
ds_read_b64_tr_b16 a[122:123], v147 offset:28864
ds_read_b64_tr_b16 a[124:125], v147 offset:26816
ds_read_b64_tr_b16 a[126:127], v147 offset:30912
s_waitcnt lgkmcnt(0)
s_mov_b32 s12, s30
s_mov_b32 s13, s31
s_mov_b32 s14, 0x158000
s_mov_b32 s15, 0x00020000
s_mul_i32 s40, s68, 49152
s_add_u32 s40, s40, 0
v_add_u32 v146, s40, v142
s_mov_b32 m0, 0
s_mov_b32 s41, 0
buffer_load_dwordx4 v146, s[12:15], s41 offen lds
s_mov_b32 m0, 1024
s_mov_b32 s41, 4096
buffer_load_dwordx4 v146, s[12:15], s41 offen lds
s_mov_b32 m0, 2048
s_mov_b32 s41, 8192
buffer_load_dwordx4 v146, s[12:15], s41 offen lds
s_mov_b32 m0, 3072
s_mov_b32 s41, 12288
buffer_load_dwordx4 v146, s[12:15], s41 offen lds
s_mov_b32 m0, 4096
s_mov_b32 s41, 16384
buffer_load_dwordx4 v146, s[12:15], s41 offen lds
s_mov_b32 m0, 5120
s_mov_b32 s41, 20480
buffer_load_dwordx4 v146, s[12:15], s41 offen lds
s_mov_b32 m0, 6144
s_mov_b32 s41, 24576
buffer_load_dwordx4 v146, s[12:15], s41 offen lds
s_mov_b32 m0, 7168
s_mov_b32 s41, 28672
buffer_load_dwordx4 v146, s[12:15], s41 offen lds
s_mov_b32 m0, 8192
s_mov_b32 s41, 32768
buffer_load_dwordx4 v146, s[12:15], s41 offen lds
s_mov_b32 m0, 9216
s_mov_b32 s41, 36864
buffer_load_dwordx4 v146, s[12:15], s41 offen lds
s_mov_b32 m0, 10240
s_mov_b32 s41, 40960
buffer_load_dwordx4 v146, s[12:15], s41 offen lds
s_mov_b32 m0, 11264
s_mov_b32 s41, 45056
buffer_load_dwordx4 v146, s[12:15], s41 offen lds
v_lshrrev_b32 v150, 1, v3
v_mul_u32_u24 v150, 2752, v150
v_and_b32 v151, 1, v3
s_mul_i32 s40, s68, 48
s_add_u32 s40, s40, 0
v_lshl_add_u32 v151, v151, 3, s40
v_lshl_add_u32 v150, v151, 1, v150
v_mov_b32 v152, 0x40000000
v_cmp_gt_u32 vcc, 1376, v151
s_nop 1
v_cndmask_b32 v150, v152, v150, vcc
s_waitcnt vmcnt(0)
ds_read_b64_tr_b16 a[128:129], v149 offset:0
ds_read_b64_tr_b16 a[130:131], v149 offset:1024
ds_read_b64_tr_b16 a[132:133], v149 offset:4096
ds_read_b64_tr_b16 a[134:135], v149 offset:5120
ds_read_b64_tr_b16 a[136:137], v149 offset:8192
ds_read_b64_tr_b16 a[138:139], v149 offset:9216
ds_read_b64_tr_b16 a[140:141], v149 offset:64
ds_read_b64_tr_b16 a[142:143], v149 offset:1088
ds_read_b64_tr_b16 a[144:145], v149 offset:4160
ds_read_b64_tr_b16 a[146:147], v149 offset:5184
ds_read_b64_tr_b16 a[148:149], v149 offset:8256
ds_read_b64_tr_b16 a[150:151], v149 offset:9280
ds_read_b64_tr_b16 a[152:153], v149 offset:128
ds_read_b64_tr_b16 a[154:155], v149 offset:1152
ds_read_b64_tr_b16 a[156:157], v149 offset:4224
ds_read_b64_tr_b16 a[158:159], v149 offset:5248
ds_read_b64_tr_b16 a[160:161], v149 offset:8320
ds_read_b64_tr_b16 a[162:163], v149 offset:9344
ds_read_b64_tr_b16 a[164:165], v149 offset:192
ds_read_b64_tr_b16 a[166:167], v149 offset:1216
ds_read_b64_tr_b16 a[168:169], v149 offset:4288
ds_read_b64_tr_b16 a[170:171], v149 offset:5312
ds_read_b64_tr_b16 a[172:173], v149 offset:8384
ds_read_b64_tr_b16 a[174:175], v149 offset:9408
s_waitcnt lgkmcnt(0)
s_mov_b32 s12, s28
s_mov_b32 s13, s29
s_mov_b32 s14, 0x158000
s_mov_b32 s15, 0x00020000
s_mov_b32 m0, 0
s_mov_b32 s41, 0
buffer_load_dwordx4 v150, s[12:15], s41 offen lds
s_mov_b32 m0, 1024
s_mov_b32 s41, 88064
buffer_load_dwordx4 v150, s[12:15], s41 offen lds
s_mov_b32 m0, 2048
s_mov_b32 s41, 176128
buffer_load_dwordx4 v150, s[12:15], s41 offen lds
s_mov_b32 m0, 3072
s_mov_b32 s41, 264192
buffer_load_dwordx4 v150, s[12:15], s41 offen lds
s_mov_b32 m0, 4096
s_mov_b32 s41, 352256
buffer_load_dwordx4 v150, s[12:15], s41 offen lds
s_mov_b32 m0, 5120
s_mov_b32 s41, 440320
buffer_load_dwordx4 v150, s[12:15], s41 offen lds
s_mov_b32 m0, 6144
s_mov_b32 s41, 528384
buffer_load_dwordx4 v150, s[12:15], s41 offen lds
s_mov_b32 m0, 7168
s_mov_b32 s41, 616448
buffer_load_dwordx4 v150, s[12:15], s41 offen lds
s_mov_b32 m0, 8192
s_mov_b32 s41, 704512
buffer_load_dwordx4 v150, s[12:15], s41 offen lds
s_mov_b32 m0, 9216
s_mov_b32 s41, 792576
buffer_load_dwordx4 v150, s[12:15], s41 offen lds
s_mov_b32 m0, 10240
s_mov_b32 s41, 880640
buffer_load_dwordx4 v150, s[12:15], s41 offen lds
s_mov_b32 m0, 11264
s_mov_b32 s41, 968704
buffer_load_dwordx4 v150, s[12:15], s41 offen lds
s_mov_b32 m0, 12288
s_mov_b32 s41, 1056768
buffer_load_dwordx4 v150, s[12:15], s41 offen lds
s_mov_b32 m0, 13312
s_mov_b32 s41, 1144832
buffer_load_dwordx4 v150, s[12:15], s41 offen lds
s_mov_b32 m0, 14336
s_mov_b32 s41, 1232896
buffer_load_dwordx4 v150, s[12:15], s41 offen lds
s_mov_b32 m0, 15360
s_mov_b32 s41, 1320960
buffer_load_dwordx4 v150, s[12:15], s41 offen lds
v_lshl_add_u32 v151, v141, 3, v143
v_lshlrev_b32 v151, 5, v151
v_and_b32 v152, 3, v3
v_lshl_add_u32 v151, v152, 3, v151
v_add_u32 v151, 0, v151
s_waitcnt vmcnt(0)
ds_read_b64_tr_b16 a[176:177], v151 offset:0
ds_read_b64_tr_b16 a[178:179], v151 offset:128
ds_read_b64_tr_b16 a[180:181], v151 offset:1024
ds_read_b64_tr_b16 a[182:183], v151 offset:1152
ds_read_b64_tr_b16 a[184:185], v151 offset:2048
ds_read_b64_tr_b16 a[186:187], v151 offset:2176
ds_read_b64_tr_b16 a[188:189], v151 offset:3072
ds_read_b64_tr_b16 a[190:191], v151 offset:3200
ds_read_b64_tr_b16 a[192:193], v151 offset:4096
ds_read_b64_tr_b16 a[194:195], v151 offset:4224
ds_read_b64_tr_b16 a[196:197], v151 offset:5120
ds_read_b64_tr_b16 a[198:199], v151 offset:5248
ds_read_b64_tr_b16 a[200:201], v151 offset:6144
ds_read_b64_tr_b16 a[202:203], v151 offset:6272
ds_read_b64_tr_b16 a[204:205], v151 offset:7168
ds_read_b64_tr_b16 a[206:207], v151 offset:7296
ds_read_b64_tr_b16 a[208:209], v151 offset:8192
ds_read_b64_tr_b16 a[210:211], v151 offset:8320
ds_read_b64_tr_b16 a[212:213], v151 offset:9216
ds_read_b64_tr_b16 a[214:215], v151 offset:9344
ds_read_b64_tr_b16 a[216:217], v151 offset:10240
ds_read_b64_tr_b16 a[218:219], v151 offset:10368
ds_read_b64_tr_b16 a[220:221], v151 offset:11264
ds_read_b64_tr_b16 a[222:223], v151 offset:11392
ds_read_b64_tr_b16 a[224:225], v151 offset:12288
ds_read_b64_tr_b16 a[226:227], v151 offset:12416
ds_read_b64_tr_b16 a[228:229], v151 offset:13312
ds_read_b64_tr_b16 a[230:231], v151 offset:13440
ds_read_b64_tr_b16 a[232:233], v151 offset:14336
ds_read_b64_tr_b16 a[234:235], v151 offset:14464
ds_read_b64_tr_b16 a[236:237], v151 offset:15360
ds_read_b64_tr_b16 a[238:239], v151 offset:15488
s_waitcnt lgkmcnt(0)
s_barrier
s_sub_u32 s36, s33, 1
s_mov_b32 s37, 0
s_cmp_lg_u32 s32, 0
s_cbranch_scc1 L_tslow0
s_mov_b32 s12, s22
s_mov_b32 s13, s23
s_mov_b32 s14, 0x200000
s_mov_b32 s15, 0x00020000
s_mov_b32 s4, s26
s_mov_b32 s5, s27
s_mov_b32 s6, 0x200000
s_mov_b32 s7, 0x00020000
s_mov_b32 s40, 0x10000
v_mov_b32 v142, 1
v_cmp_gt_u32 vcc, 48, v3
s_nop 1
v_cndmask_b32 v142, 0, v142, vcc
v_lshlrev_b32 v143, 1, v13
s_mov_b32 s42, 300000
L_pl_233:
buffer_load_dwordx2 v[140:141], v143, s[8:11], s40 offen sc1
s_sub_u32 s42, s42, 1
s_cmp_eq_u32 s42, 0
s_cbranch_scc1 L_abort
s_waitcnt vmcnt(0)
v_cmp_eq_u32 vcc, s46, v141
s_nop 1
v_cndmask_b32 v140, 0, v140, vcc
v_cmp_gt_u32 vcc, v142, v140
s_cbranch_vccz L_plx_234
s_sleep 2
s_branch L_pl_233
L_plx_234:
s_barrier
v_lshlrev_b32 v140, 1, v10
s_mov_b32 s40, 0x1000
buffer_load_dwordx2 a[240:241], v140, s[8:11], s40 offen sc1
s_mov_b32 s40, 0x1800
buffer_load_dwordx2 a[242:243], v140, s[8:11], s40 offen sc1
s_mov_b32 s40, 0x2000
buffer_load_dwordx2 a[244:245], v140, s[8:11], s40 offen sc1
s_mov_b32 s40, 0x2800
buffer_load_dwordx2 a[246:247], v140, s[8:11], s40 offen sc1
s_waitcnt vmcnt(0)
L_tail_w0_f:
s_cmp_ge_u32 s36, 64
s_cbranch_scc1 L_tailend_w0_f
s_lshl_b32 s40, s68, 6
s_add_u32 s40, s40, 0x10400
v_lshlrev_b32 v143, 1, v13
v_and_b32 v143, 63, v143
s_lshr_b32 s41, s36, 1
s_add_u32 s41, s41, 1
s_and_b32 s43, s36, 1
v_and_b32 v144, 1, v3
v_mov_b32 v142, s41
v_cmp_eq_u32 vcc, s43, v144
s_nop 1
v_cndmask_b32 v142, 0, v142, vcc
v_cmp_gt_u32 vcc, 6, v3
s_nop 1
v_cndmask_b32 v142, 0, v142, vcc
s_mov_b32 s42, 300000
L_pl_235:
buffer_load_dwordx2 v[140:141], v143, s[8:11], s40 offen sc1
s_sub_u32 s42, s42, 1
s_cmp_eq_u32 s42, 0
s_cbranch_scc1 L_abort
s_waitcnt vmcnt(0)
v_cmp_eq_u32 vcc, s46, v141
s_nop 1
v_cndmask_b32 v140, 0, v140, vcc
v_cmp_gt_u32 vcc, v142, v140
s_cbranch_vccz L_plx_236
s_sleep 4
s_branch L_pl_235
L_plx_236:
s_barrier
s_lshl_b32 s40, s36, 5
s_add_u32 s40, s40, s68
s_lshl_b32 s66, s40, 13
s_lshl_b32 s67, s40, 11
s_add_u32 s41, s66, 0x2800000
buffer_load_dwordx4 v[40:43], v2, s[8:11], s41 offen offset:0 sc1
buffer_load_dwordx4 v[44:47], v2, s[8:11], s41 offen offset:1024 sc1
buffer_load_dwordx4 v[48:51], v2, s[8:11], s41 offen offset:2048 sc1
buffer_load_dwordx4 v[52:55], v2, s[8:11], s41 offen offset:3072 sc1
s_add_u32 s41, s66, 0x800000
buffer_load_dwordx4 v[72:75], v2, s[8:11], s41 offen offset:0 sc1
buffer_load_dwordx4 v[76:79], v2, s[8:11], s41 offen offset:1024 sc1
buffer_load_dwordx4 v[80:83], v2, s[8:11], s41 offen offset:2048 sc1
buffer_load_dwordx4 v[84:87], v2, s[8:11], s41 offen offset:3072 sc1
s_add_u32 s41, s66, 0x1800000
buffer_load_dwordx4 v[104:107], v2, s[8:11], s41 offen offset:0 sc1
buffer_load_dwordx4 v[108:111], v2, s[8:11], s41 offen offset:1024 sc1
buffer_load_dwordx4 v[112:115], v2, s[8:11], s41 offen offset:2048 sc1
buffer_load_dwordx4 v[116:119], v2, s[8:11], s41 offen offset:3072 sc1
s_lshl_b32 s41, s40, 10
buffer_load_dword v152, v10, s[12:15], s41 offen
s_lshl_b32 s40, s68, 6
s_add_u32 s40, s40, 0x10400
v_lshlrev_b32 v143, 1, v13
v_and_b32 v143, 63, v143
s_add_u32 s44, s36, 1
v_mov_b32 v142, s44
v_cmp_eq_u32 vcc, 6, v3
s_nop 1
v_cndmask_b32 v142, 0, v142, vcc
s_mov_b32 s42, 300000
L_pl_237:
buffer_load_dwordx2 v[140:141], v143, s[8:11], s40 offen sc1
s_sub_u32 s42, s42, 1
s_cmp_eq_u32 s42, 0
s_cbranch_scc1 L_abort
s_waitcnt vmcnt(0)
v_cmp_eq_u32 vcc, s46, v141
s_nop 1
v_cndmask_b32 v140, 0, v140, vcc
v_cmp_gt_u32 vcc, v142, v140
s_cbranch_vccz L_plx_238
s_sleep 1
s_branch L_pl_237
L_plx_238:
s_barrier
s_add_u32 s42, s67, 0x3800000
buffer_load_dwordx4 v[56:59], v4, s[8:11], s42 offen offset:0 sc1
buffer_load_dwordx4 v[60:63], v4, s[8:11], s42 offen offset:512 sc1
buffer_load_dwordx4 v[64:67], v4, s[8:11], s42 offen offset:1024 sc1
buffer_load_dwordx4 v[68:71], v4, s[8:11], s42 offen offset:1536 sc1
s_add_u32 s42, s67, 0x3c00000
buffer_load_dword v20, v13, s[8:11], s42 offen offset:0 sc1
buffer_load_dword v24, v13, s[8:11], s42 offen offset:256 sc1
buffer_load_dword v28, v13, s[8:11], s42 offen offset:512 sc1
buffer_load_dword v32, v13, s[8:11], s42 offen offset:768 sc1
s_waitcnt vmcnt(0)
v_mfma_f32_16x16x32_bf16 v[120:123], v[56:59], v[40:43], 0
v_mfma_f32_16x16x32_bf16 v[124:127], v[72:75], v[40:43], 0
v_mfma_f32_16x16x32_bf16 v[120:123], v[60:63], v[44:47], v[120:123]
v_mfma_f32_16x16x32_bf16 v[124:127], v[76:79], v[44:47], v[124:127]
v_mfma_f32_16x16x32_bf16 v[120:123], v[64:67], v[48:51], v[120:123]
v_mfma_f32_16x16x32_bf16 v[124:127], v[80:83], v[48:51], v[124:127]
v_mfma_f32_16x16x32_bf16 v[120:123], v[68:71], v[52:55], v[120:123]
v_mfma_f32_16x16x32_bf16 v[124:127], v[84:87], v[52:55], v[124:127]
v_mov_b32 v140, 0xff800000
v_cmp_le_i32 vcc, 0, v5
s_nop 5
v_cndmask_b32 v124, v140, v124, vcc
v_cmp_le_i32 vcc, 1, v5
s_nop 1
v_cndmask_b32 v125, v140, v125, vcc
v_cmp_le_i32 vcc, 2, v5
s_nop 1
v_cndmask_b32 v126, v140, v126, vcc
v_cmp_le_i32 vcc, 3, v5
s_nop 1
v_cndmask_b32 v127, v140, v127, vcc
v_max3_f32 v141, v120, v121, v124
v_max3_f32 v141, v141, v125, v126
v_max_f32 v141, v141, v127
v_mov_b32 v142, v141
s_nop 1
v_permlane32_swap_b32 v141, v142
v_max_f32 v141, v141, v142
v_mov_b32 v142, v141
s_nop 1
v_permlane16_swap_b32 v141, v142
v_max_f32 v141, v141, v142
v_mul_f32 v143, s65, v141
v_fma_f32 v120, v120, s64, v143
v_fma_f32 v121, v121, s64, v143
v_fma_f32 v124, v124, s64, v143
v_fma_f32 v125, v125, s64, v143
v_fma_f32 v126, v126, s64, v143
v_fma_f32 v127, v127, s64, v143
v_exp_f32 v120, v120
v_exp_f32 v121, v121
v_exp_f32 v124, v124
v_exp_f32 v125, v125
v_exp_f32 v126, v126
v_exp_f32 v127, v127
v_cvt_pk_bf16_f32 v132, v124, v125
v_cvt_pk_bf16_f32 v133, v126, v127
v_cvt_pk_bf16_f32 v136, v120, v121
s_nop 0
v_mfma_f32_16x16x32_bf16 v[176:179], v[36:39], v[132:135], 0
v_mfma_f32_16x16x32_bf16 v[176:179], v[36:39], v[136:139], v[176:179]
v_mfma_f32_16x16x32_bf16 v[160:163], v[104:107], v[132:135], 0
v_mfma_f32_16x16x32_bf16 v[164:167], v[108:111], v[132:135], 0
v_mfma_f32_16x16x32_bf16 v[168:171], v[112:115], v[132:135], 0
v_mfma_f32_16x16x32_bf16 v[172:175], v[116:119], v[132:135], 0
v_mfma_f32_16x16x32_bf16 v[160:163], v[20:23], v[136:139], v[160:163]
v_mfma_f32_16x16x32_bf16 v[164:167], v[24:27], v[136:139], v[164:167]
v_mfma_f32_16x16x32_bf16 v[168:171], v[28:31], v[136:139], v[168:171]
v_mfma_f32_16x16x32_bf16 v[172:175], v[32:35], v[136:139], v[172:175]
v_rcp_f32 v142, v176
s_nop 3
v_mul_f32 v160, v160, v142
v_mul_f32 v161, v161, v142
v_mul_f32 v162, v162, v142
v_mul_f32 v163, v163, v142
v_mul_f32 v164, v164, v142
v_mul_f32 v165, v165, v142
v_mul_f32 v166, v166, v142
v_mul_f32 v167, v167, v142
v_mul_f32 v168, v168, v142
v_mul_f32 v169, v169, v142
v_mul_f32 v170, v170, v142
v_mul_f32 v171, v171, v142
v_mul_f32 v172, v172, v142
v_mul_f32 v173, v173, v142
v_mul_f32 v174, v174, v142
v_mul_f32 v175, v175, v142
v_cvt_pk_bf16_f32 v40, v160, v161
v_cvt_pk_bf16_f32 v41, v162, v163
v_cvt_pk_bf16_f32 v42, v164, v165
v_cvt_pk_bf16_f32 v43, v166, v167
ds_write_b128 v6, v[40:43] offset:0
v_cvt_pk_bf16_f32 v44, v168, v169
v_cvt_pk_bf16_f32 v45, v170, v171
v_cvt_pk_bf16_f32 v46, v172, v173
v_cvt_pk_bf16_f32 v47, v174, v175
ds_write_b128 v6, v[44:47] offset:2048
s_waitcnt lgkmcnt(0)
s_barrier
ds_read_b128 v[40:43], v2 offset:0
ds_read_b128 v[44:47], v2 offset:1024
ds_read_b128 v[48:51], v2 offset:2048
ds_read_b128 v[52:55], v2 offset:3072
ds_read_b128 v[56:59], v2 offset:4096
ds_read_b128 v[60:63], v2 offset:5120
ds_read_b128 v[64:67], v2 offset:6144
ds_read_b128 v[68:71], v2 offset:7168
s_waitcnt lgkmcnt(7)
v_mfma_f32_32x32x16_bf16 v[192:207], v[40:43], a[0:3], 0
v_mfma_f32_32x32x16_bf16 v[208:223], v[40:43], a[32:35], 0
v_mfma_f32_32x32x16_bf16 v[224:239], v[40:43], a[64:67], 0
v_mfma_f32_32x32x16_bf16 v[240:255], v[40:43], a[96:99], 0
s_waitcnt lgkmcnt(6)
v_mfma_f32_32x32x16_bf16 v[192:207], v[44:47], a[4:7], v[192:207]
v_mfma_f32_32x32x16_bf16 v[208:223], v[44:47], a[36:39], v[208:223]
v_mfma_f32_32x32x16_bf16 v[224:239], v[44:47], a[68:71], v[224:239]
v_mfma_f32_32x32x16_bf16 v[240:255], v[44:47], a[100:103], v[240:255]
s_waitcnt lgkmcnt(5)
v_mfma_f32_32x32x16_bf16 v[192:207], v[48:51], a[8:11], v[192:207]
v_mfma_f32_32x32x16_bf16 v[208:223], v[48:51], a[40:43], v[208:223]
v_mfma_f32_32x32x16_bf16 v[224:239], v[48:51], a[72:75], v[224:239]
v_mfma_f32_32x32x16_bf16 v[240:255], v[48:51], a[104:107], v[240:255]
s_waitcnt lgkmcnt(4)
v_mfma_f32_32x32x16_bf16 v[192:207], v[52:55], a[12:15], v[192:207]
v_mfma_f32_32x32x16_bf16 v[208:223], v[52:55], a[44:47], v[208:223]
v_mfma_f32_32x32x16_bf16 v[224:239], v[52:55], a[76:79], v[224:239]
v_mfma_f32_32x32x16_bf16 v[240:255], v[52:55], a[108:111], v[240:255]
s_waitcnt lgkmcnt(3)
v_mfma_f32_32x32x16_bf16 v[192:207], v[56:59], a[16:19], v[192:207]
v_mfma_f32_32x32x16_bf16 v[208:223], v[56:59], a[48:51], v[208:223]
v_mfma_f32_32x32x16_bf16 v[224:239], v[56:59], a[80:83], v[224:239]
v_mfma_f32_32x32x16_bf16 v[240:255], v[56:59], a[112:115], v[240:255]
s_waitcnt lgkmcnt(2)
v_mfma_f32_32x32x16_bf16 v[192:207], v[60:63], a[20:23], v[192:207]
v_mfma_f32_32x32x16_bf16 v[208:223], v[60:63], a[52:55], v[208:223]
v_mfma_f32_32x32x16_bf16 v[224:239], v[60:63], a[84:87], v[224:239]
v_mfma_f32_32x32x16_bf16 v[240:255], v[60:63], a[116:119], v[240:255]
s_waitcnt lgkmcnt(1)
v_mfma_f32_32x32x16_bf16 v[192:207], v[64:67], a[24:27], v[192:207]
v_mfma_f32_32x32x16_bf16 v[208:223], v[64:67], a[56:59], v[208:223]
v_mfma_f32_32x32x16_bf16 v[224:239], v[64:67], a[88:91], v[224:239]
v_mfma_f32_32x32x16_bf16 v[240:255], v[64:67], a[120:123], v[240:255]
s_waitcnt lgkmcnt(0)
v_mfma_f32_32x32x16_bf16 v[192:207], v[68:71], a[28:31], v[192:207]
v_mfma_f32_32x32x16_bf16 v[208:223], v[68:71], a[60:63], v[208:223]
v_mfma_f32_32x32x16_bf16 v[224:239], v[68:71], a[92:95], v[224:239]
v_mfma_f32_32x32x16_bf16 v[240:255], v[68:71], a[124:127], v[240:255]
s_lshl_b32 s40, s68, 10
s_add_u32 s40, s40, s38
s_add_u32 s40, s40, 0x0
s_nop 6
v_cvt_pk_bf16_f32 v40, v192, v208
s_add_u32 s41, s40, s48
buffer_store_dword v40, v7, s[8:11], s41 offen offset:0 nt
v_cvt_pk_bf16_f32 v41, v193, v209
s_add_u32 s42, s40, s49
buffer_store_dword v41, v7, s[8:11], s42 offen offset:0 nt
v_cvt_pk_bf16_f32 v42, v194, v210
s_add_u32 s41, s40, s50
buffer_store_dword v42, v7, s[8:11], s41 offen offset:0 nt
v_cvt_pk_bf16_f32 v43, v195, v211
s_add_u32 s42, s40, s51
buffer_store_dword v43, v7, s[8:11], s42 offen offset:0 nt
v_cvt_pk_bf16_f32 v44, v196, v212
s_add_u32 s41, s40, s52
buffer_store_dword v44, v7, s[8:11], s41 offen offset:0 nt
v_cvt_pk_bf16_f32 v45, v197, v213
s_add_u32 s42, s40, s53
buffer_store_dword v45, v7, s[8:11], s42 offen offset:0 nt
v_cvt_pk_bf16_f32 v46, v198, v214
s_add_u32 s41, s40, s54
buffer_store_dword v46, v7, s[8:11], s41 offen offset:0 nt
v_cvt_pk_bf16_f32 v47, v199, v215
s_add_u32 s42, s40, s55
buffer_store_dword v47, v7, s[8:11], s42 offen offset:0 nt
v_cvt_pk_bf16_f32 v40, v200, v216
s_add_u32 s41, s40, s56
buffer_store_dword v40, v7, s[8:11], s41 offen offset:0 nt
v_cvt_pk_bf16_f32 v41, v201, v217
s_add_u32 s42, s40, s57
buffer_store_dword v41, v7, s[8:11], s42 offen offset:0 nt
v_cvt_pk_bf16_f32 v42, v202, v218
s_add_u32 s41, s40, s58
buffer_store_dword v42, v7, s[8:11], s41 offen offset:0 nt
v_cvt_pk_bf16_f32 v43, v203, v219
s_add_u32 s42, s40, s59
buffer_store_dword v43, v7, s[8:11], s42 offen offset:0 nt
v_cvt_pk_bf16_f32 v44, v204, v220
s_add_u32 s41, s40, s60
buffer_store_dword v44, v7, s[8:11], s41 offen offset:0 nt
v_cvt_pk_bf16_f32 v45, v205, v221
s_add_u32 s42, s40, s61
buffer_store_dword v45, v7, s[8:11], s42 offen offset:0 nt
v_cvt_pk_bf16_f32 v46, v206, v222
s_add_u32 s41, s40, s62
buffer_store_dword v46, v7, s[8:11], s41 offen offset:0 nt
v_cvt_pk_bf16_f32 v47, v207, v223
s_add_u32 s42, s40, s63
buffer_store_dword v47, v7, s[8:11], s42 offen offset:0 nt
v_cvt_pk_bf16_f32 v40, v224, v240
s_add_u32 s41, s40, s48
buffer_store_dword v40, v7, s[8:11], s41 offen offset:128 nt
v_cvt_pk_bf16_f32 v41, v225, v241
s_add_u32 s42, s40, s49
buffer_store_dword v41, v7, s[8:11], s42 offen offset:128 nt
v_cvt_pk_bf16_f32 v42, v226, v242
s_add_u32 s41, s40, s50
buffer_store_dword v42, v7, s[8:11], s41 offen offset:128 nt
v_cvt_pk_bf16_f32 v43, v227, v243
s_add_u32 s42, s40, s51
buffer_store_dword v43, v7, s[8:11], s42 offen offset:128 nt
v_cvt_pk_bf16_f32 v44, v228, v244
s_add_u32 s41, s40, s52
buffer_store_dword v44, v7, s[8:11], s41 offen offset:128 nt
v_cvt_pk_bf16_f32 v45, v229, v245
s_add_u32 s42, s40, s53
buffer_store_dword v45, v7, s[8:11], s42 offen offset:128 nt
v_cvt_pk_bf16_f32 v46, v230, v246
s_add_u32 s41, s40, s54
buffer_store_dword v46, v7, s[8:11], s41 offen offset:128 nt
v_cvt_pk_bf16_f32 v47, v231, v247
s_add_u32 s42, s40, s55
buffer_store_dword v47, v7, s[8:11], s42 offen offset:128 nt
v_cvt_pk_bf16_f32 v40, v232, v248
s_add_u32 s41, s40, s56
buffer_store_dword v40, v7, s[8:11], s41 offen offset:128 nt
v_cvt_pk_bf16_f32 v41, v233, v249
s_add_u32 s42, s40, s57
buffer_store_dword v41, v7, s[8:11], s42 offen offset:128 nt
v_cvt_pk_bf16_f32 v42, v234, v250
s_add_u32 s41, s40, s58
buffer_store_dword v42, v7, s[8:11], s41 offen offset:128 nt
v_cvt_pk_bf16_f32 v43, v235, v251
s_add_u32 s42, s40, s59
buffer_store_dword v43, v7, s[8:11], s42 offen offset:128 nt
v_cvt_pk_bf16_f32 v44, v236, v252
s_add_u32 s41, s40, s60
buffer_store_dword v44, v7, s[8:11], s41 offen offset:128 nt
v_cvt_pk_bf16_f32 v45, v237, v253
s_add_u32 s42, s40, s61
buffer_store_dword v45, v7, s[8:11], s42 offen offset:128 nt
v_cvt_pk_bf16_f32 v46, v238, v254
s_add_u32 s41, s40, s62
buffer_store_dword v46, v7, s[8:11], s41 offen offset:128 nt
v_cvt_pk_bf16_f32 v47, v239, v255
s_add_u32 s42, s40, s63
buffer_store_dword v47, v7, s[8:11], s42 offen offset:128 nt
s_waitcnt vmcnt(0)
s_barrier
s_lshl_b32 s40, s68, 3
s_add_u32 s40, s40, s39
s_add_u32 s40, s40, 0x0
s_add_u32 s41, s37, 1
v_mov_b32 v140, s41
v_mov_b32 v141, s46
v_mov_b32 v142, 0
s_mov_b64 exec, 1
buffer_store_dwordx2 v[140:141], v142, s[8:11], s40 offen nt
s_mov_b64 exec, -1
s_add_u32 s40, s39, 0x0
s_add_u32 s41, s37, 1
v_lshlrev_b32 v143, 1, v13
v_and_b32 v143, 255, v143
v_mov_b32 v142, s41
s_mov_b32 s42, 300000
L_pl_239:
buffer_load_dwordx2 v[140:141], v143, s[8:11], s40 offen sc1
s_sub_u32 s42, s42, 1
s_cmp_eq_u32 s42, 0
s_cbranch_scc1 L_abort
s_waitcnt vmcnt(0)
v_cmp_eq_u32 vcc, s46, v141
s_nop 1
v_cndmask_b32 v140, 0, v140, vcc
v_cmp_gt_u32 vcc, v142, v140
s_cbranch_vccnz L_pl_239
s_barrier
s_lshl_b32 s40, s68, 15
s_add_u32 s40, s40, s38
s_add_u32 s40, s40, 0x0
s_add_u32 s41, s40, 0
buffer_load_dwordx4 v[40:43], v8, s[8:11], s41 offen sc1
s_add_u32 s41, s40, 4096
buffer_load_dwordx4 v[44:47], v8, s[8:11], s41 offen sc1
s_add_u32 s41, s40, 8192
buffer_load_dwordx4 v[48:51], v8, s[8:11], s41 offen sc1
s_add_u32 s41, s40, 12288
buffer_load_dwordx4 v[52:55], v8, s[8:11], s41 offen sc1
s_add_u32 s41, s40, 16384
buffer_load_dwordx4 v[56:59], v8, s[8:11], s41 offen sc1
s_add_u32 s41, s40, 20480
buffer_load_dwordx4 v[60:63], v8, s[8:11], s41 offen sc1
s_add_u32 s41, s40, 24576
buffer_load_dwordx4 v[64:67], v8, s[8:11], s41 offen sc1
s_add_u32 s41, s40, 28672
buffer_load_dwordx4 v[68:71], v8, s[8:11], s41 offen sc1
s_waitcnt vmcnt(7)
v_mfma_f32_16x16x32_bf16 v[160:163], v[40:43], v[16:19], 0
s_waitcnt vmcnt(6)
v_mfma_f32_16x16x32_bf16 v[160:163], v[44:47], v[16:19], v[160:163]
s_waitcnt vmcnt(5)
v_mfma_f32_16x16x32_bf16 v[160:163], v[48:51], v[16:19], v[160:163]
s_waitcnt vmcnt(4)
v_mfma_f32_16x16x32_bf16 v[160:163], v[52:55], v[16:19], v[160:163]
s_waitcnt vmcnt(3)
v_mfma_f32_16x16x32_bf16 v[160:163], v[56:59], v[16:19], v[160:163]
s_waitcnt vmcnt(2)
v_mfma_f32_16x16x32_bf16 v[160:163], v[60:63], v[16:19], v[160:163]
s_waitcnt vmcnt(1)
v_mfma_f32_16x16x32_bf16 v[160:163], v[64:67], v[16:19], v[160:163]
s_waitcnt vmcnt(0)
v_mfma_f32_16x16x32_bf16 v[160:163], v[68:71], v[16:19], v[160:163]
s_nop 7
ds_write_b32 v9, v160 offset:0
ds_write_b32 v9, v161 offset:16
ds_write_b32 v9, v162 offset:32
ds_write_b32 v9, v163 offset:48
s_waitcnt lgkmcnt(0)
s_barrier
v_lshlrev_b32 v147, 1, v10
ds_read_b64 v[148:149], v147 offset:8192
s_waitcnt lgkmcnt(0)
v_lshlrev_b32 v150, 16, v152
v_and_b32 v151, 0xffff0000, v152
v_accvgpr_read_b32 v144, a240
v_accvgpr_read_b32 v145, a241
v_cvt_pk_bf16_f32 v148, v148, v148
v_and_b32 v148, 0xffff0000, v148
v_mul_f32 v148, v148, v144
v_cvt_pk_bf16_f32 v148, v148, v148
v_and_b32 v148, 0xffff0000, v148
v_add_f32 v150, v150, v148
v_cvt_pk_bf16_f32 v150, v150, v150
v_and_b32 v150, 0xffff0000, v150
v_cvt_pk_bf16_f32 v149, v149, v149
v_and_b32 v149, 0xffff0000, v149
v_mul_f32 v149, v149, v145
v_cvt_pk_bf16_f32 v149, v149, v149
v_and_b32 v149, 0xffff0000, v149
v_add_f32 v151, v151, v149
v_cvt_pk_bf16_f32 v151, v151, v151
v_and_b32 v151, 0xffff0000, v151
v_accvgpr_write_b32 a248, v150
v_accvgpr_write_b32 a249, v151
v_add_f32 v156, v150, v151
v_mul_f32 v157, v150, v150
v_fmac_f32 v157, v151, v151
v_add_f32_dpp v156, v156, v156 quad_perm:[1,0,3,2] row_mask:0xf bank_mask:0xf
s_nop 1
v_add_f32_dpp v156, v156, v156 quad_perm:[2,3,0,1] row_mask:0xf bank_mask:0xf
s_nop 1
v_add_f32_dpp v156, v156, v156 row_half_mirror row_mask:0xf bank_mask:0xf
s_nop 1
v_add_f32_dpp v156, v156, v156 row_mirror row_mask:0xf bank_mask:0xf
v_mov_b32 v155, v156
s_nop 1
v_permlane16_swap_b32 v156, v155
v_add_f32 v156, v156, v155
v_mov_b32 v155, v156
s_nop 1
v_permlane32_swap_b32 v156, v155
v_add_f32 v156, v156, v155
v_add_f32_dpp v157, v157, v157 quad_perm:[1,0,3,2] row_mask:0xf bank_mask:0xf
s_nop 1
v_add_f32_dpp v157, v157, v157 quad_perm:[2,3,0,1] row_mask:0xf bank_mask:0xf
s_nop 1
v_add_f32_dpp v157, v157, v157 row_half_mirror row_mask:0xf bank_mask:0xf
s_nop 1
v_add_f32_dpp v157, v157, v157 row_mirror row_mask:0xf bank_mask:0xf
v_mov_b32 v155, v157
s_nop 1
v_permlane16_swap_b32 v157, v155
v_add_f32 v157, v157, v155
v_mov_b32 v155, v157
s_nop 1
v_permlane32_swap_b32 v157, v155
v_add_f32 v157, v157, v155
v_mov_b32 v155, 10304
ds_write_b64 v155, v[156:157]
s_waitcnt lgkmcnt(0)
s_barrier
v_mov_b32 v155, 10304
ds_read_b128 v[160:163], v155
ds_read_b128 v[164:167], v155 offset:16
s_waitcnt lgkmcnt(0)
v_add_f32 v156, v160, v162
v_add_f32 v157, v161, v163
v_add_f32 v156, v156, v164
v_add_f32 v157, v157, v165
v_add_f32 v156, v156, v166
v_add_f32 v157, v157, v167
v_mul_f32 v156, 0x3b000000, v156
v_mul_f32 v157, 0x3b000000, v157
v_fma_f32 v157, -v156, v156, v157
v_max_f32 v157, 0, v157
v_cvt_pk_bf16_f32 v156, v156, v156
v_and_b32 v156, 0xffff0000, v156
v_cvt_pk_bf16_f32 v157, v157, v157
v_and_b32 v157, 0xffff0000, v157
v_add_f32 v157, 0x3727c5ac, v157
v_cvt_pk_bf16_f32 v157, v157, v157
v_and_b32 v157, 0xffff0000, v157
v_sqrt_f32 v157, v157
s_nop 0
v_cvt_pk_bf16_f32 v157, v157, v157
v_and_b32 v157, 0xffff0000, v157
v_rcp_f32 v157, v157
v_accvgpr_read_b32 v144, a244
v_accvgpr_read_b32 v145, a245
v_accvgpr_read_b32 v148, a242
v_accvgpr_read_b32 v149, a243
v_sub_f32 v150, v150, v156
v_mul_f32 v150, v150, v157
v_fma_f32 v150, v150, v144, v148
v_sub_f32 v151, v151, v156
v_mul_f32 v151, v151, v157
v_fma_f32 v151, v151, v145, v149
v_cvt_pk_bf16_f32 v150, v150, v151
s_add_u32 s40, s38, 0x200000
buffer_store_dword v150, v11, s[8:11], s40 offen nt
s_waitcnt vmcnt(0)
s_barrier
s_lshl_b32 s40, s68, 3
s_add_u32 s40, s40, s39
s_add_u32 s40, s40, 0x100
s_add_u32 s41, s37, 1
v_mov_b32 v140, s41
v_mov_b32 v141, s46
v_mov_b32 v142, 0
s_mov_b64 exec, 1
buffer_store_dwordx2 v[140:141], v142, s[8:11], s40 offen nt
s_mov_b64 exec, -1
s_add_u32 s40, s39, 0x100
s_add_u32 s41, s37, 1
v_lshlrev_b32 v143, 1, v13
v_and_b32 v143, 255, v143
v_mov_b32 v142, s41
s_mov_b32 s42, 300000
L_pl_240:
buffer_load_dwordx2 v[140:141], v143, s[8:11], s40 offen sc1
s_sub_u32 s42, s42, 1
s_cmp_eq_u32 s42, 0
s_cbranch_scc1 L_abort
s_waitcnt vmcnt(0)
v_cmp_eq_u32 vcc, s46, v141
s_nop 1
v_cndmask_b32 v140, 0, v140, vcc
v_cmp_gt_u32 vcc, v142, v140
s_cbranch_vccnz L_pl_240
s_barrier
s_add_u32 s40, s38, 0x200000
s_mov_b32 m0, 32768
s_add_u32 s41, s40, 0
buffer_load_dwordx4 v2, s[8:11], s41 offen sc1 lds
s_mov_b32 m0, 33792
s_add_u32 s41, s40, 1024
buffer_load_dwordx4 v2, s[8:11], s41 offen sc1 lds
s_mov_b32 m0, 34816
s_add_u32 s41, s40, 2048
buffer_load_dwordx4 v2, s[8:11], s41 offen sc1 lds
s_mov_b32 m0, 35840
s_add_u32 s41, s40, 3072
buffer_load_dwordx4 v2, s[8:11], s41 offen sc1 lds
s_mov_b32 m0, 36864
s_add_u32 s41, s40, 4096
buffer_load_dwordx4 v2, s[8:11], s41 offen sc1 lds
s_mov_b32 m0, 37888
s_add_u32 s41, s40, 5120
buffer_load_dwordx4 v2, s[8:11], s41 offen sc1 lds
s_mov_b32 m0, 38912
s_add_u32 s41, s40, 6144
buffer_load_dwordx4 v2, s[8:11], s41 offen sc1 lds
s_mov_b32 m0, 39936
s_add_u32 s41, s40, 7168
buffer_load_dwordx4 v2, s[8:11], s41 offen sc1 lds
s_waitcnt vmcnt(0)
s_barrier
ds_read_b128 v[56:59], v2 offset:32768
ds_read_b128 v[60:63], v2 offset:33792
ds_read_b128 v[64:67], v2 offset:34816
ds_read_b128 v[68:71], v2 offset:35840
ds_read_b128 v[72:75], v2 offset:36864
ds_read_b128 v[76:79], v2 offset:37888
ds_read_b128 v[80:83], v2 offset:38912
ds_read_b128 v[84:87], v2 offset:39936
ds_read_b128 v[88:91], v2 offset:40960
ds_read_b128 v[92:95], v2 offset:41984
ds_read_b128 v[96:99], v2 offset:43008
ds_read_b128 v[100:103], v2 offset:44032
ds_read_b128 v[104:107], v2 offset:45056
ds_read_b128 v[108:111], v2 offset:46080
ds_read_b128 v[112:115], v2 offset:47104
ds_read_b128 v[116:119], v2 offset:48128
s_waitcnt lgkmcnt(15)
v_mfma_f32_16x16x32_bf16 v[160:163], a[176:179], v[56:59], 0
s_waitcnt lgkmcnt(14)
v_mfma_f32_16x16x32_bf16 v[160:163], a[180:183], v[60:63], v[160:163]
s_waitcnt lgkmcnt(13)
v_mfma_f32_16x16x32_bf16 v[160:163], a[184:187], v[64:67], v[160:163]
s_waitcnt lgkmcnt(12)
v_mfma_f32_16x16x32_bf16 v[160:163], a[188:191], v[68:71], v[160:163]
s_waitcnt lgkmcnt(11)
v_mfma_f32_16x16x32_bf16 v[160:163], a[192:195], v[72:75], v[160:163]
s_waitcnt lgkmcnt(10)
v_mfma_f32_16x16x32_bf16 v[160:163], a[196:199], v[76:79], v[160:163]
s_waitcnt lgkmcnt(9)
v_mfma_f32_16x16x32_bf16 v[160:163], a[200:203], v[80:83], v[160:163]
s_waitcnt lgkmcnt(8)
v_mfma_f32_16x16x32_bf16 v[160:163], a[204:207], v[84:87], v[160:163]
s_waitcnt lgkmcnt(7)
v_mfma_f32_16x16x32_bf16 v[160:163], a[208:211], v[88:91], v[160:163]
s_waitcnt lgkmcnt(6)
v_mfma_f32_16x16x32_bf16 v[160:163], a[212:215], v[92:95], v[160:163]
s_waitcnt lgkmcnt(5)
v_mfma_f32_16x16x32_bf16 v[160:163], a[216:219], v[96:99], v[160:163]
s_waitcnt lgkmcnt(4)
v_mfma_f32_16x16x32_bf16 v[160:163], a[220:223], v[100:103], v[160:163]
s_waitcnt lgkmcnt(3)
v_mfma_f32_16x16x32_bf16 v[160:163], a[224:227], v[104:107], v[160:163]
s_waitcnt lgkmcnt(2)
v_mfma_f32_16x16x32_bf16 v[160:163], a[228:231], v[108:111], v[160:163]
s_waitcnt lgkmcnt(1)
v_mfma_f32_16x16x32_bf16 v[160:163], a[232:235], v[112:115], v[160:163]
s_waitcnt lgkmcnt(0)
v_mfma_f32_16x16x32_bf16 v[160:163], a[236:239], v[116:119], v[160:163]
ds_read_b128 v[56:59], v2 offset:49152
ds_read_b128 v[60:63], v2 offset:50176
ds_read_b128 v[64:67], v2 offset:51200
ds_read_b128 v[68:71], v2 offset:52224
ds_read_b128 v[72:75], v2 offset:53248
ds_read_b128 v[76:79], v2 offset:54272
ds_read_b128 v[80:83], v2 offset:55296
ds_read_b128 v[84:87], v2 offset:56320
ds_read_b128 v[88:91], v2 offset:57344
ds_read_b128 v[92:95], v2 offset:58368
ds_read_b128 v[96:99], v2 offset:59392
ds_read_b128 v[100:103], v2 offset:60416
ds_read_b128 v[104:107], v2 offset:61440
ds_read_b128 v[108:111], v2 offset:62464
ds_read_b128 v[112:115], v2 offset:63488
ds_read_b128 v[116:119], v2 offset:64512
s_waitcnt lgkmcnt(15)
v_mfma_f32_16x16x32_bf16 v[164:167], a[176:179], v[56:59], 0
s_waitcnt lgkmcnt(14)
v_mfma_f32_16x16x32_bf16 v[164:167], a[180:183], v[60:63], v[164:167]
s_waitcnt lgkmcnt(13)
v_mfma_f32_16x16x32_bf16 v[164:167], a[184:187], v[64:67], v[164:167]
s_waitcnt lgkmcnt(12)
v_mfma_f32_16x16x32_bf16 v[164:167], a[188:191], v[68:71], v[164:167]
s_waitcnt lgkmcnt(11)
v_mfma_f32_16x16x32_bf16 v[164:167], a[192:195], v[72:75], v[164:167]
s_waitcnt lgkmcnt(10)
v_mfma_f32_16x16x32_bf16 v[164:167], a[196:199], v[76:79], v[164:167]
s_waitcnt lgkmcnt(9)
v_mfma_f32_16x16x32_bf16 v[164:167], a[200:203], v[80:83], v[164:167]
s_waitcnt lgkmcnt(8)
v_mfma_f32_16x16x32_bf16 v[164:167], a[204:207], v[84:87], v[164:167]
s_waitcnt lgkmcnt(7)
v_mfma_f32_16x16x32_bf16 v[164:167], a[208:211], v[88:91], v[164:167]
s_waitcnt lgkmcnt(6)
v_mfma_f32_16x16x32_bf16 v[164:167], a[212:215], v[92:95], v[164:167]
s_waitcnt lgkmcnt(5)
v_mfma_f32_16x16x32_bf16 v[164:167], a[216:219], v[96:99], v[164:167]
s_waitcnt lgkmcnt(4)
v_mfma_f32_16x16x32_bf16 v[164:167], a[220:223], v[100:103], v[164:167]
s_waitcnt lgkmcnt(3)
v_mfma_f32_16x16x32_bf16 v[164:167], a[224:227], v[104:107], v[164:167]
s_waitcnt lgkmcnt(2)
v_mfma_f32_16x16x32_bf16 v[164:167], a[228:231], v[108:111], v[164:167]
s_waitcnt lgkmcnt(1)
v_mfma_f32_16x16x32_bf16 v[164:167], a[232:235], v[112:115], v[164:167]
s_waitcnt lgkmcnt(0)
v_mfma_f32_16x16x32_bf16 v[164:167], a[236:239], v[116:119], v[164:167]
v_max_f32 v160, 0, v160
v_max_f32 v161, 0, v161
v_max_f32 v162, 0, v162
v_max_f32 v163, 0, v163
v_cvt_pk_bf16_f32 v168, v160, v161
v_cvt_pk_bf16_f32 v169, v162, v163
ds_write_b64 v12, v[168:169] offset:0
s_nop 0
v_max_f32 v164, 0, v164
v_max_f32 v165, 0, v165
v_max_f32 v166, 0, v166
v_max_f32 v167, 0, v167
v_cvt_pk_bf16_f32 v170, v164, v165
v_cvt_pk_bf16_f32 v171, v166, v167
ds_write_b64 v12, v[170:171] offset:256
s_waitcnt lgkmcnt(0)
s_barrier
ds_read_b128 v[40:43], v2 offset:12288
ds_read_b128 v[44:47], v2 offset:13312
ds_read_b128 v[48:51], v2 offset:14336
s_waitcnt lgkmcnt(2)
v_mfma_f32_32x32x16_bf16 v[192:207], v[40:43], a[128:131], 0
v_mfma_f32_32x32x16_bf16 v[208:223], v[40:43], a[140:143], 0
v_mfma_f32_32x32x16_bf16 v[224:239], v[40:43], a[152:155], 0
v_mfma_f32_32x32x16_bf16 v[240:255], v[40:43], a[164:167], 0
s_waitcnt lgkmcnt(1)
v_mfma_f32_32x32x16_bf16 v[192:207], v[44:47], a[132:135], v[192:207]
v_mfma_f32_32x32x16_bf16 v[208:223], v[44:47], a[144:147], v[208:223]
v_mfma_f32_32x32x16_bf16 v[224:239], v[44:47], a[156:159], v[224:239]
v_mfma_f32_32x32x16_bf16 v[240:255], v[44:47], a[168:171], v[240:255]
s_waitcnt lgkmcnt(0)
v_mfma_f32_32x32x16_bf16 v[192:207], v[48:51], a[136:139], v[192:207]
v_mfma_f32_32x32x16_bf16 v[208:223], v[48:51], a[148:151], v[208:223]
v_mfma_f32_32x32x16_bf16 v[224:239], v[48:51], a[160:163], v[224:239]
v_mfma_f32_32x32x16_bf16 v[240:255], v[48:51], a[172:175], v[240:255]
s_lshl_b32 s40, s68, 10
s_add_u32 s40, s40, s38
s_add_u32 s40, s40, 0x100000
s_nop 6
v_cvt_pk_bf16_f32 v40, v192, v208
s_add_u32 s41, s40, s48
buffer_store_dword v40, v7, s[8:11], s41 offen offset:0 nt
v_cvt_pk_bf16_f32 v41, v193, v209
s_add_u32 s42, s40, s49
buffer_store_dword v41, v7, s[8:11], s42 offen offset:0 nt
v_cvt_pk_bf16_f32 v42, v194, v210
s_add_u32 s41, s40, s50
buffer_store_dword v42, v7, s[8:11], s41 offen offset:0 nt
v_cvt_pk_bf16_f32 v43, v195, v211
s_add_u32 s42, s40, s51
buffer_store_dword v43, v7, s[8:11], s42 offen offset:0 nt
v_cvt_pk_bf16_f32 v44, v196, v212
s_add_u32 s41, s40, s52
buffer_store_dword v44, v7, s[8:11], s41 offen offset:0 nt
v_cvt_pk_bf16_f32 v45, v197, v213
s_add_u32 s42, s40, s53
buffer_store_dword v45, v7, s[8:11], s42 offen offset:0 nt
v_cvt_pk_bf16_f32 v46, v198, v214
s_add_u32 s41, s40, s54
buffer_store_dword v46, v7, s[8:11], s41 offen offset:0 nt
v_cvt_pk_bf16_f32 v47, v199, v215
s_add_u32 s42, s40, s55
buffer_store_dword v47, v7, s[8:11], s42 offen offset:0 nt
v_cvt_pk_bf16_f32 v40, v200, v216
s_add_u32 s41, s40, s56
buffer_store_dword v40, v7, s[8:11], s41 offen offset:0 nt
v_cvt_pk_bf16_f32 v41, v201, v217
s_add_u32 s42, s40, s57
buffer_store_dword v41, v7, s[8:11], s42 offen offset:0 nt
v_cvt_pk_bf16_f32 v42, v202, v218
s_add_u32 s41, s40, s58
buffer_store_dword v42, v7, s[8:11], s41 offen offset:0 nt
v_cvt_pk_bf16_f32 v43, v203, v219
s_add_u32 s42, s40, s59
buffer_store_dword v43, v7, s[8:11], s42 offen offset:0 nt
v_cvt_pk_bf16_f32 v44, v204, v220
s_add_u32 s41, s40, s60
buffer_store_dword v44, v7, s[8:11], s41 offen offset:0 nt
v_cvt_pk_bf16_f32 v45, v205, v221
s_add_u32 s42, s40, s61
buffer_store_dword v45, v7, s[8:11], s42 offen offset:0 nt
v_cvt_pk_bf16_f32 v46, v206, v222
s_add_u32 s41, s40, s62
buffer_store_dword v46, v7, s[8:11], s41 offen offset:0 nt
v_cvt_pk_bf16_f32 v47, v207, v223
s_add_u32 s42, s40, s63
buffer_store_dword v47, v7, s[8:11], s42 offen offset:0 nt
v_cvt_pk_bf16_f32 v40, v224, v240
s_add_u32 s41, s40, s48
buffer_store_dword v40, v7, s[8:11], s41 offen offset:128 nt
v_cvt_pk_bf16_f32 v41, v225, v241
s_add_u32 s42, s40, s49
buffer_store_dword v41, v7, s[8:11], s42 offen offset:128 nt
v_cvt_pk_bf16_f32 v42, v226, v242
s_add_u32 s41, s40, s50
buffer_store_dword v42, v7, s[8:11], s41 offen offset:128 nt
v_cvt_pk_bf16_f32 v43, v227, v243
s_add_u32 s42, s40, s51
buffer_store_dword v43, v7, s[8:11], s42 offen offset:128 nt
v_cvt_pk_bf16_f32 v44, v228, v244
s_add_u32 s41, s40, s52
buffer_store_dword v44, v7, s[8:11], s41 offen offset:128 nt
v_cvt_pk_bf16_f32 v45, v229, v245
s_add_u32 s42, s40, s53
buffer_store_dword v45, v7, s[8:11], s42 offen offset:128 nt
v_cvt_pk_bf16_f32 v46, v230, v246
s_add_u32 s41, s40, s54
buffer_store_dword v46, v7, s[8:11], s41 offen offset:128 nt
v_cvt_pk_bf16_f32 v47, v231, v247
s_add_u32 s42, s40, s55
buffer_store_dword v47, v7, s[8:11], s42 offen offset:128 nt
v_cvt_pk_bf16_f32 v40, v232, v248
s_add_u32 s41, s40, s56
buffer_store_dword v40, v7, s[8:11], s41 offen offset:128 nt
v_cvt_pk_bf16_f32 v41, v233, v249
s_add_u32 s42, s40, s57
buffer_store_dword v41, v7, s[8:11], s42 offen offset:128 nt
v_cvt_pk_bf16_f32 v42, v234, v250
s_add_u32 s41, s40, s58
buffer_store_dword v42, v7, s[8:11], s41 offen offset:128 nt
v_cvt_pk_bf16_f32 v43, v235, v251
s_add_u32 s42, s40, s59
buffer_store_dword v43, v7, s[8:11], s42 offen offset:128 nt
v_cvt_pk_bf16_f32 v44, v236, v252
s_add_u32 s41, s40, s60
buffer_store_dword v44, v7, s[8:11], s41 offen offset:128 nt
v_cvt_pk_bf16_f32 v45, v237, v253
s_add_u32 s42, s40, s61
buffer_store_dword v45, v7, s[8:11], s42 offen offset:128 nt
v_cvt_pk_bf16_f32 v46, v238, v254
s_add_u32 s41, s40, s62
buffer_store_dword v46, v7, s[8:11], s41 offen offset:128 nt
v_cvt_pk_bf16_f32 v47, v239, v255
s_add_u32 s42, s40, s63
buffer_store_dword v47, v7, s[8:11], s42 offen offset:128 nt
s_waitcnt vmcnt(0)
s_barrier
s_lshl_b32 s40, s68, 3
s_add_u32 s40, s40, s39
s_add_u32 s40, s40, 0x200
s_add_u32 s41, s37, 1
v_mov_b32 v140, s41
v_mov_b32 v141, s46
v_mov_b32 v142, 0
s_mov_b64 exec, 1
buffer_store_dwordx2 v[140:141], v142, s[8:11], s40 offen nt
s_mov_b64 exec, -1
s_add_u32 s40, s39, 0x200
s_add_u32 s41, s37, 1
v_lshlrev_b32 v143, 1, v13
v_and_b32 v143, 255, v143
v_mov_b32 v142, s41
s_mov_b32 s42, 300000
L_pl_241:
buffer_load_dwordx2 v[140:141], v143, s[8:11], s40 offen sc1
s_sub_u32 s42, s42, 1
s_cmp_eq_u32 s42, 0
s_cbranch_scc1 L_abort
s_waitcnt vmcnt(0)
v_cmp_eq_u32 vcc, s46, v141
s_nop 1
v_cndmask_b32 v140, 0, v140, vcc
v_cmp_gt_u32 vcc, v142, v140
s_cbranch_vccnz L_pl_241
s_barrier
s_lshl_b32 s40, s68, 15
s_add_u32 s40, s40, s38
s_add_u32 s40, s40, 0x100000
s_add_u32 s41, s40, 0
buffer_load_dwordx4 v[40:43], v8, s[8:11], s41 offen sc1
s_add_u32 s41, s40, 4096
buffer_load_dwordx4 v[44:47], v8, s[8:11], s41 offen sc1
s_add_u32 s41, s40, 8192
buffer_load_dwordx4 v[48:51], v8, s[8:11], s41 offen sc1
s_add_u32 s41, s40, 12288
buffer_load_dwordx4 v[52:55], v8, s[8:11], s41 offen sc1
s_add_u32 s41, s40, 16384
buffer_load_dwordx4 v[56:59], v8, s[8:11], s41 offen sc1
s_add_u32 s41, s40, 20480
buffer_load_dwordx4 v[60:63], v8, s[8:11], s41 offen sc1
s_add_u32 s41, s40, 24576
buffer_load_dwordx4 v[64:67], v8, s[8:11], s41 offen sc1
s_add_u32 s41, s40, 28672
buffer_load_dwordx4 v[68:71], v8, s[8:11], s41 offen sc1
s_waitcnt vmcnt(7)
v_mfma_f32_16x16x32_bf16 v[160:163], v[40:43], v[16:19], 0
s_waitcnt vmcnt(6)
v_mfma_f32_16x16x32_bf16 v[160:163], v[44:47], v[16:19], v[160:163]
s_waitcnt vmcnt(5)
v_mfma_f32_16x16x32_bf16 v[160:163], v[48:51], v[16:19], v[160:163]
s_waitcnt vmcnt(4)
v_mfma_f32_16x16x32_bf16 v[160:163], v[52:55], v[16:19], v[160:163]
s_waitcnt vmcnt(3)
v_mfma_f32_16x16x32_bf16 v[160:163], v[56:59], v[16:19], v[160:163]
s_waitcnt vmcnt(2)
v_mfma_f32_16x16x32_bf16 v[160:163], v[60:63], v[16:19], v[160:163]
s_waitcnt vmcnt(1)
v_mfma_f32_16x16x32_bf16 v[160:163], v[64:67], v[16:19], v[160:163]
s_waitcnt vmcnt(0)
v_mfma_f32_16x16x32_bf16 v[160:163], v[68:71], v[16:19], v[160:163]
s_nop 7
ds_write_b32 v9, v160 offset:0
ds_write_b32 v9, v161 offset:16
ds_write_b32 v9, v162 offset:32
ds_write_b32 v9, v163 offset:48
s_waitcnt lgkmcnt(0)
s_barrier
v_lshlrev_b32 v147, 1, v10
ds_read_b64 v[148:149], v147 offset:8192
s_waitcnt lgkmcnt(0)
v_accvgpr_read_b32 v144, a246
v_accvgpr_read_b32 v145, a247
v_accvgpr_read_b32 v150, a248
v_accvgpr_read_b32 v151, a249
v_cvt_pk_bf16_f32 v148, v148, v148
v_and_b32 v148, 0xffff0000, v148
v_mul_f32 v148, v148, v144
v_cvt_pk_bf16_f32 v148, v148, v148
v_and_b32 v148, 0xffff0000, v148
v_add_f32 v150, v150, v148
v_cvt_pk_bf16_f32 v149, v149, v149
v_and_b32 v149, 0xffff0000, v149
v_mul_f32 v149, v149, v145
v_cvt_pk_bf16_f32 v149, v149, v149
v_and_b32 v149, 0xffff0000, v149
v_add_f32 v151, v151, v149
v_cvt_pk_bf16_f32 v150, v150, v151
s_lshl_b32 s40, s36, 5
s_add_u32 s40, s40, s68
s_lshl_b32 s40, s40, 10
buffer_store_dword v150, v10, s[4:7], s40 offen
s_add_u32 s36, s36, 7
s_add_u32 s37, s37, 1
s_branch L_tail_w0_f
L_tailend_w0_f:
s_waitcnt vmcnt(0)
s_endpgm
L_tw1:
v_lshlrev_b32 v2, 4, v3
v_lshlrev_b32 v13, 2, v3
v_and_b32 v140, 15, v3
v_lshrrev_b32 v141, 4, v3
v_lshrrev_b32 v142, 2, v140
v_and_b32 v143, 1, v140
v_lshl_add_u32 v142, v142, 1, v143
v_lshl_add_u32 v142, v141, 3, v142
v_lshlrev_b32 v4, 4, v142
v_lshlrev_b32 v142, 2, v141
v_sub_u32 v5, v140, v142
v_lshrrev_b32 v142, 1, v141
v_lshlrev_b32 v142, 6, v142
v_and_b32 v143, 1, v141
v_lshl_add_u32 v142, v143, 5, v142
v_add3_u32 v142, v142, v140, 16
v_lshlrev_b32 v142, 4, v142
v_add_u32 v6, 0, v142
v_lshrrev_b32 v142, 5, v3
v_lshlrev_b32 v142, 17, v142
v_and_b32 v143, 31, v3
v_lshl_add_u32 v7, v143, 2, v142
v_lshlrev_b32 v142, 10, v141
v_lshl_add_u32 v8, v140, 4, v142
v_lshrrev_b32 v142, 1, v141
v_lshlrev_b32 v142, 6, v142
v_and_b32 v143, 1, v140
v_lshl_add_u32 v142, v143, 5, v142
v_and_b32 v143, 1, v141
v_lshl_add_u32 v142, v143, 4, v142
v_lshrrev_b32 v143, 1, v140
v_add3_u32 v142, v142, v143, 0
v_add_u32 v142, 128, v142
v_lshlrev_b32 v142, 2, v142
v_add_u32 v142, 8192, v142
v_mov_b32 v9, 10240
v_cmp_gt_u32 vcc, 8, v140
s_nop 1
v_cndmask_b32 v9, v9, v142, vcc
v_add_u32 v142, 64, v3
v_lshlrev_b32 v10, 2, v142
v_lshrrev_b32 v143, 4, v142
v_lshlrev_b32 v143, 10, v143
v_bfe_u32 v144, v142, 2, 2
v_lshl_add_u32 v143, v144, 8, v143
v_and_b32 v144, 3, v142
v_lshl_add_u32 v143, v144, 2, v143
s_lshr_b32 s40, s68, 4
s_lshl_b32 s40, s40, 14
s_and_b32 s41, s68, 15
s_lshl_b32 s41, s41, 4
s_add_u32 s40, s40, s41
v_add_u32 v11, s40, v143
v_lshrrev_b32 v142, 1, v141
v_lshlrev_b32 v142, 5, v142
v_add_u32 v142, v142, v140
v_lshlrev_b32 v142, 4, v142
v_and_b32 v143, 1, v141
v_lshl_add_u32 v142, v143, 3, v142
v_add_u32 v12, 13312, v142
v_and_b32 v142, 1, v140
v_lshlrev_b32 v142, 4, v142
v_mov_b32 v143, 0x3f80
v_lshlrev_b32 v143, v142, v143
v_lshrrev_b32 v142, 1, v140
v_cmp_eq_u32 vcc, 0, v142
s_nop 1
v_cndmask_b32 v16, 0, v143, vcc
v_cmp_eq_u32 vcc, 1, v142
s_nop 1
v_cndmask_b32 v17, 0, v143, vcc
v_cmp_eq_u32 vcc, 2, v142
s_nop 1
v_cndmask_b32 v18, 0, v143, vcc
v_cmp_eq_u32 vcc, 3, v142
s_nop 1
v_cndmask_b32 v19, 0, v143, vcc
v_mov_b32 v20, 0
v_mov_b32 v21, 0
v_mov_b32 v22, 0
v_mov_b32 v23, 0
v_mov_b32 v24, 0
v_mov_b32 v25, 0
v_mov_b32 v26, 0
v_mov_b32 v27, 0
v_mov_b32 v28, 0
v_mov_b32 v29, 0
v_mov_b32 v30, 0
v_mov_b32 v31, 0
v_mov_b32 v32, 0
v_mov_b32 v33, 0
v_mov_b32 v34, 0
v_mov_b32 v35, 0
v_mov_b32 v36, 0x3f803f80
v_mov_b32 v37, 0x3f803f80
v_mov_b32 v38, 0x3f803f80
v_mov_b32 v39, 0x3f803f80
v_mov_b32 v132, 0
v_mov_b32 v133, 0
v_mov_b32 v134, 0
v_mov_b32 v135, 0
v_mov_b32 v136, 0
v_mov_b32 v137, 0
v_mov_b32 v138, 0
v_mov_b32 v139, 0
s_mov_b32 s48, 0
s_mov_b32 s49, 32768
s_mov_b32 s50, 65536
s_mov_b32 s51, 98304
s_mov_b32 s52, 262144
s_mov_b32 s53, 294912
s_mov_b32 s54, 327680
s_mov_b32 s55, 360448
s_mov_b32 s56, 524288
s_mov_b32 s57, 557056
s_mov_b32 s58, 589824
s_mov_b32 s59, 622592
s_mov_b32 s60, 786432
s_mov_b32 s61, 819200
s_mov_b32 s62, 851968
s_mov_b32 s63, 884736
s_mov_b32 s64, 0x3e0293ee
s_mov_b32 s65, 0xbe0293ee
s_mul_i32 s38, s33, 0x400000
s_add_u32 s38, s38, 0x4000000
s_lshl_b32 s39, s33, 10
s_add_u32 s39, s39, 0x11000
v_lshlrev_b32 v142, 10, v141
v_lshl_add_u32 v142, v140, 4, v142
s_mov_b32 s12, s24
s_mov_b32 s13, s25
s_mov_b32 s14, 0x400000
s_mov_b32 s15, 0x00020000
s_lshl_b32 s40, s68, 17
s_add_u32 s40, s40, 256
v_add_u32 v146, s40, v142
s_mov_b32 m0, 32768
s_mov_b32 s41, 0
buffer_load_dwordx4 v146, s[12:15], s41 offen lds
s_mov_b32 m0, 33792
s_mov_b32 s41, 4096
buffer_load_dwordx4 v146, s[12:15], s41 offen lds
s_mov_b32 m0, 34816
s_mov_b32 s41, 8192
buffer_load_dwordx4 v146, s[12:15], s41 offen lds
s_mov_b32 m0, 35840
s_mov_b32 s41, 12288
buffer_load_dwordx4 v146, s[12:15], s41 offen lds
s_mov_b32 m0, 36864
s_mov_b32 s41, 16384
buffer_load_dwordx4 v146, s[12:15], s41 offen lds
s_mov_b32 m0, 37888
s_mov_b32 s41, 20480
buffer_load_dwordx4 v146, s[12:15], s41 offen lds
s_mov_b32 m0, 38912
s_mov_b32 s41, 24576
buffer_load_dwordx4 v146, s[12:15], s41 offen lds
s_mov_b32 m0, 39936
s_mov_b32 s41, 28672
buffer_load_dwordx4 v146, s[12:15], s41 offen lds
s_mov_b32 m0, 40960
s_mov_b32 s41, 32768
buffer_load_dwordx4 v146, s[12:15], s41 offen lds
s_mov_b32 m0, 41984
s_mov_b32 s41, 36864
buffer_load_dwordx4 v146, s[12:15], s41 offen lds
s_mov_b32 m0, 43008
s_mov_b32 s41, 40960
buffer_load_dwordx4 v146, s[12:15], s41 offen lds
s_mov_b32 m0, 44032
s_mov_b32 s41, 45056
buffer_load_dwordx4 v146, s[12:15], s41 offen lds
s_mov_b32 m0, 45056
s_mov_b32 s41, 49152
buffer_load_dwordx4 v146, s[12:15], s41 offen lds
s_mov_b32 m0, 46080
s_mov_b32 s41, 53248
buffer_load_dwordx4 v146, s[12:15], s41 offen lds
s_mov_b32 m0, 47104
s_mov_b32 s41, 57344
buffer_load_dwordx4 v146, s[12:15], s41 offen lds
s_mov_b32 m0, 48128
s_mov_b32 s41, 61440
buffer_load_dwordx4 v146, s[12:15], s41 offen lds
s_mov_b32 m0, 49152
s_mov_b32 s41, 65536
buffer_load_dwordx4 v146, s[12:15], s41 offen lds
s_mov_b32 m0, 50176
s_mov_b32 s41, 69632
buffer_load_dwordx4 v146, s[12:15], s41 offen lds
s_mov_b32 m0, 51200
s_mov_b32 s41, 73728
buffer_load_dwordx4 v146, s[12:15], s41 offen lds
s_mov_b32 m0, 52224
s_mov_b32 s41, 77824
buffer_load_dwordx4 v146, s[12:15], s41 offen lds
s_mov_b32 m0, 53248
s_mov_b32 s41, 81920
buffer_load_dwordx4 v146, s[12:15], s41 offen lds
s_mov_b32 m0, 54272
s_mov_b32 s41, 86016
buffer_load_dwordx4 v146, s[12:15], s41 offen lds
s_mov_b32 m0, 55296
s_mov_b32 s41, 90112
buffer_load_dwordx4 v146, s[12:15], s41 offen lds
s_mov_b32 m0, 56320
s_mov_b32 s41, 94208
buffer_load_dwordx4 v146, s[12:15], s41 offen lds
s_mov_b32 m0, 57344
s_mov_b32 s41, 98304
buffer_load_dwordx4 v146, s[12:15], s41 offen lds
s_mov_b32 m0, 58368
s_mov_b32 s41, 102400
buffer_load_dwordx4 v146, s[12:15], s41 offen lds
s_mov_b32 m0, 59392
s_mov_b32 s41, 106496
buffer_load_dwordx4 v146, s[12:15], s41 offen lds
s_mov_b32 m0, 60416
s_mov_b32 s41, 110592
buffer_load_dwordx4 v146, s[12:15], s41 offen lds
s_mov_b32 m0, 61440
s_mov_b32 s41, 114688
buffer_load_dwordx4 v146, s[12:15], s41 offen lds
s_mov_b32 m0, 62464
s_mov_b32 s41, 118784
buffer_load_dwordx4 v146, s[12:15], s41 offen lds
s_mov_b32 m0, 63488
s_mov_b32 s41, 122880
buffer_load_dwordx4 v146, s[12:15], s41 offen lds
s_mov_b32 m0, 64512
s_mov_b32 s41, 126976
buffer_load_dwordx4 v146, s[12:15], s41 offen lds
v_bfe_u32 v143, v3, 2, 2
v_lshrrev_b32 v144, 5, v3
v_bfe_u32 v145, v3, 4, 1
v_lshlrev_b32 v145, 5, v145
v_and_b32 v148, 3, v3
v_lshl_add_u32 v145, v148, 3, v145
v_lshl_add_u32 v148, v144, 2, v143
v_lshl_add_u32 v148, v148, 8, v145
v_add_u32 v147, 32768, v148
v_lshl_add_u32 v148, v144, 3, v143
v_lshl_add_u32 v148, v148, 8, v145
v_add_u32 v149, 32768, v148
s_waitcnt vmcnt(0)
ds_read_b64_tr_b16 a[0:1], v147 offset:0
ds_read_b64_tr_b16 a[2:3], v147 offset:4096
ds_read_b64_tr_b16 a[4:5], v147 offset:2048
ds_read_b64_tr_b16 a[6:7], v147 offset:6144
ds_read_b64_tr_b16 a[8:9], v147 offset:8192
ds_read_b64_tr_b16 a[10:11], v147 offset:12288
ds_read_b64_tr_b16 a[12:13], v147 offset:10240
ds_read_b64_tr_b16 a[14:15], v147 offset:14336
ds_read_b64_tr_b16 a[16:17], v147 offset:16384
ds_read_b64_tr_b16 a[18:19], v147 offset:20480
ds_read_b64_tr_b16 a[20:21], v147 offset:18432
ds_read_b64_tr_b16 a[22:23], v147 offset:22528
ds_read_b64_tr_b16 a[24:25], v147 offset:24576
ds_read_b64_tr_b16 a[26:27], v147 offset:28672
ds_read_b64_tr_b16 a[28:29], v147 offset:26624
ds_read_b64_tr_b16 a[30:31], v147 offset:30720
ds_read_b64_tr_b16 a[32:33], v147 offset:64
ds_read_b64_tr_b16 a[34:35], v147 offset:4160
ds_read_b64_tr_b16 a[36:37], v147 offset:2112
ds_read_b64_tr_b16 a[38:39], v147 offset:6208
ds_read_b64_tr_b16 a[40:41], v147 offset:8256
ds_read_b64_tr_b16 a[42:43], v147 offset:12352
ds_read_b64_tr_b16 a[44:45], v147 offset:10304
ds_read_b64_tr_b16 a[46:47], v147 offset:14400
ds_read_b64_tr_b16 a[48:49], v147 offset:16448
ds_read_b64_tr_b16 a[50:51], v147 offset:20544
ds_read_b64_tr_b16 a[52:53], v147 offset:18496
ds_read_b64_tr_b16 a[54:55], v147 offset:22592
ds_read_b64_tr_b16 a[56:57], v147 offset:24640
ds_read_b64_tr_b16 a[58:59], v147 offset:28736
ds_read_b64_tr_b16 a[60:61], v147 offset:26688
ds_read_b64_tr_b16 a[62:63], v147 offset:30784
ds_read_b64_tr_b16 a[64:65], v147 offset:128
ds_read_b64_tr_b16 a[66:67], v147 offset:4224
ds_read_b64_tr_b16 a[68:69], v147 offset:2176
ds_read_b64_tr_b16 a[70:71], v147 offset:6272
ds_read_b64_tr_b16 a[72:73], v147 offset:8320
ds_read_b64_tr_b16 a[74:75], v147 offset:12416
ds_read_b64_tr_b16 a[76:77], v147 offset:10368
ds_read_b64_tr_b16 a[78:79], v147 offset:14464
ds_read_b64_tr_b16 a[80:81], v147 offset:16512
ds_read_b64_tr_b16 a[82:83], v147 offset:20608
ds_read_b64_tr_b16 a[84:85], v147 offset:18560
ds_read_b64_tr_b16 a[86:87], v147 offset:22656
ds_read_b64_tr_b16 a[88:89], v147 offset:24704
ds_read_b64_tr_b16 a[90:91], v147 offset:28800
ds_read_b64_tr_b16 a[92:93], v147 offset:26752
ds_read_b64_tr_b16 a[94:95], v147 offset:30848
ds_read_b64_tr_b16 a[96:97], v147 offset:192
ds_read_b64_tr_b16 a[98:99], v147 offset:4288
ds_read_b64_tr_b16 a[100:101], v147 offset:2240
ds_read_b64_tr_b16 a[102:103], v147 offset:6336
ds_read_b64_tr_b16 a[104:105], v147 offset:8384
ds_read_b64_tr_b16 a[106:107], v147 offset:12480
ds_read_b64_tr_b16 a[108:109], v147 offset:10432
ds_read_b64_tr_b16 a[110:111], v147 offset:14528
ds_read_b64_tr_b16 a[112:113], v147 offset:16576
ds_read_b64_tr_b16 a[114:115], v147 offset:20672
ds_read_b64_tr_b16 a[116:117], v147 offset:18624
ds_read_b64_tr_b16 a[118:119], v147 offset:22720
ds_read_b64_tr_b16 a[120:121], v147 offset:24768
ds_read_b64_tr_b16 a[122:123], v147 offset:28864
ds_read_b64_tr_b16 a[124:125], v147 offset:26816
ds_read_b64_tr_b16 a[126:127], v147 offset:30912
s_waitcnt lgkmcnt(0)
s_mov_b32 s12, s30
s_mov_b32 s13, s31
s_mov_b32 s14, 0x158000
s_mov_b32 s15, 0x00020000
s_mul_i32 s40, s68, 49152
s_add_u32 s40, s40, 256
v_add_u32 v146, s40, v142
s_mov_b32 m0, 32768
s_mov_b32 s41, 0
buffer_load_dwordx4 v146, s[12:15], s41 offen lds
s_mov_b32 m0, 33792
s_mov_b32 s41, 4096
buffer_load_dwordx4 v146, s[12:15], s41 offen lds
s_mov_b32 m0, 34816
s_mov_b32 s41, 8192
buffer_load_dwordx4 v146, s[12:15], s41 offen lds
s_mov_b32 m0, 35840
s_mov_b32 s41, 12288
buffer_load_dwordx4 v146, s[12:15], s41 offen lds
s_mov_b32 m0, 36864
s_mov_b32 s41, 16384
buffer_load_dwordx4 v146, s[12:15], s41 offen lds
s_mov_b32 m0, 37888
s_mov_b32 s41, 20480
buffer_load_dwordx4 v146, s[12:15], s41 offen lds
s_mov_b32 m0, 38912
s_mov_b32 s41, 24576
buffer_load_dwordx4 v146, s[12:15], s41 offen lds
s_mov_b32 m0, 39936
s_mov_b32 s41, 28672
buffer_load_dwordx4 v146, s[12:15], s41 offen lds
s_mov_b32 m0, 40960
s_mov_b32 s41, 32768
buffer_load_dwordx4 v146, s[12:15], s41 offen lds
s_mov_b32 m0, 41984
s_mov_b32 s41, 36864
buffer_load_dwordx4 v146, s[12:15], s41 offen lds
s_mov_b32 m0, 43008
s_mov_b32 s41, 40960
buffer_load_dwordx4 v146, s[12:15], s41 offen lds
s_mov_b32 m0, 44032
s_mov_b32 s41, 45056
buffer_load_dwordx4 v146, s[12:15], s41 offen lds
v_lshrrev_b32 v150, 1, v3
v_mul_u32_u24 v150, 2752, v150
v_and_b32 v151, 1, v3
s_mul_i32 s40, s68, 48
s_add_u32 s40, s40, 16
v_lshl_add_u32 v151, v151, 3, s40
v_lshl_add_u32 v150, v151, 1, v150
v_mov_b32 v152, 0x40000000
v_cmp_gt_u32 vcc, 1376, v151
s_nop 1
v_cndmask_b32 v150, v152, v150, vcc
s_waitcnt vmcnt(0)
ds_read_b64_tr_b16 a[128:129], v149 offset:0
ds_read_b64_tr_b16 a[130:131], v149 offset:1024
ds_read_b64_tr_b16 a[132:133], v149 offset:4096
ds_read_b64_tr_b16 a[134:135], v149 offset:5120
ds_read_b64_tr_b16 a[136:137], v149 offset:8192
ds_read_b64_tr_b16 a[138:139], v149 offset:9216
ds_read_b64_tr_b16 a[140:141], v149 offset:64
ds_read_b64_tr_b16 a[142:143], v149 offset:1088
ds_read_b64_tr_b16 a[144:145], v149 offset:4160
ds_read_b64_tr_b16 a[146:147], v149 offset:5184
ds_read_b64_tr_b16 a[148:149], v149 offset:8256
ds_read_b64_tr_b16 a[150:151], v149 offset:9280
ds_read_b64_tr_b16 a[152:153], v149 offset:128
ds_read_b64_tr_b16 a[154:155], v149 offset:1152
ds_read_b64_tr_b16 a[156:157], v149 offset:4224
ds_read_b64_tr_b16 a[158:159], v149 offset:5248
ds_read_b64_tr_b16 a[160:161], v149 offset:8320
ds_read_b64_tr_b16 a[162:163], v149 offset:9344
ds_read_b64_tr_b16 a[164:165], v149 offset:192
ds_read_b64_tr_b16 a[166:167], v149 offset:1216
ds_read_b64_tr_b16 a[168:169], v149 offset:4288
ds_read_b64_tr_b16 a[170:171], v149 offset:5312
ds_read_b64_tr_b16 a[172:173], v149 offset:8384
ds_read_b64_tr_b16 a[174:175], v149 offset:9408
s_waitcnt lgkmcnt(0)
s_mov_b32 s12, s28
s_mov_b32 s13, s29
s_mov_b32 s14, 0x158000
s_mov_b32 s15, 0x00020000
s_mov_b32 m0, 32768
s_mov_b32 s41, 0
buffer_load_dwordx4 v150, s[12:15], s41 offen lds
s_mov_b32 m0, 33792
s_mov_b32 s41, 88064
buffer_load_dwordx4 v150, s[12:15], s41 offen lds
s_mov_b32 m0, 34816
s_mov_b32 s41, 176128
buffer_load_dwordx4 v150, s[12:15], s41 offen lds
s_mov_b32 m0, 35840
s_mov_b32 s41, 264192
buffer_load_dwordx4 v150, s[12:15], s41 offen lds
s_mov_b32 m0, 36864
s_mov_b32 s41, 352256
buffer_load_dwordx4 v150, s[12:15], s41 offen lds
s_mov_b32 m0, 37888
s_mov_b32 s41, 440320
buffer_load_dwordx4 v150, s[12:15], s41 offen lds
s_mov_b32 m0, 38912
s_mov_b32 s41, 528384
buffer_load_dwordx4 v150, s[12:15], s41 offen lds
s_mov_b32 m0, 39936
s_mov_b32 s41, 616448
buffer_load_dwordx4 v150, s[12:15], s41 offen lds
s_mov_b32 m0, 40960
s_mov_b32 s41, 704512
buffer_load_dwordx4 v150, s[12:15], s41 offen lds
s_mov_b32 m0, 41984
s_mov_b32 s41, 792576
buffer_load_dwordx4 v150, s[12:15], s41 offen lds
s_mov_b32 m0, 43008
s_mov_b32 s41, 880640
buffer_load_dwordx4 v150, s[12:15], s41 offen lds
s_mov_b32 m0, 44032
s_mov_b32 s41, 968704
buffer_load_dwordx4 v150, s[12:15], s41 offen lds
s_mov_b32 m0, 45056
s_mov_b32 s41, 1056768
buffer_load_dwordx4 v150, s[12:15], s41 offen lds
s_mov_b32 m0, 46080
s_mov_b32 s41, 1144832
buffer_load_dwordx4 v150, s[12:15], s41 offen lds
s_mov_b32 m0, 47104
s_mov_b32 s41, 1232896
buffer_load_dwordx4 v150, s[12:15], s41 offen lds
s_mov_b32 m0, 48128
s_mov_b32 s41, 1320960
buffer_load_dwordx4 v150, s[12:15], s41 offen lds
v_lshl_add_u32 v151, v141, 3, v143
v_lshlrev_b32 v151, 5, v151
v_and_b32 v152, 3, v3
v_lshl_add_u32 v151, v152, 3, v151
v_add_u32 v151, 32768, v151
s_waitcnt vmcnt(0)
ds_read_b64_tr_b16 a[176:177], v151 offset:0
ds_read_b64_tr_b16 a[178:179], v151 offset:128
ds_read_b64_tr_b16 a[180:181], v151 offset:1024
ds_read_b64_tr_b16 a[182:183], v151 offset:1152
ds_read_b64_tr_b16 a[184:185], v151 offset:2048
ds_read_b64_tr_b16 a[186:187], v151 offset:2176
ds_read_b64_tr_b16 a[188:189], v151 offset:3072
ds_read_b64_tr_b16 a[190:191], v151 offset:3200
ds_read_b64_tr_b16 a[192:193], v151 offset:4096
ds_read_b64_tr_b16 a[194:195], v151 offset:4224
ds_read_b64_tr_b16 a[196:197], v151 offset:5120
ds_read_b64_tr_b16 a[198:199], v151 offset:5248
ds_read_b64_tr_b16 a[200:201], v151 offset:6144
ds_read_b64_tr_b16 a[202:203], v151 offset:6272
ds_read_b64_tr_b16 a[204:205], v151 offset:7168
ds_read_b64_tr_b16 a[206:207], v151 offset:7296
ds_read_b64_tr_b16 a[208:209], v151 offset:8192
ds_read_b64_tr_b16 a[210:211], v151 offset:8320
ds_read_b64_tr_b16 a[212:213], v151 offset:9216
ds_read_b64_tr_b16 a[214:215], v151 offset:9344
ds_read_b64_tr_b16 a[216:217], v151 offset:10240
ds_read_b64_tr_b16 a[218:219], v151 offset:10368
ds_read_b64_tr_b16 a[220:221], v151 offset:11264
ds_read_b64_tr_b16 a[222:223], v151 offset:11392
ds_read_b64_tr_b16 a[224:225], v151 offset:12288
ds_read_b64_tr_b16 a[226:227], v151 offset:12416
ds_read_b64_tr_b16 a[228:229], v151 offset:13312
ds_read_b64_tr_b16 a[230:231], v151 offset:13440
ds_read_b64_tr_b16 a[232:233], v151 offset:14336
ds_read_b64_tr_b16 a[234:235], v151 offset:14464
ds_read_b64_tr_b16 a[236:237], v151 offset:15360
ds_read_b64_tr_b16 a[238:239], v151 offset:15488
s_waitcnt lgkmcnt(0)
s_barrier
s_sub_u32 s36, s33, 1
s_mov_b32 s37, 0
s_cmp_lg_u32 s32, 0
s_cbranch_scc1 L_tslow1
s_mov_b32 s12, s22
s_mov_b32 s13, s23
s_mov_b32 s14, 0x200000
s_mov_b32 s15, 0x00020000
s_mov_b32 s4, s26
s_mov_b32 s5, s27
s_mov_b32 s6, 0x200000
s_mov_b32 s7, 0x00020000
s_barrier
v_lshlrev_b32 v140, 1, v10
s_mov_b32 s40, 0x1000
buffer_load_dwordx2 a[240:241], v140, s[8:11], s40 offen sc1
s_mov_b32 s40, 0x1800
buffer_load_dwordx2 a[242:243], v140, s[8:11], s40 offen sc1
s_mov_b32 s40, 0x2000
buffer_load_dwordx2 a[244:245], v140, s[8:11], s40 offen sc1
s_mov_b32 s40, 0x2800
buffer_load_dwordx2 a[246:247], v140, s[8:11], s40 offen sc1
s_waitcnt vmcnt(0)
L_tail_w1_f:
s_cmp_ge_u32 s36, 64
s_cbranch_scc1 L_tailend_w1_f
s_barrier
s_lshl_b32 s40, s36, 5
s_add_u32 s40, s40, s68
s_lshl_b32 s66, s40, 13
s_lshl_b32 s67, s40, 11
s_add_u32 s41, s66, 0x2801000
buffer_load_dwordx4 v[40:43], v2, s[8:11], s41 offen offset:0 sc1
buffer_load_dwordx4 v[44:47], v2, s[8:11], s41 offen offset:1024 sc1
buffer_load_dwordx4 v[48:51], v2, s[8:11], s41 offen offset:2048 sc1
buffer_load_dwordx4 v[52:55], v2, s[8:11], s41 offen offset:3072 sc1
s_add_u32 s41, s66, 0x800000
buffer_load_dwordx4 v[72:75], v2, s[8:11], s41 offen offset:0 sc1
buffer_load_dwordx4 v[76:79], v2, s[8:11], s41 offen offset:1024 sc1
buffer_load_dwordx4 v[80:83], v2, s[8:11], s41 offen offset:2048 sc1
buffer_load_dwordx4 v[84:87], v2, s[8:11], s41 offen offset:3072 sc1
s_add_u32 s41, s66, 0x801000
buffer_load_dwordx4 v[88:91], v2, s[8:11], s41 offen offset:0 sc1
buffer_load_dwordx4 v[92:95], v2, s[8:11], s41 offen offset:1024 sc1
buffer_load_dwordx4 v[96:99], v2, s[8:11], s41 offen offset:2048 sc1
buffer_load_dwordx4 v[100:103], v2, s[8:11], s41 offen offset:3072 sc1
s_add_u32 s41, s66, 0x1800000
buffer_load_dwordx4 v[104:107], v2, s[8:11], s41 offen offset:0 sc1
buffer_load_dwordx4 v[108:111], v2, s[8:11], s41 offen offset:1024 sc1
buffer_load_dwordx4 v[112:115], v2, s[8:11], s41 offen offset:2048 sc1
buffer_load_dwordx4 v[116:119], v2, s[8:11], s41 offen offset:3072 sc1
s_lshl_b32 s41, s40, 10
buffer_load_dword v152, v10, s[12:15], s41 offen
s_barrier
s_add_u32 s42, s67, 0x3800000
buffer_load_dwordx4 v[56:59], v4, s[8:11], s42 offen offset:0 sc1
buffer_load_dwordx4 v[60:63], v4, s[8:11], s42 offen offset:512 sc1
buffer_load_dwordx4 v[64:67], v4, s[8:11], s42 offen offset:1024 sc1
buffer_load_dwordx4 v[68:71], v4, s[8:11], s42 offen offset:1536 sc1
s_add_u32 s42, s67, 0x3c00000
buffer_load_dword v20, v13, s[8:11], s42 offen offset:0 sc1
buffer_load_dword v24, v13, s[8:11], s42 offen offset:256 sc1
buffer_load_dword v28, v13, s[8:11], s42 offen offset:512 sc1
buffer_load_dword v32, v13, s[8:11], s42 offen offset:768 sc1
s_waitcnt vmcnt(0)
v_mfma_f32_16x16x32_bf16 v[120:123], v[56:59], v[40:43], 0
v_mfma_f32_16x16x32_bf16 v[124:127], v[72:75], v[40:43], 0
v_mfma_f32_16x16x32_bf16 v[128:131], v[88:91], v[40:43], 0
v_mfma_f32_16x16x32_bf16 v[120:123], v[60:63], v[44:47], v[120:123]
v_mfma_f32_16x16x32_bf16 v[124:127], v[76:79], v[44:47], v[124:127]
v_mfma_f32_16x16x32_bf16 v[128:131], v[92:95], v[44:47], v[128:131]
v_mfma_f32_16x16x32_bf16 v[120:123], v[64:67], v[48:51], v[120:123]
v_mfma_f32_16x16x32_bf16 v[124:127], v[80:83], v[48:51], v[124:127]
v_mfma_f32_16x16x32_bf16 v[128:131], v[96:99], v[48:51], v[128:131]
v_mfma_f32_16x16x32_bf16 v[120:123], v[68:71], v[52:55], v[120:123]
v_mfma_f32_16x16x32_bf16 v[124:127], v[84:87], v[52:55], v[124:127]
v_mfma_f32_16x16x32_bf16 v[128:131], v[100:103], v[52:55], v[128:131]
v_mov_b32 v140, 0xff800000
v_cmp_le_i32 vcc, 0, v5
s_nop 5
v_cndmask_b32 v128, v140, v128, vcc
v_cmp_le_i32 vcc, 1, v5
s_nop 1
v_cndmask_b32 v129, v140, v129, vcc
v_cmp_le_i32 vcc, 2, v5
s_nop 1
v_cndmask_b32 v130, v140, v130, vcc
v_cmp_le_i32 vcc, 3, v5
s_nop 1
v_cndmask_b32 v131, v140, v131, vcc
v_max3_f32 v141, v120, v121, v124
v_max3_f32 v141, v141, v125, v126
v_max3_f32 v141, v141, v127, v128
v_max3_f32 v141, v141, v129, v130
v_max_f32 v141, v141, v131
v_mov_b32 v142, v141
s_nop 1
v_permlane32_swap_b32 v141, v142
v_max_f32 v141, v141, v142
v_mov_b32 v142, v141
s_nop 1
v_permlane16_swap_b32 v141, v142
v_max_f32 v141, v141, v142
v_mul_f32 v143, s65, v141
v_fma_f32 v120, v120, s64, v143
v_fma_f32 v121, v121, s64, v143
v_fma_f32 v124, v124, s64, v143
v_fma_f32 v125, v125, s64, v143
v_fma_f32 v126, v126, s64, v143
v_fma_f32 v127, v127, s64, v143
v_fma_f32 v128, v128, s64, v143
v_fma_f32 v129, v129, s64, v143
v_fma_f32 v130, v130, s64, v143
v_fma_f32 v131, v131, s64, v143
v_exp_f32 v120, v120
v_exp_f32 v121, v121
v_exp_f32 v124, v124
v_exp_f32 v125, v125
v_exp_f32 v126, v126
v_exp_f32 v127, v127
v_exp_f32 v128, v128
v_exp_f32 v129, v129
v_exp_f32 v130, v130
v_exp_f32 v131, v131
v_cvt_pk_bf16_f32 v132, v124, v125
v_cvt_pk_bf16_f32 v133, v126, v127
v_cvt_pk_bf16_f32 v134, v128, v129
v_cvt_pk_bf16_f32 v135, v130, v131
v_cvt_pk_bf16_f32 v136, v120, v121
s_nop 0
v_mfma_f32_16x16x32_bf16 v[176:179], v[36:39], v[132:135], 0
v_mfma_f32_16x16x32_bf16 v[176:179], v[36:39], v[136:139], v[176:179]
v_mfma_f32_16x16x32_bf16 v[160:163], v[104:107], v[132:135], 0
v_mfma_f32_16x16x32_bf16 v[164:167], v[108:111], v[132:135], 0
v_mfma_f32_16x16x32_bf16 v[168:171], v[112:115], v[132:135], 0
v_mfma_f32_16x16x32_bf16 v[172:175], v[116:119], v[132:135], 0
v_mfma_f32_16x16x32_bf16 v[160:163], v[20:23], v[136:139], v[160:163]
v_mfma_f32_16x16x32_bf16 v[164:167], v[24:27], v[136:139], v[164:167]
v_mfma_f32_16x16x32_bf16 v[168:171], v[28:31], v[136:139], v[168:171]
v_mfma_f32_16x16x32_bf16 v[172:175], v[32:35], v[136:139], v[172:175]
v_rcp_f32 v142, v176
s_nop 3
v_mul_f32 v160, v160, v142
v_mul_f32 v161, v161, v142
v_mul_f32 v162, v162, v142
v_mul_f32 v163, v163, v142
v_mul_f32 v164, v164, v142
v_mul_f32 v165, v165, v142
v_mul_f32 v166, v166, v142
v_mul_f32 v167, v167, v142
v_mul_f32 v168, v168, v142
v_mul_f32 v169, v169, v142
v_mul_f32 v170, v170, v142
v_mul_f32 v171, v171, v142
v_mul_f32 v172, v172, v142
v_mul_f32 v173, v173, v142
v_mul_f32 v174, v174, v142
v_mul_f32 v175, v175, v142
v_cvt_pk_bf16_f32 v40, v160, v161
v_cvt_pk_bf16_f32 v41, v162, v163
v_cvt_pk_bf16_f32 v42, v164, v165
v_cvt_pk_bf16_f32 v43, v166, v167
ds_write_b128 v6, v[40:43] offset:0
v_cvt_pk_bf16_f32 v44, v168, v169
v_cvt_pk_bf16_f32 v45, v170, v171
v_cvt_pk_bf16_f32 v46, v172, v173
v_cvt_pk_bf16_f32 v47, v174, v175
ds_write_b128 v6, v[44:47] offset:2048
s_waitcnt lgkmcnt(0)
s_barrier
ds_read_b128 v[40:43], v2 offset:0
ds_read_b128 v[44:47], v2 offset:1024
ds_read_b128 v[48:51], v2 offset:2048
ds_read_b128 v[52:55], v2 offset:3072
ds_read_b128 v[56:59], v2 offset:4096
ds_read_b128 v[60:63], v2 offset:5120
ds_read_b128 v[64:67], v2 offset:6144
ds_read_b128 v[68:71], v2 offset:7168
s_waitcnt lgkmcnt(7)
v_mfma_f32_32x32x16_bf16 v[192:207], v[40:43], a[0:3], 0
v_mfma_f32_32x32x16_bf16 v[208:223], v[40:43], a[32:35], 0
v_mfma_f32_32x32x16_bf16 v[224:239], v[40:43], a[64:67], 0
v_mfma_f32_32x32x16_bf16 v[240:255], v[40:43], a[96:99], 0
s_waitcnt lgkmcnt(6)
v_mfma_f32_32x32x16_bf16 v[192:207], v[44:47], a[4:7], v[192:207]
v_mfma_f32_32x32x16_bf16 v[208:223], v[44:47], a[36:39], v[208:223]
v_mfma_f32_32x32x16_bf16 v[224:239], v[44:47], a[68:71], v[224:239]
v_mfma_f32_32x32x16_bf16 v[240:255], v[44:47], a[100:103], v[240:255]
s_waitcnt lgkmcnt(5)
v_mfma_f32_32x32x16_bf16 v[192:207], v[48:51], a[8:11], v[192:207]
v_mfma_f32_32x32x16_bf16 v[208:223], v[48:51], a[40:43], v[208:223]
v_mfma_f32_32x32x16_bf16 v[224:239], v[48:51], a[72:75], v[224:239]
v_mfma_f32_32x32x16_bf16 v[240:255], v[48:51], a[104:107], v[240:255]
s_waitcnt lgkmcnt(4)
v_mfma_f32_32x32x16_bf16 v[192:207], v[52:55], a[12:15], v[192:207]
v_mfma_f32_32x32x16_bf16 v[208:223], v[52:55], a[44:47], v[208:223]
v_mfma_f32_32x32x16_bf16 v[224:239], v[52:55], a[76:79], v[224:239]
v_mfma_f32_32x32x16_bf16 v[240:255], v[52:55], a[108:111], v[240:255]
s_waitcnt lgkmcnt(3)
v_mfma_f32_32x32x16_bf16 v[192:207], v[56:59], a[16:19], v[192:207]
v_mfma_f32_32x32x16_bf16 v[208:223], v[56:59], a[48:51], v[208:223]
v_mfma_f32_32x32x16_bf16 v[224:239], v[56:59], a[80:83], v[224:239]
v_mfma_f32_32x32x16_bf16 v[240:255], v[56:59], a[112:115], v[240:255]
s_waitcnt lgkmcnt(2)
v_mfma_f32_32x32x16_bf16 v[192:207], v[60:63], a[20:23], v[192:207]
v_mfma_f32_32x32x16_bf16 v[208:223], v[60:63], a[52:55], v[208:223]
v_mfma_f32_32x32x16_bf16 v[224:239], v[60:63], a[84:87], v[224:239]
v_mfma_f32_32x32x16_bf16 v[240:255], v[60:63], a[116:119], v[240:255]
s_waitcnt lgkmcnt(1)
v_mfma_f32_32x32x16_bf16 v[192:207], v[64:67], a[24:27], v[192:207]
v_mfma_f32_32x32x16_bf16 v[208:223], v[64:67], a[56:59], v[208:223]
v_mfma_f32_32x32x16_bf16 v[224:239], v[64:67], a[88:91], v[224:239]
v_mfma_f32_32x32x16_bf16 v[240:255], v[64:67], a[120:123], v[240:255]
s_waitcnt lgkmcnt(0)
v_mfma_f32_32x32x16_bf16 v[192:207], v[68:71], a[28:31], v[192:207]
v_mfma_f32_32x32x16_bf16 v[208:223], v[68:71], a[60:63], v[208:223]
v_mfma_f32_32x32x16_bf16 v[224:239], v[68:71], a[92:95], v[224:239]
v_mfma_f32_32x32x16_bf16 v[240:255], v[68:71], a[124:127], v[240:255]
s_lshl_b32 s40, s68, 10
s_add_u32 s40, s40, s38
s_add_u32 s40, s40, 0x100
s_nop 6
v_cvt_pk_bf16_f32 v40, v192, v208
s_add_u32 s41, s40, s48
buffer_store_dword v40, v7, s[8:11], s41 offen offset:0 nt
v_cvt_pk_bf16_f32 v41, v193, v209
s_add_u32 s42, s40, s49
buffer_store_dword v41, v7, s[8:11], s42 offen offset:0 nt
v_cvt_pk_bf16_f32 v42, v194, v210
s_add_u32 s41, s40, s50
buffer_store_dword v42, v7, s[8:11], s41 offen offset:0 nt
v_cvt_pk_bf16_f32 v43, v195, v211
s_add_u32 s42, s40, s51
buffer_store_dword v43, v7, s[8:11], s42 offen offset:0 nt
v_cvt_pk_bf16_f32 v44, v196, v212
s_add_u32 s41, s40, s52
buffer_store_dword v44, v7, s[8:11], s41 offen offset:0 nt
v_cvt_pk_bf16_f32 v45, v197, v213
s_add_u32 s42, s40, s53
buffer_store_dword v45, v7, s[8:11], s42 offen offset:0 nt
v_cvt_pk_bf16_f32 v46, v198, v214
s_add_u32 s41, s40, s54
buffer_store_dword v46, v7, s[8:11], s41 offen offset:0 nt
v_cvt_pk_bf16_f32 v47, v199, v215
s_add_u32 s42, s40, s55
buffer_store_dword v47, v7, s[8:11], s42 offen offset:0 nt
v_cvt_pk_bf16_f32 v40, v200, v216
s_add_u32 s41, s40, s56
buffer_store_dword v40, v7, s[8:11], s41 offen offset:0 nt
v_cvt_pk_bf16_f32 v41, v201, v217
s_add_u32 s42, s40, s57
buffer_store_dword v41, v7, s[8:11], s42 offen offset:0 nt
v_cvt_pk_bf16_f32 v42, v202, v218
s_add_u32 s41, s40, s58
buffer_store_dword v42, v7, s[8:11], s41 offen offset:0 nt
v_cvt_pk_bf16_f32 v43, v203, v219
s_add_u32 s42, s40, s59
buffer_store_dword v43, v7, s[8:11], s42 offen offset:0 nt
v_cvt_pk_bf16_f32 v44, v204, v220
s_add_u32 s41, s40, s60
buffer_store_dword v44, v7, s[8:11], s41 offen offset:0 nt
v_cvt_pk_bf16_f32 v45, v205, v221
s_add_u32 s42, s40, s61
buffer_store_dword v45, v7, s[8:11], s42 offen offset:0 nt
v_cvt_pk_bf16_f32 v46, v206, v222
s_add_u32 s41, s40, s62
buffer_store_dword v46, v7, s[8:11], s41 offen offset:0 nt
v_cvt_pk_bf16_f32 v47, v207, v223
s_add_u32 s42, s40, s63
buffer_store_dword v47, v7, s[8:11], s42 offen offset:0 nt
v_cvt_pk_bf16_f32 v40, v224, v240
s_add_u32 s41, s40, s48
buffer_store_dword v40, v7, s[8:11], s41 offen offset:128 nt
v_cvt_pk_bf16_f32 v41, v225, v241
s_add_u32 s42, s40, s49
buffer_store_dword v41, v7, s[8:11], s42 offen offset:128 nt
v_cvt_pk_bf16_f32 v42, v226, v242
s_add_u32 s41, s40, s50
buffer_store_dword v42, v7, s[8:11], s41 offen offset:128 nt
v_cvt_pk_bf16_f32 v43, v227, v243
s_add_u32 s42, s40, s51
buffer_store_dword v43, v7, s[8:11], s42 offen offset:128 nt
v_cvt_pk_bf16_f32 v44, v228, v244
s_add_u32 s41, s40, s52
buffer_store_dword v44, v7, s[8:11], s41 offen offset:128 nt
v_cvt_pk_bf16_f32 v45, v229, v245
s_add_u32 s42, s40, s53
buffer_store_dword v45, v7, s[8:11], s42 offen offset:128 nt
v_cvt_pk_bf16_f32 v46, v230, v246
s_add_u32 s41, s40, s54
buffer_store_dword v46, v7, s[8:11], s41 offen offset:128 nt
v_cvt_pk_bf16_f32 v47, v231, v247
s_add_u32 s42, s40, s55
buffer_store_dword v47, v7, s[8:11], s42 offen offset:128 nt
v_cvt_pk_bf16_f32 v40, v232, v248
s_add_u32 s41, s40, s56
buffer_store_dword v40, v7, s[8:11], s41 offen offset:128 nt
v_cvt_pk_bf16_f32 v41, v233, v249
s_add_u32 s42, s40, s57
buffer_store_dword v41, v7, s[8:11], s42 offen offset:128 nt
v_cvt_pk_bf16_f32 v42, v234, v250
s_add_u32 s41, s40, s58
buffer_store_dword v42, v7, s[8:11], s41 offen offset:128 nt
v_cvt_pk_bf16_f32 v43, v235, v251
s_add_u32 s42, s40, s59
buffer_store_dword v43, v7, s[8:11], s42 offen offset:128 nt
v_cvt_pk_bf16_f32 v44, v236, v252
s_add_u32 s41, s40, s60
buffer_store_dword v44, v7, s[8:11], s41 offen offset:128 nt
v_cvt_pk_bf16_f32 v45, v237, v253
s_add_u32 s42, s40, s61
buffer_store_dword v45, v7, s[8:11], s42 offen offset:128 nt
v_cvt_pk_bf16_f32 v46, v238, v254
s_add_u32 s41, s40, s62
buffer_store_dword v46, v7, s[8:11], s41 offen offset:128 nt
v_cvt_pk_bf16_f32 v47, v239, v255
s_add_u32 s42, s40, s63
buffer_store_dword v47, v7, s[8:11], s42 offen offset:128 nt
s_waitcnt vmcnt(0)
s_barrier
s_barrier
s_lshl_b32 s40, s68, 15
s_add_u32 s40, s40, s38
s_add_u32 s40, s40, 0x100
s_add_u32 s41, s40, 0
buffer_load_dwordx4 v[40:43], v8, s[8:11], s41 offen sc1
s_add_u32 s41, s40, 4096
buffer_load_dwordx4 v[44:47], v8, s[8:11], s41 offen sc1
s_add_u32 s41, s40, 8192
buffer_load_dwordx4 v[48:51], v8, s[8:11], s41 offen sc1
s_add_u32 s41, s40, 12288
buffer_load_dwordx4 v[52:55], v8, s[8:11], s41 offen sc1
s_add_u32 s41, s40, 16384
buffer_load_dwordx4 v[56:59], v8, s[8:11], s41 offen sc1
s_add_u32 s41, s40, 20480
buffer_load_dwordx4 v[60:63], v8, s[8:11], s41 offen sc1
s_add_u32 s41, s40, 24576
buffer_load_dwordx4 v[64:67], v8, s[8:11], s41 offen sc1
s_add_u32 s41, s40, 28672
buffer_load_dwordx4 v[68:71], v8, s[8:11], s41 offen sc1
s_waitcnt vmcnt(7)
v_mfma_f32_16x16x32_bf16 v[160:163], v[40:43], v[16:19], 0
s_waitcnt vmcnt(6)
v_mfma_f32_16x16x32_bf16 v[160:163], v[44:47], v[16:19], v[160:163]
s_waitcnt vmcnt(5)
v_mfma_f32_16x16x32_bf16 v[160:163], v[48:51], v[16:19], v[160:163]
s_waitcnt vmcnt(4)
v_mfma_f32_16x16x32_bf16 v[160:163], v[52:55], v[16:19], v[160:163]
s_waitcnt vmcnt(3)
v_mfma_f32_16x16x32_bf16 v[160:163], v[56:59], v[16:19], v[160:163]
s_waitcnt vmcnt(2)
v_mfma_f32_16x16x32_bf16 v[160:163], v[60:63], v[16:19], v[160:163]
s_waitcnt vmcnt(1)
v_mfma_f32_16x16x32_bf16 v[160:163], v[64:67], v[16:19], v[160:163]
s_waitcnt vmcnt(0)
v_mfma_f32_16x16x32_bf16 v[160:163], v[68:71], v[16:19], v[160:163]
s_nop 7
ds_write_b32 v9, v160 offset:0
ds_write_b32 v9, v161 offset:16
ds_write_b32 v9, v162 offset:32
ds_write_b32 v9, v163 offset:48
s_waitcnt lgkmcnt(0)
s_barrier
v_lshlrev_b32 v147, 1, v10
ds_read_b64 v[148:149], v147 offset:8192
s_waitcnt lgkmcnt(0)
v_lshlrev_b32 v150, 16, v152
v_and_b32 v151, 0xffff0000, v152
v_accvgpr_read_b32 v144, a240
v_accvgpr_read_b32 v145, a241
v_cvt_pk_bf16_f32 v148, v148, v148
v_and_b32 v148, 0xffff0000, v148
v_mul_f32 v148, v148, v144
v_cvt_pk_bf16_f32 v148, v148, v148
v_and_b32 v148, 0xffff0000, v148
v_add_f32 v150, v150, v148
v_cvt_pk_bf16_f32 v150, v150, v150
v_and_b32 v150, 0xffff0000, v150
v_cvt_pk_bf16_f32 v149, v149, v149
v_and_b32 v149, 0xffff0000, v149
v_mul_f32 v149, v149, v145
v_cvt_pk_bf16_f32 v149, v149, v149
v_and_b32 v149, 0xffff0000, v149
v_add_f32 v151, v151, v149
v_cvt_pk_bf16_f32 v151, v151, v151
v_and_b32 v151, 0xffff0000, v151
v_accvgpr_write_b32 a248, v150
v_accvgpr_write_b32 a249, v151
v_add_f32 v156, v150, v151
v_mul_f32 v157, v150, v150
v_fmac_f32 v157, v151, v151
v_add_f32_dpp v156, v156, v156 quad_perm:[1,0,3,2] row_mask:0xf bank_mask:0xf
s_nop 1
v_add_f32_dpp v156, v156, v156 quad_perm:[2,3,0,1] row_mask:0xf bank_mask:0xf
s_nop 1
v_add_f32_dpp v156, v156, v156 row_half_mirror row_mask:0xf bank_mask:0xf
s_nop 1
v_add_f32_dpp v156, v156, v156 row_mirror row_mask:0xf bank_mask:0xf
v_mov_b32 v155, v156
s_nop 1
v_permlane16_swap_b32 v156, v155
v_add_f32 v156, v156, v155
v_mov_b32 v155, v156
s_nop 1
v_permlane32_swap_b32 v156, v155
v_add_f32 v156, v156, v155
v_add_f32_dpp v157, v157, v157 quad_perm:[1,0,3,2] row_mask:0xf bank_mask:0xf
s_nop 1
v_add_f32_dpp v157, v157, v157 quad_perm:[2,3,0,1] row_mask:0xf bank_mask:0xf
s_nop 1
v_add_f32_dpp v157, v157, v157 row_half_mirror row_mask:0xf bank_mask:0xf
s_nop 1
v_add_f32_dpp v157, v157, v157 row_mirror row_mask:0xf bank_mask:0xf
v_mov_b32 v155, v157
s_nop 1
v_permlane16_swap_b32 v157, v155
v_add_f32 v157, v157, v155
v_mov_b32 v155, v157
s_nop 1
v_permlane32_swap_b32 v157, v155
v_add_f32 v157, v157, v155
v_mov_b32 v155, 10312
ds_write_b64 v155, v[156:157]
s_waitcnt lgkmcnt(0)
s_barrier
v_mov_b32 v155, 10304
ds_read_b128 v[160:163], v155
ds_read_b128 v[164:167], v155 offset:16
s_waitcnt lgkmcnt(0)
v_add_f32 v156, v160, v162
v_add_f32 v157, v161, v163
v_add_f32 v156, v156, v164
v_add_f32 v157, v157, v165
v_add_f32 v156, v156, v166
v_add_f32 v157, v157, v167
v_mul_f32 v156, 0x3b000000, v156
v_mul_f32 v157, 0x3b000000, v157
v_fma_f32 v157, -v156, v156, v157
v_max_f32 v157, 0, v157
v_cvt_pk_bf16_f32 v156, v156, v156
v_and_b32 v156, 0xffff0000, v156
v_cvt_pk_bf16_f32 v157, v157, v157
v_and_b32 v157, 0xffff0000, v157
v_add_f32 v157, 0x3727c5ac, v157
v_cvt_pk_bf16_f32 v157, v157, v157
v_and_b32 v157, 0xffff0000, v157
v_sqrt_f32 v157, v157
s_nop 0
v_cvt_pk_bf16_f32 v157, v157, v157
v_and_b32 v157, 0xffff0000, v157
v_rcp_f32 v157, v157
v_accvgpr_read_b32 v144, a244
v_accvgpr_read_b32 v145, a245
v_accvgpr_read_b32 v148, a242
v_accvgpr_read_b32 v149, a243
v_sub_f32 v150, v150, v156
v_mul_f32 v150, v150, v157
v_fma_f32 v150, v150, v144, v148
v_sub_f32 v151, v151, v156
v_mul_f32 v151, v151, v157
v_fma_f32 v151, v151, v145, v149
v_cvt_pk_bf16_f32 v150, v150, v151
s_add_u32 s40, s38, 0x200000
buffer_store_dword v150, v11, s[8:11], s40 offen nt
s_waitcnt vmcnt(0)
s_barrier
s_barrier
s_add_u32 s40, s38, 0x202000
s_mov_b32 m0, 40960
s_add_u32 s41, s40, 0
buffer_load_dwordx4 v2, s[8:11], s41 offen sc1 lds
s_mov_b32 m0, 41984
s_add_u32 s41, s40, 1024
buffer_load_dwordx4 v2, s[8:11], s41 offen sc1 lds
s_mov_b32 m0, 43008
s_add_u32 s41, s40, 2048
buffer_load_dwordx4 v2, s[8:11], s41 offen sc1 lds
s_mov_b32 m0, 44032
s_add_u32 s41, s40, 3072
buffer_load_dwordx4 v2, s[8:11], s41 offen sc1 lds
s_mov_b32 m0, 45056
s_add_u32 s41, s40, 4096
buffer_load_dwordx4 v2, s[8:11], s41 offen sc1 lds
s_mov_b32 m0, 46080
s_add_u32 s41, s40, 5120
buffer_load_dwordx4 v2, s[8:11], s41 offen sc1 lds
s_mov_b32 m0, 47104
s_add_u32 s41, s40, 6144
buffer_load_dwordx4 v2, s[8:11], s41 offen sc1 lds
s_mov_b32 m0, 48128
s_add_u32 s41, s40, 7168
buffer_load_dwordx4 v2, s[8:11], s41 offen sc1 lds
s_waitcnt vmcnt(0)
s_barrier
ds_read_b128 v[56:59], v2 offset:32768
ds_read_b128 v[60:63], v2 offset:33792
ds_read_b128 v[64:67], v2 offset:34816
ds_read_b128 v[68:71], v2 offset:35840
ds_read_b128 v[72:75], v2 offset:36864
ds_read_b128 v[76:79], v2 offset:37888
ds_read_b128 v[80:83], v2 offset:38912
ds_read_b128 v[84:87], v2 offset:39936
ds_read_b128 v[88:91], v2 offset:40960
ds_read_b128 v[92:95], v2 offset:41984
ds_read_b128 v[96:99], v2 offset:43008
ds_read_b128 v[100:103], v2 offset:44032
ds_read_b128 v[104:107], v2 offset:45056
ds_read_b128 v[108:111], v2 offset:46080
ds_read_b128 v[112:115], v2 offset:47104
ds_read_b128 v[116:119], v2 offset:48128
s_waitcnt lgkmcnt(15)
v_mfma_f32_16x16x32_bf16 v[160:163], a[176:179], v[56:59], 0
s_waitcnt lgkmcnt(14)
v_mfma_f32_16x16x32_bf16 v[160:163], a[180:183], v[60:63], v[160:163]
s_waitcnt lgkmcnt(13)
v_mfma_f32_16x16x32_bf16 v[160:163], a[184:187], v[64:67], v[160:163]
s_waitcnt lgkmcnt(12)
v_mfma_f32_16x16x32_bf16 v[160:163], a[188:191], v[68:71], v[160:163]
s_waitcnt lgkmcnt(11)
v_mfma_f32_16x16x32_bf16 v[160:163], a[192:195], v[72:75], v[160:163]
s_waitcnt lgkmcnt(10)
v_mfma_f32_16x16x32_bf16 v[160:163], a[196:199], v[76:79], v[160:163]
s_waitcnt lgkmcnt(9)
v_mfma_f32_16x16x32_bf16 v[160:163], a[200:203], v[80:83], v[160:163]
s_waitcnt lgkmcnt(8)
v_mfma_f32_16x16x32_bf16 v[160:163], a[204:207], v[84:87], v[160:163]
s_waitcnt lgkmcnt(7)
v_mfma_f32_16x16x32_bf16 v[160:163], a[208:211], v[88:91], v[160:163]
s_waitcnt lgkmcnt(6)
v_mfma_f32_16x16x32_bf16 v[160:163], a[212:215], v[92:95], v[160:163]
s_waitcnt lgkmcnt(5)
v_mfma_f32_16x16x32_bf16 v[160:163], a[216:219], v[96:99], v[160:163]
s_waitcnt lgkmcnt(4)
v_mfma_f32_16x16x32_bf16 v[160:163], a[220:223], v[100:103], v[160:163]
s_waitcnt lgkmcnt(3)
v_mfma_f32_16x16x32_bf16 v[160:163], a[224:227], v[104:107], v[160:163]
s_waitcnt lgkmcnt(2)
v_mfma_f32_16x16x32_bf16 v[160:163], a[228:231], v[108:111], v[160:163]
s_waitcnt lgkmcnt(1)
v_mfma_f32_16x16x32_bf16 v[160:163], a[232:235], v[112:115], v[160:163]
s_waitcnt lgkmcnt(0)
v_mfma_f32_16x16x32_bf16 v[160:163], a[236:239], v[116:119], v[160:163]
ds_read_b128 v[56:59], v2 offset:49152
ds_read_b128 v[60:63], v2 offset:50176
ds_read_b128 v[64:67], v2 offset:51200
ds_read_b128 v[68:71], v2 offset:52224
ds_read_b128 v[72:75], v2 offset:53248
ds_read_b128 v[76:79], v2 offset:54272
ds_read_b128 v[80:83], v2 offset:55296
ds_read_b128 v[84:87], v2 offset:56320
ds_read_b128 v[88:91], v2 offset:57344
ds_read_b128 v[92:95], v2 offset:58368
ds_read_b128 v[96:99], v2 offset:59392
ds_read_b128 v[100:103], v2 offset:60416
ds_read_b128 v[104:107], v2 offset:61440
ds_read_b128 v[108:111], v2 offset:62464
ds_read_b128 v[112:115], v2 offset:63488
ds_read_b128 v[116:119], v2 offset:64512
s_waitcnt lgkmcnt(15)
v_mfma_f32_16x16x32_bf16 v[164:167], a[176:179], v[56:59], 0
s_waitcnt lgkmcnt(14)
v_mfma_f32_16x16x32_bf16 v[164:167], a[180:183], v[60:63], v[164:167]
s_waitcnt lgkmcnt(13)
v_mfma_f32_16x16x32_bf16 v[164:167], a[184:187], v[64:67], v[164:167]
s_waitcnt lgkmcnt(12)
v_mfma_f32_16x16x32_bf16 v[164:167], a[188:191], v[68:71], v[164:167]
s_waitcnt lgkmcnt(11)
v_mfma_f32_16x16x32_bf16 v[164:167], a[192:195], v[72:75], v[164:167]
s_waitcnt lgkmcnt(10)
v_mfma_f32_16x16x32_bf16 v[164:167], a[196:199], v[76:79], v[164:167]
s_waitcnt lgkmcnt(9)
v_mfma_f32_16x16x32_bf16 v[164:167], a[200:203], v[80:83], v[164:167]
s_waitcnt lgkmcnt(8)
v_mfma_f32_16x16x32_bf16 v[164:167], a[204:207], v[84:87], v[164:167]
s_waitcnt lgkmcnt(7)
v_mfma_f32_16x16x32_bf16 v[164:167], a[208:211], v[88:91], v[164:167]
s_waitcnt lgkmcnt(6)
v_mfma_f32_16x16x32_bf16 v[164:167], a[212:215], v[92:95], v[164:167]
s_waitcnt lgkmcnt(5)
v_mfma_f32_16x16x32_bf16 v[164:167], a[216:219], v[96:99], v[164:167]
s_waitcnt lgkmcnt(4)
v_mfma_f32_16x16x32_bf16 v[164:167], a[220:223], v[100:103], v[164:167]
s_waitcnt lgkmcnt(3)
v_mfma_f32_16x16x32_bf16 v[164:167], a[224:227], v[104:107], v[164:167]
s_waitcnt lgkmcnt(2)
v_mfma_f32_16x16x32_bf16 v[164:167], a[228:231], v[108:111], v[164:167]
s_waitcnt lgkmcnt(1)
v_mfma_f32_16x16x32_bf16 v[164:167], a[232:235], v[112:115], v[164:167]
s_waitcnt lgkmcnt(0)
v_mfma_f32_16x16x32_bf16 v[164:167], a[236:239], v[116:119], v[164:167]
v_max_f32 v160, 0, v160
v_max_f32 v161, 0, v161
v_max_f32 v162, 0, v162
v_max_f32 v163, 0, v163
v_cvt_pk_bf16_f32 v168, v160, v161
v_cvt_pk_bf16_f32 v169, v162, v163
ds_write_b64 v12, v[168:169] offset:0
s_nop 0
v_max_f32 v164, 0, v164
v_max_f32 v165, 0, v165
v_max_f32 v166, 0, v166
v_max_f32 v167, 0, v167
v_cvt_pk_bf16_f32 v170, v164, v165
v_cvt_pk_bf16_f32 v171, v166, v167
ds_write_b64 v12, v[170:171] offset:256
s_waitcnt lgkmcnt(0)
s_barrier
ds_read_b128 v[40:43], v2 offset:12288
ds_read_b128 v[44:47], v2 offset:13312
ds_read_b128 v[48:51], v2 offset:14336
s_waitcnt lgkmcnt(2)
v_mfma_f32_32x32x16_bf16 v[192:207], v[40:43], a[128:131], 0
v_mfma_f32_32x32x16_bf16 v[208:223], v[40:43], a[140:143], 0
v_mfma_f32_32x32x16_bf16 v[224:239], v[40:43], a[152:155], 0
v_mfma_f32_32x32x16_bf16 v[240:255], v[40:43], a[164:167], 0
s_waitcnt lgkmcnt(1)
v_mfma_f32_32x32x16_bf16 v[192:207], v[44:47], a[132:135], v[192:207]
v_mfma_f32_32x32x16_bf16 v[208:223], v[44:47], a[144:147], v[208:223]
v_mfma_f32_32x32x16_bf16 v[224:239], v[44:47], a[156:159], v[224:239]
v_mfma_f32_32x32x16_bf16 v[240:255], v[44:47], a[168:171], v[240:255]
s_waitcnt lgkmcnt(0)
v_mfma_f32_32x32x16_bf16 v[192:207], v[48:51], a[136:139], v[192:207]
v_mfma_f32_32x32x16_bf16 v[208:223], v[48:51], a[148:151], v[208:223]
v_mfma_f32_32x32x16_bf16 v[224:239], v[48:51], a[160:163], v[224:239]
v_mfma_f32_32x32x16_bf16 v[240:255], v[48:51], a[172:175], v[240:255]
s_lshl_b32 s40, s68, 10
s_add_u32 s40, s40, s38
s_add_u32 s40, s40, 0x100100
s_nop 6
v_cvt_pk_bf16_f32 v40, v192, v208
s_add_u32 s41, s40, s48
buffer_store_dword v40, v7, s[8:11], s41 offen offset:0 nt
v_cvt_pk_bf16_f32 v41, v193, v209
s_add_u32 s42, s40, s49
buffer_store_dword v41, v7, s[8:11], s42 offen offset:0 nt
v_cvt_pk_bf16_f32 v42, v194, v210
s_add_u32 s41, s40, s50
buffer_store_dword v42, v7, s[8:11], s41 offen offset:0 nt
v_cvt_pk_bf16_f32 v43, v195, v211
s_add_u32 s42, s40, s51
buffer_store_dword v43, v7, s[8:11], s42 offen offset:0 nt
v_cvt_pk_bf16_f32 v44, v196, v212
s_add_u32 s41, s40, s52
buffer_store_dword v44, v7, s[8:11], s41 offen offset:0 nt
v_cvt_pk_bf16_f32 v45, v197, v213
s_add_u32 s42, s40, s53
buffer_store_dword v45, v7, s[8:11], s42 offen offset:0 nt
v_cvt_pk_bf16_f32 v46, v198, v214
s_add_u32 s41, s40, s54
buffer_store_dword v46, v7, s[8:11], s41 offen offset:0 nt
v_cvt_pk_bf16_f32 v47, v199, v215
s_add_u32 s42, s40, s55
buffer_store_dword v47, v7, s[8:11], s42 offen offset:0 nt
v_cvt_pk_bf16_f32 v40, v200, v216
s_add_u32 s41, s40, s56
buffer_store_dword v40, v7, s[8:11], s41 offen offset:0 nt
v_cvt_pk_bf16_f32 v41, v201, v217
s_add_u32 s42, s40, s57
buffer_store_dword v41, v7, s[8:11], s42 offen offset:0 nt
v_cvt_pk_bf16_f32 v42, v202, v218
s_add_u32 s41, s40, s58
buffer_store_dword v42, v7, s[8:11], s41 offen offset:0 nt
v_cvt_pk_bf16_f32 v43, v203, v219
s_add_u32 s42, s40, s59
buffer_store_dword v43, v7, s[8:11], s42 offen offset:0 nt
v_cvt_pk_bf16_f32 v44, v204, v220
s_add_u32 s41, s40, s60
buffer_store_dword v44, v7, s[8:11], s41 offen offset:0 nt
v_cvt_pk_bf16_f32 v45, v205, v221
s_add_u32 s42, s40, s61
buffer_store_dword v45, v7, s[8:11], s42 offen offset:0 nt
v_cvt_pk_bf16_f32 v46, v206, v222
s_add_u32 s41, s40, s62
buffer_store_dword v46, v7, s[8:11], s41 offen offset:0 nt
v_cvt_pk_bf16_f32 v47, v207, v223
s_add_u32 s42, s40, s63
buffer_store_dword v47, v7, s[8:11], s42 offen offset:0 nt
v_cvt_pk_bf16_f32 v40, v224, v240
s_add_u32 s41, s40, s48
buffer_store_dword v40, v7, s[8:11], s41 offen offset:128 nt
v_cvt_pk_bf16_f32 v41, v225, v241
s_add_u32 s42, s40, s49
buffer_store_dword v41, v7, s[8:11], s42 offen offset:128 nt
v_cvt_pk_bf16_f32 v42, v226, v242
s_add_u32 s41, s40, s50
buffer_store_dword v42, v7, s[8:11], s41 offen offset:128 nt
v_cvt_pk_bf16_f32 v43, v227, v243
s_add_u32 s42, s40, s51
buffer_store_dword v43, v7, s[8:11], s42 offen offset:128 nt
v_cvt_pk_bf16_f32 v44, v228, v244
s_add_u32 s41, s40, s52
buffer_store_dword v44, v7, s[8:11], s41 offen offset:128 nt
v_cvt_pk_bf16_f32 v45, v229, v245
s_add_u32 s42, s40, s53
buffer_store_dword v45, v7, s[8:11], s42 offen offset:128 nt
v_cvt_pk_bf16_f32 v46, v230, v246
s_add_u32 s41, s40, s54
buffer_store_dword v46, v7, s[8:11], s41 offen offset:128 nt
v_cvt_pk_bf16_f32 v47, v231, v247
s_add_u32 s42, s40, s55
buffer_store_dword v47, v7, s[8:11], s42 offen offset:128 nt
v_cvt_pk_bf16_f32 v40, v232, v248
s_add_u32 s41, s40, s56
buffer_store_dword v40, v7, s[8:11], s41 offen offset:128 nt
v_cvt_pk_bf16_f32 v41, v233, v249
s_add_u32 s42, s40, s57
buffer_store_dword v41, v7, s[8:11], s42 offen offset:128 nt
v_cvt_pk_bf16_f32 v42, v234, v250
s_add_u32 s41, s40, s58
buffer_store_dword v42, v7, s[8:11], s41 offen offset:128 nt
v_cvt_pk_bf16_f32 v43, v235, v251
s_add_u32 s42, s40, s59
buffer_store_dword v43, v7, s[8:11], s42 offen offset:128 nt
v_cvt_pk_bf16_f32 v44, v236, v252
s_add_u32 s41, s40, s60
buffer_store_dword v44, v7, s[8:11], s41 offen offset:128 nt
v_cvt_pk_bf16_f32 v45, v237, v253
s_add_u32 s42, s40, s61
buffer_store_dword v45, v7, s[8:11], s42 offen offset:128 nt
v_cvt_pk_bf16_f32 v46, v238, v254
s_add_u32 s41, s40, s62
buffer_store_dword v46, v7, s[8:11], s41 offen offset:128 nt
v_cvt_pk_bf16_f32 v47, v239, v255
s_add_u32 s42, s40, s63
buffer_store_dword v47, v7, s[8:11], s42 offen offset:128 nt
s_waitcnt vmcnt(0)
s_barrier
s_barrier
s_lshl_b32 s40, s68, 15
s_add_u32 s40, s40, s38
s_add_u32 s40, s40, 0x100100
s_add_u32 s41, s40, 0
buffer_load_dwordx4 v[40:43], v8, s[8:11], s41 offen sc1
s_add_u32 s41, s40, 4096
buffer_load_dwordx4 v[44:47], v8, s[8:11], s41 offen sc1
s_add_u32 s41, s40, 8192
buffer_load_dwordx4 v[48:51], v8, s[8:11], s41 offen sc1
s_add_u32 s41, s40, 12288
buffer_load_dwordx4 v[52:55], v8, s[8:11], s41 offen sc1
s_add_u32 s41, s40, 16384
buffer_load_dwordx4 v[56:59], v8, s[8:11], s41 offen sc1
s_add_u32 s41, s40, 20480
buffer_load_dwordx4 v[60:63], v8, s[8:11], s41 offen sc1
s_add_u32 s41, s40, 24576
buffer_load_dwordx4 v[64:67], v8, s[8:11], s41 offen sc1
s_add_u32 s41, s40, 28672
buffer_load_dwordx4 v[68:71], v8, s[8:11], s41 offen sc1
s_waitcnt vmcnt(7)
v_mfma_f32_16x16x32_bf16 v[160:163], v[40:43], v[16:19], 0
s_waitcnt vmcnt(6)
v_mfma_f32_16x16x32_bf16 v[160:163], v[44:47], v[16:19], v[160:163]
s_waitcnt vmcnt(5)
v_mfma_f32_16x16x32_bf16 v[160:163], v[48:51], v[16:19], v[160:163]
s_waitcnt vmcnt(4)
v_mfma_f32_16x16x32_bf16 v[160:163], v[52:55], v[16:19], v[160:163]
s_waitcnt vmcnt(3)
v_mfma_f32_16x16x32_bf16 v[160:163], v[56:59], v[16:19], v[160:163]
s_waitcnt vmcnt(2)
v_mfma_f32_16x16x32_bf16 v[160:163], v[60:63], v[16:19], v[160:163]
s_waitcnt vmcnt(1)
v_mfma_f32_16x16x32_bf16 v[160:163], v[64:67], v[16:19], v[160:163]
s_waitcnt vmcnt(0)
v_mfma_f32_16x16x32_bf16 v[160:163], v[68:71], v[16:19], v[160:163]
s_nop 7
ds_write_b32 v9, v160 offset:0
ds_write_b32 v9, v161 offset:16
ds_write_b32 v9, v162 offset:32
ds_write_b32 v9, v163 offset:48
s_waitcnt lgkmcnt(0)
s_barrier
v_lshlrev_b32 v147, 1, v10
ds_read_b64 v[148:149], v147 offset:8192
s_waitcnt lgkmcnt(0)
v_accvgpr_read_b32 v144, a246
v_accvgpr_read_b32 v145, a247
v_accvgpr_read_b32 v150, a248
v_accvgpr_read_b32 v151, a249
v_cvt_pk_bf16_f32 v148, v148, v148
v_and_b32 v148, 0xffff0000, v148
v_mul_f32 v148, v148, v144
v_cvt_pk_bf16_f32 v148, v148, v148
v_and_b32 v148, 0xffff0000, v148
v_add_f32 v150, v150, v148
v_cvt_pk_bf16_f32 v149, v149, v149
v_and_b32 v149, 0xffff0000, v149
v_mul_f32 v149, v149, v145
v_cvt_pk_bf16_f32 v149, v149, v149
v_and_b32 v149, 0xffff0000, v149
v_add_f32 v151, v151, v149
v_cvt_pk_bf16_f32 v150, v150, v151
s_lshl_b32 s40, s36, 5
s_add_u32 s40, s40, s68
s_lshl_b32 s40, s40, 10
buffer_store_dword v150, v10, s[4:7], s40 offen
s_add_u32 s36, s36, 7
s_add_u32 s37, s37, 1
s_branch L_tail_w1_f
L_tailend_w1_f:
s_waitcnt vmcnt(0)
s_endpgm
L_tw2:
v_lshlrev_b32 v2, 4, v3
v_lshlrev_b32 v13, 2, v3
v_and_b32 v140, 15, v3
v_lshrrev_b32 v141, 4, v3
v_lshrrev_b32 v142, 2, v140
v_and_b32 v143, 1, v140
v_lshl_add_u32 v142, v142, 1, v143
v_lshl_add_u32 v142, v141, 3, v142
v_lshlrev_b32 v4, 4, v142
v_lshlrev_b32 v142, 2, v141
v_sub_u32 v5, v140, v142
v_lshrrev_b32 v142, 1, v141
v_lshlrev_b32 v142, 6, v142
v_and_b32 v143, 1, v141
v_lshl_add_u32 v142, v143, 5, v142
v_add3_u32 v142, v142, v140, 0
v_lshlrev_b32 v142, 4, v142
v_add_u32 v6, 0, v142
v_lshrrev_b32 v142, 5, v3
v_lshlrev_b32 v142, 17, v142
v_and_b32 v143, 31, v3
v_lshl_add_u32 v7, v143, 2, v142
v_lshlrev_b32 v142, 10, v141
v_lshl_add_u32 v8, v140, 4, v142
v_lshrrev_b32 v142, 1, v141
v_lshlrev_b32 v142, 6, v142
v_and_b32 v143, 1, v140
v_lshl_add_u32 v142, v143, 5, v142
v_and_b32 v143, 1, v141
v_lshl_add_u32 v142, v143, 4, v142
v_lshrrev_b32 v143, 1, v140
v_add3_u32 v142, v142, v143, 0
v_add_u32 v142, 256, v142
v_lshlrev_b32 v142, 2, v142
v_add_u32 v142, 8192, v142
v_mov_b32 v9, 10240
v_cmp_gt_u32 vcc, 8, v140
s_nop 1
v_cndmask_b32 v9, v9, v142, vcc
v_add_u32 v142, 128, v3
v_lshlrev_b32 v10, 2, v142
v_lshrrev_b32 v143, 4, v142
v_lshlrev_b32 v143, 10, v143
v_bfe_u32 v144, v142, 2, 2
v_lshl_add_u32 v143, v144, 8, v143
v_and_b32 v144, 3, v142
v_lshl_add_u32 v143, v144, 2, v143
s_lshr_b32 s40, s68, 4
s_lshl_b32 s40, s40, 14
s_and_b32 s41, s68, 15
s_lshl_b32 s41, s41, 4
s_add_u32 s40, s40, s41
v_add_u32 v11, s40, v143
v_lshrrev_b32 v142, 1, v141
v_lshlrev_b32 v142, 5, v142
v_add_u32 v142, v142, v140
v_lshlrev_b32 v142, 4, v142
v_and_b32 v143, 1, v141
v_lshl_add_u32 v142, v143, 3, v142
v_add_u32 v12, 14336, v142
v_and_b32 v142, 1, v140
v_lshlrev_b32 v142, 4, v142
v_mov_b32 v143, 0x3f80
v_lshlrev_b32 v143, v142, v143
v_lshrrev_b32 v142, 1, v140
v_cmp_eq_u32 vcc, 0, v142
s_nop 1
v_cndmask_b32 v16, 0, v143, vcc
v_cmp_eq_u32 vcc, 1, v142
s_nop 1
v_cndmask_b32 v17, 0, v143, vcc
v_cmp_eq_u32 vcc, 2, v142
s_nop 1
v_cndmask_b32 v18, 0, v143, vcc
v_cmp_eq_u32 vcc, 3, v142
s_nop 1
v_cndmask_b32 v19, 0, v143, vcc
v_mov_b32 v20, 0
v_mov_b32 v21, 0
v_mov_b32 v22, 0
v_mov_b32 v23, 0
v_mov_b32 v24, 0
v_mov_b32 v25, 0
v_mov_b32 v26, 0
v_mov_b32 v27, 0
v_mov_b32 v28, 0
v_mov_b32 v29, 0
v_mov_b32 v30, 0
v_mov_b32 v31, 0
v_mov_b32 v32, 0
v_mov_b32 v33, 0
v_mov_b32 v34, 0
v_mov_b32 v35, 0
v_mov_b32 v36, 0x3f803f80
v_mov_b32 v37, 0x3f803f80
v_mov_b32 v38, 0x3f803f80
v_mov_b32 v39, 0x3f803f80
v_mov_b32 v132, 0
v_mov_b32 v133, 0
v_mov_b32 v134, 0
v_mov_b32 v135, 0
v_mov_b32 v136, 0
v_mov_b32 v137, 0
v_mov_b32 v138, 0
v_mov_b32 v139, 0
s_mov_b32 s48, 0
s_mov_b32 s49, 32768
s_mov_b32 s50, 65536
s_mov_b32 s51, 98304
s_mov_b32 s52, 262144
s_mov_b32 s53, 294912
s_mov_b32 s54, 327680
s_mov_b32 s55, 360448
s_mov_b32 s56, 524288
s_mov_b32 s57, 557056
s_mov_b32 s58, 589824
s_mov_b32 s59, 622592
s_mov_b32 s60, 786432
s_mov_b32 s61, 819200
s_mov_b32 s62, 851968
s_mov_b32 s63, 884736
s_mov_b32 s64, 0x3e0293ee
s_mov_b32 s65, 0xbe0293ee
s_mul_i32 s38, s33, 0x400000
s_add_u32 s38, s38, 0x4000000
s_lshl_b32 s39, s33, 10
s_add_u32 s39, s39, 0x11000
v_lshlrev_b32 v142, 10, v141
v_lshl_add_u32 v142, v140, 4, v142
s_mov_b32 s12, s24
s_mov_b32 s13, s25
s_mov_b32 s14, 0x400000
s_mov_b32 s15, 0x00020000
s_lshl_b32 s40, s68, 17
s_add_u32 s40, s40, 512
v_add_u32 v146, s40, v142
s_mov_b32 m0, 65536
s_mov_b32 s41, 0
buffer_load_dwordx4 v146, s[12:15], s41 offen lds
s_mov_b32 m0, 66560
s_mov_b32 s41, 4096
buffer_load_dwordx4 v146, s[12:15], s41 offen lds
s_mov_b32 m0, 67584
s_mov_b32 s41, 8192
buffer_load_dwordx4 v146, s[12:15], s41 offen lds
s_mov_b32 m0, 68608
s_mov_b32 s41, 12288
buffer_load_dwordx4 v146, s[12:15], s41 offen lds
s_mov_b32 m0, 69632
s_mov_b32 s41, 16384
buffer_load_dwordx4 v146, s[12:15], s41 offen lds
s_mov_b32 m0, 70656
s_mov_b32 s41, 20480
buffer_load_dwordx4 v146, s[12:15], s41 offen lds
s_mov_b32 m0, 71680
s_mov_b32 s41, 24576
buffer_load_dwordx4 v146, s[12:15], s41 offen lds
s_mov_b32 m0, 72704
s_mov_b32 s41, 28672
buffer_load_dwordx4 v146, s[12:15], s41 offen lds
s_mov_b32 m0, 73728
s_mov_b32 s41, 32768
buffer_load_dwordx4 v146, s[12:15], s41 offen lds
s_mov_b32 m0, 74752
s_mov_b32 s41, 36864
buffer_load_dwordx4 v146, s[12:15], s41 offen lds
s_mov_b32 m0, 75776
s_mov_b32 s41, 40960
buffer_load_dwordx4 v146, s[12:15], s41 offen lds
s_mov_b32 m0, 76800
s_mov_b32 s41, 45056
buffer_load_dwordx4 v146, s[12:15], s41 offen lds
s_mov_b32 m0, 77824
s_mov_b32 s41, 49152
buffer_load_dwordx4 v146, s[12:15], s41 offen lds
s_mov_b32 m0, 78848
s_mov_b32 s41, 53248
buffer_load_dwordx4 v146, s[12:15], s41 offen lds
s_mov_b32 m0, 79872
s_mov_b32 s41, 57344
buffer_load_dwordx4 v146, s[12:15], s41 offen lds
s_mov_b32 m0, 80896
s_mov_b32 s41, 61440
buffer_load_dwordx4 v146, s[12:15], s41 offen lds
s_mov_b32 m0, 81920
s_mov_b32 s41, 65536
buffer_load_dwordx4 v146, s[12:15], s41 offen lds
s_mov_b32 m0, 82944
s_mov_b32 s41, 69632
buffer_load_dwordx4 v146, s[12:15], s41 offen lds
s_mov_b32 m0, 83968
s_mov_b32 s41, 73728
buffer_load_dwordx4 v146, s[12:15], s41 offen lds
s_mov_b32 m0, 84992
s_mov_b32 s41, 77824
buffer_load_dwordx4 v146, s[12:15], s41 offen lds
s_mov_b32 m0, 86016
s_mov_b32 s41, 81920
buffer_load_dwordx4 v146, s[12:15], s41 offen lds
s_mov_b32 m0, 87040
s_mov_b32 s41, 86016
buffer_load_dwordx4 v146, s[12:15], s41 offen lds
s_mov_b32 m0, 88064
s_mov_b32 s41, 90112
buffer_load_dwordx4 v146, s[12:15], s41 offen lds
s_mov_b32 m0, 89088
s_mov_b32 s41, 94208
buffer_load_dwordx4 v146, s[12:15], s41 offen lds
s_mov_b32 m0, 90112
s_mov_b32 s41, 98304
buffer_load_dwordx4 v146, s[12:15], s41 offen lds
s_mov_b32 m0, 91136
s_mov_b32 s41, 102400
buffer_load_dwordx4 v146, s[12:15], s41 offen lds
s_mov_b32 m0, 92160
s_mov_b32 s41, 106496
buffer_load_dwordx4 v146, s[12:15], s41 offen lds
s_mov_b32 m0, 93184
s_mov_b32 s41, 110592
buffer_load_dwordx4 v146, s[12:15], s41 offen lds
s_mov_b32 m0, 94208
s_mov_b32 s41, 114688
buffer_load_dwordx4 v146, s[12:15], s41 offen lds
s_mov_b32 m0, 95232
s_mov_b32 s41, 118784
buffer_load_dwordx4 v146, s[12:15], s41 offen lds
s_mov_b32 m0, 96256
s_mov_b32 s41, 122880
buffer_load_dwordx4 v146, s[12:15], s41 offen lds
s_mov_b32 m0, 97280
s_mov_b32 s41, 126976
buffer_load_dwordx4 v146, s[12:15], s41 offen lds
v_bfe_u32 v143, v3, 2, 2
v_lshrrev_b32 v144, 5, v3
v_bfe_u32 v145, v3, 4, 1
v_lshlrev_b32 v145, 5, v145
v_and_b32 v148, 3, v3
v_lshl_add_u32 v145, v148, 3, v145
v_lshl_add_u32 v148, v144, 2, v143
v_lshl_add_u32 v148, v148, 8, v145
v_add_u32 v147, 65536, v148
v_lshl_add_u32 v148, v144, 3, v143
v_lshl_add_u32 v148, v148, 8, v145
v_add_u32 v149, 65536, v148
s_waitcnt vmcnt(0)
ds_read_b64_tr_b16 a[0:1], v147 offset:0
ds_read_b64_tr_b16 a[2:3], v147 offset:4096
ds_read_b64_tr_b16 a[4:5], v147 offset:2048
ds_read_b64_tr_b16 a[6:7], v147 offset:6144
ds_read_b64_tr_b16 a[8:9], v147 offset:8192
ds_read_b64_tr_b16 a[10:11], v147 offset:12288
ds_read_b64_tr_b16 a[12:13], v147 offset:10240
ds_read_b64_tr_b16 a[14:15], v147 offset:14336
ds_read_b64_tr_b16 a[16:17], v147 offset:16384
ds_read_b64_tr_b16 a[18:19], v147 offset:20480
ds_read_b64_tr_b16 a[20:21], v147 offset:18432
ds_read_b64_tr_b16 a[22:23], v147 offset:22528
ds_read_b64_tr_b16 a[24:25], v147 offset:24576
ds_read_b64_tr_b16 a[26:27], v147 offset:28672
ds_read_b64_tr_b16 a[28:29], v147 offset:26624
ds_read_b64_tr_b16 a[30:31], v147 offset:30720
ds_read_b64_tr_b16 a[32:33], v147 offset:64
ds_read_b64_tr_b16 a[34:35], v147 offset:4160
ds_read_b64_tr_b16 a[36:37], v147 offset:2112
ds_read_b64_tr_b16 a[38:39], v147 offset:6208
ds_read_b64_tr_b16 a[40:41], v147 offset:8256
ds_read_b64_tr_b16 a[42:43], v147 offset:12352
ds_read_b64_tr_b16 a[44:45], v147 offset:10304
ds_read_b64_tr_b16 a[46:47], v147 offset:14400
ds_read_b64_tr_b16 a[48:49], v147 offset:16448
ds_read_b64_tr_b16 a[50:51], v147 offset:20544
ds_read_b64_tr_b16 a[52:53], v147 offset:18496
ds_read_b64_tr_b16 a[54:55], v147 offset:22592
ds_read_b64_tr_b16 a[56:57], v147 offset:24640
ds_read_b64_tr_b16 a[58:59], v147 offset:28736
ds_read_b64_tr_b16 a[60:61], v147 offset:26688
ds_read_b64_tr_b16 a[62:63], v147 offset:30784
ds_read_b64_tr_b16 a[64:65], v147 offset:128
ds_read_b64_tr_b16 a[66:67], v147 offset:4224
ds_read_b64_tr_b16 a[68:69], v147 offset:2176
ds_read_b64_tr_b16 a[70:71], v147 offset:6272
ds_read_b64_tr_b16 a[72:73], v147 offset:8320
ds_read_b64_tr_b16 a[74:75], v147 offset:12416
ds_read_b64_tr_b16 a[76:77], v147 offset:10368
ds_read_b64_tr_b16 a[78:79], v147 offset:14464
ds_read_b64_tr_b16 a[80:81], v147 offset:16512
ds_read_b64_tr_b16 a[82:83], v147 offset:20608
ds_read_b64_tr_b16 a[84:85], v147 offset:18560
ds_read_b64_tr_b16 a[86:87], v147 offset:22656
ds_read_b64_tr_b16 a[88:89], v147 offset:24704
ds_read_b64_tr_b16 a[90:91], v147 offset:28800
ds_read_b64_tr_b16 a[92:93], v147 offset:26752
ds_read_b64_tr_b16 a[94:95], v147 offset:30848
ds_read_b64_tr_b16 a[96:97], v147 offset:192
ds_read_b64_tr_b16 a[98:99], v147 offset:4288
ds_read_b64_tr_b16 a[100:101], v147 offset:2240
ds_read_b64_tr_b16 a[102:103], v147 offset:6336
ds_read_b64_tr_b16 a[104:105], v147 offset:8384
ds_read_b64_tr_b16 a[106:107], v147 offset:12480
ds_read_b64_tr_b16 a[108:109], v147 offset:10432
ds_read_b64_tr_b16 a[110:111], v147 offset:14528
ds_read_b64_tr_b16 a[112:113], v147 offset:16576
ds_read_b64_tr_b16 a[114:115], v147 offset:20672
ds_read_b64_tr_b16 a[116:117], v147 offset:18624
ds_read_b64_tr_b16 a[118:119], v147 offset:22720
ds_read_b64_tr_b16 a[120:121], v147 offset:24768
ds_read_b64_tr_b16 a[122:123], v147 offset:28864
ds_read_b64_tr_b16 a[124:125], v147 offset:26816
ds_read_b64_tr_b16 a[126:127], v147 offset:30912
s_waitcnt lgkmcnt(0)
s_mov_b32 s12, s30
s_mov_b32 s13, s31
s_mov_b32 s14, 0x158000
s_mov_b32 s15, 0x00020000
s_mul_i32 s40, s68, 49152
s_add_u32 s40, s40, 512
v_add_u32 v146, s40, v142
s_mov_b32 m0, 65536
s_mov_b32 s41, 0
buffer_load_dwordx4 v146, s[12:15], s41 offen lds
s_mov_b32 m0, 66560
s_mov_b32 s41, 4096
buffer_load_dwordx4 v146, s[12:15], s41 offen lds
s_mov_b32 m0, 67584
s_mov_b32 s41, 8192
buffer_load_dwordx4 v146, s[12:15], s41 offen lds
s_mov_b32 m0, 68608
s_mov_b32 s41, 12288
buffer_load_dwordx4 v146, s[12:15], s41 offen lds
s_mov_b32 m0, 69632
s_mov_b32 s41, 16384
buffer_load_dwordx4 v146, s[12:15], s41 offen lds
s_mov_b32 m0, 70656
s_mov_b32 s41, 20480
buffer_load_dwordx4 v146, s[12:15], s41 offen lds
s_mov_b32 m0, 71680
s_mov_b32 s41, 24576
buffer_load_dwordx4 v146, s[12:15], s41 offen lds
s_mov_b32 m0, 72704
s_mov_b32 s41, 28672
buffer_load_dwordx4 v146, s[12:15], s41 offen lds
s_mov_b32 m0, 73728
s_mov_b32 s41, 32768
buffer_load_dwordx4 v146, s[12:15], s41 offen lds
s_mov_b32 m0, 74752
s_mov_b32 s41, 36864
buffer_load_dwordx4 v146, s[12:15], s41 offen lds
s_mov_b32 m0, 75776
s_mov_b32 s41, 40960
buffer_load_dwordx4 v146, s[12:15], s41 offen lds
s_mov_b32 m0, 76800
s_mov_b32 s41, 45056
buffer_load_dwordx4 v146, s[12:15], s41 offen lds
v_lshrrev_b32 v150, 1, v3
v_mul_u32_u24 v150, 2752, v150
v_and_b32 v151, 1, v3
s_mul_i32 s40, s68, 48
s_add_u32 s40, s40, 32
v_lshl_add_u32 v151, v151, 3, s40
v_lshl_add_u32 v150, v151, 1, v150
v_mov_b32 v152, 0x40000000
v_cmp_gt_u32 vcc, 1376, v151
s_nop 1
v_cndmask_b32 v150, v152, v150, vcc
s_waitcnt vmcnt(0)
ds_read_b64_tr_b16 a[128:129], v149 offset:0
ds_read_b64_tr_b16 a[130:131], v149 offset:1024
ds_read_b64_tr_b16 a[132:133], v149 offset:4096
ds_read_b64_tr_b16 a[134:135], v149 offset:5120
ds_read_b64_tr_b16 a[136:137], v149 offset:8192
ds_read_b64_tr_b16 a[138:139], v149 offset:9216
ds_read_b64_tr_b16 a[140:141], v149 offset:64
ds_read_b64_tr_b16 a[142:143], v149 offset:1088
ds_read_b64_tr_b16 a[144:145], v149 offset:4160
ds_read_b64_tr_b16 a[146:147], v149 offset:5184
ds_read_b64_tr_b16 a[148:149], v149 offset:8256
ds_read_b64_tr_b16 a[150:151], v149 offset:9280
ds_read_b64_tr_b16 a[152:153], v149 offset:128
ds_read_b64_tr_b16 a[154:155], v149 offset:1152
ds_read_b64_tr_b16 a[156:157], v149 offset:4224
ds_read_b64_tr_b16 a[158:159], v149 offset:5248
ds_read_b64_tr_b16 a[160:161], v149 offset:8320
ds_read_b64_tr_b16 a[162:163], v149 offset:9344
ds_read_b64_tr_b16 a[164:165], v149 offset:192
ds_read_b64_tr_b16 a[166:167], v149 offset:1216
ds_read_b64_tr_b16 a[168:169], v149 offset:4288
ds_read_b64_tr_b16 a[170:171], v149 offset:5312
ds_read_b64_tr_b16 a[172:173], v149 offset:8384
ds_read_b64_tr_b16 a[174:175], v149 offset:9408
s_waitcnt lgkmcnt(0)
s_mov_b32 s12, s28
s_mov_b32 s13, s29
s_mov_b32 s14, 0x158000
s_mov_b32 s15, 0x00020000
s_mov_b32 m0, 65536
s_mov_b32 s41, 0
buffer_load_dwordx4 v150, s[12:15], s41 offen lds
s_mov_b32 m0, 66560
s_mov_b32 s41, 88064
buffer_load_dwordx4 v150, s[12:15], s41 offen lds
s_mov_b32 m0, 67584
s_mov_b32 s41, 176128
buffer_load_dwordx4 v150, s[12:15], s41 offen lds
s_mov_b32 m0, 68608
s_mov_b32 s41, 264192
buffer_load_dwordx4 v150, s[12:15], s41 offen lds
s_mov_b32 m0, 69632
s_mov_b32 s41, 352256
buffer_load_dwordx4 v150, s[12:15], s41 offen lds
s_mov_b32 m0, 70656
s_mov_b32 s41, 440320
buffer_load_dwordx4 v150, s[12:15], s41 offen lds
s_mov_b32 m0, 71680
s_mov_b32 s41, 528384
buffer_load_dwordx4 v150, s[12:15], s41 offen lds
s_mov_b32 m0, 72704
s_mov_b32 s41, 616448
buffer_load_dwordx4 v150, s[12:15], s41 offen lds
s_mov_b32 m0, 73728
s_mov_b32 s41, 704512
buffer_load_dwordx4 v150, s[12:15], s41 offen lds
s_mov_b32 m0, 74752
s_mov_b32 s41, 792576
buffer_load_dwordx4 v150, s[12:15], s41 offen lds
s_mov_b32 m0, 75776
s_mov_b32 s41, 880640
buffer_load_dwordx4 v150, s[12:15], s41 offen lds
s_mov_b32 m0, 76800
s_mov_b32 s41, 968704
buffer_load_dwordx4 v150, s[12:15], s41 offen lds
s_mov_b32 m0, 77824
s_mov_b32 s41, 1056768
buffer_load_dwordx4 v150, s[12:15], s41 offen lds
s_mov_b32 m0, 78848
s_mov_b32 s41, 1144832
buffer_load_dwordx4 v150, s[12:15], s41 offen lds
s_mov_b32 m0, 79872
s_mov_b32 s41, 1232896
buffer_load_dwordx4 v150, s[12:15], s41 offen lds
s_mov_b32 m0, 80896
s_mov_b32 s41, 1320960
buffer_load_dwordx4 v150, s[12:15], s41 offen lds
v_lshl_add_u32 v151, v141, 3, v143
v_lshlrev_b32 v151, 5, v151
v_and_b32 v152, 3, v3
v_lshl_add_u32 v151, v152, 3, v151
v_add_u32 v151, 65536, v151
s_waitcnt vmcnt(0)
ds_read_b64_tr_b16 a[176:177], v151 offset:0
ds_read_b64_tr_b16 a[178:179], v151 offset:128
ds_read_b64_tr_b16 a[180:181], v151 offset:1024
ds_read_b64_tr_b16 a[182:183], v151 offset:1152
ds_read_b64_tr_b16 a[184:185], v151 offset:2048
ds_read_b64_tr_b16 a[186:187], v151 offset:2176
ds_read_b64_tr_b16 a[188:189], v151 offset:3072
ds_read_b64_tr_b16 a[190:191], v151 offset:3200
ds_read_b64_tr_b16 a[192:193], v151 offset:4096
ds_read_b64_tr_b16 a[194:195], v151 offset:4224
ds_read_b64_tr_b16 a[196:197], v151 offset:5120
ds_read_b64_tr_b16 a[198:199], v151 offset:5248
ds_read_b64_tr_b16 a[200:201], v151 offset:6144
ds_read_b64_tr_b16 a[202:203], v151 offset:6272
ds_read_b64_tr_b16 a[204:205], v151 offset:7168
ds_read_b64_tr_b16 a[206:207], v151 offset:7296
ds_read_b64_tr_b16 a[208:209], v151 offset:8192
ds_read_b64_tr_b16 a[210:211], v151 offset:8320
ds_read_b64_tr_b16 a[212:213], v151 offset:9216
ds_read_b64_tr_b16 a[214:215], v151 offset:9344
ds_read_b64_tr_b16 a[216:217], v151 offset:10240
ds_read_b64_tr_b16 a[218:219], v151 offset:10368
ds_read_b64_tr_b16 a[220:221], v151 offset:11264
ds_read_b64_tr_b16 a[222:223], v151 offset:11392
ds_read_b64_tr_b16 a[224:225], v151 offset:12288
ds_read_b64_tr_b16 a[226:227], v151 offset:12416
ds_read_b64_tr_b16 a[228:229], v151 offset:13312
ds_read_b64_tr_b16 a[230:231], v151 offset:13440
ds_read_b64_tr_b16 a[232:233], v151 offset:14336
ds_read_b64_tr_b16 a[234:235], v151 offset:14464
ds_read_b64_tr_b16 a[236:237], v151 offset:15360
ds_read_b64_tr_b16 a[238:239], v151 offset:15488
s_waitcnt lgkmcnt(0)
s_barrier
s_sub_u32 s36, s33, 1
s_mov_b32 s37, 0
s_cmp_lg_u32 s32, 0
s_cbranch_scc1 L_tslow2
s_mov_b32 s12, s22
s_mov_b32 s13, s23
s_mov_b32 s14, 0x200000
s_mov_b32 s15, 0x00020000
s_mov_b32 s4, s26
s_mov_b32 s5, s27
s_mov_b32 s6, 0x200000
s_mov_b32 s7, 0x00020000
s_barrier
v_lshlrev_b32 v140, 1, v10
s_mov_b32 s40, 0x1000
buffer_load_dwordx2 a[240:241], v140, s[8:11], s40 offen sc1
s_mov_b32 s40, 0x1800
buffer_load_dwordx2 a[242:243], v140, s[8:11], s40 offen sc1
s_mov_b32 s40, 0x2000
buffer_load_dwordx2 a[244:245], v140, s[8:11], s40 offen sc1
s_mov_b32 s40, 0x2800
buffer_load_dwordx2 a[246:247], v140, s[8:11], s40 offen sc1
s_waitcnt vmcnt(0)
L_tail_w2_f:
s_cmp_ge_u32 s36, 64
s_cbranch_scc1 L_tailend_w2_f
s_barrier
s_lshl_b32 s40, s36, 5
s_add_u32 s40, s40, s68
s_lshl_b32 s66, s40, 13
s_lshl_b32 s67, s40, 11
s_add_u32 s41, s66, 0x2800000
buffer_load_dwordx4 v[40:43], v2, s[8:11], s41 offen offset:0 sc1
buffer_load_dwordx4 v[44:47], v2, s[8:11], s41 offen offset:1024 sc1
buffer_load_dwordx4 v[48:51], v2, s[8:11], s41 offen offset:2048 sc1
buffer_load_dwordx4 v[52:55], v2, s[8:11], s41 offen offset:3072 sc1
s_add_u32 s41, s66, 0x800000
buffer_load_dwordx4 v[72:75], v2, s[8:11], s41 offen offset:0 sc1
buffer_load_dwordx4 v[76:79], v2, s[8:11], s41 offen offset:1024 sc1
buffer_load_dwordx4 v[80:83], v2, s[8:11], s41 offen offset:2048 sc1
buffer_load_dwordx4 v[84:87], v2, s[8:11], s41 offen offset:3072 sc1
s_add_u32 s41, s66, 0x1801000
buffer_load_dwordx4 v[104:107], v2, s[8:11], s41 offen offset:0 sc1
buffer_load_dwordx4 v[108:111], v2, s[8:11], s41 offen offset:1024 sc1
buffer_load_dwordx4 v[112:115], v2, s[8:11], s41 offen offset:2048 sc1
buffer_load_dwordx4 v[116:119], v2, s[8:11], s41 offen offset:3072 sc1
s_lshl_b32 s41, s40, 10
buffer_load_dword v152, v10, s[12:15], s41 offen
s_barrier
s_add_u32 s42, s67, 0x3800000
buffer_load_dwordx4 v[56:59], v4, s[8:11], s42 offen offset:0 sc1
buffer_load_dwordx4 v[60:63], v4, s[8:11], s42 offen offset:512 sc1
buffer_load_dwordx4 v[64:67], v4, s[8:11], s42 offen offset:1024 sc1
buffer_load_dwordx4 v[68:71], v4, s[8:11], s42 offen offset:1536 sc1
s_add_u32 s42, s67, 0x3c00400
buffer_load_dword v20, v13, s[8:11], s42 offen offset:0 sc1
buffer_load_dword v24, v13, s[8:11], s42 offen offset:256 sc1
buffer_load_dword v28, v13, s[8:11], s42 offen offset:512 sc1
buffer_load_dword v32, v13, s[8:11], s42 offen offset:768 sc1
s_waitcnt vmcnt(0)
v_mfma_f32_16x16x32_bf16 v[120:123], v[56:59], v[40:43], 0
v_mfma_f32_16x16x32_bf16 v[124:127], v[72:75], v[40:43], 0
v_mfma_f32_16x16x32_bf16 v[120:123], v[60:63], v[44:47], v[120:123]
v_mfma_f32_16x16x32_bf16 v[124:127], v[76:79], v[44:47], v[124:127]
v_mfma_f32_16x16x32_bf16 v[120:123], v[64:67], v[48:51], v[120:123]
v_mfma_f32_16x16x32_bf16 v[124:127], v[80:83], v[48:51], v[124:127]
v_mfma_f32_16x16x32_bf16 v[120:123], v[68:71], v[52:55], v[120:123]
v_mfma_f32_16x16x32_bf16 v[124:127], v[84:87], v[52:55], v[124:127]
v_mov_b32 v140, 0xff800000
v_cmp_le_i32 vcc, 0, v5
s_nop 5
v_cndmask_b32 v124, v140, v124, vcc
v_cmp_le_i32 vcc, 1, v5
s_nop 1
v_cndmask_b32 v125, v140, v125, vcc
v_cmp_le_i32 vcc, 2, v5
s_nop 1
v_cndmask_b32 v126, v140, v126, vcc
v_cmp_le_i32 vcc, 3, v5
s_nop 1
v_cndmask_b32 v127, v140, v127, vcc
v_max3_f32 v141, v120, v121, v124
v_max3_f32 v141, v141, v125, v126
v_max_f32 v141, v141, v127
v_mov_b32 v142, v141
s_nop 1
v_permlane32_swap_b32 v141, v142
v_max_f32 v141, v141, v142
v_mov_b32 v142, v141
s_nop 1
v_permlane16_swap_b32 v141, v142
v_max_f32 v141, v141, v142
v_mul_f32 v143, s65, v141
v_fma_f32 v120, v120, s64, v143
v_fma_f32 v121, v121, s64, v143
v_fma_f32 v124, v124, s64, v143
v_fma_f32 v125, v125, s64, v143
v_fma_f32 v126, v126, s64, v143
v_fma_f32 v127, v127, s64, v143
v_exp_f32 v120, v120
v_exp_f32 v121, v121
v_exp_f32 v124, v124
v_exp_f32 v125, v125
v_exp_f32 v126, v126
v_exp_f32 v127, v127
v_cvt_pk_bf16_f32 v132, v124, v125
v_cvt_pk_bf16_f32 v133, v126, v127
v_cvt_pk_bf16_f32 v136, v120, v121
s_nop 0
v_mfma_f32_16x16x32_bf16 v[176:179], v[36:39], v[132:135], 0
v_mfma_f32_16x16x32_bf16 v[176:179], v[36:39], v[136:139], v[176:179]
v_mfma_f32_16x16x32_bf16 v[160:163], v[104:107], v[132:135], 0
v_mfma_f32_16x16x32_bf16 v[164:167], v[108:111], v[132:135], 0
v_mfma_f32_16x16x32_bf16 v[168:171], v[112:115], v[132:135], 0
v_mfma_f32_16x16x32_bf16 v[172:175], v[116:119], v[132:135], 0
v_mfma_f32_16x16x32_bf16 v[160:163], v[20:23], v[136:139], v[160:163]
v_mfma_f32_16x16x32_bf16 v[164:167], v[24:27], v[136:139], v[164:167]
v_mfma_f32_16x16x32_bf16 v[168:171], v[28:31], v[136:139], v[168:171]
v_mfma_f32_16x16x32_bf16 v[172:175], v[32:35], v[136:139], v[172:175]
v_rcp_f32 v142, v176
s_nop 3
v_mul_f32 v160, v160, v142
v_mul_f32 v161, v161, v142
v_mul_f32 v162, v162, v142
v_mul_f32 v163, v163, v142
v_mul_f32 v164, v164, v142
v_mul_f32 v165, v165, v142
v_mul_f32 v166, v166, v142
v_mul_f32 v167, v167, v142
v_mul_f32 v168, v168, v142
v_mul_f32 v169, v169, v142
v_mul_f32 v170, v170, v142
v_mul_f32 v171, v171, v142
v_mul_f32 v172, v172, v142
v_mul_f32 v173, v173, v142
v_mul_f32 v174, v174, v142
v_mul_f32 v175, v175, v142
v_cvt_pk_bf16_f32 v40, v160, v161
v_cvt_pk_bf16_f32 v41, v162, v163
v_cvt_pk_bf16_f32 v42, v164, v165
v_cvt_pk_bf16_f32 v43, v166, v167
ds_write_b128 v6, v[40:43] offset:4096
v_cvt_pk_bf16_f32 v44, v168, v169
v_cvt_pk_bf16_f32 v45, v170, v171
v_cvt_pk_bf16_f32 v46, v172, v173
v_cvt_pk_bf16_f32 v47, v174, v175
ds_write_b128 v6, v[44:47] offset:6144
s_waitcnt lgkmcnt(0)
s_barrier
ds_read_b128 v[40:43], v2 offset:0
ds_read_b128 v[44:47], v2 offset:1024
ds_read_b128 v[48:51], v2 offset:2048
ds_read_b128 v[52:55], v2 offset:3072
ds_read_b128 v[56:59], v2 offset:4096
ds_read_b128 v[60:63], v2 offset:5120
ds_read_b128 v[64:67], v2 offset:6144
ds_read_b128 v[68:71], v2 offset:7168
s_waitcnt lgkmcnt(7)
v_mfma_f32_32x32x16_bf16 v[192:207], v[40:43], a[0:3], 0
v_mfma_f32_32x32x16_bf16 v[208:223], v[40:43], a[32:35], 0
v_mfma_f32_32x32x16_bf16 v[224:239], v[40:43], a[64:67], 0
v_mfma_f32_32x32x16_bf16 v[240:255], v[40:43], a[96:99], 0
s_waitcnt lgkmcnt(6)
v_mfma_f32_32x32x16_bf16 v[192:207], v[44:47], a[4:7], v[192:207]
v_mfma_f32_32x32x16_bf16 v[208:223], v[44:47], a[36:39], v[208:223]
v_mfma_f32_32x32x16_bf16 v[224:239], v[44:47], a[68:71], v[224:239]
v_mfma_f32_32x32x16_bf16 v[240:255], v[44:47], a[100:103], v[240:255]
s_waitcnt lgkmcnt(5)
v_mfma_f32_32x32x16_bf16 v[192:207], v[48:51], a[8:11], v[192:207]
v_mfma_f32_32x32x16_bf16 v[208:223], v[48:51], a[40:43], v[208:223]
v_mfma_f32_32x32x16_bf16 v[224:239], v[48:51], a[72:75], v[224:239]
v_mfma_f32_32x32x16_bf16 v[240:255], v[48:51], a[104:107], v[240:255]
s_waitcnt lgkmcnt(4)
v_mfma_f32_32x32x16_bf16 v[192:207], v[52:55], a[12:15], v[192:207]
v_mfma_f32_32x32x16_bf16 v[208:223], v[52:55], a[44:47], v[208:223]
v_mfma_f32_32x32x16_bf16 v[224:239], v[52:55], a[76:79], v[224:239]
v_mfma_f32_32x32x16_bf16 v[240:255], v[52:55], a[108:111], v[240:255]
s_waitcnt lgkmcnt(3)
v_mfma_f32_32x32x16_bf16 v[192:207], v[56:59], a[16:19], v[192:207]
v_mfma_f32_32x32x16_bf16 v[208:223], v[56:59], a[48:51], v[208:223]
v_mfma_f32_32x32x16_bf16 v[224:239], v[56:59], a[80:83], v[224:239]
v_mfma_f32_32x32x16_bf16 v[240:255], v[56:59], a[112:115], v[240:255]
s_waitcnt lgkmcnt(2)
v_mfma_f32_32x32x16_bf16 v[192:207], v[60:63], a[20:23], v[192:207]
v_mfma_f32_32x32x16_bf16 v[208:223], v[60:63], a[52:55], v[208:223]
v_mfma_f32_32x32x16_bf16 v[224:239], v[60:63], a[84:87], v[224:239]
v_mfma_f32_32x32x16_bf16 v[240:255], v[60:63], a[116:119], v[240:255]
s_waitcnt lgkmcnt(1)
v_mfma_f32_32x32x16_bf16 v[192:207], v[64:67], a[24:27], v[192:207]
v_mfma_f32_32x32x16_bf16 v[208:223], v[64:67], a[56:59], v[208:223]
v_mfma_f32_32x32x16_bf16 v[224:239], v[64:67], a[88:91], v[224:239]
v_mfma_f32_32x32x16_bf16 v[240:255], v[64:67], a[120:123], v[240:255]
s_waitcnt lgkmcnt(0)
v_mfma_f32_32x32x16_bf16 v[192:207], v[68:71], a[28:31], v[192:207]
v_mfma_f32_32x32x16_bf16 v[208:223], v[68:71], a[60:63], v[208:223]
v_mfma_f32_32x32x16_bf16 v[224:239], v[68:71], a[92:95], v[224:239]
v_mfma_f32_32x32x16_bf16 v[240:255], v[68:71], a[124:127], v[240:255]
s_lshl_b32 s40, s68, 10
s_add_u32 s40, s40, s38
s_add_u32 s40, s40, 0x200
s_nop 6
v_cvt_pk_bf16_f32 v40, v192, v208
s_add_u32 s41, s40, s48
buffer_store_dword v40, v7, s[8:11], s41 offen offset:0 nt
v_cvt_pk_bf16_f32 v41, v193, v209
s_add_u32 s42, s40, s49
buffer_store_dword v41, v7, s[8:11], s42 offen offset:0 nt
v_cvt_pk_bf16_f32 v42, v194, v210
s_add_u32 s41, s40, s50
buffer_store_dword v42, v7, s[8:11], s41 offen offset:0 nt
v_cvt_pk_bf16_f32 v43, v195, v211
s_add_u32 s42, s40, s51
buffer_store_dword v43, v7, s[8:11], s42 offen offset:0 nt
v_cvt_pk_bf16_f32 v44, v196, v212
s_add_u32 s41, s40, s52
buffer_store_dword v44, v7, s[8:11], s41 offen offset:0 nt
v_cvt_pk_bf16_f32 v45, v197, v213
s_add_u32 s42, s40, s53
buffer_store_dword v45, v7, s[8:11], s42 offen offset:0 nt
v_cvt_pk_bf16_f32 v46, v198, v214
s_add_u32 s41, s40, s54
buffer_store_dword v46, v7, s[8:11], s41 offen offset:0 nt
v_cvt_pk_bf16_f32 v47, v199, v215
s_add_u32 s42, s40, s55
buffer_store_dword v47, v7, s[8:11], s42 offen offset:0 nt
v_cvt_pk_bf16_f32 v40, v200, v216
s_add_u32 s41, s40, s56
buffer_store_dword v40, v7, s[8:11], s41 offen offset:0 nt
v_cvt_pk_bf16_f32 v41, v201, v217
s_add_u32 s42, s40, s57
buffer_store_dword v41, v7, s[8:11], s42 offen offset:0 nt
v_cvt_pk_bf16_f32 v42, v202, v218
s_add_u32 s41, s40, s58
buffer_store_dword v42, v7, s[8:11], s41 offen offset:0 nt
v_cvt_pk_bf16_f32 v43, v203, v219
s_add_u32 s42, s40, s59
buffer_store_dword v43, v7, s[8:11], s42 offen offset:0 nt
v_cvt_pk_bf16_f32 v44, v204, v220
s_add_u32 s41, s40, s60
buffer_store_dword v44, v7, s[8:11], s41 offen offset:0 nt
v_cvt_pk_bf16_f32 v45, v205, v221
s_add_u32 s42, s40, s61
buffer_store_dword v45, v7, s[8:11], s42 offen offset:0 nt
v_cvt_pk_bf16_f32 v46, v206, v222
s_add_u32 s41, s40, s62
buffer_store_dword v46, v7, s[8:11], s41 offen offset:0 nt
v_cvt_pk_bf16_f32 v47, v207, v223
s_add_u32 s42, s40, s63
buffer_store_dword v47, v7, s[8:11], s42 offen offset:0 nt
v_cvt_pk_bf16_f32 v40, v224, v240
s_add_u32 s41, s40, s48
buffer_store_dword v40, v7, s[8:11], s41 offen offset:128 nt
v_cvt_pk_bf16_f32 v41, v225, v241
s_add_u32 s42, s40, s49
buffer_store_dword v41, v7, s[8:11], s42 offen offset:128 nt
v_cvt_pk_bf16_f32 v42, v226, v242
s_add_u32 s41, s40, s50
buffer_store_dword v42, v7, s[8:11], s41 offen offset:128 nt
v_cvt_pk_bf16_f32 v43, v227, v243
s_add_u32 s42, s40, s51
buffer_store_dword v43, v7, s[8:11], s42 offen offset:128 nt
v_cvt_pk_bf16_f32 v44, v228, v244
s_add_u32 s41, s40, s52
buffer_store_dword v44, v7, s[8:11], s41 offen offset:128 nt
v_cvt_pk_bf16_f32 v45, v229, v245
s_add_u32 s42, s40, s53
buffer_store_dword v45, v7, s[8:11], s42 offen offset:128 nt
v_cvt_pk_bf16_f32 v46, v230, v246
s_add_u32 s41, s40, s54
buffer_store_dword v46, v7, s[8:11], s41 offen offset:128 nt
v_cvt_pk_bf16_f32 v47, v231, v247
s_add_u32 s42, s40, s55
buffer_store_dword v47, v7, s[8:11], s42 offen offset:128 nt
v_cvt_pk_bf16_f32 v40, v232, v248
s_add_u32 s41, s40, s56
buffer_store_dword v40, v7, s[8:11], s41 offen offset:128 nt
v_cvt_pk_bf16_f32 v41, v233, v249
s_add_u32 s42, s40, s57
buffer_store_dword v41, v7, s[8:11], s42 offen offset:128 nt
v_cvt_pk_bf16_f32 v42, v234, v250
s_add_u32 s41, s40, s58
buffer_store_dword v42, v7, s[8:11], s41 offen offset:128 nt
v_cvt_pk_bf16_f32 v43, v235, v251
s_add_u32 s42, s40, s59
buffer_store_dword v43, v7, s[8:11], s42 offen offset:128 nt
v_cvt_pk_bf16_f32 v44, v236, v252
s_add_u32 s41, s40, s60
buffer_store_dword v44, v7, s[8:11], s41 offen offset:128 nt
v_cvt_pk_bf16_f32 v45, v237, v253
s_add_u32 s42, s40, s61
buffer_store_dword v45, v7, s[8:11], s42 offen offset:128 nt
v_cvt_pk_bf16_f32 v46, v238, v254
s_add_u32 s41, s40, s62
buffer_store_dword v46, v7, s[8:11], s41 offen offset:128 nt
v_cvt_pk_bf16_f32 v47, v239, v255
s_add_u32 s42, s40, s63
buffer_store_dword v47, v7, s[8:11], s42 offen offset:128 nt
s_waitcnt vmcnt(0)
s_barrier
s_barrier
s_lshl_b32 s40, s68, 15
s_add_u32 s40, s40, s38
s_add_u32 s40, s40, 0x200
s_add_u32 s41, s40, 0
buffer_load_dwordx4 v[40:43], v8, s[8:11], s41 offen sc1
s_add_u32 s41, s40, 4096
buffer_load_dwordx4 v[44:47], v8, s[8:11], s41 offen sc1
s_add_u32 s41, s40, 8192
buffer_load_dwordx4 v[48:51], v8, s[8:11], s41 offen sc1
s_add_u32 s41, s40, 12288
buffer_load_dwordx4 v[52:55], v8, s[8:11], s41 offen sc1
s_add_u32 s41, s40, 16384
buffer_load_dwordx4 v[56:59], v8, s[8:11], s41 offen sc1
s_add_u32 s41, s40, 20480
buffer_load_dwordx4 v[60:63], v8, s[8:11], s41 offen sc1
s_add_u32 s41, s40, 24576
buffer_load_dwordx4 v[64:67], v8, s[8:11], s41 offen sc1
s_add_u32 s41, s40, 28672
buffer_load_dwordx4 v[68:71], v8, s[8:11], s41 offen sc1
s_waitcnt vmcnt(7)
v_mfma_f32_16x16x32_bf16 v[160:163], v[40:43], v[16:19], 0
s_waitcnt vmcnt(6)
v_mfma_f32_16x16x32_bf16 v[160:163], v[44:47], v[16:19], v[160:163]
s_waitcnt vmcnt(5)
v_mfma_f32_16x16x32_bf16 v[160:163], v[48:51], v[16:19], v[160:163]
s_waitcnt vmcnt(4)
v_mfma_f32_16x16x32_bf16 v[160:163], v[52:55], v[16:19], v[160:163]
s_waitcnt vmcnt(3)
v_mfma_f32_16x16x32_bf16 v[160:163], v[56:59], v[16:19], v[160:163]
s_waitcnt vmcnt(2)
v_mfma_f32_16x16x32_bf16 v[160:163], v[60:63], v[16:19], v[160:163]
s_waitcnt vmcnt(1)
v_mfma_f32_16x16x32_bf16 v[160:163], v[64:67], v[16:19], v[160:163]
s_waitcnt vmcnt(0)
v_mfma_f32_16x16x32_bf16 v[160:163], v[68:71], v[16:19], v[160:163]
s_nop 7
ds_write_b32 v9, v160 offset:0
ds_write_b32 v9, v161 offset:16
ds_write_b32 v9, v162 offset:32
ds_write_b32 v9, v163 offset:48
s_waitcnt lgkmcnt(0)
s_barrier
v_lshlrev_b32 v147, 1, v10
ds_read_b64 v[148:149], v147 offset:8192
s_waitcnt lgkmcnt(0)
v_lshlrev_b32 v150, 16, v152
v_and_b32 v151, 0xffff0000, v152
v_accvgpr_read_b32 v144, a240
v_accvgpr_read_b32 v145, a241
v_cvt_pk_bf16_f32 v148, v148, v148
v_and_b32 v148, 0xffff0000, v148
v_mul_f32 v148, v148, v144
v_cvt_pk_bf16_f32 v148, v148, v148
v_and_b32 v148, 0xffff0000, v148
v_add_f32 v150, v150, v148
v_cvt_pk_bf16_f32 v150, v150, v150
v_and_b32 v150, 0xffff0000, v150
v_cvt_pk_bf16_f32 v149, v149, v149
v_and_b32 v149, 0xffff0000, v149
v_mul_f32 v149, v149, v145
v_cvt_pk_bf16_f32 v149, v149, v149
v_and_b32 v149, 0xffff0000, v149
v_add_f32 v151, v151, v149
v_cvt_pk_bf16_f32 v151, v151, v151
v_and_b32 v151, 0xffff0000, v151
v_accvgpr_write_b32 a248, v150
v_accvgpr_write_b32 a249, v151
v_add_f32 v156, v150, v151
v_mul_f32 v157, v150, v150
v_fmac_f32 v157, v151, v151
v_add_f32_dpp v156, v156, v156 quad_perm:[1,0,3,2] row_mask:0xf bank_mask:0xf
s_nop 1
v_add_f32_dpp v156, v156, v156 quad_perm:[2,3,0,1] row_mask:0xf bank_mask:0xf
s_nop 1
v_add_f32_dpp v156, v156, v156 row_half_mirror row_mask:0xf bank_mask:0xf
s_nop 1
v_add_f32_dpp v156, v156, v156 row_mirror row_mask:0xf bank_mask:0xf
v_mov_b32 v155, v156
s_nop 1
v_permlane16_swap_b32 v156, v155
v_add_f32 v156, v156, v155
v_mov_b32 v155, v156
s_nop 1
v_permlane32_swap_b32 v156, v155
v_add_f32 v156, v156, v155
v_add_f32_dpp v157, v157, v157 quad_perm:[1,0,3,2] row_mask:0xf bank_mask:0xf
s_nop 1
v_add_f32_dpp v157, v157, v157 quad_perm:[2,3,0,1] row_mask:0xf bank_mask:0xf
s_nop 1
v_add_f32_dpp v157, v157, v157 row_half_mirror row_mask:0xf bank_mask:0xf
s_nop 1
v_add_f32_dpp v157, v157, v157 row_mirror row_mask:0xf bank_mask:0xf
v_mov_b32 v155, v157
s_nop 1
v_permlane16_swap_b32 v157, v155
v_add_f32 v157, v157, v155
v_mov_b32 v155, v157
s_nop 1
v_permlane32_swap_b32 v157, v155
v_add_f32 v157, v157, v155
v_mov_b32 v155, 10320
ds_write_b64 v155, v[156:157]
s_waitcnt lgkmcnt(0)
s_barrier
v_mov_b32 v155, 10304
ds_read_b128 v[160:163], v155
ds_read_b128 v[164:167], v155 offset:16
s_waitcnt lgkmcnt(0)
v_add_f32 v156, v160, v162
v_add_f32 v157, v161, v163
v_add_f32 v156, v156, v164
v_add_f32 v157, v157, v165
v_add_f32 v156, v156, v166
v_add_f32 v157, v157, v167
v_mul_f32 v156, 0x3b000000, v156
v_mul_f32 v157, 0x3b000000, v157
v_fma_f32 v157, -v156, v156, v157
v_max_f32 v157, 0, v157
v_cvt_pk_bf16_f32 v156, v156, v156
v_and_b32 v156, 0xffff0000, v156
v_cvt_pk_bf16_f32 v157, v157, v157
v_and_b32 v157, 0xffff0000, v157
v_add_f32 v157, 0x3727c5ac, v157
v_cvt_pk_bf16_f32 v157, v157, v157
v_and_b32 v157, 0xffff0000, v157
v_sqrt_f32 v157, v157
s_nop 0
v_cvt_pk_bf16_f32 v157, v157, v157
v_and_b32 v157, 0xffff0000, v157
v_rcp_f32 v157, v157
v_accvgpr_read_b32 v144, a244
v_accvgpr_read_b32 v145, a245
v_accvgpr_read_b32 v148, a242
v_accvgpr_read_b32 v149, a243
v_sub_f32 v150, v150, v156
v_mul_f32 v150, v150, v157
v_fma_f32 v150, v150, v144, v148
v_sub_f32 v151, v151, v156
v_mul_f32 v151, v151, v157
v_fma_f32 v151, v151, v145, v149
v_cvt_pk_bf16_f32 v150, v150, v151
s_add_u32 s40, s38, 0x200000
buffer_store_dword v150, v11, s[8:11], s40 offen nt
s_waitcnt vmcnt(0)
s_barrier
s_barrier
s_add_u32 s40, s38, 0x204000
s_mov_b32 m0, 49152
s_add_u32 s41, s40, 0
buffer_load_dwordx4 v2, s[8:11], s41 offen sc1 lds
s_mov_b32 m0, 50176
s_add_u32 s41, s40, 1024
buffer_load_dwordx4 v2, s[8:11], s41 offen sc1 lds
s_mov_b32 m0, 51200
s_add_u32 s41, s40, 2048
buffer_load_dwordx4 v2, s[8:11], s41 offen sc1 lds
s_mov_b32 m0, 52224
s_add_u32 s41, s40, 3072
buffer_load_dwordx4 v2, s[8:11], s41 offen sc1 lds
s_mov_b32 m0, 53248
s_add_u32 s41, s40, 4096
buffer_load_dwordx4 v2, s[8:11], s41 offen sc1 lds
s_mov_b32 m0, 54272
s_add_u32 s41, s40, 5120
buffer_load_dwordx4 v2, s[8:11], s41 offen sc1 lds
s_mov_b32 m0, 55296
s_add_u32 s41, s40, 6144
buffer_load_dwordx4 v2, s[8:11], s41 offen sc1 lds
s_mov_b32 m0, 56320
s_add_u32 s41, s40, 7168
buffer_load_dwordx4 v2, s[8:11], s41 offen sc1 lds
s_waitcnt vmcnt(0)
s_barrier
ds_read_b128 v[56:59], v2 offset:32768
ds_read_b128 v[60:63], v2 offset:33792
ds_read_b128 v[64:67], v2 offset:34816
ds_read_b128 v[68:71], v2 offset:35840
ds_read_b128 v[72:75], v2 offset:36864
ds_read_b128 v[76:79], v2 offset:37888
ds_read_b128 v[80:83], v2 offset:38912
ds_read_b128 v[84:87], v2 offset:39936
ds_read_b128 v[88:91], v2 offset:40960
ds_read_b128 v[92:95], v2 offset:41984
ds_read_b128 v[96:99], v2 offset:43008
ds_read_b128 v[100:103], v2 offset:44032
ds_read_b128 v[104:107], v2 offset:45056
ds_read_b128 v[108:111], v2 offset:46080
ds_read_b128 v[112:115], v2 offset:47104
ds_read_b128 v[116:119], v2 offset:48128
s_waitcnt lgkmcnt(15)
v_mfma_f32_16x16x32_bf16 v[160:163], a[176:179], v[56:59], 0
s_waitcnt lgkmcnt(14)
v_mfma_f32_16x16x32_bf16 v[160:163], a[180:183], v[60:63], v[160:163]
s_waitcnt lgkmcnt(13)
v_mfma_f32_16x16x32_bf16 v[160:163], a[184:187], v[64:67], v[160:163]
s_waitcnt lgkmcnt(12)
v_mfma_f32_16x16x32_bf16 v[160:163], a[188:191], v[68:71], v[160:163]
s_waitcnt lgkmcnt(11)
v_mfma_f32_16x16x32_bf16 v[160:163], a[192:195], v[72:75], v[160:163]
s_waitcnt lgkmcnt(10)
v_mfma_f32_16x16x32_bf16 v[160:163], a[196:199], v[76:79], v[160:163]
s_waitcnt lgkmcnt(9)
v_mfma_f32_16x16x32_bf16 v[160:163], a[200:203], v[80:83], v[160:163]
s_waitcnt lgkmcnt(8)
v_mfma_f32_16x16x32_bf16 v[160:163], a[204:207], v[84:87], v[160:163]
s_waitcnt lgkmcnt(7)
v_mfma_f32_16x16x32_bf16 v[160:163], a[208:211], v[88:91], v[160:163]
s_waitcnt lgkmcnt(6)
v_mfma_f32_16x16x32_bf16 v[160:163], a[212:215], v[92:95], v[160:163]
s_waitcnt lgkmcnt(5)
v_mfma_f32_16x16x32_bf16 v[160:163], a[216:219], v[96:99], v[160:163]
s_waitcnt lgkmcnt(4)
v_mfma_f32_16x16x32_bf16 v[160:163], a[220:223], v[100:103], v[160:163]
s_waitcnt lgkmcnt(3)
v_mfma_f32_16x16x32_bf16 v[160:163], a[224:227], v[104:107], v[160:163]
s_waitcnt lgkmcnt(2)
v_mfma_f32_16x16x32_bf16 v[160:163], a[228:231], v[108:111], v[160:163]
s_waitcnt lgkmcnt(1)
v_mfma_f32_16x16x32_bf16 v[160:163], a[232:235], v[112:115], v[160:163]
s_waitcnt lgkmcnt(0)
v_mfma_f32_16x16x32_bf16 v[160:163], a[236:239], v[116:119], v[160:163]
ds_read_b128 v[56:59], v2 offset:49152
ds_read_b128 v[60:63], v2 offset:50176
ds_read_b128 v[64:67], v2 offset:51200
ds_read_b128 v[68:71], v2 offset:52224
ds_read_b128 v[72:75], v2 offset:53248
ds_read_b128 v[76:79], v2 offset:54272
ds_read_b128 v[80:83], v2 offset:55296
ds_read_b128 v[84:87], v2 offset:56320
ds_read_b128 v[88:91], v2 offset:57344
ds_read_b128 v[92:95], v2 offset:58368
ds_read_b128 v[96:99], v2 offset:59392
ds_read_b128 v[100:103], v2 offset:60416
ds_read_b128 v[104:107], v2 offset:61440
ds_read_b128 v[108:111], v2 offset:62464
ds_read_b128 v[112:115], v2 offset:63488
ds_read_b128 v[116:119], v2 offset:64512
s_waitcnt lgkmcnt(15)
v_mfma_f32_16x16x32_bf16 v[164:167], a[176:179], v[56:59], 0
s_waitcnt lgkmcnt(14)
v_mfma_f32_16x16x32_bf16 v[164:167], a[180:183], v[60:63], v[164:167]
s_waitcnt lgkmcnt(13)
v_mfma_f32_16x16x32_bf16 v[164:167], a[184:187], v[64:67], v[164:167]
s_waitcnt lgkmcnt(12)
v_mfma_f32_16x16x32_bf16 v[164:167], a[188:191], v[68:71], v[164:167]
s_waitcnt lgkmcnt(11)
v_mfma_f32_16x16x32_bf16 v[164:167], a[192:195], v[72:75], v[164:167]
s_waitcnt lgkmcnt(10)
v_mfma_f32_16x16x32_bf16 v[164:167], a[196:199], v[76:79], v[164:167]
s_waitcnt lgkmcnt(9)
v_mfma_f32_16x16x32_bf16 v[164:167], a[200:203], v[80:83], v[164:167]
s_waitcnt lgkmcnt(8)
v_mfma_f32_16x16x32_bf16 v[164:167], a[204:207], v[84:87], v[164:167]
s_waitcnt lgkmcnt(7)
v_mfma_f32_16x16x32_bf16 v[164:167], a[208:211], v[88:91], v[164:167]
s_waitcnt lgkmcnt(6)
v_mfma_f32_16x16x32_bf16 v[164:167], a[212:215], v[92:95], v[164:167]
s_waitcnt lgkmcnt(5)
v_mfma_f32_16x16x32_bf16 v[164:167], a[216:219], v[96:99], v[164:167]
s_waitcnt lgkmcnt(4)
v_mfma_f32_16x16x32_bf16 v[164:167], a[220:223], v[100:103], v[164:167]
s_waitcnt lgkmcnt(3)
v_mfma_f32_16x16x32_bf16 v[164:167], a[224:227], v[104:107], v[164:167]
s_waitcnt lgkmcnt(2)
v_mfma_f32_16x16x32_bf16 v[164:167], a[228:231], v[108:111], v[164:167]
s_waitcnt lgkmcnt(1)
v_mfma_f32_16x16x32_bf16 v[164:167], a[232:235], v[112:115], v[164:167]
s_waitcnt lgkmcnt(0)
v_mfma_f32_16x16x32_bf16 v[164:167], a[236:239], v[116:119], v[164:167]
v_max_f32 v160, 0, v160
v_max_f32 v161, 0, v161
v_max_f32 v162, 0, v162
v_max_f32 v163, 0, v163
v_cvt_pk_bf16_f32 v168, v160, v161
v_cvt_pk_bf16_f32 v169, v162, v163
ds_write_b64 v12, v[168:169] offset:0
s_nop 0
v_max_f32 v164, 0, v164
v_max_f32 v165, 0, v165
v_max_f32 v166, 0, v166
v_max_f32 v167, 0, v167
v_cvt_pk_bf16_f32 v170, v164, v165
v_cvt_pk_bf16_f32 v171, v166, v167
ds_write_b64 v12, v[170:171] offset:256
s_waitcnt lgkmcnt(0)
s_barrier
ds_read_b128 v[40:43], v2 offset:12288
ds_read_b128 v[44:47], v2 offset:13312
ds_read_b128 v[48:51], v2 offset:14336
s_waitcnt lgkmcnt(2)
v_mfma_f32_32x32x16_bf16 v[192:207], v[40:43], a[128:131], 0
v_mfma_f32_32x32x16_bf16 v[208:223], v[40:43], a[140:143], 0
v_mfma_f32_32x32x16_bf16 v[224:239], v[40:43], a[152:155], 0
v_mfma_f32_32x32x16_bf16 v[240:255], v[40:43], a[164:167], 0
s_waitcnt lgkmcnt(1)
v_mfma_f32_32x32x16_bf16 v[192:207], v[44:47], a[132:135], v[192:207]
v_mfma_f32_32x32x16_bf16 v[208:223], v[44:47], a[144:147], v[208:223]
v_mfma_f32_32x32x16_bf16 v[224:239], v[44:47], a[156:159], v[224:239]
v_mfma_f32_32x32x16_bf16 v[240:255], v[44:47], a[168:171], v[240:255]
s_waitcnt lgkmcnt(0)
v_mfma_f32_32x32x16_bf16 v[192:207], v[48:51], a[136:139], v[192:207]
v_mfma_f32_32x32x16_bf16 v[208:223], v[48:51], a[148:151], v[208:223]
v_mfma_f32_32x32x16_bf16 v[224:239], v[48:51], a[160:163], v[224:239]
v_mfma_f32_32x32x16_bf16 v[240:255], v[48:51], a[172:175], v[240:255]
s_lshl_b32 s40, s68, 10
s_add_u32 s40, s40, s38
s_add_u32 s40, s40, 0x100200
s_nop 6
v_cvt_pk_bf16_f32 v40, v192, v208
s_add_u32 s41, s40, s48
buffer_store_dword v40, v7, s[8:11], s41 offen offset:0 nt
v_cvt_pk_bf16_f32 v41, v193, v209
s_add_u32 s42, s40, s49
buffer_store_dword v41, v7, s[8:11], s42 offen offset:0 nt
v_cvt_pk_bf16_f32 v42, v194, v210
s_add_u32 s41, s40, s50
buffer_store_dword v42, v7, s[8:11], s41 offen offset:0 nt
v_cvt_pk_bf16_f32 v43, v195, v211
s_add_u32 s42, s40, s51
buffer_store_dword v43, v7, s[8:11], s42 offen offset:0 nt
v_cvt_pk_bf16_f32 v44, v196, v212
s_add_u32 s41, s40, s52
buffer_store_dword v44, v7, s[8:11], s41 offen offset:0 nt
v_cvt_pk_bf16_f32 v45, v197, v213
s_add_u32 s42, s40, s53
buffer_store_dword v45, v7, s[8:11], s42 offen offset:0 nt
v_cvt_pk_bf16_f32 v46, v198, v214
s_add_u32 s41, s40, s54
buffer_store_dword v46, v7, s[8:11], s41 offen offset:0 nt
v_cvt_pk_bf16_f32 v47, v199, v215
s_add_u32 s42, s40, s55
buffer_store_dword v47, v7, s[8:11], s42 offen offset:0 nt
v_cvt_pk_bf16_f32 v40, v200, v216
s_add_u32 s41, s40, s56
buffer_store_dword v40, v7, s[8:11], s41 offen offset:0 nt
v_cvt_pk_bf16_f32 v41, v201, v217
s_add_u32 s42, s40, s57
buffer_store_dword v41, v7, s[8:11], s42 offen offset:0 nt
v_cvt_pk_bf16_f32 v42, v202, v218
s_add_u32 s41, s40, s58
buffer_store_dword v42, v7, s[8:11], s41 offen offset:0 nt
v_cvt_pk_bf16_f32 v43, v203, v219
s_add_u32 s42, s40, s59
buffer_store_dword v43, v7, s[8:11], s42 offen offset:0 nt
v_cvt_pk_bf16_f32 v44, v204, v220
s_add_u32 s41, s40, s60
buffer_store_dword v44, v7, s[8:11], s41 offen offset:0 nt
v_cvt_pk_bf16_f32 v45, v205, v221
s_add_u32 s42, s40, s61
buffer_store_dword v45, v7, s[8:11], s42 offen offset:0 nt
v_cvt_pk_bf16_f32 v46, v206, v222
s_add_u32 s41, s40, s62
buffer_store_dword v46, v7, s[8:11], s41 offen offset:0 nt
v_cvt_pk_bf16_f32 v47, v207, v223
s_add_u32 s42, s40, s63
buffer_store_dword v47, v7, s[8:11], s42 offen offset:0 nt
v_cvt_pk_bf16_f32 v40, v224, v240
s_add_u32 s41, s40, s48
buffer_store_dword v40, v7, s[8:11], s41 offen offset:128 nt
v_cvt_pk_bf16_f32 v41, v225, v241
s_add_u32 s42, s40, s49
buffer_store_dword v41, v7, s[8:11], s42 offen offset:128 nt
v_cvt_pk_bf16_f32 v42, v226, v242
s_add_u32 s41, s40, s50
buffer_store_dword v42, v7, s[8:11], s41 offen offset:128 nt
v_cvt_pk_bf16_f32 v43, v227, v243
s_add_u32 s42, s40, s51
buffer_store_dword v43, v7, s[8:11], s42 offen offset:128 nt
v_cvt_pk_bf16_f32 v44, v228, v244
s_add_u32 s41, s40, s52
buffer_store_dword v44, v7, s[8:11], s41 offen offset:128 nt
v_cvt_pk_bf16_f32 v45, v229, v245
s_add_u32 s42, s40, s53
buffer_store_dword v45, v7, s[8:11], s42 offen offset:128 nt
v_cvt_pk_bf16_f32 v46, v230, v246
s_add_u32 s41, s40, s54
buffer_store_dword v46, v7, s[8:11], s41 offen offset:128 nt
v_cvt_pk_bf16_f32 v47, v231, v247
s_add_u32 s42, s40, s55
buffer_store_dword v47, v7, s[8:11], s42 offen offset:128 nt
v_cvt_pk_bf16_f32 v40, v232, v248
s_add_u32 s41, s40, s56
buffer_store_dword v40, v7, s[8:11], s41 offen offset:128 nt
v_cvt_pk_bf16_f32 v41, v233, v249
s_add_u32 s42, s40, s57
buffer_store_dword v41, v7, s[8:11], s42 offen offset:128 nt
v_cvt_pk_bf16_f32 v42, v234, v250
s_add_u32 s41, s40, s58
buffer_store_dword v42, v7, s[8:11], s41 offen offset:128 nt
v_cvt_pk_bf16_f32 v43, v235, v251
s_add_u32 s42, s40, s59
buffer_store_dword v43, v7, s[8:11], s42 offen offset:128 nt
v_cvt_pk_bf16_f32 v44, v236, v252
s_add_u32 s41, s40, s60
buffer_store_dword v44, v7, s[8:11], s41 offen offset:128 nt
v_cvt_pk_bf16_f32 v45, v237, v253
s_add_u32 s42, s40, s61
buffer_store_dword v45, v7, s[8:11], s42 offen offset:128 nt
v_cvt_pk_bf16_f32 v46, v238, v254
s_add_u32 s41, s40, s62
buffer_store_dword v46, v7, s[8:11], s41 offen offset:128 nt
v_cvt_pk_bf16_f32 v47, v239, v255
s_add_u32 s42, s40, s63
buffer_store_dword v47, v7, s[8:11], s42 offen offset:128 nt
s_waitcnt vmcnt(0)
s_barrier
s_barrier
s_lshl_b32 s40, s68, 15
s_add_u32 s40, s40, s38
s_add_u32 s40, s40, 0x100200
s_add_u32 s41, s40, 0
buffer_load_dwordx4 v[40:43], v8, s[8:11], s41 offen sc1
s_add_u32 s41, s40, 4096
buffer_load_dwordx4 v[44:47], v8, s[8:11], s41 offen sc1
s_add_u32 s41, s40, 8192
buffer_load_dwordx4 v[48:51], v8, s[8:11], s41 offen sc1
s_add_u32 s41, s40, 12288
buffer_load_dwordx4 v[52:55], v8, s[8:11], s41 offen sc1
s_add_u32 s41, s40, 16384
buffer_load_dwordx4 v[56:59], v8, s[8:11], s41 offen sc1
s_add_u32 s41, s40, 20480
buffer_load_dwordx4 v[60:63], v8, s[8:11], s41 offen sc1
s_add_u32 s41, s40, 24576
buffer_load_dwordx4 v[64:67], v8, s[8:11], s41 offen sc1
s_add_u32 s41, s40, 28672
buffer_load_dwordx4 v[68:71], v8, s[8:11], s41 offen sc1
s_waitcnt vmcnt(7)
v_mfma_f32_16x16x32_bf16 v[160:163], v[40:43], v[16:19], 0
s_waitcnt vmcnt(6)
v_mfma_f32_16x16x32_bf16 v[160:163], v[44:47], v[16:19], v[160:163]
s_waitcnt vmcnt(5)
v_mfma_f32_16x16x32_bf16 v[160:163], v[48:51], v[16:19], v[160:163]
s_waitcnt vmcnt(4)
v_mfma_f32_16x16x32_bf16 v[160:163], v[52:55], v[16:19], v[160:163]
s_waitcnt vmcnt(3)
v_mfma_f32_16x16x32_bf16 v[160:163], v[56:59], v[16:19], v[160:163]
s_waitcnt vmcnt(2)
v_mfma_f32_16x16x32_bf16 v[160:163], v[60:63], v[16:19], v[160:163]
s_waitcnt vmcnt(1)
v_mfma_f32_16x16x32_bf16 v[160:163], v[64:67], v[16:19], v[160:163]
s_waitcnt vmcnt(0)
v_mfma_f32_16x16x32_bf16 v[160:163], v[68:71], v[16:19], v[160:163]
s_nop 7
ds_write_b32 v9, v160 offset:0
ds_write_b32 v9, v161 offset:16
ds_write_b32 v9, v162 offset:32
ds_write_b32 v9, v163 offset:48
s_waitcnt lgkmcnt(0)
s_barrier
v_lshlrev_b32 v147, 1, v10
ds_read_b64 v[148:149], v147 offset:8192
s_waitcnt lgkmcnt(0)
v_accvgpr_read_b32 v144, a246
v_accvgpr_read_b32 v145, a247
v_accvgpr_read_b32 v150, a248
v_accvgpr_read_b32 v151, a249
v_cvt_pk_bf16_f32 v148, v148, v148
v_and_b32 v148, 0xffff0000, v148
v_mul_f32 v148, v148, v144
v_cvt_pk_bf16_f32 v148, v148, v148
v_and_b32 v148, 0xffff0000, v148
v_add_f32 v150, v150, v148
v_cvt_pk_bf16_f32 v149, v149, v149
v_and_b32 v149, 0xffff0000, v149
v_mul_f32 v149, v149, v145
v_cvt_pk_bf16_f32 v149, v149, v149
v_and_b32 v149, 0xffff0000, v149
v_add_f32 v151, v151, v149
v_cvt_pk_bf16_f32 v150, v150, v151
s_lshl_b32 s40, s36, 5
s_add_u32 s40, s40, s68
s_lshl_b32 s40, s40, 10
buffer_store_dword v150, v10, s[4:7], s40 offen
s_add_u32 s36, s36, 7
s_add_u32 s37, s37, 1
s_branch L_tail_w2_f
L_tailend_w2_f:
s_waitcnt vmcnt(0)
s_endpgm
L_tw3:
v_lshlrev_b32 v2, 4, v3
v_lshlrev_b32 v13, 2, v3
v_and_b32 v140, 15, v3
v_lshrrev_b32 v141, 4, v3
v_lshrrev_b32 v142, 2, v140
v_and_b32 v143, 1, v140
v_lshl_add_u32 v142, v142, 1, v143
v_lshl_add_u32 v142, v141, 3, v142
v_lshlrev_b32 v4, 4, v142
v_lshlrev_b32 v142, 2, v141
v_sub_u32 v5, v140, v142
v_lshrrev_b32 v142, 1, v141
v_lshlrev_b32 v142, 6, v142
v_and_b32 v143, 1, v141
v_lshl_add_u32 v142, v143, 5, v142
v_add3_u32 v142, v142, v140, 16
v_lshlrev_b32 v142, 4, v142
v_add_u32 v6, 0, v142
v_lshrrev_b32 v142, 5, v3
v_lshlrev_b32 v142, 17, v142
v_and_b32 v143, 31, v3
v_lshl_add_u32 v7, v143, 2, v142
v_lshlrev_b32 v142, 10, v141
v_lshl_add_u32 v8, v140, 4, v142
v_lshrrev_b32 v142, 1, v141
v_lshlrev_b32 v142, 6, v142
v_and_b32 v143, 1, v140
v_lshl_add_u32 v142, v143, 5, v142
v_and_b32 v143, 1, v141
v_lshl_add_u32 v142, v143, 4, v142
v_lshrrev_b32 v143, 1, v140
v_add3_u32 v142, v142, v143, 0
v_add_u32 v142, 384, v142
v_lshlrev_b32 v142, 2, v142
v_add_u32 v142, 8192, v142
v_mov_b32 v9, 10240
v_cmp_gt_u32 vcc, 8, v140
s_nop 1
v_cndmask_b32 v9, v9, v142, vcc
v_add_u32 v142, 192, v3
v_lshlrev_b32 v10, 2, v142
v_lshrrev_b32 v143, 4, v142
v_lshlrev_b32 v143, 10, v143
v_bfe_u32 v144, v142, 2, 2
v_lshl_add_u32 v143, v144, 8, v143
v_and_b32 v144, 3, v142
v_lshl_add_u32 v143, v144, 2, v143
s_lshr_b32 s40, s68, 4
s_lshl_b32 s40, s40, 14
s_and_b32 s41, s68, 15
s_lshl_b32 s41, s41, 4
s_add_u32 s40, s40, s41
v_add_u32 v11, s40, v143
v_lshrrev_b32 v142, 1, v141
v_lshlrev_b32 v142, 5, v142
v_add_u32 v142, v142, v140
v_lshlrev_b32 v142, 4, v142
v_and_b32 v143, 1, v141
v_lshl_add_u32 v142, v143, 3, v142
v_add_u32 v12, 15360, v142
v_and_b32 v142, 1, v140
v_lshlrev_b32 v142, 4, v142
v_mov_b32 v143, 0x3f80
v_lshlrev_b32 v143, v142, v143
v_lshrrev_b32 v142, 1, v140
v_cmp_eq_u32 vcc, 0, v142
s_nop 1
v_cndmask_b32 v16, 0, v143, vcc
v_cmp_eq_u32 vcc, 1, v142
s_nop 1
v_cndmask_b32 v17, 0, v143, vcc
v_cmp_eq_u32 vcc, 2, v142
s_nop 1
v_cndmask_b32 v18, 0, v143, vcc
v_cmp_eq_u32 vcc, 3, v142
s_nop 1
v_cndmask_b32 v19, 0, v143, vcc
v_mov_b32 v20, 0
v_mov_b32 v21, 0
v_mov_b32 v22, 0
v_mov_b32 v23, 0
v_mov_b32 v24, 0
v_mov_b32 v25, 0
v_mov_b32 v26, 0
v_mov_b32 v27, 0
v_mov_b32 v28, 0
v_mov_b32 v29, 0
v_mov_b32 v30, 0
v_mov_b32 v31, 0
v_mov_b32 v32, 0
v_mov_b32 v33, 0
v_mov_b32 v34, 0
v_mov_b32 v35, 0
v_mov_b32 v36, 0x3f803f80
v_mov_b32 v37, 0x3f803f80
v_mov_b32 v38, 0x3f803f80
v_mov_b32 v39, 0x3f803f80
v_mov_b32 v132, 0
v_mov_b32 v133, 0
v_mov_b32 v134, 0
v_mov_b32 v135, 0
v_mov_b32 v136, 0
v_mov_b32 v137, 0
v_mov_b32 v138, 0
v_mov_b32 v139, 0
s_mov_b32 s48, 0
s_mov_b32 s49, 32768
s_mov_b32 s50, 65536
s_mov_b32 s51, 98304
s_mov_b32 s52, 262144
s_mov_b32 s53, 294912
s_mov_b32 s54, 327680
s_mov_b32 s55, 360448
s_mov_b32 s56, 524288
s_mov_b32 s57, 557056
s_mov_b32 s58, 589824
s_mov_b32 s59, 622592
s_mov_b32 s60, 786432
s_mov_b32 s61, 819200
s_mov_b32 s62, 851968
s_mov_b32 s63, 884736
s_mov_b32 s64, 0x3e0293ee
s_mov_b32 s65, 0xbe0293ee
s_mul_i32 s38, s33, 0x400000
s_add_u32 s38, s38, 0x4000000
s_lshl_b32 s39, s33, 10
s_add_u32 s39, s39, 0x11000
v_lshlrev_b32 v142, 10, v141
v_lshl_add_u32 v142, v140, 4, v142
s_mov_b32 s12, s24
s_mov_b32 s13, s25
s_mov_b32 s14, 0x400000
s_mov_b32 s15, 0x00020000
s_lshl_b32 s40, s68, 17
s_add_u32 s40, s40, 768
v_add_u32 v146, s40, v142
s_mov_b32 m0, 98304
s_mov_b32 s41, 0
buffer_load_dwordx4 v146, s[12:15], s41 offen lds
s_mov_b32 m0, 99328
s_mov_b32 s41, 4096
buffer_load_dwordx4 v146, s[12:15], s41 offen lds
s_mov_b32 m0, 100352
s_mov_b32 s41, 8192
buffer_load_dwordx4 v146, s[12:15], s41 offen lds
s_mov_b32 m0, 101376
s_mov_b32 s41, 12288
buffer_load_dwordx4 v146, s[12:15], s41 offen lds
s_mov_b32 m0, 102400
s_mov_b32 s41, 16384
buffer_load_dwordx4 v146, s[12:15], s41 offen lds
s_mov_b32 m0, 103424
s_mov_b32 s41, 20480
buffer_load_dwordx4 v146, s[12:15], s41 offen lds
s_mov_b32 m0, 104448
s_mov_b32 s41, 24576
buffer_load_dwordx4 v146, s[12:15], s41 offen lds
s_mov_b32 m0, 105472
s_mov_b32 s41, 28672
buffer_load_dwordx4 v146, s[12:15], s41 offen lds
s_mov_b32 m0, 106496
s_mov_b32 s41, 32768
buffer_load_dwordx4 v146, s[12:15], s41 offen lds
s_mov_b32 m0, 107520
s_mov_b32 s41, 36864
buffer_load_dwordx4 v146, s[12:15], s41 offen lds
s_mov_b32 m0, 108544
s_mov_b32 s41, 40960
buffer_load_dwordx4 v146, s[12:15], s41 offen lds
s_mov_b32 m0, 109568
s_mov_b32 s41, 45056
buffer_load_dwordx4 v146, s[12:15], s41 offen lds
s_mov_b32 m0, 110592
s_mov_b32 s41, 49152
buffer_load_dwordx4 v146, s[12:15], s41 offen lds
s_mov_b32 m0, 111616
s_mov_b32 s41, 53248
buffer_load_dwordx4 v146, s[12:15], s41 offen lds
s_mov_b32 m0, 112640
s_mov_b32 s41, 57344
buffer_load_dwordx4 v146, s[12:15], s41 offen lds
s_mov_b32 m0, 113664
s_mov_b32 s41, 61440
buffer_load_dwordx4 v146, s[12:15], s41 offen lds
s_mov_b32 m0, 114688
s_mov_b32 s41, 65536
buffer_load_dwordx4 v146, s[12:15], s41 offen lds
s_mov_b32 m0, 115712
s_mov_b32 s41, 69632
buffer_load_dwordx4 v146, s[12:15], s41 offen lds
s_mov_b32 m0, 116736
s_mov_b32 s41, 73728
buffer_load_dwordx4 v146, s[12:15], s41 offen lds
s_mov_b32 m0, 117760
s_mov_b32 s41, 77824
buffer_load_dwordx4 v146, s[12:15], s41 offen lds
s_mov_b32 m0, 118784
s_mov_b32 s41, 81920
buffer_load_dwordx4 v146, s[12:15], s41 offen lds
s_mov_b32 m0, 119808
s_mov_b32 s41, 86016
buffer_load_dwordx4 v146, s[12:15], s41 offen lds
s_mov_b32 m0, 120832
s_mov_b32 s41, 90112
buffer_load_dwordx4 v146, s[12:15], s41 offen lds
s_mov_b32 m0, 121856
s_mov_b32 s41, 94208
buffer_load_dwordx4 v146, s[12:15], s41 offen lds
s_mov_b32 m0, 122880
s_mov_b32 s41, 98304
buffer_load_dwordx4 v146, s[12:15], s41 offen lds
s_mov_b32 m0, 123904
s_mov_b32 s41, 102400
buffer_load_dwordx4 v146, s[12:15], s41 offen lds
s_mov_b32 m0, 124928
s_mov_b32 s41, 106496
buffer_load_dwordx4 v146, s[12:15], s41 offen lds
s_mov_b32 m0, 125952
s_mov_b32 s41, 110592
buffer_load_dwordx4 v146, s[12:15], s41 offen lds
s_mov_b32 m0, 126976
s_mov_b32 s41, 114688
buffer_load_dwordx4 v146, s[12:15], s41 offen lds
s_mov_b32 m0, 128000
s_mov_b32 s41, 118784
buffer_load_dwordx4 v146, s[12:15], s41 offen lds
s_mov_b32 m0, 129024
s_mov_b32 s41, 122880
buffer_load_dwordx4 v146, s[12:15], s41 offen lds
s_mov_b32 m0, 130048
s_mov_b32 s41, 126976
buffer_load_dwordx4 v146, s[12:15], s41 offen lds
v_bfe_u32 v143, v3, 2, 2
v_lshrrev_b32 v144, 5, v3
v_bfe_u32 v145, v3, 4, 1
v_lshlrev_b32 v145, 5, v145
v_and_b32 v148, 3, v3
v_lshl_add_u32 v145, v148, 3, v145
v_lshl_add_u32 v148, v144, 2, v143
v_lshl_add_u32 v148, v148, 8, v145
v_add_u32 v147, 98304, v148
v_lshl_add_u32 v148, v144, 3, v143
v_lshl_add_u32 v148, v148, 8, v145
v_add_u32 v149, 98304, v148
s_waitcnt vmcnt(0)
ds_read_b64_tr_b16 a[0:1], v147 offset:0
ds_read_b64_tr_b16 a[2:3], v147 offset:4096
ds_read_b64_tr_b16 a[4:5], v147 offset:2048
ds_read_b64_tr_b16 a[6:7], v147 offset:6144
ds_read_b64_tr_b16 a[8:9], v147 offset:8192
ds_read_b64_tr_b16 a[10:11], v147 offset:12288
ds_read_b64_tr_b16 a[12:13], v147 offset:10240
ds_read_b64_tr_b16 a[14:15], v147 offset:14336
ds_read_b64_tr_b16 a[16:17], v147 offset:16384
ds_read_b64_tr_b16 a[18:19], v147 offset:20480
ds_read_b64_tr_b16 a[20:21], v147 offset:18432
ds_read_b64_tr_b16 a[22:23], v147 offset:22528
ds_read_b64_tr_b16 a[24:25], v147 offset:24576
ds_read_b64_tr_b16 a[26:27], v147 offset:28672
ds_read_b64_tr_b16 a[28:29], v147 offset:26624
ds_read_b64_tr_b16 a[30:31], v147 offset:30720
ds_read_b64_tr_b16 a[32:33], v147 offset:64
ds_read_b64_tr_b16 a[34:35], v147 offset:4160
ds_read_b64_tr_b16 a[36:37], v147 offset:2112
ds_read_b64_tr_b16 a[38:39], v147 offset:6208
ds_read_b64_tr_b16 a[40:41], v147 offset:8256
ds_read_b64_tr_b16 a[42:43], v147 offset:12352
ds_read_b64_tr_b16 a[44:45], v147 offset:10304
ds_read_b64_tr_b16 a[46:47], v147 offset:14400
ds_read_b64_tr_b16 a[48:49], v147 offset:16448
ds_read_b64_tr_b16 a[50:51], v147 offset:20544
ds_read_b64_tr_b16 a[52:53], v147 offset:18496
ds_read_b64_tr_b16 a[54:55], v147 offset:22592
ds_read_b64_tr_b16 a[56:57], v147 offset:24640
ds_read_b64_tr_b16 a[58:59], v147 offset:28736
ds_read_b64_tr_b16 a[60:61], v147 offset:26688
ds_read_b64_tr_b16 a[62:63], v147 offset:30784
ds_read_b64_tr_b16 a[64:65], v147 offset:128
ds_read_b64_tr_b16 a[66:67], v147 offset:4224
ds_read_b64_tr_b16 a[68:69], v147 offset:2176
ds_read_b64_tr_b16 a[70:71], v147 offset:6272
ds_read_b64_tr_b16 a[72:73], v147 offset:8320
ds_read_b64_tr_b16 a[74:75], v147 offset:12416
ds_read_b64_tr_b16 a[76:77], v147 offset:10368
ds_read_b64_tr_b16 a[78:79], v147 offset:14464
ds_read_b64_tr_b16 a[80:81], v147 offset:16512
ds_read_b64_tr_b16 a[82:83], v147 offset:20608
ds_read_b64_tr_b16 a[84:85], v147 offset:18560
ds_read_b64_tr_b16 a[86:87], v147 offset:22656
ds_read_b64_tr_b16 a[88:89], v147 offset:24704
ds_read_b64_tr_b16 a[90:91], v147 offset:28800
ds_read_b64_tr_b16 a[92:93], v147 offset:26752
ds_read_b64_tr_b16 a[94:95], v147 offset:30848
ds_read_b64_tr_b16 a[96:97], v147 offset:192
ds_read_b64_tr_b16 a[98:99], v147 offset:4288
ds_read_b64_tr_b16 a[100:101], v147 offset:2240
ds_read_b64_tr_b16 a[102:103], v147 offset:6336
ds_read_b64_tr_b16 a[104:105], v147 offset:8384
ds_read_b64_tr_b16 a[106:107], v147 offset:12480
ds_read_b64_tr_b16 a[108:109], v147 offset:10432
ds_read_b64_tr_b16 a[110:111], v147 offset:14528
ds_read_b64_tr_b16 a[112:113], v147 offset:16576
ds_read_b64_tr_b16 a[114:115], v147 offset:20672
ds_read_b64_tr_b16 a[116:117], v147 offset:18624
ds_read_b64_tr_b16 a[118:119], v147 offset:22720
ds_read_b64_tr_b16 a[120:121], v147 offset:24768
ds_read_b64_tr_b16 a[122:123], v147 offset:28864
ds_read_b64_tr_b16 a[124:125], v147 offset:26816
ds_read_b64_tr_b16 a[126:127], v147 offset:30912
s_waitcnt lgkmcnt(0)
s_mov_b32 s12, s30
s_mov_b32 s13, s31
s_mov_b32 s14, 0x158000
s_mov_b32 s15, 0x00020000
s_mul_i32 s40, s68, 49152
s_add_u32 s40, s40, 768
v_add_u32 v146, s40, v142
s_mov_b32 m0, 98304
s_mov_b32 s41, 0
buffer_load_dwordx4 v146, s[12:15], s41 offen lds
s_mov_b32 m0, 99328
s_mov_b32 s41, 4096
buffer_load_dwordx4 v146, s[12:15], s41 offen lds
s_mov_b32 m0, 100352
s_mov_b32 s41, 8192
buffer_load_dwordx4 v146, s[12:15], s41 offen lds
s_mov_b32 m0, 101376
s_mov_b32 s41, 12288
buffer_load_dwordx4 v146, s[12:15], s41 offen lds
s_mov_b32 m0, 102400
s_mov_b32 s41, 16384
buffer_load_dwordx4 v146, s[12:15], s41 offen lds
s_mov_b32 m0, 103424
s_mov_b32 s41, 20480
buffer_load_dwordx4 v146, s[12:15], s41 offen lds
s_mov_b32 m0, 104448
s_mov_b32 s41, 24576
buffer_load_dwordx4 v146, s[12:15], s41 offen lds
s_mov_b32 m0, 105472
s_mov_b32 s41, 28672
buffer_load_dwordx4 v146, s[12:15], s41 offen lds
s_mov_b32 m0, 106496
s_mov_b32 s41, 32768
buffer_load_dwordx4 v146, s[12:15], s41 offen lds
s_mov_b32 m0, 107520
s_mov_b32 s41, 36864
buffer_load_dwordx4 v146, s[12:15], s41 offen lds
s_mov_b32 m0, 108544
s_mov_b32 s41, 40960
buffer_load_dwordx4 v146, s[12:15], s41 offen lds
s_mov_b32 m0, 109568
s_mov_b32 s41, 45056
buffer_load_dwordx4 v146, s[12:15], s41 offen lds
s_waitcnt vmcnt(0)
ds_read_b64_tr_b16 a[128:129], v149 offset:0
ds_read_b64_tr_b16 a[130:131], v149 offset:1024
ds_read_b64_tr_b16 a[132:133], v149 offset:4096
ds_read_b64_tr_b16 a[134:135], v149 offset:5120
ds_read_b64_tr_b16 a[136:137], v149 offset:8192
ds_read_b64_tr_b16 a[138:139], v149 offset:9216
ds_read_b64_tr_b16 a[140:141], v149 offset:64
ds_read_b64_tr_b16 a[142:143], v149 offset:1088
ds_read_b64_tr_b16 a[144:145], v149 offset:4160
ds_read_b64_tr_b16 a[146:147], v149 offset:5184
ds_read_b64_tr_b16 a[148:149], v149 offset:8256
ds_read_b64_tr_b16 a[150:151], v149 offset:9280
ds_read_b64_tr_b16 a[152:153], v149 offset:128
ds_read_b64_tr_b16 a[154:155], v149 offset:1152
ds_read_b64_tr_b16 a[156:157], v149 offset:4224
ds_read_b64_tr_b16 a[158:159], v149 offset:5248
ds_read_b64_tr_b16 a[160:161], v149 offset:8320
ds_read_b64_tr_b16 a[162:163], v149 offset:9344
ds_read_b64_tr_b16 a[164:165], v149 offset:192
ds_read_b64_tr_b16 a[166:167], v149 offset:1216
ds_read_b64_tr_b16 a[168:169], v149 offset:4288
ds_read_b64_tr_b16 a[170:171], v149 offset:5312
ds_read_b64_tr_b16 a[172:173], v149 offset:8384
ds_read_b64_tr_b16 a[174:175], v149 offset:9408
s_waitcnt lgkmcnt(0)
s_barrier
s_sub_u32 s36, s33, 1
s_mov_b32 s37, 0
s_cmp_lg_u32 s32, 0
s_cbranch_scc1 L_tslow3
s_mov_b32 s12, s22
s_mov_b32 s13, s23
s_mov_b32 s14, 0x200000
s_mov_b32 s15, 0x00020000
s_mov_b32 s4, s26
s_mov_b32 s5, s27
s_mov_b32 s6, 0x200000
s_mov_b32 s7, 0x00020000
s_barrier
v_lshlrev_b32 v140, 1, v10
s_mov_b32 s40, 0x1000
buffer_load_dwordx2 a[240:241], v140, s[8:11], s40 offen sc1
s_mov_b32 s40, 0x1800
buffer_load_dwordx2 a[242:243], v140, s[8:11], s40 offen sc1
s_mov_b32 s40, 0x2000
buffer_load_dwordx2 a[244:245], v140, s[8:11], s40 offen sc1
s_mov_b32 s40, 0x2800
buffer_load_dwordx2 a[246:247], v140, s[8:11], s40 offen sc1
s_waitcnt vmcnt(0)
L_tail_w3_f:
s_cmp_ge_u32 s36, 64
s_cbranch_scc1 L_tailend_w3_f
s_barrier
s_lshl_b32 s40, s36, 5
s_add_u32 s40, s40, s68
s_lshl_b32 s66, s40, 13
s_lshl_b32 s67, s40, 11
s_add_u32 s41, s66, 0x2801000
buffer_load_dwordx4 v[40:43], v2, s[8:11], s41 offen offset:0 sc1
buffer_load_dwordx4 v[44:47], v2, s[8:11], s41 offen offset:1024 sc1
buffer_load_dwordx4 v[48:51], v2, s[8:11], s41 offen offset:2048 sc1
buffer_load_dwordx4 v[52:55], v2, s[8:11], s41 offen offset:3072 sc1
s_add_u32 s41, s66, 0x800000
buffer_load_dwordx4 v[72:75], v2, s[8:11], s41 offen offset:0 sc1
buffer_load_dwordx4 v[76:79], v2, s[8:11], s41 offen offset:1024 sc1
buffer_load_dwordx4 v[80:83], v2, s[8:11], s41 offen offset:2048 sc1
buffer_load_dwordx4 v[84:87], v2, s[8:11], s41 offen offset:3072 sc1
s_add_u32 s41, s66, 0x801000
buffer_load_dwordx4 v[88:91], v2, s[8:11], s41 offen offset:0 sc1
buffer_load_dwordx4 v[92:95], v2, s[8:11], s41 offen offset:1024 sc1
buffer_load_dwordx4 v[96:99], v2, s[8:11], s41 offen offset:2048 sc1
buffer_load_dwordx4 v[100:103], v2, s[8:11], s41 offen offset:3072 sc1
s_add_u32 s41, s66, 0x1801000
buffer_load_dwordx4 v[104:107], v2, s[8:11], s41 offen offset:0 sc1
buffer_load_dwordx4 v[108:111], v2, s[8:11], s41 offen offset:1024 sc1
buffer_load_dwordx4 v[112:115], v2, s[8:11], s41 offen offset:2048 sc1
buffer_load_dwordx4 v[116:119], v2, s[8:11], s41 offen offset:3072 sc1
s_lshl_b32 s41, s40, 10
buffer_load_dword v152, v10, s[12:15], s41 offen
s_barrier
s_add_u32 s42, s67, 0x3800000
buffer_load_dwordx4 v[56:59], v4, s[8:11], s42 offen offset:0 sc1
buffer_load_dwordx4 v[60:63], v4, s[8:11], s42 offen offset:512 sc1
buffer_load_dwordx4 v[64:67], v4, s[8:11], s42 offen offset:1024 sc1
buffer_load_dwordx4 v[68:71], v4, s[8:11], s42 offen offset:1536 sc1
s_add_u32 s42, s67, 0x3c00400
buffer_load_dword v20, v13, s[8:11], s42 offen offset:0 sc1
buffer_load_dword v24, v13, s[8:11], s42 offen offset:256 sc1
buffer_load_dword v28, v13, s[8:11], s42 offen offset:512 sc1
buffer_load_dword v32, v13, s[8:11], s42 offen offset:768 sc1
s_waitcnt vmcnt(0)
v_mfma_f32_16x16x32_bf16 v[120:123], v[56:59], v[40:43], 0
v_mfma_f32_16x16x32_bf16 v[124:127], v[72:75], v[40:43], 0
v_mfma_f32_16x16x32_bf16 v[128:131], v[88:91], v[40:43], 0
v_mfma_f32_16x16x32_bf16 v[120:123], v[60:63], v[44:47], v[120:123]
v_mfma_f32_16x16x32_bf16 v[124:127], v[76:79], v[44:47], v[124:127]
v_mfma_f32_16x16x32_bf16 v[128:131], v[92:95], v[44:47], v[128:131]
v_mfma_f32_16x16x32_bf16 v[120:123], v[64:67], v[48:51], v[120:123]
v_mfma_f32_16x16x32_bf16 v[124:127], v[80:83], v[48:51], v[124:127]
v_mfma_f32_16x16x32_bf16 v[128:131], v[96:99], v[48:51], v[128:131]
v_mfma_f32_16x16x32_bf16 v[120:123], v[68:71], v[52:55], v[120:123]
v_mfma_f32_16x16x32_bf16 v[124:127], v[84:87], v[52:55], v[124:127]
v_mfma_f32_16x16x32_bf16 v[128:131], v[100:103], v[52:55], v[128:131]
v_mov_b32 v140, 0xff800000
v_cmp_le_i32 vcc, 0, v5
s_nop 5
v_cndmask_b32 v128, v140, v128, vcc
v_cmp_le_i32 vcc, 1, v5
s_nop 1
v_cndmask_b32 v129, v140, v129, vcc
v_cmp_le_i32 vcc, 2, v5
s_nop 1
v_cndmask_b32 v130, v140, v130, vcc
v_cmp_le_i32 vcc, 3, v5
s_nop 1
v_cndmask_b32 v131, v140, v131, vcc
v_max3_f32 v141, v120, v121, v124
v_max3_f32 v141, v141, v125, v126
v_max3_f32 v141, v141, v127, v128
v_max3_f32 v141, v141, v129, v130
v_max_f32 v141, v141, v131
v_mov_b32 v142, v141
s_nop 1
v_permlane32_swap_b32 v141, v142
v_max_f32 v141, v141, v142
v_mov_b32 v142, v141
s_nop 1
v_permlane16_swap_b32 v141, v142
v_max_f32 v141, v141, v142
v_mul_f32 v143, s65, v141
v_fma_f32 v120, v120, s64, v143
v_fma_f32 v121, v121, s64, v143
v_fma_f32 v124, v124, s64, v143
v_fma_f32 v125, v125, s64, v143
v_fma_f32 v126, v126, s64, v143
v_fma_f32 v127, v127, s64, v143
v_fma_f32 v128, v128, s64, v143
v_fma_f32 v129, v129, s64, v143
v_fma_f32 v130, v130, s64, v143
v_fma_f32 v131, v131, s64, v143
v_exp_f32 v120, v120
v_exp_f32 v121, v121
v_exp_f32 v124, v124
v_exp_f32 v125, v125
v_exp_f32 v126, v126
v_exp_f32 v127, v127
v_exp_f32 v128, v128
v_exp_f32 v129, v129
v_exp_f32 v130, v130
v_exp_f32 v131, v131
v_cvt_pk_bf16_f32 v132, v124, v125
v_cvt_pk_bf16_f32 v133, v126, v127
v_cvt_pk_bf16_f32 v134, v128, v129
v_cvt_pk_bf16_f32 v135, v130, v131
v_cvt_pk_bf16_f32 v136, v120, v121
s_nop 0
v_mfma_f32_16x16x32_bf16 v[176:179], v[36:39], v[132:135], 0
v_mfma_f32_16x16x32_bf16 v[176:179], v[36:39], v[136:139], v[176:179]
v_mfma_f32_16x16x32_bf16 v[160:163], v[104:107], v[132:135], 0
v_mfma_f32_16x16x32_bf16 v[164:167], v[108:111], v[132:135], 0
v_mfma_f32_16x16x32_bf16 v[168:171], v[112:115], v[132:135], 0
v_mfma_f32_16x16x32_bf16 v[172:175], v[116:119], v[132:135], 0
v_mfma_f32_16x16x32_bf16 v[160:163], v[20:23], v[136:139], v[160:163]
v_mfma_f32_16x16x32_bf16 v[164:167], v[24:27], v[136:139], v[164:167]
v_mfma_f32_16x16x32_bf16 v[168:171], v[28:31], v[136:139], v[168:171]
v_mfma_f32_16x16x32_bf16 v[172:175], v[32:35], v[136:139], v[172:175]
v_rcp_f32 v142, v176
s_nop 3
v_mul_f32 v160, v160, v142
v_mul_f32 v161, v161, v142
v_mul_f32 v162, v162, v142
v_mul_f32 v163, v163, v142
v_mul_f32 v164, v164, v142
v_mul_f32 v165, v165, v142
v_mul_f32 v166, v166, v142
v_mul_f32 v167, v167, v142
v_mul_f32 v168, v168, v142
v_mul_f32 v169, v169, v142
v_mul_f32 v170, v170, v142
v_mul_f32 v171, v171, v142
v_mul_f32 v172, v172, v142
v_mul_f32 v173, v173, v142
v_mul_f32 v174, v174, v142
v_mul_f32 v175, v175, v142
v_cvt_pk_bf16_f32 v40, v160, v161
v_cvt_pk_bf16_f32 v41, v162, v163
v_cvt_pk_bf16_f32 v42, v164, v165
v_cvt_pk_bf16_f32 v43, v166, v167
ds_write_b128 v6, v[40:43] offset:4096
v_cvt_pk_bf16_f32 v44, v168, v169
v_cvt_pk_bf16_f32 v45, v170, v171
v_cvt_pk_bf16_f32 v46, v172, v173
v_cvt_pk_bf16_f32 v47, v174, v175
ds_write_b128 v6, v[44:47] offset:6144
s_waitcnt lgkmcnt(0)
s_barrier
ds_read_b128 v[40:43], v2 offset:0
ds_read_b128 v[44:47], v2 offset:1024
ds_read_b128 v[48:51], v2 offset:2048
ds_read_b128 v[52:55], v2 offset:3072
ds_read_b128 v[56:59], v2 offset:4096
ds_read_b128 v[60:63], v2 offset:5120
ds_read_b128 v[64:67], v2 offset:6144
ds_read_b128 v[68:71], v2 offset:7168
s_waitcnt lgkmcnt(7)
v_mfma_f32_32x32x16_bf16 v[192:207], v[40:43], a[0:3], 0
v_mfma_f32_32x32x16_bf16 v[208:223], v[40:43], a[32:35], 0
v_mfma_f32_32x32x16_bf16 v[224:239], v[40:43], a[64:67], 0
v_mfma_f32_32x32x16_bf16 v[240:255], v[40:43], a[96:99], 0
s_waitcnt lgkmcnt(6)
v_mfma_f32_32x32x16_bf16 v[192:207], v[44:47], a[4:7], v[192:207]
v_mfma_f32_32x32x16_bf16 v[208:223], v[44:47], a[36:39], v[208:223]
v_mfma_f32_32x32x16_bf16 v[224:239], v[44:47], a[68:71], v[224:239]
v_mfma_f32_32x32x16_bf16 v[240:255], v[44:47], a[100:103], v[240:255]
s_waitcnt lgkmcnt(5)
v_mfma_f32_32x32x16_bf16 v[192:207], v[48:51], a[8:11], v[192:207]
v_mfma_f32_32x32x16_bf16 v[208:223], v[48:51], a[40:43], v[208:223]
v_mfma_f32_32x32x16_bf16 v[224:239], v[48:51], a[72:75], v[224:239]
v_mfma_f32_32x32x16_bf16 v[240:255], v[48:51], a[104:107], v[240:255]
s_waitcnt lgkmcnt(4)
v_mfma_f32_32x32x16_bf16 v[192:207], v[52:55], a[12:15], v[192:207]
v_mfma_f32_32x32x16_bf16 v[208:223], v[52:55], a[44:47], v[208:223]
v_mfma_f32_32x32x16_bf16 v[224:239], v[52:55], a[76:79], v[224:239]
v_mfma_f32_32x32x16_bf16 v[240:255], v[52:55], a[108:111], v[240:255]
s_waitcnt lgkmcnt(3)
v_mfma_f32_32x32x16_bf16 v[192:207], v[56:59], a[16:19], v[192:207]
v_mfma_f32_32x32x16_bf16 v[208:223], v[56:59], a[48:51], v[208:223]
v_mfma_f32_32x32x16_bf16 v[224:239], v[56:59], a[80:83], v[224:239]
v_mfma_f32_32x32x16_bf16 v[240:255], v[56:59], a[112:115], v[240:255]
s_waitcnt lgkmcnt(2)
v_mfma_f32_32x32x16_bf16 v[192:207], v[60:63], a[20:23], v[192:207]
v_mfma_f32_32x32x16_bf16 v[208:223], v[60:63], a[52:55], v[208:223]
v_mfma_f32_32x32x16_bf16 v[224:239], v[60:63], a[84:87], v[224:239]
v_mfma_f32_32x32x16_bf16 v[240:255], v[60:63], a[116:119], v[240:255]
s_waitcnt lgkmcnt(1)
v_mfma_f32_32x32x16_bf16 v[192:207], v[64:67], a[24:27], v[192:207]
v_mfma_f32_32x32x16_bf16 v[208:223], v[64:67], a[56:59], v[208:223]
v_mfma_f32_32x32x16_bf16 v[224:239], v[64:67], a[88:91], v[224:239]
v_mfma_f32_32x32x16_bf16 v[240:255], v[64:67], a[120:123], v[240:255]
s_waitcnt lgkmcnt(0)
v_mfma_f32_32x32x16_bf16 v[192:207], v[68:71], a[28:31], v[192:207]
v_mfma_f32_32x32x16_bf16 v[208:223], v[68:71], a[60:63], v[208:223]
v_mfma_f32_32x32x16_bf16 v[224:239], v[68:71], a[92:95], v[224:239]
v_mfma_f32_32x32x16_bf16 v[240:255], v[68:71], a[124:127], v[240:255]
s_lshl_b32 s40, s68, 10
s_add_u32 s40, s40, s38
s_add_u32 s40, s40, 0x300
s_nop 6
v_cvt_pk_bf16_f32 v40, v192, v208
s_add_u32 s41, s40, s48
buffer_store_dword v40, v7, s[8:11], s41 offen offset:0 nt
v_cvt_pk_bf16_f32 v41, v193, v209
s_add_u32 s42, s40, s49
buffer_store_dword v41, v7, s[8:11], s42 offen offset:0 nt
v_cvt_pk_bf16_f32 v42, v194, v210
s_add_u32 s41, s40, s50
buffer_store_dword v42, v7, s[8:11], s41 offen offset:0 nt
v_cvt_pk_bf16_f32 v43, v195, v211
s_add_u32 s42, s40, s51
buffer_store_dword v43, v7, s[8:11], s42 offen offset:0 nt
v_cvt_pk_bf16_f32 v44, v196, v212
s_add_u32 s41, s40, s52
buffer_store_dword v44, v7, s[8:11], s41 offen offset:0 nt
v_cvt_pk_bf16_f32 v45, v197, v213
s_add_u32 s42, s40, s53
buffer_store_dword v45, v7, s[8:11], s42 offen offset:0 nt
v_cvt_pk_bf16_f32 v46, v198, v214
s_add_u32 s41, s40, s54
buffer_store_dword v46, v7, s[8:11], s41 offen offset:0 nt
v_cvt_pk_bf16_f32 v47, v199, v215
s_add_u32 s42, s40, s55
buffer_store_dword v47, v7, s[8:11], s42 offen offset:0 nt
v_cvt_pk_bf16_f32 v40, v200, v216
s_add_u32 s41, s40, s56
buffer_store_dword v40, v7, s[8:11], s41 offen offset:0 nt
v_cvt_pk_bf16_f32 v41, v201, v217
s_add_u32 s42, s40, s57
buffer_store_dword v41, v7, s[8:11], s42 offen offset:0 nt
v_cvt_pk_bf16_f32 v42, v202, v218
s_add_u32 s41, s40, s58
buffer_store_dword v42, v7, s[8:11], s41 offen offset:0 nt
v_cvt_pk_bf16_f32 v43, v203, v219
s_add_u32 s42, s40, s59
buffer_store_dword v43, v7, s[8:11], s42 offen offset:0 nt
v_cvt_pk_bf16_f32 v44, v204, v220
s_add_u32 s41, s40, s60
buffer_store_dword v44, v7, s[8:11], s41 offen offset:0 nt
v_cvt_pk_bf16_f32 v45, v205, v221
s_add_u32 s42, s40, s61
buffer_store_dword v45, v7, s[8:11], s42 offen offset:0 nt
v_cvt_pk_bf16_f32 v46, v206, v222
s_add_u32 s41, s40, s62
buffer_store_dword v46, v7, s[8:11], s41 offen offset:0 nt
v_cvt_pk_bf16_f32 v47, v207, v223
s_add_u32 s42, s40, s63
buffer_store_dword v47, v7, s[8:11], s42 offen offset:0 nt
v_cvt_pk_bf16_f32 v40, v224, v240
s_add_u32 s41, s40, s48
buffer_store_dword v40, v7, s[8:11], s41 offen offset:128 nt
v_cvt_pk_bf16_f32 v41, v225, v241
s_add_u32 s42, s40, s49
buffer_store_dword v41, v7, s[8:11], s42 offen offset:128 nt
v_cvt_pk_bf16_f32 v42, v226, v242
s_add_u32 s41, s40, s50
buffer_store_dword v42, v7, s[8:11], s41 offen offset:128 nt
v_cvt_pk_bf16_f32 v43, v227, v243
s_add_u32 s42, s40, s51
buffer_store_dword v43, v7, s[8:11], s42 offen offset:128 nt
v_cvt_pk_bf16_f32 v44, v228, v244
s_add_u32 s41, s40, s52
buffer_store_dword v44, v7, s[8:11], s41 offen offset:128 nt
v_cvt_pk_bf16_f32 v45, v229, v245
s_add_u32 s42, s40, s53
buffer_store_dword v45, v7, s[8:11], s42 offen offset:128 nt
v_cvt_pk_bf16_f32 v46, v230, v246
s_add_u32 s41, s40, s54
buffer_store_dword v46, v7, s[8:11], s41 offen offset:128 nt
v_cvt_pk_bf16_f32 v47, v231, v247
s_add_u32 s42, s40, s55
buffer_store_dword v47, v7, s[8:11], s42 offen offset:128 nt
v_cvt_pk_bf16_f32 v40, v232, v248
s_add_u32 s41, s40, s56
buffer_store_dword v40, v7, s[8:11], s41 offen offset:128 nt
v_cvt_pk_bf16_f32 v41, v233, v249
s_add_u32 s42, s40, s57
buffer_store_dword v41, v7, s[8:11], s42 offen offset:128 nt
v_cvt_pk_bf16_f32 v42, v234, v250
s_add_u32 s41, s40, s58
buffer_store_dword v42, v7, s[8:11], s41 offen offset:128 nt
v_cvt_pk_bf16_f32 v43, v235, v251
s_add_u32 s42, s40, s59
buffer_store_dword v43, v7, s[8:11], s42 offen offset:128 nt
v_cvt_pk_bf16_f32 v44, v236, v252
s_add_u32 s41, s40, s60
buffer_store_dword v44, v7, s[8:11], s41 offen offset:128 nt
v_cvt_pk_bf16_f32 v45, v237, v253
s_add_u32 s42, s40, s61
buffer_store_dword v45, v7, s[8:11], s42 offen offset:128 nt
v_cvt_pk_bf16_f32 v46, v238, v254
s_add_u32 s41, s40, s62
buffer_store_dword v46, v7, s[8:11], s41 offen offset:128 nt
v_cvt_pk_bf16_f32 v47, v239, v255
s_add_u32 s42, s40, s63
buffer_store_dword v47, v7, s[8:11], s42 offen offset:128 nt
s_waitcnt vmcnt(0)
s_barrier
s_barrier
s_lshl_b32 s40, s68, 15
s_add_u32 s40, s40, s38
s_add_u32 s40, s40, 0x300
s_add_u32 s41, s40, 0
buffer_load_dwordx4 v[40:43], v8, s[8:11], s41 offen sc1
s_add_u32 s41, s40, 4096
buffer_load_dwordx4 v[44:47], v8, s[8:11], s41 offen sc1
s_add_u32 s41, s40, 8192
buffer_load_dwordx4 v[48:51], v8, s[8:11], s41 offen sc1
s_add_u32 s41, s40, 12288
buffer_load_dwordx4 v[52:55], v8, s[8:11], s41 offen sc1
s_add_u32 s41, s40, 16384
buffer_load_dwordx4 v[56:59], v8, s[8:11], s41 offen sc1
s_add_u32 s41, s40, 20480
buffer_load_dwordx4 v[60:63], v8, s[8:11], s41 offen sc1
s_add_u32 s41, s40, 24576
buffer_load_dwordx4 v[64:67], v8, s[8:11], s41 offen sc1
s_add_u32 s41, s40, 28672
buffer_load_dwordx4 v[68:71], v8, s[8:11], s41 offen sc1
s_waitcnt vmcnt(7)
v_mfma_f32_16x16x32_bf16 v[160:163], v[40:43], v[16:19], 0
s_waitcnt vmcnt(6)
v_mfma_f32_16x16x32_bf16 v[160:163], v[44:47], v[16:19], v[160:163]
s_waitcnt vmcnt(5)
v_mfma_f32_16x16x32_bf16 v[160:163], v[48:51], v[16:19], v[160:163]
s_waitcnt vmcnt(4)
v_mfma_f32_16x16x32_bf16 v[160:163], v[52:55], v[16:19], v[160:163]
s_waitcnt vmcnt(3)
v_mfma_f32_16x16x32_bf16 v[160:163], v[56:59], v[16:19], v[160:163]
s_waitcnt vmcnt(2)
v_mfma_f32_16x16x32_bf16 v[160:163], v[60:63], v[16:19], v[160:163]
s_waitcnt vmcnt(1)
v_mfma_f32_16x16x32_bf16 v[160:163], v[64:67], v[16:19], v[160:163]
s_waitcnt vmcnt(0)
v_mfma_f32_16x16x32_bf16 v[160:163], v[68:71], v[16:19], v[160:163]
s_nop 7
ds_write_b32 v9, v160 offset:0
ds_write_b32 v9, v161 offset:16
ds_write_b32 v9, v162 offset:32
ds_write_b32 v9, v163 offset:48
s_waitcnt lgkmcnt(0)
s_barrier
v_lshlrev_b32 v147, 1, v10
ds_read_b64 v[148:149], v147 offset:8192
s_waitcnt lgkmcnt(0)
v_lshlrev_b32 v150, 16, v152
v_and_b32 v151, 0xffff0000, v152
v_accvgpr_read_b32 v144, a240
v_accvgpr_read_b32 v145, a241
v_cvt_pk_bf16_f32 v148, v148, v148
v_and_b32 v148, 0xffff0000, v148
v_mul_f32 v148, v148, v144
v_cvt_pk_bf16_f32 v148, v148, v148
v_and_b32 v148, 0xffff0000, v148
v_add_f32 v150, v150, v148
v_cvt_pk_bf16_f32 v150, v150, v150
v_and_b32 v150, 0xffff0000, v150
v_cvt_pk_bf16_f32 v149, v149, v149
v_and_b32 v149, 0xffff0000, v149
v_mul_f32 v149, v149, v145
v_cvt_pk_bf16_f32 v149, v149, v149
v_and_b32 v149, 0xffff0000, v149
v_add_f32 v151, v151, v149
v_cvt_pk_bf16_f32 v151, v151, v151
v_and_b32 v151, 0xffff0000, v151
v_accvgpr_write_b32 a248, v150
v_accvgpr_write_b32 a249, v151
v_add_f32 v156, v150, v151
v_mul_f32 v157, v150, v150
v_fmac_f32 v157, v151, v151
v_add_f32_dpp v156, v156, v156 quad_perm:[1,0,3,2] row_mask:0xf bank_mask:0xf
s_nop 1
v_add_f32_dpp v156, v156, v156 quad_perm:[2,3,0,1] row_mask:0xf bank_mask:0xf
s_nop 1
v_add_f32_dpp v156, v156, v156 row_half_mirror row_mask:0xf bank_mask:0xf
s_nop 1
v_add_f32_dpp v156, v156, v156 row_mirror row_mask:0xf bank_mask:0xf
v_mov_b32 v155, v156
s_nop 1
v_permlane16_swap_b32 v156, v155
v_add_f32 v156, v156, v155
v_mov_b32 v155, v156
s_nop 1
v_permlane32_swap_b32 v156, v155
v_add_f32 v156, v156, v155
v_add_f32_dpp v157, v157, v157 quad_perm:[1,0,3,2] row_mask:0xf bank_mask:0xf
s_nop 1
v_add_f32_dpp v157, v157, v157 quad_perm:[2,3,0,1] row_mask:0xf bank_mask:0xf
s_nop 1
v_add_f32_dpp v157, v157, v157 row_half_mirror row_mask:0xf bank_mask:0xf
s_nop 1
v_add_f32_dpp v157, v157, v157 row_mirror row_mask:0xf bank_mask:0xf
v_mov_b32 v155, v157
s_nop 1
v_permlane16_swap_b32 v157, v155
v_add_f32 v157, v157, v155
v_mov_b32 v155, v157
s_nop 1
v_permlane32_swap_b32 v157, v155
v_add_f32 v157, v157, v155
v_mov_b32 v155, 10328
ds_write_b64 v155, v[156:157]
s_waitcnt lgkmcnt(0)
s_barrier
v_mov_b32 v155, 10304
ds_read_b128 v[160:163], v155
ds_read_b128 v[164:167], v155 offset:16
s_waitcnt lgkmcnt(0)
v_add_f32 v156, v160, v162
v_add_f32 v157, v161, v163
v_add_f32 v156, v156, v164
v_add_f32 v157, v157, v165
v_add_f32 v156, v156, v166
v_add_f32 v157, v157, v167
v_mul_f32 v156, 0x3b000000, v156
v_mul_f32 v157, 0x3b000000, v157
v_fma_f32 v157, -v156, v156, v157
v_max_f32 v157, 0, v157
v_cvt_pk_bf16_f32 v156, v156, v156
v_and_b32 v156, 0xffff0000, v156
v_cvt_pk_bf16_f32 v157, v157, v157
v_and_b32 v157, 0xffff0000, v157
v_add_f32 v157, 0x3727c5ac, v157
v_cvt_pk_bf16_f32 v157, v157, v157
v_and_b32 v157, 0xffff0000, v157
v_sqrt_f32 v157, v157
s_nop 0
v_cvt_pk_bf16_f32 v157, v157, v157
v_and_b32 v157, 0xffff0000, v157
v_rcp_f32 v157, v157
v_accvgpr_read_b32 v144, a244
v_accvgpr_read_b32 v145, a245
v_accvgpr_read_b32 v148, a242
v_accvgpr_read_b32 v149, a243
v_sub_f32 v150, v150, v156
v_mul_f32 v150, v150, v157
v_fma_f32 v150, v150, v144, v148
v_sub_f32 v151, v151, v156
v_mul_f32 v151, v151, v157
v_fma_f32 v151, v151, v145, v149
v_cvt_pk_bf16_f32 v150, v150, v151
s_add_u32 s40, s38, 0x200000
buffer_store_dword v150, v11, s[8:11], s40 offen nt
s_waitcnt vmcnt(0)
s_barrier
s_barrier
s_add_u32 s40, s38, 0x206000
s_mov_b32 m0, 57344
s_add_u32 s41, s40, 0
buffer_load_dwordx4 v2, s[8:11], s41 offen sc1 lds
s_mov_b32 m0, 58368
s_add_u32 s41, s40, 1024
buffer_load_dwordx4 v2, s[8:11], s41 offen sc1 lds
s_mov_b32 m0, 59392
s_add_u32 s41, s40, 2048
buffer_load_dwordx4 v2, s[8:11], s41 offen sc1 lds
s_mov_b32 m0, 60416
s_add_u32 s41, s40, 3072
buffer_load_dwordx4 v2, s[8:11], s41 offen sc1 lds
s_mov_b32 m0, 61440
s_add_u32 s41, s40, 4096
buffer_load_dwordx4 v2, s[8:11], s41 offen sc1 lds
s_mov_b32 m0, 62464
s_add_u32 s41, s40, 5120
buffer_load_dwordx4 v2, s[8:11], s41 offen sc1 lds
s_mov_b32 m0, 63488
s_add_u32 s41, s40, 6144
buffer_load_dwordx4 v2, s[8:11], s41 offen sc1 lds
s_mov_b32 m0, 64512
s_add_u32 s41, s40, 7168
buffer_load_dwordx4 v2, s[8:11], s41 offen sc1 lds
s_waitcnt vmcnt(0)
s_barrier
s_barrier
ds_read_b128 v[40:43], v2 offset:12288
ds_read_b128 v[44:47], v2 offset:13312
ds_read_b128 v[48:51], v2 offset:14336
s_waitcnt lgkmcnt(2)
v_mfma_f32_32x32x16_bf16 v[192:207], v[40:43], a[128:131], 0
v_mfma_f32_32x32x16_bf16 v[208:223], v[40:43], a[140:143], 0
v_mfma_f32_32x32x16_bf16 v[224:239], v[40:43], a[152:155], 0
v_mfma_f32_32x32x16_bf16 v[240:255], v[40:43], a[164:167], 0
s_waitcnt lgkmcnt(1)
v_mfma_f32_32x32x16_bf16 v[192:207], v[44:47], a[132:135], v[192:207]
v_mfma_f32_32x32x16_bf16 v[208:223], v[44:47], a[144:147], v[208:223]
v_mfma_f32_32x32x16_bf16 v[224:239], v[44:47], a[156:159], v[224:239]
v_mfma_f32_32x32x16_bf16 v[240:255], v[44:47], a[168:171], v[240:255]
s_waitcnt lgkmcnt(0)
v_mfma_f32_32x32x16_bf16 v[192:207], v[48:51], a[136:139], v[192:207]
v_mfma_f32_32x32x16_bf16 v[208:223], v[48:51], a[148:151], v[208:223]
v_mfma_f32_32x32x16_bf16 v[224:239], v[48:51], a[160:163], v[224:239]
v_mfma_f32_32x32x16_bf16 v[240:255], v[48:51], a[172:175], v[240:255]
s_lshl_b32 s40, s68, 10
s_add_u32 s40, s40, s38
s_add_u32 s40, s40, 0x100300
s_nop 6
v_cvt_pk_bf16_f32 v40, v192, v208
s_add_u32 s41, s40, s48
buffer_store_dword v40, v7, s[8:11], s41 offen offset:0 nt
v_cvt_pk_bf16_f32 v41, v193, v209
s_add_u32 s42, s40, s49
buffer_store_dword v41, v7, s[8:11], s42 offen offset:0 nt
v_cvt_pk_bf16_f32 v42, v194, v210
s_add_u32 s41, s40, s50
buffer_store_dword v42, v7, s[8:11], s41 offen offset:0 nt
v_cvt_pk_bf16_f32 v43, v195, v211
s_add_u32 s42, s40, s51
buffer_store_dword v43, v7, s[8:11], s42 offen offset:0 nt
v_cvt_pk_bf16_f32 v44, v196, v212
s_add_u32 s41, s40, s52
buffer_store_dword v44, v7, s[8:11], s41 offen offset:0 nt
v_cvt_pk_bf16_f32 v45, v197, v213
s_add_u32 s42, s40, s53
buffer_store_dword v45, v7, s[8:11], s42 offen offset:0 nt
v_cvt_pk_bf16_f32 v46, v198, v214
s_add_u32 s41, s40, s54
buffer_store_dword v46, v7, s[8:11], s41 offen offset:0 nt
v_cvt_pk_bf16_f32 v47, v199, v215
s_add_u32 s42, s40, s55
buffer_store_dword v47, v7, s[8:11], s42 offen offset:0 nt
v_cvt_pk_bf16_f32 v40, v200, v216
s_add_u32 s41, s40, s56
buffer_store_dword v40, v7, s[8:11], s41 offen offset:0 nt
v_cvt_pk_bf16_f32 v41, v201, v217
s_add_u32 s42, s40, s57
buffer_store_dword v41, v7, s[8:11], s42 offen offset:0 nt
v_cvt_pk_bf16_f32 v42, v202, v218
s_add_u32 s41, s40, s58
buffer_store_dword v42, v7, s[8:11], s41 offen offset:0 nt
v_cvt_pk_bf16_f32 v43, v203, v219
s_add_u32 s42, s40, s59
buffer_store_dword v43, v7, s[8:11], s42 offen offset:0 nt
v_cvt_pk_bf16_f32 v44, v204, v220
s_add_u32 s41, s40, s60
buffer_store_dword v44, v7, s[8:11], s41 offen offset:0 nt
v_cvt_pk_bf16_f32 v45, v205, v221
s_add_u32 s42, s40, s61
buffer_store_dword v45, v7, s[8:11], s42 offen offset:0 nt
v_cvt_pk_bf16_f32 v46, v206, v222
s_add_u32 s41, s40, s62
buffer_store_dword v46, v7, s[8:11], s41 offen offset:0 nt
v_cvt_pk_bf16_f32 v47, v207, v223
s_add_u32 s42, s40, s63
buffer_store_dword v47, v7, s[8:11], s42 offen offset:0 nt
v_cvt_pk_bf16_f32 v40, v224, v240
s_add_u32 s41, s40, s48
buffer_store_dword v40, v7, s[8:11], s41 offen offset:128 nt
v_cvt_pk_bf16_f32 v41, v225, v241
s_add_u32 s42, s40, s49
buffer_store_dword v41, v7, s[8:11], s42 offen offset:128 nt
v_cvt_pk_bf16_f32 v42, v226, v242
s_add_u32 s41, s40, s50
buffer_store_dword v42, v7, s[8:11], s41 offen offset:128 nt
v_cvt_pk_bf16_f32 v43, v227, v243
s_add_u32 s42, s40, s51
buffer_store_dword v43, v7, s[8:11], s42 offen offset:128 nt
v_cvt_pk_bf16_f32 v44, v228, v244
s_add_u32 s41, s40, s52
buffer_store_dword v44, v7, s[8:11], s41 offen offset:128 nt
v_cvt_pk_bf16_f32 v45, v229, v245
s_add_u32 s42, s40, s53
buffer_store_dword v45, v7, s[8:11], s42 offen offset:128 nt
v_cvt_pk_bf16_f32 v46, v230, v246
s_add_u32 s41, s40, s54
buffer_store_dword v46, v7, s[8:11], s41 offen offset:128 nt
v_cvt_pk_bf16_f32 v47, v231, v247
s_add_u32 s42, s40, s55
buffer_store_dword v47, v7, s[8:11], s42 offen offset:128 nt
v_cvt_pk_bf16_f32 v40, v232, v248
s_add_u32 s41, s40, s56
buffer_store_dword v40, v7, s[8:11], s41 offen offset:128 nt
v_cvt_pk_bf16_f32 v41, v233, v249
s_add_u32 s42, s40, s57
buffer_store_dword v41, v7, s[8:11], s42 offen offset:128 nt
v_cvt_pk_bf16_f32 v42, v234, v250
s_add_u32 s41, s40, s58
buffer_store_dword v42, v7, s[8:11], s41 offen offset:128 nt
v_cvt_pk_bf16_f32 v43, v235, v251
s_add_u32 s42, s40, s59
buffer_store_dword v43, v7, s[8:11], s42 offen offset:128 nt
v_cvt_pk_bf16_f32 v44, v236, v252
s_add_u32 s41, s40, s60
buffer_store_dword v44, v7, s[8:11], s41 offen offset:128 nt
v_cvt_pk_bf16_f32 v45, v237, v253
s_add_u32 s42, s40, s61
buffer_store_dword v45, v7, s[8:11], s42 offen offset:128 nt
v_cvt_pk_bf16_f32 v46, v238, v254
s_add_u32 s41, s40, s62
buffer_store_dword v46, v7, s[8:11], s41 offen offset:128 nt
v_cvt_pk_bf16_f32 v47, v239, v255
s_add_u32 s42, s40, s63
buffer_store_dword v47, v7, s[8:11], s42 offen offset:128 nt
s_waitcnt vmcnt(0)
s_barrier
s_barrier
s_lshl_b32 s40, s68, 15
s_add_u32 s40, s40, s38
s_add_u32 s40, s40, 0x100300
s_add_u32 s41, s40, 0
buffer_load_dwordx4 v[40:43], v8, s[8:11], s41 offen sc1
s_add_u32 s41, s40, 4096
buffer_load_dwordx4 v[44:47], v8, s[8:11], s41 offen sc1
s_add_u32 s41, s40, 8192
buffer_load_dwordx4 v[48:51], v8, s[8:11], s41 offen sc1
s_add_u32 s41, s40, 12288
buffer_load_dwordx4 v[52:55], v8, s[8:11], s41 offen sc1
s_add_u32 s41, s40, 16384
buffer_load_dwordx4 v[56:59], v8, s[8:11], s41 offen sc1
s_add_u32 s41, s40, 20480
buffer_load_dwordx4 v[60:63], v8, s[8:11], s41 offen sc1
s_add_u32 s41, s40, 24576
buffer_load_dwordx4 v[64:67], v8, s[8:11], s41 offen sc1
s_add_u32 s41, s40, 28672
buffer_load_dwordx4 v[68:71], v8, s[8:11], s41 offen sc1
s_waitcnt vmcnt(7)
v_mfma_f32_16x16x32_bf16 v[160:163], v[40:43], v[16:19], 0
s_waitcnt vmcnt(6)
v_mfma_f32_16x16x32_bf16 v[160:163], v[44:47], v[16:19], v[160:163]
s_waitcnt vmcnt(5)
v_mfma_f32_16x16x32_bf16 v[160:163], v[48:51], v[16:19], v[160:163]
s_waitcnt vmcnt(4)
v_mfma_f32_16x16x32_bf16 v[160:163], v[52:55], v[16:19], v[160:163]
s_waitcnt vmcnt(3)
v_mfma_f32_16x16x32_bf16 v[160:163], v[56:59], v[16:19], v[160:163]
s_waitcnt vmcnt(2)
v_mfma_f32_16x16x32_bf16 v[160:163], v[60:63], v[16:19], v[160:163]
s_waitcnt vmcnt(1)
v_mfma_f32_16x16x32_bf16 v[160:163], v[64:67], v[16:19], v[160:163]
s_waitcnt vmcnt(0)
v_mfma_f32_16x16x32_bf16 v[160:163], v[68:71], v[16:19], v[160:163]
s_nop 7
ds_write_b32 v9, v160 offset:0
ds_write_b32 v9, v161 offset:16
ds_write_b32 v9, v162 offset:32
ds_write_b32 v9, v163 offset:48
s_waitcnt lgkmcnt(0)
s_barrier
v_lshlrev_b32 v147, 1, v10
ds_read_b64 v[148:149], v147 offset:8192
s_waitcnt lgkmcnt(0)
v_accvgpr_read_b32 v144, a246
v_accvgpr_read_b32 v145, a247
v_accvgpr_read_b32 v150, a248
v_accvgpr_read_b32 v151, a249
v_cvt_pk_bf16_f32 v148, v148, v148
v_and_b32 v148, 0xffff0000, v148
v_mul_f32 v148, v148, v144
v_cvt_pk_bf16_f32 v148, v148, v148
v_and_b32 v148, 0xffff0000, v148
v_add_f32 v150, v150, v148
v_cvt_pk_bf16_f32 v149, v149, v149
v_and_b32 v149, 0xffff0000, v149
v_mul_f32 v149, v149, v145
v_cvt_pk_bf16_f32 v149, v149, v149
v_and_b32 v149, 0xffff0000, v149
v_add_f32 v151, v151, v149
v_cvt_pk_bf16_f32 v150, v150, v151
s_lshl_b32 s40, s36, 5
s_add_u32 s40, s40, s68
s_lshl_b32 s40, s40, 10
buffer_store_dword v150, v10, s[4:7], s40 offen
s_add_u32 s36, s36, 7
s_add_u32 s37, s37, 1
s_branch L_tail_w3_f
L_tailend_w3_f:
s_waitcnt vmcnt(0)
s_endpgm
L_tslow0:
s_mov_b32 s12, s22
s_mov_b32 s13, s23
s_mov_b32 s14, 0x200000
s_mov_b32 s15, 0x00020000
s_mov_b32 s4, s26
s_mov_b32 s5, s27
s_mov_b32 s6, 0x200000
s_mov_b32 s7, 0x00020000
s_mov_b32 s40, 0x10000
v_mov_b32 v142, 1
v_cmp_gt_u32 vcc, 48, v3
s_nop 1
v_cndmask_b32 v142, 0, v142, vcc
v_lshlrev_b32 v143, 1, v13
s_mov_b32 s42, 300000
L_pl_242:
buffer_load_dwordx2 v[140:141], v143, s[8:11], s40 offen sc1
s_sub_u32 s42, s42, 1
s_cmp_eq_u32 s42, 0
s_cbranch_scc1 L_abort
s_waitcnt vmcnt(0)
v_cmp_eq_u32 vcc, s46, v141
s_nop 1
v_cndmask_b32 v140, 0, v140, vcc
v_cmp_gt_u32 vcc, v142, v140
s_cbranch_vccz L_plx_243
s_sleep 2
s_branch L_pl_242
L_plx_243:
s_barrier
v_lshlrev_b32 v140, 1, v10
s_mov_b32 s40, 0x1000
buffer_load_dwordx2 a[240:241], v140, s[8:11], s40 offen sc1
s_mov_b32 s40, 0x1800
buffer_load_dwordx2 a[242:243], v140, s[8:11], s40 offen sc1
s_mov_b32 s40, 0x2000
buffer_load_dwordx2 a[244:245], v140, s[8:11], s40 offen sc1
s_mov_b32 s40, 0x2800
buffer_load_dwordx2 a[246:247], v140, s[8:11], s40 offen sc1
s_waitcnt vmcnt(0)
L_tail_w0_s:
s_cmp_ge_u32 s36, 64
s_cbranch_scc1 L_tailend_w0_s
s_lshl_b32 s40, s68, 6
s_add_u32 s40, s40, 0x10400
v_lshlrev_b32 v143, 1, v13
v_and_b32 v143, 63, v143
s_lshr_b32 s41, s36, 1
s_add_u32 s41, s41, 1
s_and_b32 s43, s36, 1
v_and_b32 v144, 1, v3
v_mov_b32 v142, s41
v_cmp_eq_u32 vcc, s43, v144
s_nop 1
v_cndmask_b32 v142, 0, v142, vcc
v_cmp_gt_u32 vcc, 6, v3
s_nop 1
v_cndmask_b32 v142, 0, v142, vcc
s_mov_b32 s42, 300000
L_pl_244:
buffer_load_dwordx2 v[140:141], v143, s[8:11], s40 offen sc1
s_sub_u32 s42, s42, 1
s_cmp_eq_u32 s42, 0
s_cbranch_scc1 L_abort
s_waitcnt vmcnt(0)
v_cmp_eq_u32 vcc, s46, v141
s_nop 1
v_cndmask_b32 v140, 0, v140, vcc
v_cmp_gt_u32 vcc, v142, v140
s_cbranch_vccz L_plx_245
s_sleep 4
s_branch L_pl_244
L_plx_245:
s_barrier
s_lshl_b32 s40, s36, 5
s_add_u32 s40, s40, s68
s_lshl_b32 s66, s40, 13
s_lshl_b32 s67, s40, 11
s_add_u32 s41, s66, 0x2800000
buffer_load_dwordx4 v[40:43], v2, s[8:11], s41 offen offset:0 sc1
buffer_load_dwordx4 v[44:47], v2, s[8:11], s41 offen offset:1024 sc1
buffer_load_dwordx4 v[48:51], v2, s[8:11], s41 offen offset:2048 sc1
buffer_load_dwordx4 v[52:55], v2, s[8:11], s41 offen offset:3072 sc1
s_add_u32 s41, s66, 0x800000
buffer_load_dwordx4 v[72:75], v2, s[8:11], s41 offen offset:0 sc1
buffer_load_dwordx4 v[76:79], v2, s[8:11], s41 offen offset:1024 sc1
buffer_load_dwordx4 v[80:83], v2, s[8:11], s41 offen offset:2048 sc1
buffer_load_dwordx4 v[84:87], v2, s[8:11], s41 offen offset:3072 sc1
s_add_u32 s41, s66, 0x1800000
buffer_load_dwordx4 v[104:107], v2, s[8:11], s41 offen offset:0 sc1
buffer_load_dwordx4 v[108:111], v2, s[8:11], s41 offen offset:1024 sc1
buffer_load_dwordx4 v[112:115], v2, s[8:11], s41 offen offset:2048 sc1
buffer_load_dwordx4 v[116:119], v2, s[8:11], s41 offen offset:3072 sc1
s_lshl_b32 s41, s40, 10
buffer_load_dword v152, v10, s[12:15], s41 offen
s_lshl_b32 s40, s68, 6
s_add_u32 s40, s40, 0x10400
v_lshlrev_b32 v143, 1, v13
v_and_b32 v143, 63, v143
s_add_u32 s44, s36, 1
v_mov_b32 v142, s44
v_cmp_eq_u32 vcc, 6, v3
s_nop 1
v_cndmask_b32 v142, 0, v142, vcc
s_mov_b32 s42, 300000
L_pl_246:
buffer_load_dwordx2 v[140:141], v143, s[8:11], s40 offen sc1
s_sub_u32 s42, s42, 1
s_cmp_eq_u32 s42, 0
s_cbranch_scc1 L_abort
s_waitcnt vmcnt(0)
v_cmp_eq_u32 vcc, s46, v141
s_nop 1
v_cndmask_b32 v140, 0, v140, vcc
v_cmp_gt_u32 vcc, v142, v140
s_cbranch_vccz L_plx_247
s_sleep 1
s_branch L_pl_246
L_plx_247:
s_barrier
s_add_u32 s42, s67, 0x3800000
buffer_load_dwordx4 v[56:59], v4, s[8:11], s42 offen offset:0 sc1
buffer_load_dwordx4 v[60:63], v4, s[8:11], s42 offen offset:512 sc1
buffer_load_dwordx4 v[64:67], v4, s[8:11], s42 offen offset:1024 sc1
buffer_load_dwordx4 v[68:71], v4, s[8:11], s42 offen offset:1536 sc1
s_add_u32 s42, s67, 0x3c00000
buffer_load_dword v20, v13, s[8:11], s42 offen offset:0 sc1
buffer_load_dword v24, v13, s[8:11], s42 offen offset:256 sc1
buffer_load_dword v28, v13, s[8:11], s42 offen offset:512 sc1
buffer_load_dword v32, v13, s[8:11], s42 offen offset:768 sc1
s_waitcnt vmcnt(0)
v_mfma_f32_16x16x32_bf16 v[120:123], v[56:59], v[40:43], 0
v_mfma_f32_16x16x32_bf16 v[124:127], v[72:75], v[40:43], 0
v_mfma_f32_16x16x32_bf16 v[120:123], v[60:63], v[44:47], v[120:123]
v_mfma_f32_16x16x32_bf16 v[124:127], v[76:79], v[44:47], v[124:127]
v_mfma_f32_16x16x32_bf16 v[120:123], v[64:67], v[48:51], v[120:123]
v_mfma_f32_16x16x32_bf16 v[124:127], v[80:83], v[48:51], v[124:127]
v_mfma_f32_16x16x32_bf16 v[120:123], v[68:71], v[52:55], v[120:123]
v_mfma_f32_16x16x32_bf16 v[124:127], v[84:87], v[52:55], v[124:127]
v_mov_b32 v140, 0xff800000
v_cmp_le_i32 vcc, 0, v5
s_nop 5
v_cndmask_b32 v124, v140, v124, vcc
v_cmp_le_i32 vcc, 1, v5
s_nop 1
v_cndmask_b32 v125, v140, v125, vcc
v_cmp_le_i32 vcc, 2, v5
s_nop 1
v_cndmask_b32 v126, v140, v126, vcc
v_cmp_le_i32 vcc, 3, v5
s_nop 1
v_cndmask_b32 v127, v140, v127, vcc
v_max3_f32 v141, v120, v121, v124
v_max3_f32 v141, v141, v125, v126
v_max_f32 v141, v141, v127
v_mov_b32 v142, v141
s_nop 1
v_permlane32_swap_b32 v141, v142
v_max_f32 v141, v141, v142
v_mov_b32 v142, v141
s_nop 1
v_permlane16_swap_b32 v141, v142
v_max_f32 v141, v141, v142
v_mul_f32 v143, s65, v141
v_fma_f32 v120, v120, s64, v143
v_fma_f32 v121, v121, s64, v143
v_fma_f32 v124, v124, s64, v143
v_fma_f32 v125, v125, s64, v143
v_fma_f32 v126, v126, s64, v143
v_fma_f32 v127, v127, s64, v143
v_exp_f32 v120, v120
v_exp_f32 v121, v121
v_exp_f32 v124, v124
v_exp_f32 v125, v125
v_exp_f32 v126, v126
v_exp_f32 v127, v127
v_cvt_pk_bf16_f32 v132, v124, v125
v_cvt_pk_bf16_f32 v133, v126, v127
v_cvt_pk_bf16_f32 v136, v120, v121
s_nop 0
v_mfma_f32_16x16x32_bf16 v[176:179], v[36:39], v[132:135], 0
v_mfma_f32_16x16x32_bf16 v[176:179], v[36:39], v[136:139], v[176:179]
v_mfma_f32_16x16x32_bf16 v[160:163], v[104:107], v[132:135], 0
v_mfma_f32_16x16x32_bf16 v[164:167], v[108:111], v[132:135], 0
v_mfma_f32_16x16x32_bf16 v[168:171], v[112:115], v[132:135], 0
v_mfma_f32_16x16x32_bf16 v[172:175], v[116:119], v[132:135], 0
v_mfma_f32_16x16x32_bf16 v[160:163], v[20:23], v[136:139], v[160:163]
v_mfma_f32_16x16x32_bf16 v[164:167], v[24:27], v[136:139], v[164:167]
v_mfma_f32_16x16x32_bf16 v[168:171], v[28:31], v[136:139], v[168:171]
v_mfma_f32_16x16x32_bf16 v[172:175], v[32:35], v[136:139], v[172:175]
v_rcp_f32 v142, v176
s_nop 3
v_mul_f32 v160, v160, v142
v_mul_f32 v161, v161, v142
v_mul_f32 v162, v162, v142
v_mul_f32 v163, v163, v142
v_mul_f32 v164, v164, v142
v_mul_f32 v165, v165, v142
v_mul_f32 v166, v166, v142
v_mul_f32 v167, v167, v142
v_mul_f32 v168, v168, v142
v_mul_f32 v169, v169, v142
v_mul_f32 v170, v170, v142
v_mul_f32 v171, v171, v142
v_mul_f32 v172, v172, v142
v_mul_f32 v173, v173, v142
v_mul_f32 v174, v174, v142
v_mul_f32 v175, v175, v142
v_cvt_pk_bf16_f32 v40, v160, v161
v_cvt_pk_bf16_f32 v41, v162, v163
v_cvt_pk_bf16_f32 v42, v164, v165
v_cvt_pk_bf16_f32 v43, v166, v167
ds_write_b128 v6, v[40:43] offset:0
v_cvt_pk_bf16_f32 v44, v168, v169
v_cvt_pk_bf16_f32 v45, v170, v171
v_cvt_pk_bf16_f32 v46, v172, v173
v_cvt_pk_bf16_f32 v47, v174, v175
ds_write_b128 v6, v[44:47] offset:2048
s_waitcnt lgkmcnt(0)
s_barrier
ds_read_b128 v[40:43], v2 offset:0
ds_read_b128 v[44:47], v2 offset:1024
ds_read_b128 v[48:51], v2 offset:2048
ds_read_b128 v[52:55], v2 offset:3072
ds_read_b128 v[56:59], v2 offset:4096
ds_read_b128 v[60:63], v2 offset:5120
ds_read_b128 v[64:67], v2 offset:6144
ds_read_b128 v[68:71], v2 offset:7168
s_waitcnt lgkmcnt(7)
v_mfma_f32_32x32x16_bf16 v[192:207], v[40:43], a[0:3], 0
v_mfma_f32_32x32x16_bf16 v[208:223], v[40:43], a[32:35], 0
v_mfma_f32_32x32x16_bf16 v[224:239], v[40:43], a[64:67], 0
v_mfma_f32_32x32x16_bf16 v[240:255], v[40:43], a[96:99], 0
s_waitcnt lgkmcnt(6)
v_mfma_f32_32x32x16_bf16 v[192:207], v[44:47], a[4:7], v[192:207]
v_mfma_f32_32x32x16_bf16 v[208:223], v[44:47], a[36:39], v[208:223]
v_mfma_f32_32x32x16_bf16 v[224:239], v[44:47], a[68:71], v[224:239]
v_mfma_f32_32x32x16_bf16 v[240:255], v[44:47], a[100:103], v[240:255]
s_waitcnt lgkmcnt(5)
v_mfma_f32_32x32x16_bf16 v[192:207], v[48:51], a[8:11], v[192:207]
v_mfma_f32_32x32x16_bf16 v[208:223], v[48:51], a[40:43], v[208:223]
v_mfma_f32_32x32x16_bf16 v[224:239], v[48:51], a[72:75], v[224:239]
v_mfma_f32_32x32x16_bf16 v[240:255], v[48:51], a[104:107], v[240:255]
s_waitcnt lgkmcnt(4)
v_mfma_f32_32x32x16_bf16 v[192:207], v[52:55], a[12:15], v[192:207]
v_mfma_f32_32x32x16_bf16 v[208:223], v[52:55], a[44:47], v[208:223]
v_mfma_f32_32x32x16_bf16 v[224:239], v[52:55], a[76:79], v[224:239]
v_mfma_f32_32x32x16_bf16 v[240:255], v[52:55], a[108:111], v[240:255]
s_waitcnt lgkmcnt(3)
v_mfma_f32_32x32x16_bf16 v[192:207], v[56:59], a[16:19], v[192:207]
v_mfma_f32_32x32x16_bf16 v[208:223], v[56:59], a[48:51], v[208:223]
v_mfma_f32_32x32x16_bf16 v[224:239], v[56:59], a[80:83], v[224:239]
v_mfma_f32_32x32x16_bf16 v[240:255], v[56:59], a[112:115], v[240:255]
s_waitcnt lgkmcnt(2)
v_mfma_f32_32x32x16_bf16 v[192:207], v[60:63], a[20:23], v[192:207]
v_mfma_f32_32x32x16_bf16 v[208:223], v[60:63], a[52:55], v[208:223]
v_mfma_f32_32x32x16_bf16 v[224:239], v[60:63], a[84:87], v[224:239]
v_mfma_f32_32x32x16_bf16 v[240:255], v[60:63], a[116:119], v[240:255]
s_waitcnt lgkmcnt(1)
v_mfma_f32_32x32x16_bf16 v[192:207], v[64:67], a[24:27], v[192:207]
v_mfma_f32_32x32x16_bf16 v[208:223], v[64:67], a[56:59], v[208:223]
v_mfma_f32_32x32x16_bf16 v[224:239], v[64:67], a[88:91], v[224:239]
v_mfma_f32_32x32x16_bf16 v[240:255], v[64:67], a[120:123], v[240:255]
s_waitcnt lgkmcnt(0)
v_mfma_f32_32x32x16_bf16 v[192:207], v[68:71], a[28:31], v[192:207]
v_mfma_f32_32x32x16_bf16 v[208:223], v[68:71], a[60:63], v[208:223]
v_mfma_f32_32x32x16_bf16 v[224:239], v[68:71], a[92:95], v[224:239]
v_mfma_f32_32x32x16_bf16 v[240:255], v[68:71], a[124:127], v[240:255]
s_lshl_b32 s40, s68, 10
s_add_u32 s40, s40, s38
s_add_u32 s40, s40, 0x0
s_nop 6
v_cvt_pk_bf16_f32 v40, v192, v208
s_add_u32 s41, s40, s48
buffer_store_dword v40, v7, s[8:11], s41 offen offset:0 sc1
v_cvt_pk_bf16_f32 v41, v193, v209
s_add_u32 s42, s40, s49
buffer_store_dword v41, v7, s[8:11], s42 offen offset:0 sc1
v_cvt_pk_bf16_f32 v42, v194, v210
s_add_u32 s41, s40, s50
buffer_store_dword v42, v7, s[8:11], s41 offen offset:0 sc1
v_cvt_pk_bf16_f32 v43, v195, v211
s_add_u32 s42, s40, s51
buffer_store_dword v43, v7, s[8:11], s42 offen offset:0 sc1
v_cvt_pk_bf16_f32 v44, v196, v212
s_add_u32 s41, s40, s52
buffer_store_dword v44, v7, s[8:11], s41 offen offset:0 sc1
v_cvt_pk_bf16_f32 v45, v197, v213
s_add_u32 s42, s40, s53
buffer_store_dword v45, v7, s[8:11], s42 offen offset:0 sc1
v_cvt_pk_bf16_f32 v46, v198, v214
s_add_u32 s41, s40, s54
buffer_store_dword v46, v7, s[8:11], s41 offen offset:0 sc1
v_cvt_pk_bf16_f32 v47, v199, v215
s_add_u32 s42, s40, s55
buffer_store_dword v47, v7, s[8:11], s42 offen offset:0 sc1
v_cvt_pk_bf16_f32 v40, v200, v216
s_add_u32 s41, s40, s56
buffer_store_dword v40, v7, s[8:11], s41 offen offset:0 sc1
v_cvt_pk_bf16_f32 v41, v201, v217
s_add_u32 s42, s40, s57
buffer_store_dword v41, v7, s[8:11], s42 offen offset:0 sc1
v_cvt_pk_bf16_f32 v42, v202, v218
s_add_u32 s41, s40, s58
buffer_store_dword v42, v7, s[8:11], s41 offen offset:0 sc1
v_cvt_pk_bf16_f32 v43, v203, v219
s_add_u32 s42, s40, s59
buffer_store_dword v43, v7, s[8:11], s42 offen offset:0 sc1
v_cvt_pk_bf16_f32 v44, v204, v220
s_add_u32 s41, s40, s60
buffer_store_dword v44, v7, s[8:11], s41 offen offset:0 sc1
v_cvt_pk_bf16_f32 v45, v205, v221
s_add_u32 s42, s40, s61
buffer_store_dword v45, v7, s[8:11], s42 offen offset:0 sc1
v_cvt_pk_bf16_f32 v46, v206, v222
s_add_u32 s41, s40, s62
buffer_store_dword v46, v7, s[8:11], s41 offen offset:0 sc1
v_cvt_pk_bf16_f32 v47, v207, v223
s_add_u32 s42, s40, s63
buffer_store_dword v47, v7, s[8:11], s42 offen offset:0 sc1
v_cvt_pk_bf16_f32 v40, v224, v240
s_add_u32 s41, s40, s48
buffer_store_dword v40, v7, s[8:11], s41 offen offset:128 sc1
v_cvt_pk_bf16_f32 v41, v225, v241
s_add_u32 s42, s40, s49
buffer_store_dword v41, v7, s[8:11], s42 offen offset:128 sc1
v_cvt_pk_bf16_f32 v42, v226, v242
s_add_u32 s41, s40, s50
buffer_store_dword v42, v7, s[8:11], s41 offen offset:128 sc1
v_cvt_pk_bf16_f32 v43, v227, v243
s_add_u32 s42, s40, s51
buffer_store_dword v43, v7, s[8:11], s42 offen offset:128 sc1
v_cvt_pk_bf16_f32 v44, v228, v244
s_add_u32 s41, s40, s52
buffer_store_dword v44, v7, s[8:11], s41 offen offset:128 sc1
v_cvt_pk_bf16_f32 v45, v229, v245
s_add_u32 s42, s40, s53
buffer_store_dword v45, v7, s[8:11], s42 offen offset:128 sc1
v_cvt_pk_bf16_f32 v46, v230, v246
s_add_u32 s41, s40, s54
buffer_store_dword v46, v7, s[8:11], s41 offen offset:128 sc1
v_cvt_pk_bf16_f32 v47, v231, v247
s_add_u32 s42, s40, s55
buffer_store_dword v47, v7, s[8:11], s42 offen offset:128 sc1
v_cvt_pk_bf16_f32 v40, v232, v248
s_add_u32 s41, s40, s56
buffer_store_dword v40, v7, s[8:11], s41 offen offset:128 sc1
v_cvt_pk_bf16_f32 v41, v233, v249
s_add_u32 s42, s40, s57
buffer_store_dword v41, v7, s[8:11], s42 offen offset:128 sc1
v_cvt_pk_bf16_f32 v42, v234, v250
s_add_u32 s41, s40, s58
buffer_store_dword v42, v7, s[8:11], s41 offen offset:128 sc1
v_cvt_pk_bf16_f32 v43, v235, v251
s_add_u32 s42, s40, s59
buffer_store_dword v43, v7, s[8:11], s42 offen offset:128 sc1
v_cvt_pk_bf16_f32 v44, v236, v252
s_add_u32 s41, s40, s60
buffer_store_dword v44, v7, s[8:11], s41 offen offset:128 sc1
v_cvt_pk_bf16_f32 v45, v237, v253
s_add_u32 s42, s40, s61
buffer_store_dword v45, v7, s[8:11], s42 offen offset:128 sc1
v_cvt_pk_bf16_f32 v46, v238, v254
s_add_u32 s41, s40, s62
buffer_store_dword v46, v7, s[8:11], s41 offen offset:128 sc1
v_cvt_pk_bf16_f32 v47, v239, v255
s_add_u32 s42, s40, s63
buffer_store_dword v47, v7, s[8:11], s42 offen offset:128 sc1
s_waitcnt vmcnt(0)
s_barrier
s_lshl_b32 s40, s68, 3
s_add_u32 s40, s40, s39
s_add_u32 s40, s40, 0x0
s_add_u32 s41, s37, 1
v_mov_b32 v140, s41
v_mov_b32 v141, s46
v_mov_b32 v142, 0
s_mov_b64 exec, 1
buffer_store_dwordx2 v[140:141], v142, s[8:11], s40 offen sc1
s_mov_b64 exec, -1
s_add_u32 s40, s39, 0x0
s_add_u32 s41, s37, 1
v_lshlrev_b32 v143, 1, v13
v_and_b32 v143, 255, v143
v_mov_b32 v142, s41
s_mov_b32 s42, 300000
L_pl_248:
buffer_load_dwordx2 v[140:141], v143, s[8:11], s40 offen sc1
s_sub_u32 s42, s42, 1
s_cmp_eq_u32 s42, 0
s_cbranch_scc1 L_abort
s_waitcnt vmcnt(0)
v_cmp_eq_u32 vcc, s46, v141
s_nop 1
v_cndmask_b32 v140, 0, v140, vcc
v_cmp_gt_u32 vcc, v142, v140
s_cbranch_vccnz L_pl_248
s_barrier
s_lshl_b32 s40, s68, 15
s_add_u32 s40, s40, s38
s_add_u32 s40, s40, 0x0
s_add_u32 s41, s40, 0
buffer_load_dwordx4 v[40:43], v8, s[8:11], s41 offen sc1
s_add_u32 s41, s40, 4096
buffer_load_dwordx4 v[44:47], v8, s[8:11], s41 offen sc1
s_add_u32 s41, s40, 8192
buffer_load_dwordx4 v[48:51], v8, s[8:11], s41 offen sc1
s_add_u32 s41, s40, 12288
buffer_load_dwordx4 v[52:55], v8, s[8:11], s41 offen sc1
s_add_u32 s41, s40, 16384
buffer_load_dwordx4 v[56:59], v8, s[8:11], s41 offen sc1
s_add_u32 s41, s40, 20480
buffer_load_dwordx4 v[60:63], v8, s[8:11], s41 offen sc1
s_add_u32 s41, s40, 24576
buffer_load_dwordx4 v[64:67], v8, s[8:11], s41 offen sc1
s_add_u32 s41, s40, 28672
buffer_load_dwordx4 v[68:71], v8, s[8:11], s41 offen sc1
s_waitcnt vmcnt(7)
v_mfma_f32_16x16x32_bf16 v[160:163], v[40:43], v[16:19], 0
s_waitcnt vmcnt(6)
v_mfma_f32_16x16x32_bf16 v[160:163], v[44:47], v[16:19], v[160:163]
s_waitcnt vmcnt(5)
v_mfma_f32_16x16x32_bf16 v[160:163], v[48:51], v[16:19], v[160:163]
s_waitcnt vmcnt(4)
v_mfma_f32_16x16x32_bf16 v[160:163], v[52:55], v[16:19], v[160:163]
s_waitcnt vmcnt(3)
v_mfma_f32_16x16x32_bf16 v[160:163], v[56:59], v[16:19], v[160:163]
s_waitcnt vmcnt(2)
v_mfma_f32_16x16x32_bf16 v[160:163], v[60:63], v[16:19], v[160:163]
s_waitcnt vmcnt(1)
v_mfma_f32_16x16x32_bf16 v[160:163], v[64:67], v[16:19], v[160:163]
s_waitcnt vmcnt(0)
v_mfma_f32_16x16x32_bf16 v[160:163], v[68:71], v[16:19], v[160:163]
s_nop 7
ds_write_b32 v9, v160 offset:0
ds_write_b32 v9, v161 offset:16
ds_write_b32 v9, v162 offset:32
ds_write_b32 v9, v163 offset:48
s_waitcnt lgkmcnt(0)
s_barrier
v_lshlrev_b32 v147, 1, v10
ds_read_b64 v[148:149], v147 offset:8192
s_waitcnt lgkmcnt(0)
v_lshlrev_b32 v150, 16, v152
v_and_b32 v151, 0xffff0000, v152
v_accvgpr_read_b32 v144, a240
v_accvgpr_read_b32 v145, a241
v_cvt_pk_bf16_f32 v148, v148, v148
v_and_b32 v148, 0xffff0000, v148
v_mul_f32 v148, v148, v144
v_cvt_pk_bf16_f32 v148, v148, v148
v_and_b32 v148, 0xffff0000, v148
v_add_f32 v150, v150, v148
v_cvt_pk_bf16_f32 v150, v150, v150
v_and_b32 v150, 0xffff0000, v150
v_cvt_pk_bf16_f32 v149, v149, v149
v_and_b32 v149, 0xffff0000, v149
v_mul_f32 v149, v149, v145
v_cvt_pk_bf16_f32 v149, v149, v149
v_and_b32 v149, 0xffff0000, v149
v_add_f32 v151, v151, v149
v_cvt_pk_bf16_f32 v151, v151, v151
v_and_b32 v151, 0xffff0000, v151
v_accvgpr_write_b32 a248, v150
v_accvgpr_write_b32 a249, v151
v_add_f32 v156, v150, v151
v_mul_f32 v157, v150, v150
v_fmac_f32 v157, v151, v151
v_add_f32_dpp v156, v156, v156 quad_perm:[1,0,3,2] row_mask:0xf bank_mask:0xf
s_nop 1
v_add_f32_dpp v156, v156, v156 quad_perm:[2,3,0,1] row_mask:0xf bank_mask:0xf
s_nop 1
v_add_f32_dpp v156, v156, v156 row_half_mirror row_mask:0xf bank_mask:0xf
s_nop 1
v_add_f32_dpp v156, v156, v156 row_mirror row_mask:0xf bank_mask:0xf
v_mov_b32 v155, v156
s_nop 1
v_permlane16_swap_b32 v156, v155
v_add_f32 v156, v156, v155
v_mov_b32 v155, v156
s_nop 1
v_permlane32_swap_b32 v156, v155
v_add_f32 v156, v156, v155
v_add_f32_dpp v157, v157, v157 quad_perm:[1,0,3,2] row_mask:0xf bank_mask:0xf
s_nop 1
v_add_f32_dpp v157, v157, v157 quad_perm:[2,3,0,1] row_mask:0xf bank_mask:0xf
s_nop 1
v_add_f32_dpp v157, v157, v157 row_half_mirror row_mask:0xf bank_mask:0xf
s_nop 1
v_add_f32_dpp v157, v157, v157 row_mirror row_mask:0xf bank_mask:0xf
v_mov_b32 v155, v157
s_nop 1
v_permlane16_swap_b32 v157, v155
v_add_f32 v157, v157, v155
v_mov_b32 v155, v157
s_nop 1
v_permlane32_swap_b32 v157, v155
v_add_f32 v157, v157, v155
v_mov_b32 v155, 10304
ds_write_b64 v155, v[156:157]
s_waitcnt lgkmcnt(0)
s_barrier
v_mov_b32 v155, 10304
ds_read_b128 v[160:163], v155
ds_read_b128 v[164:167], v155 offset:16
s_waitcnt lgkmcnt(0)
v_add_f32 v156, v160, v162
v_add_f32 v157, v161, v163
v_add_f32 v156, v156, v164
v_add_f32 v157, v157, v165
v_add_f32 v156, v156, v166
v_add_f32 v157, v157, v167
v_mul_f32 v156, 0x3b000000, v156
v_mul_f32 v157, 0x3b000000, v157
v_fma_f32 v157, -v156, v156, v157
v_max_f32 v157, 0, v157
v_cvt_pk_bf16_f32 v156, v156, v156
v_and_b32 v156, 0xffff0000, v156
v_cvt_pk_bf16_f32 v157, v157, v157
v_and_b32 v157, 0xffff0000, v157
v_add_f32 v157, 0x3727c5ac, v157
v_cvt_pk_bf16_f32 v157, v157, v157
v_and_b32 v157, 0xffff0000, v157
v_sqrt_f32 v157, v157
s_nop 0
v_cvt_pk_bf16_f32 v157, v157, v157
v_and_b32 v157, 0xffff0000, v157
v_rcp_f32 v157, v157
v_accvgpr_read_b32 v144, a244
v_accvgpr_read_b32 v145, a245
v_accvgpr_read_b32 v148, a242
v_accvgpr_read_b32 v149, a243
v_sub_f32 v150, v150, v156
v_mul_f32 v150, v150, v157
v_fma_f32 v150, v150, v144, v148
v_sub_f32 v151, v151, v156
v_mul_f32 v151, v151, v157
v_fma_f32 v151, v151, v145, v149
v_cvt_pk_bf16_f32 v150, v150, v151
s_add_u32 s40, s38, 0x200000
buffer_store_dword v150, v11, s[8:11], s40 offen sc1
s_waitcnt vmcnt(0)
s_barrier
s_lshl_b32 s40, s68, 3
s_add_u32 s40, s40, s39
s_add_u32 s40, s40, 0x100
s_add_u32 s41, s37, 1
v_mov_b32 v140, s41
v_mov_b32 v141, s46
v_mov_b32 v142, 0
s_mov_b64 exec, 1
buffer_store_dwordx2 v[140:141], v142, s[8:11], s40 offen sc1
s_mov_b64 exec, -1
s_add_u32 s40, s39, 0x100
s_add_u32 s41, s37, 1
v_lshlrev_b32 v143, 1, v13
v_and_b32 v143, 255, v143
v_mov_b32 v142, s41
s_mov_b32 s42, 300000
L_pl_249:
buffer_load_dwordx2 v[140:141], v143, s[8:11], s40 offen sc1
s_sub_u32 s42, s42, 1
s_cmp_eq_u32 s42, 0
s_cbranch_scc1 L_abort
s_waitcnt vmcnt(0)
v_cmp_eq_u32 vcc, s46, v141
s_nop 1
v_cndmask_b32 v140, 0, v140, vcc
v_cmp_gt_u32 vcc, v142, v140
s_cbranch_vccnz L_pl_249
s_barrier
s_add_u32 s40, s38, 0x200000
s_mov_b32 m0, 32768
s_add_u32 s41, s40, 0
buffer_load_dwordx4 v2, s[8:11], s41 offen sc1 lds
s_mov_b32 m0, 33792
s_add_u32 s41, s40, 1024
buffer_load_dwordx4 v2, s[8:11], s41 offen sc1 lds
s_mov_b32 m0, 34816
s_add_u32 s41, s40, 2048
buffer_load_dwordx4 v2, s[8:11], s41 offen sc1 lds
s_mov_b32 m0, 35840
s_add_u32 s41, s40, 3072
buffer_load_dwordx4 v2, s[8:11], s41 offen sc1 lds
s_mov_b32 m0, 36864
s_add_u32 s41, s40, 4096
buffer_load_dwordx4 v2, s[8:11], s41 offen sc1 lds
s_mov_b32 m0, 37888
s_add_u32 s41, s40, 5120
buffer_load_dwordx4 v2, s[8:11], s41 offen sc1 lds
s_mov_b32 m0, 38912
s_add_u32 s41, s40, 6144
buffer_load_dwordx4 v2, s[8:11], s41 offen sc1 lds
s_mov_b32 m0, 39936
s_add_u32 s41, s40, 7168
buffer_load_dwordx4 v2, s[8:11], s41 offen sc1 lds
s_waitcnt vmcnt(0)
s_barrier
ds_read_b128 v[56:59], v2 offset:32768
ds_read_b128 v[60:63], v2 offset:33792
ds_read_b128 v[64:67], v2 offset:34816
ds_read_b128 v[68:71], v2 offset:35840
ds_read_b128 v[72:75], v2 offset:36864
ds_read_b128 v[76:79], v2 offset:37888
ds_read_b128 v[80:83], v2 offset:38912
ds_read_b128 v[84:87], v2 offset:39936
ds_read_b128 v[88:91], v2 offset:40960
ds_read_b128 v[92:95], v2 offset:41984
ds_read_b128 v[96:99], v2 offset:43008
ds_read_b128 v[100:103], v2 offset:44032
ds_read_b128 v[104:107], v2 offset:45056
ds_read_b128 v[108:111], v2 offset:46080
ds_read_b128 v[112:115], v2 offset:47104
ds_read_b128 v[116:119], v2 offset:48128
s_waitcnt lgkmcnt(15)
v_mfma_f32_16x16x32_bf16 v[160:163], a[176:179], v[56:59], 0
s_waitcnt lgkmcnt(14)
v_mfma_f32_16x16x32_bf16 v[160:163], a[180:183], v[60:63], v[160:163]
s_waitcnt lgkmcnt(13)
v_mfma_f32_16x16x32_bf16 v[160:163], a[184:187], v[64:67], v[160:163]
s_waitcnt lgkmcnt(12)
v_mfma_f32_16x16x32_bf16 v[160:163], a[188:191], v[68:71], v[160:163]
s_waitcnt lgkmcnt(11)
v_mfma_f32_16x16x32_bf16 v[160:163], a[192:195], v[72:75], v[160:163]
s_waitcnt lgkmcnt(10)
v_mfma_f32_16x16x32_bf16 v[160:163], a[196:199], v[76:79], v[160:163]
s_waitcnt lgkmcnt(9)
v_mfma_f32_16x16x32_bf16 v[160:163], a[200:203], v[80:83], v[160:163]
s_waitcnt lgkmcnt(8)
v_mfma_f32_16x16x32_bf16 v[160:163], a[204:207], v[84:87], v[160:163]
s_waitcnt lgkmcnt(7)
v_mfma_f32_16x16x32_bf16 v[160:163], a[208:211], v[88:91], v[160:163]
s_waitcnt lgkmcnt(6)
v_mfma_f32_16x16x32_bf16 v[160:163], a[212:215], v[92:95], v[160:163]
s_waitcnt lgkmcnt(5)
v_mfma_f32_16x16x32_bf16 v[160:163], a[216:219], v[96:99], v[160:163]
s_waitcnt lgkmcnt(4)
v_mfma_f32_16x16x32_bf16 v[160:163], a[220:223], v[100:103], v[160:163]
s_waitcnt lgkmcnt(3)
v_mfma_f32_16x16x32_bf16 v[160:163], a[224:227], v[104:107], v[160:163]
s_waitcnt lgkmcnt(2)
v_mfma_f32_16x16x32_bf16 v[160:163], a[228:231], v[108:111], v[160:163]
s_waitcnt lgkmcnt(1)
v_mfma_f32_16x16x32_bf16 v[160:163], a[232:235], v[112:115], v[160:163]
s_waitcnt lgkmcnt(0)
v_mfma_f32_16x16x32_bf16 v[160:163], a[236:239], v[116:119], v[160:163]
ds_read_b128 v[56:59], v2 offset:49152
ds_read_b128 v[60:63], v2 offset:50176
ds_read_b128 v[64:67], v2 offset:51200
ds_read_b128 v[68:71], v2 offset:52224
ds_read_b128 v[72:75], v2 offset:53248
ds_read_b128 v[76:79], v2 offset:54272
ds_read_b128 v[80:83], v2 offset:55296
ds_read_b128 v[84:87], v2 offset:56320
ds_read_b128 v[88:91], v2 offset:57344
ds_read_b128 v[92:95], v2 offset:58368
ds_read_b128 v[96:99], v2 offset:59392
ds_read_b128 v[100:103], v2 offset:60416
ds_read_b128 v[104:107], v2 offset:61440
ds_read_b128 v[108:111], v2 offset:62464
ds_read_b128 v[112:115], v2 offset:63488
ds_read_b128 v[116:119], v2 offset:64512
s_waitcnt lgkmcnt(15)
v_mfma_f32_16x16x32_bf16 v[164:167], a[176:179], v[56:59], 0
s_waitcnt lgkmcnt(14)
v_mfma_f32_16x16x32_bf16 v[164:167], a[180:183], v[60:63], v[164:167]
s_waitcnt lgkmcnt(13)
v_mfma_f32_16x16x32_bf16 v[164:167], a[184:187], v[64:67], v[164:167]
s_waitcnt lgkmcnt(12)
v_mfma_f32_16x16x32_bf16 v[164:167], a[188:191], v[68:71], v[164:167]
s_waitcnt lgkmcnt(11)
v_mfma_f32_16x16x32_bf16 v[164:167], a[192:195], v[72:75], v[164:167]
s_waitcnt lgkmcnt(10)
v_mfma_f32_16x16x32_bf16 v[164:167], a[196:199], v[76:79], v[164:167]
s_waitcnt lgkmcnt(9)
v_mfma_f32_16x16x32_bf16 v[164:167], a[200:203], v[80:83], v[164:167]
s_waitcnt lgkmcnt(8)
v_mfma_f32_16x16x32_bf16 v[164:167], a[204:207], v[84:87], v[164:167]
s_waitcnt lgkmcnt(7)
v_mfma_f32_16x16x32_bf16 v[164:167], a[208:211], v[88:91], v[164:167]
s_waitcnt lgkmcnt(6)
v_mfma_f32_16x16x32_bf16 v[164:167], a[212:215], v[92:95], v[164:167]
s_waitcnt lgkmcnt(5)
v_mfma_f32_16x16x32_bf16 v[164:167], a[216:219], v[96:99], v[164:167]
s_waitcnt lgkmcnt(4)
v_mfma_f32_16x16x32_bf16 v[164:167], a[220:223], v[100:103], v[164:167]
s_waitcnt lgkmcnt(3)
v_mfma_f32_16x16x32_bf16 v[164:167], a[224:227], v[104:107], v[164:167]
s_waitcnt lgkmcnt(2)
v_mfma_f32_16x16x32_bf16 v[164:167], a[228:231], v[108:111], v[164:167]
s_waitcnt lgkmcnt(1)
v_mfma_f32_16x16x32_bf16 v[164:167], a[232:235], v[112:115], v[164:167]
s_waitcnt lgkmcnt(0)
v_mfma_f32_16x16x32_bf16 v[164:167], a[236:239], v[116:119], v[164:167]
v_max_f32 v160, 0, v160
v_max_f32 v161, 0, v161
v_max_f32 v162, 0, v162
v_max_f32 v163, 0, v163
v_cvt_pk_bf16_f32 v168, v160, v161
v_cvt_pk_bf16_f32 v169, v162, v163
ds_write_b64 v12, v[168:169] offset:0
s_nop 0
v_max_f32 v164, 0, v164
v_max_f32 v165, 0, v165
v_max_f32 v166, 0, v166
v_max_f32 v167, 0, v167
v_cvt_pk_bf16_f32 v170, v164, v165
v_cvt_pk_bf16_f32 v171, v166, v167
ds_write_b64 v12, v[170:171] offset:256
s_waitcnt lgkmcnt(0)
s_barrier
ds_read_b128 v[40:43], v2 offset:12288
ds_read_b128 v[44:47], v2 offset:13312
ds_read_b128 v[48:51], v2 offset:14336
s_waitcnt lgkmcnt(2)
v_mfma_f32_32x32x16_bf16 v[192:207], v[40:43], a[128:131], 0
v_mfma_f32_32x32x16_bf16 v[208:223], v[40:43], a[140:143], 0
v_mfma_f32_32x32x16_bf16 v[224:239], v[40:43], a[152:155], 0
v_mfma_f32_32x32x16_bf16 v[240:255], v[40:43], a[164:167], 0
s_waitcnt lgkmcnt(1)
v_mfma_f32_32x32x16_bf16 v[192:207], v[44:47], a[132:135], v[192:207]
v_mfma_f32_32x32x16_bf16 v[208:223], v[44:47], a[144:147], v[208:223]
v_mfma_f32_32x32x16_bf16 v[224:239], v[44:47], a[156:159], v[224:239]
v_mfma_f32_32x32x16_bf16 v[240:255], v[44:47], a[168:171], v[240:255]
s_waitcnt lgkmcnt(0)
v_mfma_f32_32x32x16_bf16 v[192:207], v[48:51], a[136:139], v[192:207]
v_mfma_f32_32x32x16_bf16 v[208:223], v[48:51], a[148:151], v[208:223]
v_mfma_f32_32x32x16_bf16 v[224:239], v[48:51], a[160:163], v[224:239]
v_mfma_f32_32x32x16_bf16 v[240:255], v[48:51], a[172:175], v[240:255]
s_lshl_b32 s40, s68, 10
s_add_u32 s40, s40, s38
s_add_u32 s40, s40, 0x100000
s_nop 6
v_cvt_pk_bf16_f32 v40, v192, v208
s_add_u32 s41, s40, s48
buffer_store_dword v40, v7, s[8:11], s41 offen offset:0 sc1
v_cvt_pk_bf16_f32 v41, v193, v209
s_add_u32 s42, s40, s49
buffer_store_dword v41, v7, s[8:11], s42 offen offset:0 sc1
v_cvt_pk_bf16_f32 v42, v194, v210
s_add_u32 s41, s40, s50
buffer_store_dword v42, v7, s[8:11], s41 offen offset:0 sc1
v_cvt_pk_bf16_f32 v43, v195, v211
s_add_u32 s42, s40, s51
buffer_store_dword v43, v7, s[8:11], s42 offen offset:0 sc1
v_cvt_pk_bf16_f32 v44, v196, v212
s_add_u32 s41, s40, s52
buffer_store_dword v44, v7, s[8:11], s41 offen offset:0 sc1
v_cvt_pk_bf16_f32 v45, v197, v213
s_add_u32 s42, s40, s53
buffer_store_dword v45, v7, s[8:11], s42 offen offset:0 sc1
v_cvt_pk_bf16_f32 v46, v198, v214
s_add_u32 s41, s40, s54
buffer_store_dword v46, v7, s[8:11], s41 offen offset:0 sc1
v_cvt_pk_bf16_f32 v47, v199, v215
s_add_u32 s42, s40, s55
buffer_store_dword v47, v7, s[8:11], s42 offen offset:0 sc1
v_cvt_pk_bf16_f32 v40, v200, v216
s_add_u32 s41, s40, s56
buffer_store_dword v40, v7, s[8:11], s41 offen offset:0 sc1
v_cvt_pk_bf16_f32 v41, v201, v217
s_add_u32 s42, s40, s57
buffer_store_dword v41, v7, s[8:11], s42 offen offset:0 sc1
v_cvt_pk_bf16_f32 v42, v202, v218
s_add_u32 s41, s40, s58
buffer_store_dword v42, v7, s[8:11], s41 offen offset:0 sc1
v_cvt_pk_bf16_f32 v43, v203, v219
s_add_u32 s42, s40, s59
buffer_store_dword v43, v7, s[8:11], s42 offen offset:0 sc1
v_cvt_pk_bf16_f32 v44, v204, v220
s_add_u32 s41, s40, s60
buffer_store_dword v44, v7, s[8:11], s41 offen offset:0 sc1
v_cvt_pk_bf16_f32 v45, v205, v221
s_add_u32 s42, s40, s61
buffer_store_dword v45, v7, s[8:11], s42 offen offset:0 sc1
v_cvt_pk_bf16_f32 v46, v206, v222
s_add_u32 s41, s40, s62
buffer_store_dword v46, v7, s[8:11], s41 offen offset:0 sc1
v_cvt_pk_bf16_f32 v47, v207, v223
s_add_u32 s42, s40, s63
buffer_store_dword v47, v7, s[8:11], s42 offen offset:0 sc1
v_cvt_pk_bf16_f32 v40, v224, v240
s_add_u32 s41, s40, s48
buffer_store_dword v40, v7, s[8:11], s41 offen offset:128 sc1
v_cvt_pk_bf16_f32 v41, v225, v241
s_add_u32 s42, s40, s49
buffer_store_dword v41, v7, s[8:11], s42 offen offset:128 sc1
v_cvt_pk_bf16_f32 v42, v226, v242
s_add_u32 s41, s40, s50
buffer_store_dword v42, v7, s[8:11], s41 offen offset:128 sc1
v_cvt_pk_bf16_f32 v43, v227, v243
s_add_u32 s42, s40, s51
buffer_store_dword v43, v7, s[8:11], s42 offen offset:128 sc1
v_cvt_pk_bf16_f32 v44, v228, v244
s_add_u32 s41, s40, s52
buffer_store_dword v44, v7, s[8:11], s41 offen offset:128 sc1
v_cvt_pk_bf16_f32 v45, v229, v245
s_add_u32 s42, s40, s53
buffer_store_dword v45, v7, s[8:11], s42 offen offset:128 sc1
v_cvt_pk_bf16_f32 v46, v230, v246
s_add_u32 s41, s40, s54
buffer_store_dword v46, v7, s[8:11], s41 offen offset:128 sc1
v_cvt_pk_bf16_f32 v47, v231, v247
s_add_u32 s42, s40, s55
buffer_store_dword v47, v7, s[8:11], s42 offen offset:128 sc1
v_cvt_pk_bf16_f32 v40, v232, v248
s_add_u32 s41, s40, s56
buffer_store_dword v40, v7, s[8:11], s41 offen offset:128 sc1
v_cvt_pk_bf16_f32 v41, v233, v249
s_add_u32 s42, s40, s57
buffer_store_dword v41, v7, s[8:11], s42 offen offset:128 sc1
v_cvt_pk_bf16_f32 v42, v234, v250
s_add_u32 s41, s40, s58
buffer_store_dword v42, v7, s[8:11], s41 offen offset:128 sc1
v_cvt_pk_bf16_f32 v43, v235, v251
s_add_u32 s42, s40, s59
buffer_store_dword v43, v7, s[8:11], s42 offen offset:128 sc1
v_cvt_pk_bf16_f32 v44, v236, v252
s_add_u32 s41, s40, s60
buffer_store_dword v44, v7, s[8:11], s41 offen offset:128 sc1
v_cvt_pk_bf16_f32 v45, v237, v253
s_add_u32 s42, s40, s61
buffer_store_dword v45, v7, s[8:11], s42 offen offset:128 sc1
v_cvt_pk_bf16_f32 v46, v238, v254
s_add_u32 s41, s40, s62
buffer_store_dword v46, v7, s[8:11], s41 offen offset:128 sc1
v_cvt_pk_bf16_f32 v47, v239, v255
s_add_u32 s42, s40, s63
buffer_store_dword v47, v7, s[8:11], s42 offen offset:128 sc1
s_waitcnt vmcnt(0)
s_barrier
s_lshl_b32 s40, s68, 3
s_add_u32 s40, s40, s39
s_add_u32 s40, s40, 0x200
s_add_u32 s41, s37, 1
v_mov_b32 v140, s41
v_mov_b32 v141, s46
v_mov_b32 v142, 0
s_mov_b64 exec, 1
buffer_store_dwordx2 v[140:141], v142, s[8:11], s40 offen sc1
s_mov_b64 exec, -1
s_add_u32 s40, s39, 0x200
s_add_u32 s41, s37, 1
v_lshlrev_b32 v143, 1, v13
v_and_b32 v143, 255, v143
v_mov_b32 v142, s41
s_mov_b32 s42, 300000
L_pl_250:
buffer_load_dwordx2 v[140:141], v143, s[8:11], s40 offen sc1
s_sub_u32 s42, s42, 1
s_cmp_eq_u32 s42, 0
s_cbranch_scc1 L_abort
s_waitcnt vmcnt(0)
v_cmp_eq_u32 vcc, s46, v141
s_nop 1
v_cndmask_b32 v140, 0, v140, vcc
v_cmp_gt_u32 vcc, v142, v140
s_cbranch_vccnz L_pl_250
s_barrier
s_lshl_b32 s40, s68, 15
s_add_u32 s40, s40, s38
s_add_u32 s40, s40, 0x100000
s_add_u32 s41, s40, 0
buffer_load_dwordx4 v[40:43], v8, s[8:11], s41 offen sc1
s_add_u32 s41, s40, 4096
buffer_load_dwordx4 v[44:47], v8, s[8:11], s41 offen sc1
s_add_u32 s41, s40, 8192
buffer_load_dwordx4 v[48:51], v8, s[8:11], s41 offen sc1
s_add_u32 s41, s40, 12288
buffer_load_dwordx4 v[52:55], v8, s[8:11], s41 offen sc1
s_add_u32 s41, s40, 16384
buffer_load_dwordx4 v[56:59], v8, s[8:11], s41 offen sc1
s_add_u32 s41, s40, 20480
buffer_load_dwordx4 v[60:63], v8, s[8:11], s41 offen sc1
s_add_u32 s41, s40, 24576
buffer_load_dwordx4 v[64:67], v8, s[8:11], s41 offen sc1
s_add_u32 s41, s40, 28672
buffer_load_dwordx4 v[68:71], v8, s[8:11], s41 offen sc1
s_waitcnt vmcnt(7)
v_mfma_f32_16x16x32_bf16 v[160:163], v[40:43], v[16:19], 0
s_waitcnt vmcnt(6)
v_mfma_f32_16x16x32_bf16 v[160:163], v[44:47], v[16:19], v[160:163]
s_waitcnt vmcnt(5)
v_mfma_f32_16x16x32_bf16 v[160:163], v[48:51], v[16:19], v[160:163]
s_waitcnt vmcnt(4)
v_mfma_f32_16x16x32_bf16 v[160:163], v[52:55], v[16:19], v[160:163]
s_waitcnt vmcnt(3)
v_mfma_f32_16x16x32_bf16 v[160:163], v[56:59], v[16:19], v[160:163]
s_waitcnt vmcnt(2)
v_mfma_f32_16x16x32_bf16 v[160:163], v[60:63], v[16:19], v[160:163]
s_waitcnt vmcnt(1)
v_mfma_f32_16x16x32_bf16 v[160:163], v[64:67], v[16:19], v[160:163]
s_waitcnt vmcnt(0)
v_mfma_f32_16x16x32_bf16 v[160:163], v[68:71], v[16:19], v[160:163]
s_nop 7
ds_write_b32 v9, v160 offset:0
ds_write_b32 v9, v161 offset:16
ds_write_b32 v9, v162 offset:32
ds_write_b32 v9, v163 offset:48
s_waitcnt lgkmcnt(0)
s_barrier
v_lshlrev_b32 v147, 1, v10
ds_read_b64 v[148:149], v147 offset:8192
s_waitcnt lgkmcnt(0)
v_accvgpr_read_b32 v144, a246
v_accvgpr_read_b32 v145, a247
v_accvgpr_read_b32 v150, a248
v_accvgpr_read_b32 v151, a249
v_cvt_pk_bf16_f32 v148, v148, v148
v_and_b32 v148, 0xffff0000, v148
v_mul_f32 v148, v148, v144
v_cvt_pk_bf16_f32 v148, v148, v148
v_and_b32 v148, 0xffff0000, v148
v_add_f32 v150, v150, v148
v_cvt_pk_bf16_f32 v149, v149, v149
v_and_b32 v149, 0xffff0000, v149
v_mul_f32 v149, v149, v145
v_cvt_pk_bf16_f32 v149, v149, v149
v_and_b32 v149, 0xffff0000, v149
v_add_f32 v151, v151, v149
v_cvt_pk_bf16_f32 v150, v150, v151
s_lshl_b32 s40, s36, 5
s_add_u32 s40, s40, s68
s_lshl_b32 s40, s40, 10
buffer_store_dword v150, v10, s[4:7], s40 offen
s_add_u32 s36, s36, 7
s_add_u32 s37, s37, 1
s_branch L_tail_w0_s
L_tailend_w0_s:
s_waitcnt vmcnt(0)
s_endpgm
L_tslow1:
s_mov_b32 s12, s22
s_mov_b32 s13, s23
s_mov_b32 s14, 0x200000
s_mov_b32 s15, 0x00020000
s_mov_b32 s4, s26
s_mov_b32 s5, s27
s_mov_b32 s6, 0x200000
s_mov_b32 s7, 0x00020000
s_barrier
v_lshlrev_b32 v140, 1, v10
s_mov_b32 s40, 0x1000
buffer_load_dwordx2 a[240:241], v140, s[8:11], s40 offen sc1
s_mov_b32 s40, 0x1800
buffer_load_dwordx2 a[242:243], v140, s[8:11], s40 offen sc1
s_mov_b32 s40, 0x2000
buffer_load_dwordx2 a[244:245], v140, s[8:11], s40 offen sc1
s_mov_b32 s40, 0x2800
buffer_load_dwordx2 a[246:247], v140, s[8:11], s40 offen sc1
s_waitcnt vmcnt(0)
L_tail_w1_s:
s_cmp_ge_u32 s36, 64
s_cbranch_scc1 L_tailend_w1_s
s_barrier
s_lshl_b32 s40, s36, 5
s_add_u32 s40, s40, s68
s_lshl_b32 s66, s40, 13
s_lshl_b32 s67, s40, 11
s_add_u32 s41, s66, 0x2801000
buffer_load_dwordx4 v[40:43], v2, s[8:11], s41 offen offset:0 sc1
buffer_load_dwordx4 v[44:47], v2, s[8:11], s41 offen offset:1024 sc1
buffer_load_dwordx4 v[48:51], v2, s[8:11], s41 offen offset:2048 sc1
buffer_load_dwordx4 v[52:55], v2, s[8:11], s41 offen offset:3072 sc1
s_add_u32 s41, s66, 0x800000
buffer_load_dwordx4 v[72:75], v2, s[8:11], s41 offen offset:0 sc1
buffer_load_dwordx4 v[76:79], v2, s[8:11], s41 offen offset:1024 sc1
buffer_load_dwordx4 v[80:83], v2, s[8:11], s41 offen offset:2048 sc1
buffer_load_dwordx4 v[84:87], v2, s[8:11], s41 offen offset:3072 sc1
s_add_u32 s41, s66, 0x801000
buffer_load_dwordx4 v[88:91], v2, s[8:11], s41 offen offset:0 sc1
buffer_load_dwordx4 v[92:95], v2, s[8:11], s41 offen offset:1024 sc1
buffer_load_dwordx4 v[96:99], v2, s[8:11], s41 offen offset:2048 sc1
buffer_load_dwordx4 v[100:103], v2, s[8:11], s41 offen offset:3072 sc1
s_add_u32 s41, s66, 0x1800000
buffer_load_dwordx4 v[104:107], v2, s[8:11], s41 offen offset:0 sc1
buffer_load_dwordx4 v[108:111], v2, s[8:11], s41 offen offset:1024 sc1
buffer_load_dwordx4 v[112:115], v2, s[8:11], s41 offen offset:2048 sc1
buffer_load_dwordx4 v[116:119], v2, s[8:11], s41 offen offset:3072 sc1
s_lshl_b32 s41, s40, 10
buffer_load_dword v152, v10, s[12:15], s41 offen
s_barrier
s_add_u32 s42, s67, 0x3800000
buffer_load_dwordx4 v[56:59], v4, s[8:11], s42 offen offset:0 sc1
buffer_load_dwordx4 v[60:63], v4, s[8:11], s42 offen offset:512 sc1
buffer_load_dwordx4 v[64:67], v4, s[8:11], s42 offen offset:1024 sc1
buffer_load_dwordx4 v[68:71], v4, s[8:11], s42 offen offset:1536 sc1
s_add_u32 s42, s67, 0x3c00000
buffer_load_dword v20, v13, s[8:11], s42 offen offset:0 sc1
buffer_load_dword v24, v13, s[8:11], s42 offen offset:256 sc1
buffer_load_dword v28, v13, s[8:11], s42 offen offset:512 sc1
buffer_load_dword v32, v13, s[8:11], s42 offen offset:768 sc1
s_waitcnt vmcnt(0)
v_mfma_f32_16x16x32_bf16 v[120:123], v[56:59], v[40:43], 0
v_mfma_f32_16x16x32_bf16 v[124:127], v[72:75], v[40:43], 0
v_mfma_f32_16x16x32_bf16 v[128:131], v[88:91], v[40:43], 0
v_mfma_f32_16x16x32_bf16 v[120:123], v[60:63], v[44:47], v[120:123]
v_mfma_f32_16x16x32_bf16 v[124:127], v[76:79], v[44:47], v[124:127]
v_mfma_f32_16x16x32_bf16 v[128:131], v[92:95], v[44:47], v[128:131]
v_mfma_f32_16x16x32_bf16 v[120:123], v[64:67], v[48:51], v[120:123]
v_mfma_f32_16x16x32_bf16 v[124:127], v[80:83], v[48:51], v[124:127]
v_mfma_f32_16x16x32_bf16 v[128:131], v[96:99], v[48:51], v[128:131]
v_mfma_f32_16x16x32_bf16 v[120:123], v[68:71], v[52:55], v[120:123]
v_mfma_f32_16x16x32_bf16 v[124:127], v[84:87], v[52:55], v[124:127]
v_mfma_f32_16x16x32_bf16 v[128:131], v[100:103], v[52:55], v[128:131]
v_mov_b32 v140, 0xff800000
v_cmp_le_i32 vcc, 0, v5
s_nop 5
v_cndmask_b32 v128, v140, v128, vcc
v_cmp_le_i32 vcc, 1, v5
s_nop 1
v_cndmask_b32 v129, v140, v129, vcc
v_cmp_le_i32 vcc, 2, v5
s_nop 1
v_cndmask_b32 v130, v140, v130, vcc
v_cmp_le_i32 vcc, 3, v5
s_nop 1
v_cndmask_b32 v131, v140, v131, vcc
v_max3_f32 v141, v120, v121, v124
v_max3_f32 v141, v141, v125, v126
v_max3_f32 v141, v141, v127, v128
v_max3_f32 v141, v141, v129, v130
v_max_f32 v141, v141, v131
v_mov_b32 v142, v141
s_nop 1
v_permlane32_swap_b32 v141, v142
v_max_f32 v141, v141, v142
v_mov_b32 v142, v141
s_nop 1
v_permlane16_swap_b32 v141, v142
v_max_f32 v141, v141, v142
v_mul_f32 v143, s65, v141
v_fma_f32 v120, v120, s64, v143
v_fma_f32 v121, v121, s64, v143
v_fma_f32 v124, v124, s64, v143
v_fma_f32 v125, v125, s64, v143
v_fma_f32 v126, v126, s64, v143
v_fma_f32 v127, v127, s64, v143
v_fma_f32 v128, v128, s64, v143
v_fma_f32 v129, v129, s64, v143
v_fma_f32 v130, v130, s64, v143
v_fma_f32 v131, v131, s64, v143
v_exp_f32 v120, v120
v_exp_f32 v121, v121
v_exp_f32 v124, v124
v_exp_f32 v125, v125
v_exp_f32 v126, v126
v_exp_f32 v127, v127
v_exp_f32 v128, v128
v_exp_f32 v129, v129
v_exp_f32 v130, v130
v_exp_f32 v131, v131
v_cvt_pk_bf16_f32 v132, v124, v125
v_cvt_pk_bf16_f32 v133, v126, v127
v_cvt_pk_bf16_f32 v134, v128, v129
v_cvt_pk_bf16_f32 v135, v130, v131
v_cvt_pk_bf16_f32 v136, v120, v121
s_nop 0
v_mfma_f32_16x16x32_bf16 v[176:179], v[36:39], v[132:135], 0
v_mfma_f32_16x16x32_bf16 v[176:179], v[36:39], v[136:139], v[176:179]
v_mfma_f32_16x16x32_bf16 v[160:163], v[104:107], v[132:135], 0
v_mfma_f32_16x16x32_bf16 v[164:167], v[108:111], v[132:135], 0
v_mfma_f32_16x16x32_bf16 v[168:171], v[112:115], v[132:135], 0
v_mfma_f32_16x16x32_bf16 v[172:175], v[116:119], v[132:135], 0
v_mfma_f32_16x16x32_bf16 v[160:163], v[20:23], v[136:139], v[160:163]
v_mfma_f32_16x16x32_bf16 v[164:167], v[24:27], v[136:139], v[164:167]
v_mfma_f32_16x16x32_bf16 v[168:171], v[28:31], v[136:139], v[168:171]
v_mfma_f32_16x16x32_bf16 v[172:175], v[32:35], v[136:139], v[172:175]
v_rcp_f32 v142, v176
s_nop 3
v_mul_f32 v160, v160, v142
v_mul_f32 v161, v161, v142
v_mul_f32 v162, v162, v142
v_mul_f32 v163, v163, v142
v_mul_f32 v164, v164, v142
v_mul_f32 v165, v165, v142
v_mul_f32 v166, v166, v142
v_mul_f32 v167, v167, v142
v_mul_f32 v168, v168, v142
v_mul_f32 v169, v169, v142
v_mul_f32 v170, v170, v142
v_mul_f32 v171, v171, v142
v_mul_f32 v172, v172, v142
v_mul_f32 v173, v173, v142
v_mul_f32 v174, v174, v142
v_mul_f32 v175, v175, v142
v_cvt_pk_bf16_f32 v40, v160, v161
v_cvt_pk_bf16_f32 v41, v162, v163
v_cvt_pk_bf16_f32 v42, v164, v165
v_cvt_pk_bf16_f32 v43, v166, v167
ds_write_b128 v6, v[40:43] offset:0
v_cvt_pk_bf16_f32 v44, v168, v169
v_cvt_pk_bf16_f32 v45, v170, v171
v_cvt_pk_bf16_f32 v46, v172, v173
v_cvt_pk_bf16_f32 v47, v174, v175
ds_write_b128 v6, v[44:47] offset:2048
s_waitcnt lgkmcnt(0)
s_barrier
ds_read_b128 v[40:43], v2 offset:0
ds_read_b128 v[44:47], v2 offset:1024
ds_read_b128 v[48:51], v2 offset:2048
ds_read_b128 v[52:55], v2 offset:3072
ds_read_b128 v[56:59], v2 offset:4096
ds_read_b128 v[60:63], v2 offset:5120
ds_read_b128 v[64:67], v2 offset:6144
ds_read_b128 v[68:71], v2 offset:7168
s_waitcnt lgkmcnt(7)
v_mfma_f32_32x32x16_bf16 v[192:207], v[40:43], a[0:3], 0
v_mfma_f32_32x32x16_bf16 v[208:223], v[40:43], a[32:35], 0
v_mfma_f32_32x32x16_bf16 v[224:239], v[40:43], a[64:67], 0
v_mfma_f32_32x32x16_bf16 v[240:255], v[40:43], a[96:99], 0
s_waitcnt lgkmcnt(6)
v_mfma_f32_32x32x16_bf16 v[192:207], v[44:47], a[4:7], v[192:207]
v_mfma_f32_32x32x16_bf16 v[208:223], v[44:47], a[36:39], v[208:223]
v_mfma_f32_32x32x16_bf16 v[224:239], v[44:47], a[68:71], v[224:239]
v_mfma_f32_32x32x16_bf16 v[240:255], v[44:47], a[100:103], v[240:255]
s_waitcnt lgkmcnt(5)
v_mfma_f32_32x32x16_bf16 v[192:207], v[48:51], a[8:11], v[192:207]
v_mfma_f32_32x32x16_bf16 v[208:223], v[48:51], a[40:43], v[208:223]
v_mfma_f32_32x32x16_bf16 v[224:239], v[48:51], a[72:75], v[224:239]
v_mfma_f32_32x32x16_bf16 v[240:255], v[48:51], a[104:107], v[240:255]
s_waitcnt lgkmcnt(4)
v_mfma_f32_32x32x16_bf16 v[192:207], v[52:55], a[12:15], v[192:207]
v_mfma_f32_32x32x16_bf16 v[208:223], v[52:55], a[44:47], v[208:223]
v_mfma_f32_32x32x16_bf16 v[224:239], v[52:55], a[76:79], v[224:239]
v_mfma_f32_32x32x16_bf16 v[240:255], v[52:55], a[108:111], v[240:255]
s_waitcnt lgkmcnt(3)
v_mfma_f32_32x32x16_bf16 v[192:207], v[56:59], a[16:19], v[192:207]
v_mfma_f32_32x32x16_bf16 v[208:223], v[56:59], a[48:51], v[208:223]
v_mfma_f32_32x32x16_bf16 v[224:239], v[56:59], a[80:83], v[224:239]
v_mfma_f32_32x32x16_bf16 v[240:255], v[56:59], a[112:115], v[240:255]
s_waitcnt lgkmcnt(2)
v_mfma_f32_32x32x16_bf16 v[192:207], v[60:63], a[20:23], v[192:207]
v_mfma_f32_32x32x16_bf16 v[208:223], v[60:63], a[52:55], v[208:223]
v_mfma_f32_32x32x16_bf16 v[224:239], v[60:63], a[84:87], v[224:239]
v_mfma_f32_32x32x16_bf16 v[240:255], v[60:63], a[116:119], v[240:255]
s_waitcnt lgkmcnt(1)
v_mfma_f32_32x32x16_bf16 v[192:207], v[64:67], a[24:27], v[192:207]
v_mfma_f32_32x32x16_bf16 v[208:223], v[64:67], a[56:59], v[208:223]
v_mfma_f32_32x32x16_bf16 v[224:239], v[64:67], a[88:91], v[224:239]
v_mfma_f32_32x32x16_bf16 v[240:255], v[64:67], a[120:123], v[240:255]
s_waitcnt lgkmcnt(0)
v_mfma_f32_32x32x16_bf16 v[192:207], v[68:71], a[28:31], v[192:207]
v_mfma_f32_32x32x16_bf16 v[208:223], v[68:71], a[60:63], v[208:223]
v_mfma_f32_32x32x16_bf16 v[224:239], v[68:71], a[92:95], v[224:239]
v_mfma_f32_32x32x16_bf16 v[240:255], v[68:71], a[124:127], v[240:255]
s_lshl_b32 s40, s68, 10
s_add_u32 s40, s40, s38
s_add_u32 s40, s40, 0x100
s_nop 6
v_cvt_pk_bf16_f32 v40, v192, v208
s_add_u32 s41, s40, s48
buffer_store_dword v40, v7, s[8:11], s41 offen offset:0 sc1
v_cvt_pk_bf16_f32 v41, v193, v209
s_add_u32 s42, s40, s49
buffer_store_dword v41, v7, s[8:11], s42 offen offset:0 sc1
v_cvt_pk_bf16_f32 v42, v194, v210
s_add_u32 s41, s40, s50
buffer_store_dword v42, v7, s[8:11], s41 offen offset:0 sc1
v_cvt_pk_bf16_f32 v43, v195, v211
s_add_u32 s42, s40, s51
buffer_store_dword v43, v7, s[8:11], s42 offen offset:0 sc1
v_cvt_pk_bf16_f32 v44, v196, v212
s_add_u32 s41, s40, s52
buffer_store_dword v44, v7, s[8:11], s41 offen offset:0 sc1
v_cvt_pk_bf16_f32 v45, v197, v213
s_add_u32 s42, s40, s53
buffer_store_dword v45, v7, s[8:11], s42 offen offset:0 sc1
v_cvt_pk_bf16_f32 v46, v198, v214
s_add_u32 s41, s40, s54
buffer_store_dword v46, v7, s[8:11], s41 offen offset:0 sc1
v_cvt_pk_bf16_f32 v47, v199, v215
s_add_u32 s42, s40, s55
buffer_store_dword v47, v7, s[8:11], s42 offen offset:0 sc1
v_cvt_pk_bf16_f32 v40, v200, v216
s_add_u32 s41, s40, s56
buffer_store_dword v40, v7, s[8:11], s41 offen offset:0 sc1
v_cvt_pk_bf16_f32 v41, v201, v217
s_add_u32 s42, s40, s57
buffer_store_dword v41, v7, s[8:11], s42 offen offset:0 sc1
v_cvt_pk_bf16_f32 v42, v202, v218
s_add_u32 s41, s40, s58
buffer_store_dword v42, v7, s[8:11], s41 offen offset:0 sc1
v_cvt_pk_bf16_f32 v43, v203, v219
s_add_u32 s42, s40, s59
buffer_store_dword v43, v7, s[8:11], s42 offen offset:0 sc1
v_cvt_pk_bf16_f32 v44, v204, v220
s_add_u32 s41, s40, s60
buffer_store_dword v44, v7, s[8:11], s41 offen offset:0 sc1
v_cvt_pk_bf16_f32 v45, v205, v221
s_add_u32 s42, s40, s61
buffer_store_dword v45, v7, s[8:11], s42 offen offset:0 sc1
v_cvt_pk_bf16_f32 v46, v206, v222
s_add_u32 s41, s40, s62
buffer_store_dword v46, v7, s[8:11], s41 offen offset:0 sc1
v_cvt_pk_bf16_f32 v47, v207, v223
s_add_u32 s42, s40, s63
buffer_store_dword v47, v7, s[8:11], s42 offen offset:0 sc1
v_cvt_pk_bf16_f32 v40, v224, v240
s_add_u32 s41, s40, s48
buffer_store_dword v40, v7, s[8:11], s41 offen offset:128 sc1
v_cvt_pk_bf16_f32 v41, v225, v241
s_add_u32 s42, s40, s49
buffer_store_dword v41, v7, s[8:11], s42 offen offset:128 sc1
v_cvt_pk_bf16_f32 v42, v226, v242
s_add_u32 s41, s40, s50
buffer_store_dword v42, v7, s[8:11], s41 offen offset:128 sc1
v_cvt_pk_bf16_f32 v43, v227, v243
s_add_u32 s42, s40, s51
buffer_store_dword v43, v7, s[8:11], s42 offen offset:128 sc1
v_cvt_pk_bf16_f32 v44, v228, v244
s_add_u32 s41, s40, s52
buffer_store_dword v44, v7, s[8:11], s41 offen offset:128 sc1
v_cvt_pk_bf16_f32 v45, v229, v245
s_add_u32 s42, s40, s53
buffer_store_dword v45, v7, s[8:11], s42 offen offset:128 sc1
v_cvt_pk_bf16_f32 v46, v230, v246
s_add_u32 s41, s40, s54
buffer_store_dword v46, v7, s[8:11], s41 offen offset:128 sc1
v_cvt_pk_bf16_f32 v47, v231, v247
s_add_u32 s42, s40, s55
buffer_store_dword v47, v7, s[8:11], s42 offen offset:128 sc1
v_cvt_pk_bf16_f32 v40, v232, v248
s_add_u32 s41, s40, s56
buffer_store_dword v40, v7, s[8:11], s41 offen offset:128 sc1
v_cvt_pk_bf16_f32 v41, v233, v249
s_add_u32 s42, s40, s57
buffer_store_dword v41, v7, s[8:11], s42 offen offset:128 sc1
v_cvt_pk_bf16_f32 v42, v234, v250
s_add_u32 s41, s40, s58
buffer_store_dword v42, v7, s[8:11], s41 offen offset:128 sc1
v_cvt_pk_bf16_f32 v43, v235, v251
s_add_u32 s42, s40, s59
buffer_store_dword v43, v7, s[8:11], s42 offen offset:128 sc1
v_cvt_pk_bf16_f32 v44, v236, v252
s_add_u32 s41, s40, s60
buffer_store_dword v44, v7, s[8:11], s41 offen offset:128 sc1
v_cvt_pk_bf16_f32 v45, v237, v253
s_add_u32 s42, s40, s61
buffer_store_dword v45, v7, s[8:11], s42 offen offset:128 sc1
v_cvt_pk_bf16_f32 v46, v238, v254
s_add_u32 s41, s40, s62
buffer_store_dword v46, v7, s[8:11], s41 offen offset:128 sc1
v_cvt_pk_bf16_f32 v47, v239, v255
s_add_u32 s42, s40, s63
buffer_store_dword v47, v7, s[8:11], s42 offen offset:128 sc1
s_waitcnt vmcnt(0)
s_barrier
s_barrier
s_lshl_b32 s40, s68, 15
s_add_u32 s40, s40, s38
s_add_u32 s40, s40, 0x100
s_add_u32 s41, s40, 0
buffer_load_dwordx4 v[40:43], v8, s[8:11], s41 offen sc1
s_add_u32 s41, s40, 4096
buffer_load_dwordx4 v[44:47], v8, s[8:11], s41 offen sc1
s_add_u32 s41, s40, 8192
buffer_load_dwordx4 v[48:51], v8, s[8:11], s41 offen sc1
s_add_u32 s41, s40, 12288
buffer_load_dwordx4 v[52:55], v8, s[8:11], s41 offen sc1
s_add_u32 s41, s40, 16384
buffer_load_dwordx4 v[56:59], v8, s[8:11], s41 offen sc1
s_add_u32 s41, s40, 20480
buffer_load_dwordx4 v[60:63], v8, s[8:11], s41 offen sc1
s_add_u32 s41, s40, 24576
buffer_load_dwordx4 v[64:67], v8, s[8:11], s41 offen sc1
s_add_u32 s41, s40, 28672
buffer_load_dwordx4 v[68:71], v8, s[8:11], s41 offen sc1
s_waitcnt vmcnt(7)
v_mfma_f32_16x16x32_bf16 v[160:163], v[40:43], v[16:19], 0
s_waitcnt vmcnt(6)
v_mfma_f32_16x16x32_bf16 v[160:163], v[44:47], v[16:19], v[160:163]
s_waitcnt vmcnt(5)
v_mfma_f32_16x16x32_bf16 v[160:163], v[48:51], v[16:19], v[160:163]
s_waitcnt vmcnt(4)
v_mfma_f32_16x16x32_bf16 v[160:163], v[52:55], v[16:19], v[160:163]
s_waitcnt vmcnt(3)
v_mfma_f32_16x16x32_bf16 v[160:163], v[56:59], v[16:19], v[160:163]
s_waitcnt vmcnt(2)
v_mfma_f32_16x16x32_bf16 v[160:163], v[60:63], v[16:19], v[160:163]
s_waitcnt vmcnt(1)
v_mfma_f32_16x16x32_bf16 v[160:163], v[64:67], v[16:19], v[160:163]
s_waitcnt vmcnt(0)
v_mfma_f32_16x16x32_bf16 v[160:163], v[68:71], v[16:19], v[160:163]
s_nop 7
ds_write_b32 v9, v160 offset:0
ds_write_b32 v9, v161 offset:16
ds_write_b32 v9, v162 offset:32
ds_write_b32 v9, v163 offset:48
s_waitcnt lgkmcnt(0)
s_barrier
v_lshlrev_b32 v147, 1, v10
ds_read_b64 v[148:149], v147 offset:8192
s_waitcnt lgkmcnt(0)
v_lshlrev_b32 v150, 16, v152
v_and_b32 v151, 0xffff0000, v152
v_accvgpr_read_b32 v144, a240
v_accvgpr_read_b32 v145, a241
v_cvt_pk_bf16_f32 v148, v148, v148
v_and_b32 v148, 0xffff0000, v148
v_mul_f32 v148, v148, v144
v_cvt_pk_bf16_f32 v148, v148, v148
v_and_b32 v148, 0xffff0000, v148
v_add_f32 v150, v150, v148
v_cvt_pk_bf16_f32 v150, v150, v150
v_and_b32 v150, 0xffff0000, v150
v_cvt_pk_bf16_f32 v149, v149, v149
v_and_b32 v149, 0xffff0000, v149
v_mul_f32 v149, v149, v145
v_cvt_pk_bf16_f32 v149, v149, v149
v_and_b32 v149, 0xffff0000, v149
v_add_f32 v151, v151, v149
v_cvt_pk_bf16_f32 v151, v151, v151
v_and_b32 v151, 0xffff0000, v151
v_accvgpr_write_b32 a248, v150
v_accvgpr_write_b32 a249, v151
v_add_f32 v156, v150, v151
v_mul_f32 v157, v150, v150
v_fmac_f32 v157, v151, v151
v_add_f32_dpp v156, v156, v156 quad_perm:[1,0,3,2] row_mask:0xf bank_mask:0xf
s_nop 1
v_add_f32_dpp v156, v156, v156 quad_perm:[2,3,0,1] row_mask:0xf bank_mask:0xf
s_nop 1
v_add_f32_dpp v156, v156, v156 row_half_mirror row_mask:0xf bank_mask:0xf
s_nop 1
v_add_f32_dpp v156, v156, v156 row_mirror row_mask:0xf bank_mask:0xf
v_mov_b32 v155, v156
s_nop 1
v_permlane16_swap_b32 v156, v155
v_add_f32 v156, v156, v155
v_mov_b32 v155, v156
s_nop 1
v_permlane32_swap_b32 v156, v155
v_add_f32 v156, v156, v155
v_add_f32_dpp v157, v157, v157 quad_perm:[1,0,3,2] row_mask:0xf bank_mask:0xf
s_nop 1
v_add_f32_dpp v157, v157, v157 quad_perm:[2,3,0,1] row_mask:0xf bank_mask:0xf
s_nop 1
v_add_f32_dpp v157, v157, v157 row_half_mirror row_mask:0xf bank_mask:0xf
s_nop 1
v_add_f32_dpp v157, v157, v157 row_mirror row_mask:0xf bank_mask:0xf
v_mov_b32 v155, v157
s_nop 1
v_permlane16_swap_b32 v157, v155
v_add_f32 v157, v157, v155
v_mov_b32 v155, v157
s_nop 1
v_permlane32_swap_b32 v157, v155
v_add_f32 v157, v157, v155
v_mov_b32 v155, 10312
ds_write_b64 v155, v[156:157]
s_waitcnt lgkmcnt(0)
s_barrier
v_mov_b32 v155, 10304
ds_read_b128 v[160:163], v155
ds_read_b128 v[164:167], v155 offset:16
s_waitcnt lgkmcnt(0)
v_add_f32 v156, v160, v162
v_add_f32 v157, v161, v163
v_add_f32 v156, v156, v164
v_add_f32 v157, v157, v165
v_add_f32 v156, v156, v166
v_add_f32 v157, v157, v167
v_mul_f32 v156, 0x3b000000, v156
v_mul_f32 v157, 0x3b000000, v157
v_fma_f32 v157, -v156, v156, v157
v_max_f32 v157, 0, v157
v_cvt_pk_bf16_f32 v156, v156, v156
v_and_b32 v156, 0xffff0000, v156
v_cvt_pk_bf16_f32 v157, v157, v157
v_and_b32 v157, 0xffff0000, v157
v_add_f32 v157, 0x3727c5ac, v157
v_cvt_pk_bf16_f32 v157, v157, v157
v_and_b32 v157, 0xffff0000, v157
v_sqrt_f32 v157, v157
s_nop 0
v_cvt_pk_bf16_f32 v157, v157, v157
v_and_b32 v157, 0xffff0000, v157
v_rcp_f32 v157, v157
v_accvgpr_read_b32 v144, a244
v_accvgpr_read_b32 v145, a245
v_accvgpr_read_b32 v148, a242
v_accvgpr_read_b32 v149, a243
v_sub_f32 v150, v150, v156
v_mul_f32 v150, v150, v157
v_fma_f32 v150, v150, v144, v148
v_sub_f32 v151, v151, v156
v_mul_f32 v151, v151, v157
v_fma_f32 v151, v151, v145, v149
v_cvt_pk_bf16_f32 v150, v150, v151
s_add_u32 s40, s38, 0x200000
buffer_store_dword v150, v11, s[8:11], s40 offen sc1
s_waitcnt vmcnt(0)
s_barrier
s_barrier
s_add_u32 s40, s38, 0x202000
s_mov_b32 m0, 40960
s_add_u32 s41, s40, 0
buffer_load_dwordx4 v2, s[8:11], s41 offen sc1 lds
s_mov_b32 m0, 41984
s_add_u32 s41, s40, 1024
buffer_load_dwordx4 v2, s[8:11], s41 offen sc1 lds
s_mov_b32 m0, 43008
s_add_u32 s41, s40, 2048
buffer_load_dwordx4 v2, s[8:11], s41 offen sc1 lds
s_mov_b32 m0, 44032
s_add_u32 s41, s40, 3072
buffer_load_dwordx4 v2, s[8:11], s41 offen sc1 lds
s_mov_b32 m0, 45056
s_add_u32 s41, s40, 4096
buffer_load_dwordx4 v2, s[8:11], s41 offen sc1 lds
s_mov_b32 m0, 46080
s_add_u32 s41, s40, 5120
buffer_load_dwordx4 v2, s[8:11], s41 offen sc1 lds
s_mov_b32 m0, 47104
s_add_u32 s41, s40, 6144
buffer_load_dwordx4 v2, s[8:11], s41 offen sc1 lds
s_mov_b32 m0, 48128
s_add_u32 s41, s40, 7168
buffer_load_dwordx4 v2, s[8:11], s41 offen sc1 lds
s_waitcnt vmcnt(0)
s_barrier
ds_read_b128 v[56:59], v2 offset:32768
ds_read_b128 v[60:63], v2 offset:33792
ds_read_b128 v[64:67], v2 offset:34816
ds_read_b128 v[68:71], v2 offset:35840
ds_read_b128 v[72:75], v2 offset:36864
ds_read_b128 v[76:79], v2 offset:37888
ds_read_b128 v[80:83], v2 offset:38912
ds_read_b128 v[84:87], v2 offset:39936
ds_read_b128 v[88:91], v2 offset:40960
ds_read_b128 v[92:95], v2 offset:41984
ds_read_b128 v[96:99], v2 offset:43008
ds_read_b128 v[100:103], v2 offset:44032
ds_read_b128 v[104:107], v2 offset:45056
ds_read_b128 v[108:111], v2 offset:46080
ds_read_b128 v[112:115], v2 offset:47104
ds_read_b128 v[116:119], v2 offset:48128
s_waitcnt lgkmcnt(15)
v_mfma_f32_16x16x32_bf16 v[160:163], a[176:179], v[56:59], 0
s_waitcnt lgkmcnt(14)
v_mfma_f32_16x16x32_bf16 v[160:163], a[180:183], v[60:63], v[160:163]
s_waitcnt lgkmcnt(13)
v_mfma_f32_16x16x32_bf16 v[160:163], a[184:187], v[64:67], v[160:163]
s_waitcnt lgkmcnt(12)
v_mfma_f32_16x16x32_bf16 v[160:163], a[188:191], v[68:71], v[160:163]
s_waitcnt lgkmcnt(11)
v_mfma_f32_16x16x32_bf16 v[160:163], a[192:195], v[72:75], v[160:163]
s_waitcnt lgkmcnt(10)
v_mfma_f32_16x16x32_bf16 v[160:163], a[196:199], v[76:79], v[160:163]
s_waitcnt lgkmcnt(9)
v_mfma_f32_16x16x32_bf16 v[160:163], a[200:203], v[80:83], v[160:163]
s_waitcnt lgkmcnt(8)
v_mfma_f32_16x16x32_bf16 v[160:163], a[204:207], v[84:87], v[160:163]
s_waitcnt lgkmcnt(7)
v_mfma_f32_16x16x32_bf16 v[160:163], a[208:211], v[88:91], v[160:163]
s_waitcnt lgkmcnt(6)
v_mfma_f32_16x16x32_bf16 v[160:163], a[212:215], v[92:95], v[160:163]
s_waitcnt lgkmcnt(5)
v_mfma_f32_16x16x32_bf16 v[160:163], a[216:219], v[96:99], v[160:163]
s_waitcnt lgkmcnt(4)
v_mfma_f32_16x16x32_bf16 v[160:163], a[220:223], v[100:103], v[160:163]
s_waitcnt lgkmcnt(3)
v_mfma_f32_16x16x32_bf16 v[160:163], a[224:227], v[104:107], v[160:163]
s_waitcnt lgkmcnt(2)
v_mfma_f32_16x16x32_bf16 v[160:163], a[228:231], v[108:111], v[160:163]
s_waitcnt lgkmcnt(1)
v_mfma_f32_16x16x32_bf16 v[160:163], a[232:235], v[112:115], v[160:163]
s_waitcnt lgkmcnt(0)
v_mfma_f32_16x16x32_bf16 v[160:163], a[236:239], v[116:119], v[160:163]
ds_read_b128 v[56:59], v2 offset:49152
ds_read_b128 v[60:63], v2 offset:50176
ds_read_b128 v[64:67], v2 offset:51200
ds_read_b128 v[68:71], v2 offset:52224
ds_read_b128 v[72:75], v2 offset:53248
ds_read_b128 v[76:79], v2 offset:54272
ds_read_b128 v[80:83], v2 offset:55296
ds_read_b128 v[84:87], v2 offset:56320
ds_read_b128 v[88:91], v2 offset:57344
ds_read_b128 v[92:95], v2 offset:58368
ds_read_b128 v[96:99], v2 offset:59392
ds_read_b128 v[100:103], v2 offset:60416
ds_read_b128 v[104:107], v2 offset:61440
ds_read_b128 v[108:111], v2 offset:62464
ds_read_b128 v[112:115], v2 offset:63488
ds_read_b128 v[116:119], v2 offset:64512
s_waitcnt lgkmcnt(15)
v_mfma_f32_16x16x32_bf16 v[164:167], a[176:179], v[56:59], 0
s_waitcnt lgkmcnt(14)
v_mfma_f32_16x16x32_bf16 v[164:167], a[180:183], v[60:63], v[164:167]
s_waitcnt lgkmcnt(13)
v_mfma_f32_16x16x32_bf16 v[164:167], a[184:187], v[64:67], v[164:167]
s_waitcnt lgkmcnt(12)
v_mfma_f32_16x16x32_bf16 v[164:167], a[188:191], v[68:71], v[164:167]
s_waitcnt lgkmcnt(11)
v_mfma_f32_16x16x32_bf16 v[164:167], a[192:195], v[72:75], v[164:167]
s_waitcnt lgkmcnt(10)
v_mfma_f32_16x16x32_bf16 v[164:167], a[196:199], v[76:79], v[164:167]
s_waitcnt lgkmcnt(9)
v_mfma_f32_16x16x32_bf16 v[164:167], a[200:203], v[80:83], v[164:167]
s_waitcnt lgkmcnt(8)
v_mfma_f32_16x16x32_bf16 v[164:167], a[204:207], v[84:87], v[164:167]
s_waitcnt lgkmcnt(7)
v_mfma_f32_16x16x32_bf16 v[164:167], a[208:211], v[88:91], v[164:167]
s_waitcnt lgkmcnt(6)
v_mfma_f32_16x16x32_bf16 v[164:167], a[212:215], v[92:95], v[164:167]
s_waitcnt lgkmcnt(5)
v_mfma_f32_16x16x32_bf16 v[164:167], a[216:219], v[96:99], v[164:167]
s_waitcnt lgkmcnt(4)
v_mfma_f32_16x16x32_bf16 v[164:167], a[220:223], v[100:103], v[164:167]
s_waitcnt lgkmcnt(3)
v_mfma_f32_16x16x32_bf16 v[164:167], a[224:227], v[104:107], v[164:167]
s_waitcnt lgkmcnt(2)
v_mfma_f32_16x16x32_bf16 v[164:167], a[228:231], v[108:111], v[164:167]
s_waitcnt lgkmcnt(1)
v_mfma_f32_16x16x32_bf16 v[164:167], a[232:235], v[112:115], v[164:167]
s_waitcnt lgkmcnt(0)
v_mfma_f32_16x16x32_bf16 v[164:167], a[236:239], v[116:119], v[164:167]
v_max_f32 v160, 0, v160
v_max_f32 v161, 0, v161
v_max_f32 v162, 0, v162
v_max_f32 v163, 0, v163
v_cvt_pk_bf16_f32 v168, v160, v161
v_cvt_pk_bf16_f32 v169, v162, v163
ds_write_b64 v12, v[168:169] offset:0
s_nop 0
v_max_f32 v164, 0, v164
v_max_f32 v165, 0, v165
v_max_f32 v166, 0, v166
v_max_f32 v167, 0, v167
v_cvt_pk_bf16_f32 v170, v164, v165
v_cvt_pk_bf16_f32 v171, v166, v167
ds_write_b64 v12, v[170:171] offset:256
s_waitcnt lgkmcnt(0)
s_barrier
ds_read_b128 v[40:43], v2 offset:12288
ds_read_b128 v[44:47], v2 offset:13312
ds_read_b128 v[48:51], v2 offset:14336
s_waitcnt lgkmcnt(2)
v_mfma_f32_32x32x16_bf16 v[192:207], v[40:43], a[128:131], 0
v_mfma_f32_32x32x16_bf16 v[208:223], v[40:43], a[140:143], 0
v_mfma_f32_32x32x16_bf16 v[224:239], v[40:43], a[152:155], 0
v_mfma_f32_32x32x16_bf16 v[240:255], v[40:43], a[164:167], 0
s_waitcnt lgkmcnt(1)
v_mfma_f32_32x32x16_bf16 v[192:207], v[44:47], a[132:135], v[192:207]
v_mfma_f32_32x32x16_bf16 v[208:223], v[44:47], a[144:147], v[208:223]
v_mfma_f32_32x32x16_bf16 v[224:239], v[44:47], a[156:159], v[224:239]
v_mfma_f32_32x32x16_bf16 v[240:255], v[44:47], a[168:171], v[240:255]
s_waitcnt lgkmcnt(0)
v_mfma_f32_32x32x16_bf16 v[192:207], v[48:51], a[136:139], v[192:207]
v_mfma_f32_32x32x16_bf16 v[208:223], v[48:51], a[148:151], v[208:223]
v_mfma_f32_32x32x16_bf16 v[224:239], v[48:51], a[160:163], v[224:239]
v_mfma_f32_32x32x16_bf16 v[240:255], v[48:51], a[172:175], v[240:255]
s_lshl_b32 s40, s68, 10
s_add_u32 s40, s40, s38
s_add_u32 s40, s40, 0x100100
s_nop 6
v_cvt_pk_bf16_f32 v40, v192, v208
s_add_u32 s41, s40, s48
buffer_store_dword v40, v7, s[8:11], s41 offen offset:0 sc1
v_cvt_pk_bf16_f32 v41, v193, v209
s_add_u32 s42, s40, s49
buffer_store_dword v41, v7, s[8:11], s42 offen offset:0 sc1
v_cvt_pk_bf16_f32 v42, v194, v210
s_add_u32 s41, s40, s50
buffer_store_dword v42, v7, s[8:11], s41 offen offset:0 sc1
v_cvt_pk_bf16_f32 v43, v195, v211
s_add_u32 s42, s40, s51
buffer_store_dword v43, v7, s[8:11], s42 offen offset:0 sc1
v_cvt_pk_bf16_f32 v44, v196, v212
s_add_u32 s41, s40, s52
buffer_store_dword v44, v7, s[8:11], s41 offen offset:0 sc1
v_cvt_pk_bf16_f32 v45, v197, v213
s_add_u32 s42, s40, s53
buffer_store_dword v45, v7, s[8:11], s42 offen offset:0 sc1
v_cvt_pk_bf16_f32 v46, v198, v214
s_add_u32 s41, s40, s54
buffer_store_dword v46, v7, s[8:11], s41 offen offset:0 sc1
v_cvt_pk_bf16_f32 v47, v199, v215
s_add_u32 s42, s40, s55
buffer_store_dword v47, v7, s[8:11], s42 offen offset:0 sc1
v_cvt_pk_bf16_f32 v40, v200, v216
s_add_u32 s41, s40, s56
buffer_store_dword v40, v7, s[8:11], s41 offen offset:0 sc1
v_cvt_pk_bf16_f32 v41, v201, v217
s_add_u32 s42, s40, s57
buffer_store_dword v41, v7, s[8:11], s42 offen offset:0 sc1
v_cvt_pk_bf16_f32 v42, v202, v218
s_add_u32 s41, s40, s58
buffer_store_dword v42, v7, s[8:11], s41 offen offset:0 sc1
v_cvt_pk_bf16_f32 v43, v203, v219
s_add_u32 s42, s40, s59
buffer_store_dword v43, v7, s[8:11], s42 offen offset:0 sc1
v_cvt_pk_bf16_f32 v44, v204, v220
s_add_u32 s41, s40, s60
buffer_store_dword v44, v7, s[8:11], s41 offen offset:0 sc1
v_cvt_pk_bf16_f32 v45, v205, v221
s_add_u32 s42, s40, s61
buffer_store_dword v45, v7, s[8:11], s42 offen offset:0 sc1
v_cvt_pk_bf16_f32 v46, v206, v222
s_add_u32 s41, s40, s62
buffer_store_dword v46, v7, s[8:11], s41 offen offset:0 sc1
v_cvt_pk_bf16_f32 v47, v207, v223
s_add_u32 s42, s40, s63
buffer_store_dword v47, v7, s[8:11], s42 offen offset:0 sc1
v_cvt_pk_bf16_f32 v40, v224, v240
s_add_u32 s41, s40, s48
buffer_store_dword v40, v7, s[8:11], s41 offen offset:128 sc1
v_cvt_pk_bf16_f32 v41, v225, v241
s_add_u32 s42, s40, s49
buffer_store_dword v41, v7, s[8:11], s42 offen offset:128 sc1
v_cvt_pk_bf16_f32 v42, v226, v242
s_add_u32 s41, s40, s50
buffer_store_dword v42, v7, s[8:11], s41 offen offset:128 sc1
v_cvt_pk_bf16_f32 v43, v227, v243
s_add_u32 s42, s40, s51
buffer_store_dword v43, v7, s[8:11], s42 offen offset:128 sc1
v_cvt_pk_bf16_f32 v44, v228, v244
s_add_u32 s41, s40, s52
buffer_store_dword v44, v7, s[8:11], s41 offen offset:128 sc1
v_cvt_pk_bf16_f32 v45, v229, v245
s_add_u32 s42, s40, s53
buffer_store_dword v45, v7, s[8:11], s42 offen offset:128 sc1
v_cvt_pk_bf16_f32 v46, v230, v246
s_add_u32 s41, s40, s54
buffer_store_dword v46, v7, s[8:11], s41 offen offset:128 sc1
v_cvt_pk_bf16_f32 v47, v231, v247
s_add_u32 s42, s40, s55
buffer_store_dword v47, v7, s[8:11], s42 offen offset:128 sc1
v_cvt_pk_bf16_f32 v40, v232, v248
s_add_u32 s41, s40, s56
buffer_store_dword v40, v7, s[8:11], s41 offen offset:128 sc1
v_cvt_pk_bf16_f32 v41, v233, v249
s_add_u32 s42, s40, s57
buffer_store_dword v41, v7, s[8:11], s42 offen offset:128 sc1
v_cvt_pk_bf16_f32 v42, v234, v250
s_add_u32 s41, s40, s58
buffer_store_dword v42, v7, s[8:11], s41 offen offset:128 sc1
v_cvt_pk_bf16_f32 v43, v235, v251
s_add_u32 s42, s40, s59
buffer_store_dword v43, v7, s[8:11], s42 offen offset:128 sc1
v_cvt_pk_bf16_f32 v44, v236, v252
s_add_u32 s41, s40, s60
buffer_store_dword v44, v7, s[8:11], s41 offen offset:128 sc1
v_cvt_pk_bf16_f32 v45, v237, v253
s_add_u32 s42, s40, s61
buffer_store_dword v45, v7, s[8:11], s42 offen offset:128 sc1
v_cvt_pk_bf16_f32 v46, v238, v254
s_add_u32 s41, s40, s62
buffer_store_dword v46, v7, s[8:11], s41 offen offset:128 sc1
v_cvt_pk_bf16_f32 v47, v239, v255
s_add_u32 s42, s40, s63
buffer_store_dword v47, v7, s[8:11], s42 offen offset:128 sc1
s_waitcnt vmcnt(0)
s_barrier
s_barrier
s_lshl_b32 s40, s68, 15
s_add_u32 s40, s40, s38
s_add_u32 s40, s40, 0x100100
s_add_u32 s41, s40, 0
buffer_load_dwordx4 v[40:43], v8, s[8:11], s41 offen sc1
s_add_u32 s41, s40, 4096
buffer_load_dwordx4 v[44:47], v8, s[8:11], s41 offen sc1
s_add_u32 s41, s40, 8192
buffer_load_dwordx4 v[48:51], v8, s[8:11], s41 offen sc1
s_add_u32 s41, s40, 12288
buffer_load_dwordx4 v[52:55], v8, s[8:11], s41 offen sc1
s_add_u32 s41, s40, 16384
buffer_load_dwordx4 v[56:59], v8, s[8:11], s41 offen sc1
s_add_u32 s41, s40, 20480
buffer_load_dwordx4 v[60:63], v8, s[8:11], s41 offen sc1
s_add_u32 s41, s40, 24576
buffer_load_dwordx4 v[64:67], v8, s[8:11], s41 offen sc1
s_add_u32 s41, s40, 28672
buffer_load_dwordx4 v[68:71], v8, s[8:11], s41 offen sc1
s_waitcnt vmcnt(7)
v_mfma_f32_16x16x32_bf16 v[160:163], v[40:43], v[16:19], 0
s_waitcnt vmcnt(6)
v_mfma_f32_16x16x32_bf16 v[160:163], v[44:47], v[16:19], v[160:163]
s_waitcnt vmcnt(5)
v_mfma_f32_16x16x32_bf16 v[160:163], v[48:51], v[16:19], v[160:163]
s_waitcnt vmcnt(4)
v_mfma_f32_16x16x32_bf16 v[160:163], v[52:55], v[16:19], v[160:163]
s_waitcnt vmcnt(3)
v_mfma_f32_16x16x32_bf16 v[160:163], v[56:59], v[16:19], v[160:163]
s_waitcnt vmcnt(2)
v_mfma_f32_16x16x32_bf16 v[160:163], v[60:63], v[16:19], v[160:163]
s_waitcnt vmcnt(1)
v_mfma_f32_16x16x32_bf16 v[160:163], v[64:67], v[16:19], v[160:163]
s_waitcnt vmcnt(0)
v_mfma_f32_16x16x32_bf16 v[160:163], v[68:71], v[16:19], v[160:163]
s_nop 7
ds_write_b32 v9, v160 offset:0
ds_write_b32 v9, v161 offset:16
ds_write_b32 v9, v162 offset:32
ds_write_b32 v9, v163 offset:48
s_waitcnt lgkmcnt(0)
s_barrier
v_lshlrev_b32 v147, 1, v10
ds_read_b64 v[148:149], v147 offset:8192
s_waitcnt lgkmcnt(0)
v_accvgpr_read_b32 v144, a246
v_accvgpr_read_b32 v145, a247
v_accvgpr_read_b32 v150, a248
v_accvgpr_read_b32 v151, a249
v_cvt_pk_bf16_f32 v148, v148, v148
v_and_b32 v148, 0xffff0000, v148
v_mul_f32 v148, v148, v144
v_cvt_pk_bf16_f32 v148, v148, v148
v_and_b32 v148, 0xffff0000, v148
v_add_f32 v150, v150, v148
v_cvt_pk_bf16_f32 v149, v149, v149
v_and_b32 v149, 0xffff0000, v149
v_mul_f32 v149, v149, v145
v_cvt_pk_bf16_f32 v149, v149, v149
v_and_b32 v149, 0xffff0000, v149
v_add_f32 v151, v151, v149
v_cvt_pk_bf16_f32 v150, v150, v151
s_lshl_b32 s40, s36, 5
s_add_u32 s40, s40, s68
s_lshl_b32 s40, s40, 10
buffer_store_dword v150, v10, s[4:7], s40 offen
s_add_u32 s36, s36, 7
s_add_u32 s37, s37, 1
s_branch L_tail_w1_s
L_tailend_w1_s:
s_waitcnt vmcnt(0)
s_endpgm
L_tslow2:
s_mov_b32 s12, s22
s_mov_b32 s13, s23
s_mov_b32 s14, 0x200000
s_mov_b32 s15, 0x00020000
s_mov_b32 s4, s26
s_mov_b32 s5, s27
s_mov_b32 s6, 0x200000
s_mov_b32 s7, 0x00020000
s_barrier
v_lshlrev_b32 v140, 1, v10
s_mov_b32 s40, 0x1000
buffer_load_dwordx2 a[240:241], v140, s[8:11], s40 offen sc1
s_mov_b32 s40, 0x1800
buffer_load_dwordx2 a[242:243], v140, s[8:11], s40 offen sc1
s_mov_b32 s40, 0x2000
buffer_load_dwordx2 a[244:245], v140, s[8:11], s40 offen sc1
s_mov_b32 s40, 0x2800
buffer_load_dwordx2 a[246:247], v140, s[8:11], s40 offen sc1
s_waitcnt vmcnt(0)
L_tail_w2_s:
s_cmp_ge_u32 s36, 64
s_cbranch_scc1 L_tailend_w2_s
s_barrier
s_lshl_b32 s40, s36, 5
s_add_u32 s40, s40, s68
s_lshl_b32 s66, s40, 13
s_lshl_b32 s67, s40, 11
s_add_u32 s41, s66, 0x2800000
buffer_load_dwordx4 v[40:43], v2, s[8:11], s41 offen offset:0 sc1
buffer_load_dwordx4 v[44:47], v2, s[8:11], s41 offen offset:1024 sc1
buffer_load_dwordx4 v[48:51], v2, s[8:11], s41 offen offset:2048 sc1
buffer_load_dwordx4 v[52:55], v2, s[8:11], s41 offen offset:3072 sc1
s_add_u32 s41, s66, 0x800000
buffer_load_dwordx4 v[72:75], v2, s[8:11], s41 offen offset:0 sc1
buffer_load_dwordx4 v[76:79], v2, s[8:11], s41 offen offset:1024 sc1
buffer_load_dwordx4 v[80:83], v2, s[8:11], s41 offen offset:2048 sc1
buffer_load_dwordx4 v[84:87], v2, s[8:11], s41 offen offset:3072 sc1
s_add_u32 s41, s66, 0x1801000
buffer_load_dwordx4 v[104:107], v2, s[8:11], s41 offen offset:0 sc1
buffer_load_dwordx4 v[108:111], v2, s[8:11], s41 offen offset:1024 sc1
buffer_load_dwordx4 v[112:115], v2, s[8:11], s41 offen offset:2048 sc1
buffer_load_dwordx4 v[116:119], v2, s[8:11], s41 offen offset:3072 sc1
s_lshl_b32 s41, s40, 10
buffer_load_dword v152, v10, s[12:15], s41 offen
s_barrier
s_add_u32 s42, s67, 0x3800000
buffer_load_dwordx4 v[56:59], v4, s[8:11], s42 offen offset:0 sc1
buffer_load_dwordx4 v[60:63], v4, s[8:11], s42 offen offset:512 sc1
buffer_load_dwordx4 v[64:67], v4, s[8:11], s42 offen offset:1024 sc1
buffer_load_dwordx4 v[68:71], v4, s[8:11], s42 offen offset:1536 sc1
s_add_u32 s42, s67, 0x3c00400
buffer_load_dword v20, v13, s[8:11], s42 offen offset:0 sc1
buffer_load_dword v24, v13, s[8:11], s42 offen offset:256 sc1
buffer_load_dword v28, v13, s[8:11], s42 offen offset:512 sc1
buffer_load_dword v32, v13, s[8:11], s42 offen offset:768 sc1
s_waitcnt vmcnt(0)
v_mfma_f32_16x16x32_bf16 v[120:123], v[56:59], v[40:43], 0
v_mfma_f32_16x16x32_bf16 v[124:127], v[72:75], v[40:43], 0
v_mfma_f32_16x16x32_bf16 v[120:123], v[60:63], v[44:47], v[120:123]
v_mfma_f32_16x16x32_bf16 v[124:127], v[76:79], v[44:47], v[124:127]
v_mfma_f32_16x16x32_bf16 v[120:123], v[64:67], v[48:51], v[120:123]
v_mfma_f32_16x16x32_bf16 v[124:127], v[80:83], v[48:51], v[124:127]
v_mfma_f32_16x16x32_bf16 v[120:123], v[68:71], v[52:55], v[120:123]
v_mfma_f32_16x16x32_bf16 v[124:127], v[84:87], v[52:55], v[124:127]
v_mov_b32 v140, 0xff800000
v_cmp_le_i32 vcc, 0, v5
s_nop 5
v_cndmask_b32 v124, v140, v124, vcc
v_cmp_le_i32 vcc, 1, v5
s_nop 1
v_cndmask_b32 v125, v140, v125, vcc
v_cmp_le_i32 vcc, 2, v5
s_nop 1
v_cndmask_b32 v126, v140, v126, vcc
v_cmp_le_i32 vcc, 3, v5
s_nop 1
v_cndmask_b32 v127, v140, v127, vcc
v_max3_f32 v141, v120, v121, v124
v_max3_f32 v141, v141, v125, v126
v_max_f32 v141, v141, v127
v_mov_b32 v142, v141
s_nop 1
v_permlane32_swap_b32 v141, v142
v_max_f32 v141, v141, v142
v_mov_b32 v142, v141
s_nop 1
v_permlane16_swap_b32 v141, v142
v_max_f32 v141, v141, v142
v_mul_f32 v143, s65, v141
v_fma_f32 v120, v120, s64, v143
v_fma_f32 v121, v121, s64, v143
v_fma_f32 v124, v124, s64, v143
v_fma_f32 v125, v125, s64, v143
v_fma_f32 v126, v126, s64, v143
v_fma_f32 v127, v127, s64, v143
v_exp_f32 v120, v120
v_exp_f32 v121, v121
v_exp_f32 v124, v124
v_exp_f32 v125, v125
v_exp_f32 v126, v126
v_exp_f32 v127, v127
v_cvt_pk_bf16_f32 v132, v124, v125
v_cvt_pk_bf16_f32 v133, v126, v127
v_cvt_pk_bf16_f32 v136, v120, v121
s_nop 0
v_mfma_f32_16x16x32_bf16 v[176:179], v[36:39], v[132:135], 0
v_mfma_f32_16x16x32_bf16 v[176:179], v[36:39], v[136:139], v[176:179]
v_mfma_f32_16x16x32_bf16 v[160:163], v[104:107], v[132:135], 0
v_mfma_f32_16x16x32_bf16 v[164:167], v[108:111], v[132:135], 0
v_mfma_f32_16x16x32_bf16 v[168:171], v[112:115], v[132:135], 0
v_mfma_f32_16x16x32_bf16 v[172:175], v[116:119], v[132:135], 0
v_mfma_f32_16x16x32_bf16 v[160:163], v[20:23], v[136:139], v[160:163]
v_mfma_f32_16x16x32_bf16 v[164:167], v[24:27], v[136:139], v[164:167]
v_mfma_f32_16x16x32_bf16 v[168:171], v[28:31], v[136:139], v[168:171]
v_mfma_f32_16x16x32_bf16 v[172:175], v[32:35], v[136:139], v[172:175]
v_rcp_f32 v142, v176
s_nop 3
v_mul_f32 v160, v160, v142
v_mul_f32 v161, v161, v142
v_mul_f32 v162, v162, v142
v_mul_f32 v163, v163, v142
v_mul_f32 v164, v164, v142
v_mul_f32 v165, v165, v142
v_mul_f32 v166, v166, v142
v_mul_f32 v167, v167, v142
v_mul_f32 v168, v168, v142
v_mul_f32 v169, v169, v142
v_mul_f32 v170, v170, v142
v_mul_f32 v171, v171, v142
v_mul_f32 v172, v172, v142
v_mul_f32 v173, v173, v142
v_mul_f32 v174, v174, v142
v_mul_f32 v175, v175, v142
v_cvt_pk_bf16_f32 v40, v160, v161
v_cvt_pk_bf16_f32 v41, v162, v163
v_cvt_pk_bf16_f32 v42, v164, v165
v_cvt_pk_bf16_f32 v43, v166, v167
ds_write_b128 v6, v[40:43] offset:4096
v_cvt_pk_bf16_f32 v44, v168, v169
v_cvt_pk_bf16_f32 v45, v170, v171
v_cvt_pk_bf16_f32 v46, v172, v173
v_cvt_pk_bf16_f32 v47, v174, v175
ds_write_b128 v6, v[44:47] offset:6144
s_waitcnt lgkmcnt(0)
s_barrier
ds_read_b128 v[40:43], v2 offset:0
ds_read_b128 v[44:47], v2 offset:1024
ds_read_b128 v[48:51], v2 offset:2048
ds_read_b128 v[52:55], v2 offset:3072
ds_read_b128 v[56:59], v2 offset:4096
ds_read_b128 v[60:63], v2 offset:5120
ds_read_b128 v[64:67], v2 offset:6144
ds_read_b128 v[68:71], v2 offset:7168
s_waitcnt lgkmcnt(7)
v_mfma_f32_32x32x16_bf16 v[192:207], v[40:43], a[0:3], 0
v_mfma_f32_32x32x16_bf16 v[208:223], v[40:43], a[32:35], 0
v_mfma_f32_32x32x16_bf16 v[224:239], v[40:43], a[64:67], 0
v_mfma_f32_32x32x16_bf16 v[240:255], v[40:43], a[96:99], 0
s_waitcnt lgkmcnt(6)
v_mfma_f32_32x32x16_bf16 v[192:207], v[44:47], a[4:7], v[192:207]
v_mfma_f32_32x32x16_bf16 v[208:223], v[44:47], a[36:39], v[208:223]
v_mfma_f32_32x32x16_bf16 v[224:239], v[44:47], a[68:71], v[224:239]
v_mfma_f32_32x32x16_bf16 v[240:255], v[44:47], a[100:103], v[240:255]
s_waitcnt lgkmcnt(5)
v_mfma_f32_32x32x16_bf16 v[192:207], v[48:51], a[8:11], v[192:207]
v_mfma_f32_32x32x16_bf16 v[208:223], v[48:51], a[40:43], v[208:223]
v_mfma_f32_32x32x16_bf16 v[224:239], v[48:51], a[72:75], v[224:239]
v_mfma_f32_32x32x16_bf16 v[240:255], v[48:51], a[104:107], v[240:255]
s_waitcnt lgkmcnt(4)
v_mfma_f32_32x32x16_bf16 v[192:207], v[52:55], a[12:15], v[192:207]
v_mfma_f32_32x32x16_bf16 v[208:223], v[52:55], a[44:47], v[208:223]
v_mfma_f32_32x32x16_bf16 v[224:239], v[52:55], a[76:79], v[224:239]
v_mfma_f32_32x32x16_bf16 v[240:255], v[52:55], a[108:111], v[240:255]
s_waitcnt lgkmcnt(3)
v_mfma_f32_32x32x16_bf16 v[192:207], v[56:59], a[16:19], v[192:207]
v_mfma_f32_32x32x16_bf16 v[208:223], v[56:59], a[48:51], v[208:223]
v_mfma_f32_32x32x16_bf16 v[224:239], v[56:59], a[80:83], v[224:239]
v_mfma_f32_32x32x16_bf16 v[240:255], v[56:59], a[112:115], v[240:255]
s_waitcnt lgkmcnt(2)
v_mfma_f32_32x32x16_bf16 v[192:207], v[60:63], a[20:23], v[192:207]
v_mfma_f32_32x32x16_bf16 v[208:223], v[60:63], a[52:55], v[208:223]
v_mfma_f32_32x32x16_bf16 v[224:239], v[60:63], a[84:87], v[224:239]
v_mfma_f32_32x32x16_bf16 v[240:255], v[60:63], a[116:119], v[240:255]
s_waitcnt lgkmcnt(1)
v_mfma_f32_32x32x16_bf16 v[192:207], v[64:67], a[24:27], v[192:207]
v_mfma_f32_32x32x16_bf16 v[208:223], v[64:67], a[56:59], v[208:223]
v_mfma_f32_32x32x16_bf16 v[224:239], v[64:67], a[88:91], v[224:239]
v_mfma_f32_32x32x16_bf16 v[240:255], v[64:67], a[120:123], v[240:255]
s_waitcnt lgkmcnt(0)
v_mfma_f32_32x32x16_bf16 v[192:207], v[68:71], a[28:31], v[192:207]
v_mfma_f32_32x32x16_bf16 v[208:223], v[68:71], a[60:63], v[208:223]
v_mfma_f32_32x32x16_bf16 v[224:239], v[68:71], a[92:95], v[224:239]
v_mfma_f32_32x32x16_bf16 v[240:255], v[68:71], a[124:127], v[240:255]
s_lshl_b32 s40, s68, 10
s_add_u32 s40, s40, s38
s_add_u32 s40, s40, 0x200
s_nop 6
v_cvt_pk_bf16_f32 v40, v192, v208
s_add_u32 s41, s40, s48
buffer_store_dword v40, v7, s[8:11], s41 offen offset:0 sc1
v_cvt_pk_bf16_f32 v41, v193, v209
s_add_u32 s42, s40, s49
buffer_store_dword v41, v7, s[8:11], s42 offen offset:0 sc1
v_cvt_pk_bf16_f32 v42, v194, v210
s_add_u32 s41, s40, s50
buffer_store_dword v42, v7, s[8:11], s41 offen offset:0 sc1
v_cvt_pk_bf16_f32 v43, v195, v211
s_add_u32 s42, s40, s51
buffer_store_dword v43, v7, s[8:11], s42 offen offset:0 sc1
v_cvt_pk_bf16_f32 v44, v196, v212
s_add_u32 s41, s40, s52
buffer_store_dword v44, v7, s[8:11], s41 offen offset:0 sc1
v_cvt_pk_bf16_f32 v45, v197, v213
s_add_u32 s42, s40, s53
buffer_store_dword v45, v7, s[8:11], s42 offen offset:0 sc1
v_cvt_pk_bf16_f32 v46, v198, v214
s_add_u32 s41, s40, s54
buffer_store_dword v46, v7, s[8:11], s41 offen offset:0 sc1
v_cvt_pk_bf16_f32 v47, v199, v215
s_add_u32 s42, s40, s55
buffer_store_dword v47, v7, s[8:11], s42 offen offset:0 sc1
v_cvt_pk_bf16_f32 v40, v200, v216
s_add_u32 s41, s40, s56
buffer_store_dword v40, v7, s[8:11], s41 offen offset:0 sc1
v_cvt_pk_bf16_f32 v41, v201, v217
s_add_u32 s42, s40, s57
buffer_store_dword v41, v7, s[8:11], s42 offen offset:0 sc1
v_cvt_pk_bf16_f32 v42, v202, v218
s_add_u32 s41, s40, s58
buffer_store_dword v42, v7, s[8:11], s41 offen offset:0 sc1
v_cvt_pk_bf16_f32 v43, v203, v219
s_add_u32 s42, s40, s59
buffer_store_dword v43, v7, s[8:11], s42 offen offset:0 sc1
v_cvt_pk_bf16_f32 v44, v204, v220
s_add_u32 s41, s40, s60
buffer_store_dword v44, v7, s[8:11], s41 offen offset:0 sc1
v_cvt_pk_bf16_f32 v45, v205, v221
s_add_u32 s42, s40, s61
buffer_store_dword v45, v7, s[8:11], s42 offen offset:0 sc1
v_cvt_pk_bf16_f32 v46, v206, v222
s_add_u32 s41, s40, s62
buffer_store_dword v46, v7, s[8:11], s41 offen offset:0 sc1
v_cvt_pk_bf16_f32 v47, v207, v223
s_add_u32 s42, s40, s63
buffer_store_dword v47, v7, s[8:11], s42 offen offset:0 sc1
v_cvt_pk_bf16_f32 v40, v224, v240
s_add_u32 s41, s40, s48
buffer_store_dword v40, v7, s[8:11], s41 offen offset:128 sc1
v_cvt_pk_bf16_f32 v41, v225, v241
s_add_u32 s42, s40, s49
buffer_store_dword v41, v7, s[8:11], s42 offen offset:128 sc1
v_cvt_pk_bf16_f32 v42, v226, v242
s_add_u32 s41, s40, s50
buffer_store_dword v42, v7, s[8:11], s41 offen offset:128 sc1
v_cvt_pk_bf16_f32 v43, v227, v243
s_add_u32 s42, s40, s51
buffer_store_dword v43, v7, s[8:11], s42 offen offset:128 sc1
v_cvt_pk_bf16_f32 v44, v228, v244
s_add_u32 s41, s40, s52
buffer_store_dword v44, v7, s[8:11], s41 offen offset:128 sc1
v_cvt_pk_bf16_f32 v45, v229, v245
s_add_u32 s42, s40, s53
buffer_store_dword v45, v7, s[8:11], s42 offen offset:128 sc1
v_cvt_pk_bf16_f32 v46, v230, v246
s_add_u32 s41, s40, s54
buffer_store_dword v46, v7, s[8:11], s41 offen offset:128 sc1
v_cvt_pk_bf16_f32 v47, v231, v247
s_add_u32 s42, s40, s55
buffer_store_dword v47, v7, s[8:11], s42 offen offset:128 sc1
v_cvt_pk_bf16_f32 v40, v232, v248
s_add_u32 s41, s40, s56
buffer_store_dword v40, v7, s[8:11], s41 offen offset:128 sc1
v_cvt_pk_bf16_f32 v41, v233, v249
s_add_u32 s42, s40, s57
buffer_store_dword v41, v7, s[8:11], s42 offen offset:128 sc1
v_cvt_pk_bf16_f32 v42, v234, v250
s_add_u32 s41, s40, s58
buffer_store_dword v42, v7, s[8:11], s41 offen offset:128 sc1
v_cvt_pk_bf16_f32 v43, v235, v251
s_add_u32 s42, s40, s59
buffer_store_dword v43, v7, s[8:11], s42 offen offset:128 sc1
v_cvt_pk_bf16_f32 v44, v236, v252
s_add_u32 s41, s40, s60
buffer_store_dword v44, v7, s[8:11], s41 offen offset:128 sc1
v_cvt_pk_bf16_f32 v45, v237, v253
s_add_u32 s42, s40, s61
buffer_store_dword v45, v7, s[8:11], s42 offen offset:128 sc1
v_cvt_pk_bf16_f32 v46, v238, v254
s_add_u32 s41, s40, s62
buffer_store_dword v46, v7, s[8:11], s41 offen offset:128 sc1
v_cvt_pk_bf16_f32 v47, v239, v255
s_add_u32 s42, s40, s63
buffer_store_dword v47, v7, s[8:11], s42 offen offset:128 sc1
s_waitcnt vmcnt(0)
s_barrier
s_barrier
s_lshl_b32 s40, s68, 15
s_add_u32 s40, s40, s38
s_add_u32 s40, s40, 0x200
s_add_u32 s41, s40, 0
buffer_load_dwordx4 v[40:43], v8, s[8:11], s41 offen sc1
s_add_u32 s41, s40, 4096
buffer_load_dwordx4 v[44:47], v8, s[8:11], s41 offen sc1
s_add_u32 s41, s40, 8192
buffer_load_dwordx4 v[48:51], v8, s[8:11], s41 offen sc1
s_add_u32 s41, s40, 12288
buffer_load_dwordx4 v[52:55], v8, s[8:11], s41 offen sc1
s_add_u32 s41, s40, 16384
buffer_load_dwordx4 v[56:59], v8, s[8:11], s41 offen sc1
s_add_u32 s41, s40, 20480
buffer_load_dwordx4 v[60:63], v8, s[8:11], s41 offen sc1
s_add_u32 s41, s40, 24576
buffer_load_dwordx4 v[64:67], v8, s[8:11], s41 offen sc1
s_add_u32 s41, s40, 28672
buffer_load_dwordx4 v[68:71], v8, s[8:11], s41 offen sc1
s_waitcnt vmcnt(7)
v_mfma_f32_16x16x32_bf16 v[160:163], v[40:43], v[16:19], 0
s_waitcnt vmcnt(6)
v_mfma_f32_16x16x32_bf16 v[160:163], v[44:47], v[16:19], v[160:163]
s_waitcnt vmcnt(5)
v_mfma_f32_16x16x32_bf16 v[160:163], v[48:51], v[16:19], v[160:163]
s_waitcnt vmcnt(4)
v_mfma_f32_16x16x32_bf16 v[160:163], v[52:55], v[16:19], v[160:163]
s_waitcnt vmcnt(3)
v_mfma_f32_16x16x32_bf16 v[160:163], v[56:59], v[16:19], v[160:163]
s_waitcnt vmcnt(2)
v_mfma_f32_16x16x32_bf16 v[160:163], v[60:63], v[16:19], v[160:163]
s_waitcnt vmcnt(1)
v_mfma_f32_16x16x32_bf16 v[160:163], v[64:67], v[16:19], v[160:163]
s_waitcnt vmcnt(0)
v_mfma_f32_16x16x32_bf16 v[160:163], v[68:71], v[16:19], v[160:163]
s_nop 7
ds_write_b32 v9, v160 offset:0
ds_write_b32 v9, v161 offset:16
ds_write_b32 v9, v162 offset:32
ds_write_b32 v9, v163 offset:48
s_waitcnt lgkmcnt(0)
s_barrier
v_lshlrev_b32 v147, 1, v10
ds_read_b64 v[148:149], v147 offset:8192
s_waitcnt lgkmcnt(0)
v_lshlrev_b32 v150, 16, v152
v_and_b32 v151, 0xffff0000, v152
v_accvgpr_read_b32 v144, a240
v_accvgpr_read_b32 v145, a241
v_cvt_pk_bf16_f32 v148, v148, v148
v_and_b32 v148, 0xffff0000, v148
v_mul_f32 v148, v148, v144
v_cvt_pk_bf16_f32 v148, v148, v148
v_and_b32 v148, 0xffff0000, v148
v_add_f32 v150, v150, v148
v_cvt_pk_bf16_f32 v150, v150, v150
v_and_b32 v150, 0xffff0000, v150
v_cvt_pk_bf16_f32 v149, v149, v149
v_and_b32 v149, 0xffff0000, v149
v_mul_f32 v149, v149, v145
v_cvt_pk_bf16_f32 v149, v149, v149
v_and_b32 v149, 0xffff0000, v149
v_add_f32 v151, v151, v149
v_cvt_pk_bf16_f32 v151, v151, v151
v_and_b32 v151, 0xffff0000, v151
v_accvgpr_write_b32 a248, v150
v_accvgpr_write_b32 a249, v151
v_add_f32 v156, v150, v151
v_mul_f32 v157, v150, v150
v_fmac_f32 v157, v151, v151
v_add_f32_dpp v156, v156, v156 quad_perm:[1,0,3,2] row_mask:0xf bank_mask:0xf
s_nop 1
v_add_f32_dpp v156, v156, v156 quad_perm:[2,3,0,1] row_mask:0xf bank_mask:0xf
s_nop 1
v_add_f32_dpp v156, v156, v156 row_half_mirror row_mask:0xf bank_mask:0xf
s_nop 1
v_add_f32_dpp v156, v156, v156 row_mirror row_mask:0xf bank_mask:0xf
v_mov_b32 v155, v156
s_nop 1
v_permlane16_swap_b32 v156, v155
v_add_f32 v156, v156, v155
v_mov_b32 v155, v156
s_nop 1
v_permlane32_swap_b32 v156, v155
v_add_f32 v156, v156, v155
v_add_f32_dpp v157, v157, v157 quad_perm:[1,0,3,2] row_mask:0xf bank_mask:0xf
s_nop 1
v_add_f32_dpp v157, v157, v157 quad_perm:[2,3,0,1] row_mask:0xf bank_mask:0xf
s_nop 1
v_add_f32_dpp v157, v157, v157 row_half_mirror row_mask:0xf bank_mask:0xf
s_nop 1
v_add_f32_dpp v157, v157, v157 row_mirror row_mask:0xf bank_mask:0xf
v_mov_b32 v155, v157
s_nop 1
v_permlane16_swap_b32 v157, v155
v_add_f32 v157, v157, v155
v_mov_b32 v155, v157
s_nop 1
v_permlane32_swap_b32 v157, v155
v_add_f32 v157, v157, v155
v_mov_b32 v155, 10320
ds_write_b64 v155, v[156:157]
s_waitcnt lgkmcnt(0)
s_barrier
v_mov_b32 v155, 10304
ds_read_b128 v[160:163], v155
ds_read_b128 v[164:167], v155 offset:16
s_waitcnt lgkmcnt(0)
v_add_f32 v156, v160, v162
v_add_f32 v157, v161, v163
v_add_f32 v156, v156, v164
v_add_f32 v157, v157, v165
v_add_f32 v156, v156, v166
v_add_f32 v157, v157, v167
v_mul_f32 v156, 0x3b000000, v156
v_mul_f32 v157, 0x3b000000, v157
v_fma_f32 v157, -v156, v156, v157
v_max_f32 v157, 0, v157
v_cvt_pk_bf16_f32 v156, v156, v156
v_and_b32 v156, 0xffff0000, v156
v_cvt_pk_bf16_f32 v157, v157, v157
v_and_b32 v157, 0xffff0000, v157
v_add_f32 v157, 0x3727c5ac, v157
v_cvt_pk_bf16_f32 v157, v157, v157
v_and_b32 v157, 0xffff0000, v157
v_sqrt_f32 v157, v157
s_nop 0
v_cvt_pk_bf16_f32 v157, v157, v157
v_and_b32 v157, 0xffff0000, v157
v_rcp_f32 v157, v157
v_accvgpr_read_b32 v144, a244
v_accvgpr_read_b32 v145, a245
v_accvgpr_read_b32 v148, a242
v_accvgpr_read_b32 v149, a243
v_sub_f32 v150, v150, v156
v_mul_f32 v150, v150, v157
v_fma_f32 v150, v150, v144, v148
v_sub_f32 v151, v151, v156
v_mul_f32 v151, v151, v157
v_fma_f32 v151, v151, v145, v149
v_cvt_pk_bf16_f32 v150, v150, v151
s_add_u32 s40, s38, 0x200000
buffer_store_dword v150, v11, s[8:11], s40 offen sc1
s_waitcnt vmcnt(0)
s_barrier
s_barrier
s_add_u32 s40, s38, 0x204000
s_mov_b32 m0, 49152
s_add_u32 s41, s40, 0
buffer_load_dwordx4 v2, s[8:11], s41 offen sc1 lds
s_mov_b32 m0, 50176
s_add_u32 s41, s40, 1024
buffer_load_dwordx4 v2, s[8:11], s41 offen sc1 lds
s_mov_b32 m0, 51200
s_add_u32 s41, s40, 2048
buffer_load_dwordx4 v2, s[8:11], s41 offen sc1 lds
s_mov_b32 m0, 52224
s_add_u32 s41, s40, 3072
buffer_load_dwordx4 v2, s[8:11], s41 offen sc1 lds
s_mov_b32 m0, 53248
s_add_u32 s41, s40, 4096
buffer_load_dwordx4 v2, s[8:11], s41 offen sc1 lds
s_mov_b32 m0, 54272
s_add_u32 s41, s40, 5120
buffer_load_dwordx4 v2, s[8:11], s41 offen sc1 lds
s_mov_b32 m0, 55296
s_add_u32 s41, s40, 6144
buffer_load_dwordx4 v2, s[8:11], s41 offen sc1 lds
s_mov_b32 m0, 56320
s_add_u32 s41, s40, 7168
buffer_load_dwordx4 v2, s[8:11], s41 offen sc1 lds
s_waitcnt vmcnt(0)
s_barrier
ds_read_b128 v[56:59], v2 offset:32768
ds_read_b128 v[60:63], v2 offset:33792
ds_read_b128 v[64:67], v2 offset:34816
ds_read_b128 v[68:71], v2 offset:35840
ds_read_b128 v[72:75], v2 offset:36864
ds_read_b128 v[76:79], v2 offset:37888
ds_read_b128 v[80:83], v2 offset:38912
ds_read_b128 v[84:87], v2 offset:39936
ds_read_b128 v[88:91], v2 offset:40960
ds_read_b128 v[92:95], v2 offset:41984
ds_read_b128 v[96:99], v2 offset:43008
ds_read_b128 v[100:103], v2 offset:44032
ds_read_b128 v[104:107], v2 offset:45056
ds_read_b128 v[108:111], v2 offset:46080
ds_read_b128 v[112:115], v2 offset:47104
ds_read_b128 v[116:119], v2 offset:48128
s_waitcnt lgkmcnt(15)
v_mfma_f32_16x16x32_bf16 v[160:163], a[176:179], v[56:59], 0
s_waitcnt lgkmcnt(14)
v_mfma_f32_16x16x32_bf16 v[160:163], a[180:183], v[60:63], v[160:163]
s_waitcnt lgkmcnt(13)
v_mfma_f32_16x16x32_bf16 v[160:163], a[184:187], v[64:67], v[160:163]
s_waitcnt lgkmcnt(12)
v_mfma_f32_16x16x32_bf16 v[160:163], a[188:191], v[68:71], v[160:163]
s_waitcnt lgkmcnt(11)
v_mfma_f32_16x16x32_bf16 v[160:163], a[192:195], v[72:75], v[160:163]
s_waitcnt lgkmcnt(10)
v_mfma_f32_16x16x32_bf16 v[160:163], a[196:199], v[76:79], v[160:163]
s_waitcnt lgkmcnt(9)
v_mfma_f32_16x16x32_bf16 v[160:163], a[200:203], v[80:83], v[160:163]
s_waitcnt lgkmcnt(8)
v_mfma_f32_16x16x32_bf16 v[160:163], a[204:207], v[84:87], v[160:163]
s_waitcnt lgkmcnt(7)
v_mfma_f32_16x16x32_bf16 v[160:163], a[208:211], v[88:91], v[160:163]
s_waitcnt lgkmcnt(6)
v_mfma_f32_16x16x32_bf16 v[160:163], a[212:215], v[92:95], v[160:163]
s_waitcnt lgkmcnt(5)
v_mfma_f32_16x16x32_bf16 v[160:163], a[216:219], v[96:99], v[160:163]
s_waitcnt lgkmcnt(4)
v_mfma_f32_16x16x32_bf16 v[160:163], a[220:223], v[100:103], v[160:163]
s_waitcnt lgkmcnt(3)
v_mfma_f32_16x16x32_bf16 v[160:163], a[224:227], v[104:107], v[160:163]
s_waitcnt lgkmcnt(2)
v_mfma_f32_16x16x32_bf16 v[160:163], a[228:231], v[108:111], v[160:163]
s_waitcnt lgkmcnt(1)
v_mfma_f32_16x16x32_bf16 v[160:163], a[232:235], v[112:115], v[160:163]
s_waitcnt lgkmcnt(0)
v_mfma_f32_16x16x32_bf16 v[160:163], a[236:239], v[116:119], v[160:163]
ds_read_b128 v[56:59], v2 offset:49152
ds_read_b128 v[60:63], v2 offset:50176
ds_read_b128 v[64:67], v2 offset:51200
ds_read_b128 v[68:71], v2 offset:52224
ds_read_b128 v[72:75], v2 offset:53248
ds_read_b128 v[76:79], v2 offset:54272
ds_read_b128 v[80:83], v2 offset:55296
ds_read_b128 v[84:87], v2 offset:56320
ds_read_b128 v[88:91], v2 offset:57344
ds_read_b128 v[92:95], v2 offset:58368
ds_read_b128 v[96:99], v2 offset:59392
ds_read_b128 v[100:103], v2 offset:60416
ds_read_b128 v[104:107], v2 offset:61440
ds_read_b128 v[108:111], v2 offset:62464
ds_read_b128 v[112:115], v2 offset:63488
ds_read_b128 v[116:119], v2 offset:64512
s_waitcnt lgkmcnt(15)
v_mfma_f32_16x16x32_bf16 v[164:167], a[176:179], v[56:59], 0
s_waitcnt lgkmcnt(14)
v_mfma_f32_16x16x32_bf16 v[164:167], a[180:183], v[60:63], v[164:167]
s_waitcnt lgkmcnt(13)
v_mfma_f32_16x16x32_bf16 v[164:167], a[184:187], v[64:67], v[164:167]
s_waitcnt lgkmcnt(12)
v_mfma_f32_16x16x32_bf16 v[164:167], a[188:191], v[68:71], v[164:167]
s_waitcnt lgkmcnt(11)
v_mfma_f32_16x16x32_bf16 v[164:167], a[192:195], v[72:75], v[164:167]
s_waitcnt lgkmcnt(10)
v_mfma_f32_16x16x32_bf16 v[164:167], a[196:199], v[76:79], v[164:167]
s_waitcnt lgkmcnt(9)
v_mfma_f32_16x16x32_bf16 v[164:167], a[200:203], v[80:83], v[164:167]
s_waitcnt lgkmcnt(8)
v_mfma_f32_16x16x32_bf16 v[164:167], a[204:207], v[84:87], v[164:167]
s_waitcnt lgkmcnt(7)
v_mfma_f32_16x16x32_bf16 v[164:167], a[208:211], v[88:91], v[164:167]
s_waitcnt lgkmcnt(6)
v_mfma_f32_16x16x32_bf16 v[164:167], a[212:215], v[92:95], v[164:167]
s_waitcnt lgkmcnt(5)
v_mfma_f32_16x16x32_bf16 v[164:167], a[216:219], v[96:99], v[164:167]
s_waitcnt lgkmcnt(4)
v_mfma_f32_16x16x32_bf16 v[164:167], a[220:223], v[100:103], v[164:167]
s_waitcnt lgkmcnt(3)
v_mfma_f32_16x16x32_bf16 v[164:167], a[224:227], v[104:107], v[164:167]
s_waitcnt lgkmcnt(2)
v_mfma_f32_16x16x32_bf16 v[164:167], a[228:231], v[108:111], v[164:167]
s_waitcnt lgkmcnt(1)
v_mfma_f32_16x16x32_bf16 v[164:167], a[232:235], v[112:115], v[164:167]
s_waitcnt lgkmcnt(0)
v_mfma_f32_16x16x32_bf16 v[164:167], a[236:239], v[116:119], v[164:167]
v_max_f32 v160, 0, v160
v_max_f32 v161, 0, v161
v_max_f32 v162, 0, v162
v_max_f32 v163, 0, v163
v_cvt_pk_bf16_f32 v168, v160, v161
v_cvt_pk_bf16_f32 v169, v162, v163
ds_write_b64 v12, v[168:169] offset:0
s_nop 0
v_max_f32 v164, 0, v164
v_max_f32 v165, 0, v165
v_max_f32 v166, 0, v166
v_max_f32 v167, 0, v167
v_cvt_pk_bf16_f32 v170, v164, v165
v_cvt_pk_bf16_f32 v171, v166, v167
ds_write_b64 v12, v[170:171] offset:256
s_waitcnt lgkmcnt(0)
s_barrier
ds_read_b128 v[40:43], v2 offset:12288
ds_read_b128 v[44:47], v2 offset:13312
ds_read_b128 v[48:51], v2 offset:14336
s_waitcnt lgkmcnt(2)
v_mfma_f32_32x32x16_bf16 v[192:207], v[40:43], a[128:131], 0
v_mfma_f32_32x32x16_bf16 v[208:223], v[40:43], a[140:143], 0
v_mfma_f32_32x32x16_bf16 v[224:239], v[40:43], a[152:155], 0
v_mfma_f32_32x32x16_bf16 v[240:255], v[40:43], a[164:167], 0
s_waitcnt lgkmcnt(1)
v_mfma_f32_32x32x16_bf16 v[192:207], v[44:47], a[132:135], v[192:207]
v_mfma_f32_32x32x16_bf16 v[208:223], v[44:47], a[144:147], v[208:223]
v_mfma_f32_32x32x16_bf16 v[224:239], v[44:47], a[156:159], v[224:239]
v_mfma_f32_32x32x16_bf16 v[240:255], v[44:47], a[168:171], v[240:255]
s_waitcnt lgkmcnt(0)
v_mfma_f32_32x32x16_bf16 v[192:207], v[48:51], a[136:139], v[192:207]
v_mfma_f32_32x32x16_bf16 v[208:223], v[48:51], a[148:151], v[208:223]
v_mfma_f32_32x32x16_bf16 v[224:239], v[48:51], a[160:163], v[224:239]
v_mfma_f32_32x32x16_bf16 v[240:255], v[48:51], a[172:175], v[240:255]
s_lshl_b32 s40, s68, 10
s_add_u32 s40, s40, s38
s_add_u32 s40, s40, 0x100200
s_nop 6
v_cvt_pk_bf16_f32 v40, v192, v208
s_add_u32 s41, s40, s48
buffer_store_dword v40, v7, s[8:11], s41 offen offset:0 sc1
v_cvt_pk_bf16_f32 v41, v193, v209
s_add_u32 s42, s40, s49
buffer_store_dword v41, v7, s[8:11], s42 offen offset:0 sc1
v_cvt_pk_bf16_f32 v42, v194, v210
s_add_u32 s41, s40, s50
buffer_store_dword v42, v7, s[8:11], s41 offen offset:0 sc1
v_cvt_pk_bf16_f32 v43, v195, v211
s_add_u32 s42, s40, s51
buffer_store_dword v43, v7, s[8:11], s42 offen offset:0 sc1
v_cvt_pk_bf16_f32 v44, v196, v212
s_add_u32 s41, s40, s52
buffer_store_dword v44, v7, s[8:11], s41 offen offset:0 sc1
v_cvt_pk_bf16_f32 v45, v197, v213
s_add_u32 s42, s40, s53
buffer_store_dword v45, v7, s[8:11], s42 offen offset:0 sc1
v_cvt_pk_bf16_f32 v46, v198, v214
s_add_u32 s41, s40, s54
buffer_store_dword v46, v7, s[8:11], s41 offen offset:0 sc1
v_cvt_pk_bf16_f32 v47, v199, v215
s_add_u32 s42, s40, s55
buffer_store_dword v47, v7, s[8:11], s42 offen offset:0 sc1
v_cvt_pk_bf16_f32 v40, v200, v216
s_add_u32 s41, s40, s56
buffer_store_dword v40, v7, s[8:11], s41 offen offset:0 sc1
v_cvt_pk_bf16_f32 v41, v201, v217
s_add_u32 s42, s40, s57
buffer_store_dword v41, v7, s[8:11], s42 offen offset:0 sc1
v_cvt_pk_bf16_f32 v42, v202, v218
s_add_u32 s41, s40, s58
buffer_store_dword v42, v7, s[8:11], s41 offen offset:0 sc1
v_cvt_pk_bf16_f32 v43, v203, v219
s_add_u32 s42, s40, s59
buffer_store_dword v43, v7, s[8:11], s42 offen offset:0 sc1
v_cvt_pk_bf16_f32 v44, v204, v220
s_add_u32 s41, s40, s60
buffer_store_dword v44, v7, s[8:11], s41 offen offset:0 sc1
v_cvt_pk_bf16_f32 v45, v205, v221
s_add_u32 s42, s40, s61
buffer_store_dword v45, v7, s[8:11], s42 offen offset:0 sc1
v_cvt_pk_bf16_f32 v46, v206, v222
s_add_u32 s41, s40, s62
buffer_store_dword v46, v7, s[8:11], s41 offen offset:0 sc1
v_cvt_pk_bf16_f32 v47, v207, v223
s_add_u32 s42, s40, s63
buffer_store_dword v47, v7, s[8:11], s42 offen offset:0 sc1
v_cvt_pk_bf16_f32 v40, v224, v240
s_add_u32 s41, s40, s48
buffer_store_dword v40, v7, s[8:11], s41 offen offset:128 sc1
v_cvt_pk_bf16_f32 v41, v225, v241
s_add_u32 s42, s40, s49
buffer_store_dword v41, v7, s[8:11], s42 offen offset:128 sc1
v_cvt_pk_bf16_f32 v42, v226, v242
s_add_u32 s41, s40, s50
buffer_store_dword v42, v7, s[8:11], s41 offen offset:128 sc1
v_cvt_pk_bf16_f32 v43, v227, v243
s_add_u32 s42, s40, s51
buffer_store_dword v43, v7, s[8:11], s42 offen offset:128 sc1
v_cvt_pk_bf16_f32 v44, v228, v244
s_add_u32 s41, s40, s52
buffer_store_dword v44, v7, s[8:11], s41 offen offset:128 sc1
v_cvt_pk_bf16_f32 v45, v229, v245
s_add_u32 s42, s40, s53
buffer_store_dword v45, v7, s[8:11], s42 offen offset:128 sc1
v_cvt_pk_bf16_f32 v46, v230, v246
s_add_u32 s41, s40, s54
buffer_store_dword v46, v7, s[8:11], s41 offen offset:128 sc1
v_cvt_pk_bf16_f32 v47, v231, v247
s_add_u32 s42, s40, s55
buffer_store_dword v47, v7, s[8:11], s42 offen offset:128 sc1
v_cvt_pk_bf16_f32 v40, v232, v248
s_add_u32 s41, s40, s56
buffer_store_dword v40, v7, s[8:11], s41 offen offset:128 sc1
v_cvt_pk_bf16_f32 v41, v233, v249
s_add_u32 s42, s40, s57
buffer_store_dword v41, v7, s[8:11], s42 offen offset:128 sc1
v_cvt_pk_bf16_f32 v42, v234, v250
s_add_u32 s41, s40, s58
buffer_store_dword v42, v7, s[8:11], s41 offen offset:128 sc1
v_cvt_pk_bf16_f32 v43, v235, v251
s_add_u32 s42, s40, s59
buffer_store_dword v43, v7, s[8:11], s42 offen offset:128 sc1
v_cvt_pk_bf16_f32 v44, v236, v252
s_add_u32 s41, s40, s60
buffer_store_dword v44, v7, s[8:11], s41 offen offset:128 sc1
v_cvt_pk_bf16_f32 v45, v237, v253
s_add_u32 s42, s40, s61
buffer_store_dword v45, v7, s[8:11], s42 offen offset:128 sc1
v_cvt_pk_bf16_f32 v46, v238, v254
s_add_u32 s41, s40, s62
buffer_store_dword v46, v7, s[8:11], s41 offen offset:128 sc1
v_cvt_pk_bf16_f32 v47, v239, v255
s_add_u32 s42, s40, s63
buffer_store_dword v47, v7, s[8:11], s42 offen offset:128 sc1
s_waitcnt vmcnt(0)
s_barrier
s_barrier
s_lshl_b32 s40, s68, 15
s_add_u32 s40, s40, s38
s_add_u32 s40, s40, 0x100200
s_add_u32 s41, s40, 0
buffer_load_dwordx4 v[40:43], v8, s[8:11], s41 offen sc1
s_add_u32 s41, s40, 4096
buffer_load_dwordx4 v[44:47], v8, s[8:11], s41 offen sc1
s_add_u32 s41, s40, 8192
buffer_load_dwordx4 v[48:51], v8, s[8:11], s41 offen sc1
s_add_u32 s41, s40, 12288
buffer_load_dwordx4 v[52:55], v8, s[8:11], s41 offen sc1
s_add_u32 s41, s40, 16384
buffer_load_dwordx4 v[56:59], v8, s[8:11], s41 offen sc1
s_add_u32 s41, s40, 20480
buffer_load_dwordx4 v[60:63], v8, s[8:11], s41 offen sc1
s_add_u32 s41, s40, 24576
buffer_load_dwordx4 v[64:67], v8, s[8:11], s41 offen sc1
s_add_u32 s41, s40, 28672
buffer_load_dwordx4 v[68:71], v8, s[8:11], s41 offen sc1
s_waitcnt vmcnt(7)
v_mfma_f32_16x16x32_bf16 v[160:163], v[40:43], v[16:19], 0
s_waitcnt vmcnt(6)
v_mfma_f32_16x16x32_bf16 v[160:163], v[44:47], v[16:19], v[160:163]
s_waitcnt vmcnt(5)
v_mfma_f32_16x16x32_bf16 v[160:163], v[48:51], v[16:19], v[160:163]
s_waitcnt vmcnt(4)
v_mfma_f32_16x16x32_bf16 v[160:163], v[52:55], v[16:19], v[160:163]
s_waitcnt vmcnt(3)
v_mfma_f32_16x16x32_bf16 v[160:163], v[56:59], v[16:19], v[160:163]
s_waitcnt vmcnt(2)
v_mfma_f32_16x16x32_bf16 v[160:163], v[60:63], v[16:19], v[160:163]
s_waitcnt vmcnt(1)
v_mfma_f32_16x16x32_bf16 v[160:163], v[64:67], v[16:19], v[160:163]
s_waitcnt vmcnt(0)
v_mfma_f32_16x16x32_bf16 v[160:163], v[68:71], v[16:19], v[160:163]
s_nop 7
ds_write_b32 v9, v160 offset:0
ds_write_b32 v9, v161 offset:16
ds_write_b32 v9, v162 offset:32
ds_write_b32 v9, v163 offset:48
s_waitcnt lgkmcnt(0)
s_barrier
v_lshlrev_b32 v147, 1, v10
ds_read_b64 v[148:149], v147 offset:8192
s_waitcnt lgkmcnt(0)
v_accvgpr_read_b32 v144, a246
v_accvgpr_read_b32 v145, a247
v_accvgpr_read_b32 v150, a248
v_accvgpr_read_b32 v151, a249
v_cvt_pk_bf16_f32 v148, v148, v148
v_and_b32 v148, 0xffff0000, v148
v_mul_f32 v148, v148, v144
v_cvt_pk_bf16_f32 v148, v148, v148
v_and_b32 v148, 0xffff0000, v148
v_add_f32 v150, v150, v148
v_cvt_pk_bf16_f32 v149, v149, v149
v_and_b32 v149, 0xffff0000, v149
v_mul_f32 v149, v149, v145
v_cvt_pk_bf16_f32 v149, v149, v149
v_and_b32 v149, 0xffff0000, v149
v_add_f32 v151, v151, v149
v_cvt_pk_bf16_f32 v150, v150, v151
s_lshl_b32 s40, s36, 5
s_add_u32 s40, s40, s68
s_lshl_b32 s40, s40, 10
buffer_store_dword v150, v10, s[4:7], s40 offen
s_add_u32 s36, s36, 7
s_add_u32 s37, s37, 1
s_branch L_tail_w2_s
L_tailend_w2_s:
s_waitcnt vmcnt(0)
s_endpgm
L_tslow3:
s_mov_b32 s12, s22
s_mov_b32 s13, s23
s_mov_b32 s14, 0x200000
s_mov_b32 s15, 0x00020000
s_mov_b32 s4, s26
s_mov_b32 s5, s27
s_mov_b32 s6, 0x200000
s_mov_b32 s7, 0x00020000
s_barrier
v_lshlrev_b32 v140, 1, v10
s_mov_b32 s40, 0x1000
buffer_load_dwordx2 a[240:241], v140, s[8:11], s40 offen sc1
s_mov_b32 s40, 0x1800
buffer_load_dwordx2 a[242:243], v140, s[8:11], s40 offen sc1
s_mov_b32 s40, 0x2000
buffer_load_dwordx2 a[244:245], v140, s[8:11], s40 offen sc1
s_mov_b32 s40, 0x2800
buffer_load_dwordx2 a[246:247], v140, s[8:11], s40 offen sc1
s_waitcnt vmcnt(0)
L_tail_w3_s:
s_cmp_ge_u32 s36, 64
s_cbranch_scc1 L_tailend_w3_s
s_barrier
s_lshl_b32 s40, s36, 5
s_add_u32 s40, s40, s68
s_lshl_b32 s66, s40, 13
s_lshl_b32 s67, s40, 11
s_add_u32 s41, s66, 0x2801000
buffer_load_dwordx4 v[40:43], v2, s[8:11], s41 offen offset:0 sc1
buffer_load_dwordx4 v[44:47], v2, s[8:11], s41 offen offset:1024 sc1
buffer_load_dwordx4 v[48:51], v2, s[8:11], s41 offen offset:2048 sc1
buffer_load_dwordx4 v[52:55], v2, s[8:11], s41 offen offset:3072 sc1
s_add_u32 s41, s66, 0x800000
buffer_load_dwordx4 v[72:75], v2, s[8:11], s41 offen offset:0 sc1
buffer_load_dwordx4 v[76:79], v2, s[8:11], s41 offen offset:1024 sc1
buffer_load_dwordx4 v[80:83], v2, s[8:11], s41 offen offset:2048 sc1
buffer_load_dwordx4 v[84:87], v2, s[8:11], s41 offen offset:3072 sc1
s_add_u32 s41, s66, 0x801000
buffer_load_dwordx4 v[88:91], v2, s[8:11], s41 offen offset:0 sc1
buffer_load_dwordx4 v[92:95], v2, s[8:11], s41 offen offset:1024 sc1
buffer_load_dwordx4 v[96:99], v2, s[8:11], s41 offen offset:2048 sc1
buffer_load_dwordx4 v[100:103], v2, s[8:11], s41 offen offset:3072 sc1
s_add_u32 s41, s66, 0x1801000
buffer_load_dwordx4 v[104:107], v2, s[8:11], s41 offen offset:0 sc1
buffer_load_dwordx4 v[108:111], v2, s[8:11], s41 offen offset:1024 sc1
buffer_load_dwordx4 v[112:115], v2, s[8:11], s41 offen offset:2048 sc1
buffer_load_dwordx4 v[116:119], v2, s[8:11], s41 offen offset:3072 sc1
s_lshl_b32 s41, s40, 10
buffer_load_dword v152, v10, s[12:15], s41 offen
s_barrier
s_add_u32 s42, s67, 0x3800000
buffer_load_dwordx4 v[56:59], v4, s[8:11], s42 offen offset:0 sc1
buffer_load_dwordx4 v[60:63], v4, s[8:11], s42 offen offset:512 sc1
buffer_load_dwordx4 v[64:67], v4, s[8:11], s42 offen offset:1024 sc1
buffer_load_dwordx4 v[68:71], v4, s[8:11], s42 offen offset:1536 sc1
s_add_u32 s42, s67, 0x3c00400
buffer_load_dword v20, v13, s[8:11], s42 offen offset:0 sc1
buffer_load_dword v24, v13, s[8:11], s42 offen offset:256 sc1
buffer_load_dword v28, v13, s[8:11], s42 offen offset:512 sc1
buffer_load_dword v32, v13, s[8:11], s42 offen offset:768 sc1
s_waitcnt vmcnt(0)
v_mfma_f32_16x16x32_bf16 v[120:123], v[56:59], v[40:43], 0
v_mfma_f32_16x16x32_bf16 v[124:127], v[72:75], v[40:43], 0
v_mfma_f32_16x16x32_bf16 v[128:131], v[88:91], v[40:43], 0
v_mfma_f32_16x16x32_bf16 v[120:123], v[60:63], v[44:47], v[120:123]
v_mfma_f32_16x16x32_bf16 v[124:127], v[76:79], v[44:47], v[124:127]
v_mfma_f32_16x16x32_bf16 v[128:131], v[92:95], v[44:47], v[128:131]
v_mfma_f32_16x16x32_bf16 v[120:123], v[64:67], v[48:51], v[120:123]
v_mfma_f32_16x16x32_bf16 v[124:127], v[80:83], v[48:51], v[124:127]
v_mfma_f32_16x16x32_bf16 v[128:131], v[96:99], v[48:51], v[128:131]
v_mfma_f32_16x16x32_bf16 v[120:123], v[68:71], v[52:55], v[120:123]
v_mfma_f32_16x16x32_bf16 v[124:127], v[84:87], v[52:55], v[124:127]
v_mfma_f32_16x16x32_bf16 v[128:131], v[100:103], v[52:55], v[128:131]
v_mov_b32 v140, 0xff800000
v_cmp_le_i32 vcc, 0, v5
s_nop 5
v_cndmask_b32 v128, v140, v128, vcc
v_cmp_le_i32 vcc, 1, v5
s_nop 1
v_cndmask_b32 v129, v140, v129, vcc
v_cmp_le_i32 vcc, 2, v5
s_nop 1
v_cndmask_b32 v130, v140, v130, vcc
v_cmp_le_i32 vcc, 3, v5
s_nop 1
v_cndmask_b32 v131, v140, v131, vcc
v_max3_f32 v141, v120, v121, v124
v_max3_f32 v141, v141, v125, v126
v_max3_f32 v141, v141, v127, v128
v_max3_f32 v141, v141, v129, v130
v_max_f32 v141, v141, v131
v_mov_b32 v142, v141
s_nop 1
v_permlane32_swap_b32 v141, v142
v_max_f32 v141, v141, v142
v_mov_b32 v142, v141
s_nop 1
v_permlane16_swap_b32 v141, v142
v_max_f32 v141, v141, v142
v_mul_f32 v143, s65, v141
v_fma_f32 v120, v120, s64, v143
v_fma_f32 v121, v121, s64, v143
v_fma_f32 v124, v124, s64, v143
v_fma_f32 v125, v125, s64, v143
v_fma_f32 v126, v126, s64, v143
v_fma_f32 v127, v127, s64, v143
v_fma_f32 v128, v128, s64, v143
v_fma_f32 v129, v129, s64, v143
v_fma_f32 v130, v130, s64, v143
v_fma_f32 v131, v131, s64, v143
v_exp_f32 v120, v120
v_exp_f32 v121, v121
v_exp_f32 v124, v124
v_exp_f32 v125, v125
v_exp_f32 v126, v126
v_exp_f32 v127, v127
v_exp_f32 v128, v128
v_exp_f32 v129, v129
v_exp_f32 v130, v130
v_exp_f32 v131, v131
v_cvt_pk_bf16_f32 v132, v124, v125
v_cvt_pk_bf16_f32 v133, v126, v127
v_cvt_pk_bf16_f32 v134, v128, v129
v_cvt_pk_bf16_f32 v135, v130, v131
v_cvt_pk_bf16_f32 v136, v120, v121
s_nop 0
v_mfma_f32_16x16x32_bf16 v[176:179], v[36:39], v[132:135], 0
v_mfma_f32_16x16x32_bf16 v[176:179], v[36:39], v[136:139], v[176:179]
v_mfma_f32_16x16x32_bf16 v[160:163], v[104:107], v[132:135], 0
v_mfma_f32_16x16x32_bf16 v[164:167], v[108:111], v[132:135], 0
v_mfma_f32_16x16x32_bf16 v[168:171], v[112:115], v[132:135], 0
v_mfma_f32_16x16x32_bf16 v[172:175], v[116:119], v[132:135], 0
v_mfma_f32_16x16x32_bf16 v[160:163], v[20:23], v[136:139], v[160:163]
v_mfma_f32_16x16x32_bf16 v[164:167], v[24:27], v[136:139], v[164:167]
v_mfma_f32_16x16x32_bf16 v[168:171], v[28:31], v[136:139], v[168:171]
v_mfma_f32_16x16x32_bf16 v[172:175], v[32:35], v[136:139], v[172:175]
v_rcp_f32 v142, v176
s_nop 3
v_mul_f32 v160, v160, v142
v_mul_f32 v161, v161, v142
v_mul_f32 v162, v162, v142
v_mul_f32 v163, v163, v142
v_mul_f32 v164, v164, v142
v_mul_f32 v165, v165, v142
v_mul_f32 v166, v166, v142
v_mul_f32 v167, v167, v142
v_mul_f32 v168, v168, v142
v_mul_f32 v169, v169, v142
v_mul_f32 v170, v170, v142
v_mul_f32 v171, v171, v142
v_mul_f32 v172, v172, v142
v_mul_f32 v173, v173, v142
v_mul_f32 v174, v174, v142
v_mul_f32 v175, v175, v142
v_cvt_pk_bf16_f32 v40, v160, v161
v_cvt_pk_bf16_f32 v41, v162, v163
v_cvt_pk_bf16_f32 v42, v164, v165
v_cvt_pk_bf16_f32 v43, v166, v167
ds_write_b128 v6, v[40:43] offset:4096
v_cvt_pk_bf16_f32 v44, v168, v169
v_cvt_pk_bf16_f32 v45, v170, v171
v_cvt_pk_bf16_f32 v46, v172, v173
v_cvt_pk_bf16_f32 v47, v174, v175
ds_write_b128 v6, v[44:47] offset:6144
s_waitcnt lgkmcnt(0)
s_barrier
ds_read_b128 v[40:43], v2 offset:0
ds_read_b128 v[44:47], v2 offset:1024
ds_read_b128 v[48:51], v2 offset:2048
ds_read_b128 v[52:55], v2 offset:3072
ds_read_b128 v[56:59], v2 offset:4096
ds_read_b128 v[60:63], v2 offset:5120
ds_read_b128 v[64:67], v2 offset:6144
ds_read_b128 v[68:71], v2 offset:7168
s_waitcnt lgkmcnt(7)
v_mfma_f32_32x32x16_bf16 v[192:207], v[40:43], a[0:3], 0
v_mfma_f32_32x32x16_bf16 v[208:223], v[40:43], a[32:35], 0
v_mfma_f32_32x32x16_bf16 v[224:239], v[40:43], a[64:67], 0
v_mfma_f32_32x32x16_bf16 v[240:255], v[40:43], a[96:99], 0
s_waitcnt lgkmcnt(6)
v_mfma_f32_32x32x16_bf16 v[192:207], v[44:47], a[4:7], v[192:207]
v_mfma_f32_32x32x16_bf16 v[208:223], v[44:47], a[36:39], v[208:223]
v_mfma_f32_32x32x16_bf16 v[224:239], v[44:47], a[68:71], v[224:239]
v_mfma_f32_32x32x16_bf16 v[240:255], v[44:47], a[100:103], v[240:255]
s_waitcnt lgkmcnt(5)
v_mfma_f32_32x32x16_bf16 v[192:207], v[48:51], a[8:11], v[192:207]
v_mfma_f32_32x32x16_bf16 v[208:223], v[48:51], a[40:43], v[208:223]
v_mfma_f32_32x32x16_bf16 v[224:239], v[48:51], a[72:75], v[224:239]
v_mfma_f32_32x32x16_bf16 v[240:255], v[48:51], a[104:107], v[240:255]
s_waitcnt lgkmcnt(4)
v_mfma_f32_32x32x16_bf16 v[192:207], v[52:55], a[12:15], v[192:207]
v_mfma_f32_32x32x16_bf16 v[208:223], v[52:55], a[44:47], v[208:223]
v_mfma_f32_32x32x16_bf16 v[224:239], v[52:55], a[76:79], v[224:239]
v_mfma_f32_32x32x16_bf16 v[240:255], v[52:55], a[108:111], v[240:255]
s_waitcnt lgkmcnt(3)
v_mfma_f32_32x32x16_bf16 v[192:207], v[56:59], a[16:19], v[192:207]
v_mfma_f32_32x32x16_bf16 v[208:223], v[56:59], a[48:51], v[208:223]
v_mfma_f32_32x32x16_bf16 v[224:239], v[56:59], a[80:83], v[224:239]
v_mfma_f32_32x32x16_bf16 v[240:255], v[56:59], a[112:115], v[240:255]
s_waitcnt lgkmcnt(2)
v_mfma_f32_32x32x16_bf16 v[192:207], v[60:63], a[20:23], v[192:207]
v_mfma_f32_32x32x16_bf16 v[208:223], v[60:63], a[52:55], v[208:223]
v_mfma_f32_32x32x16_bf16 v[224:239], v[60:63], a[84:87], v[224:239]
v_mfma_f32_32x32x16_bf16 v[240:255], v[60:63], a[116:119], v[240:255]
s_waitcnt lgkmcnt(1)
v_mfma_f32_32x32x16_bf16 v[192:207], v[64:67], a[24:27], v[192:207]
v_mfma_f32_32x32x16_bf16 v[208:223], v[64:67], a[56:59], v[208:223]
v_mfma_f32_32x32x16_bf16 v[224:239], v[64:67], a[88:91], v[224:239]
v_mfma_f32_32x32x16_bf16 v[240:255], v[64:67], a[120:123], v[240:255]
s_waitcnt lgkmcnt(0)
v_mfma_f32_32x32x16_bf16 v[192:207], v[68:71], a[28:31], v[192:207]
v_mfma_f32_32x32x16_bf16 v[208:223], v[68:71], a[60:63], v[208:223]
v_mfma_f32_32x32x16_bf16 v[224:239], v[68:71], a[92:95], v[224:239]
v_mfma_f32_32x32x16_bf16 v[240:255], v[68:71], a[124:127], v[240:255]
s_lshl_b32 s40, s68, 10
s_add_u32 s40, s40, s38
s_add_u32 s40, s40, 0x300
s_nop 6
v_cvt_pk_bf16_f32 v40, v192, v208
s_add_u32 s41, s40, s48
buffer_store_dword v40, v7, s[8:11], s41 offen offset:0 sc1
v_cvt_pk_bf16_f32 v41, v193, v209
s_add_u32 s42, s40, s49
buffer_store_dword v41, v7, s[8:11], s42 offen offset:0 sc1
v_cvt_pk_bf16_f32 v42, v194, v210
s_add_u32 s41, s40, s50
buffer_store_dword v42, v7, s[8:11], s41 offen offset:0 sc1
v_cvt_pk_bf16_f32 v43, v195, v211
s_add_u32 s42, s40, s51
buffer_store_dword v43, v7, s[8:11], s42 offen offset:0 sc1
v_cvt_pk_bf16_f32 v44, v196, v212
s_add_u32 s41, s40, s52
buffer_store_dword v44, v7, s[8:11], s41 offen offset:0 sc1
v_cvt_pk_bf16_f32 v45, v197, v213
s_add_u32 s42, s40, s53
buffer_store_dword v45, v7, s[8:11], s42 offen offset:0 sc1
v_cvt_pk_bf16_f32 v46, v198, v214
s_add_u32 s41, s40, s54
buffer_store_dword v46, v7, s[8:11], s41 offen offset:0 sc1
v_cvt_pk_bf16_f32 v47, v199, v215
s_add_u32 s42, s40, s55
buffer_store_dword v47, v7, s[8:11], s42 offen offset:0 sc1
v_cvt_pk_bf16_f32 v40, v200, v216
s_add_u32 s41, s40, s56
buffer_store_dword v40, v7, s[8:11], s41 offen offset:0 sc1
v_cvt_pk_bf16_f32 v41, v201, v217
s_add_u32 s42, s40, s57
buffer_store_dword v41, v7, s[8:11], s42 offen offset:0 sc1
v_cvt_pk_bf16_f32 v42, v202, v218
s_add_u32 s41, s40, s58
buffer_store_dword v42, v7, s[8:11], s41 offen offset:0 sc1
v_cvt_pk_bf16_f32 v43, v203, v219
s_add_u32 s42, s40, s59
buffer_store_dword v43, v7, s[8:11], s42 offen offset:0 sc1
v_cvt_pk_bf16_f32 v44, v204, v220
s_add_u32 s41, s40, s60
buffer_store_dword v44, v7, s[8:11], s41 offen offset:0 sc1
v_cvt_pk_bf16_f32 v45, v205, v221
s_add_u32 s42, s40, s61
buffer_store_dword v45, v7, s[8:11], s42 offen offset:0 sc1
v_cvt_pk_bf16_f32 v46, v206, v222
s_add_u32 s41, s40, s62
buffer_store_dword v46, v7, s[8:11], s41 offen offset:0 sc1
v_cvt_pk_bf16_f32 v47, v207, v223
s_add_u32 s42, s40, s63
buffer_store_dword v47, v7, s[8:11], s42 offen offset:0 sc1
v_cvt_pk_bf16_f32 v40, v224, v240
s_add_u32 s41, s40, s48
buffer_store_dword v40, v7, s[8:11], s41 offen offset:128 sc1
v_cvt_pk_bf16_f32 v41, v225, v241
s_add_u32 s42, s40, s49
buffer_store_dword v41, v7, s[8:11], s42 offen offset:128 sc1
v_cvt_pk_bf16_f32 v42, v226, v242
s_add_u32 s41, s40, s50
buffer_store_dword v42, v7, s[8:11], s41 offen offset:128 sc1
v_cvt_pk_bf16_f32 v43, v227, v243
s_add_u32 s42, s40, s51
buffer_store_dword v43, v7, s[8:11], s42 offen offset:128 sc1
v_cvt_pk_bf16_f32 v44, v228, v244
s_add_u32 s41, s40, s52
buffer_store_dword v44, v7, s[8:11], s41 offen offset:128 sc1
v_cvt_pk_bf16_f32 v45, v229, v245
s_add_u32 s42, s40, s53
buffer_store_dword v45, v7, s[8:11], s42 offen offset:128 sc1
v_cvt_pk_bf16_f32 v46, v230, v246
s_add_u32 s41, s40, s54
buffer_store_dword v46, v7, s[8:11], s41 offen offset:128 sc1
v_cvt_pk_bf16_f32 v47, v231, v247
s_add_u32 s42, s40, s55
buffer_store_dword v47, v7, s[8:11], s42 offen offset:128 sc1
v_cvt_pk_bf16_f32 v40, v232, v248
s_add_u32 s41, s40, s56
buffer_store_dword v40, v7, s[8:11], s41 offen offset:128 sc1
v_cvt_pk_bf16_f32 v41, v233, v249
s_add_u32 s42, s40, s57
buffer_store_dword v41, v7, s[8:11], s42 offen offset:128 sc1
v_cvt_pk_bf16_f32 v42, v234, v250
s_add_u32 s41, s40, s58
buffer_store_dword v42, v7, s[8:11], s41 offen offset:128 sc1
v_cvt_pk_bf16_f32 v43, v235, v251
s_add_u32 s42, s40, s59
buffer_store_dword v43, v7, s[8:11], s42 offen offset:128 sc1
v_cvt_pk_bf16_f32 v44, v236, v252
s_add_u32 s41, s40, s60
buffer_store_dword v44, v7, s[8:11], s41 offen offset:128 sc1
v_cvt_pk_bf16_f32 v45, v237, v253
s_add_u32 s42, s40, s61
buffer_store_dword v45, v7, s[8:11], s42 offen offset:128 sc1
v_cvt_pk_bf16_f32 v46, v238, v254
s_add_u32 s41, s40, s62
buffer_store_dword v46, v7, s[8:11], s41 offen offset:128 sc1
v_cvt_pk_bf16_f32 v47, v239, v255
s_add_u32 s42, s40, s63
buffer_store_dword v47, v7, s[8:11], s42 offen offset:128 sc1
s_waitcnt vmcnt(0)
s_barrier
s_barrier
s_lshl_b32 s40, s68, 15
s_add_u32 s40, s40, s38
s_add_u32 s40, s40, 0x300
s_add_u32 s41, s40, 0
buffer_load_dwordx4 v[40:43], v8, s[8:11], s41 offen sc1
s_add_u32 s41, s40, 4096
buffer_load_dwordx4 v[44:47], v8, s[8:11], s41 offen sc1
s_add_u32 s41, s40, 8192
buffer_load_dwordx4 v[48:51], v8, s[8:11], s41 offen sc1
s_add_u32 s41, s40, 12288
buffer_load_dwordx4 v[52:55], v8, s[8:11], s41 offen sc1
s_add_u32 s41, s40, 16384
buffer_load_dwordx4 v[56:59], v8, s[8:11], s41 offen sc1
s_add_u32 s41, s40, 20480
buffer_load_dwordx4 v[60:63], v8, s[8:11], s41 offen sc1
s_add_u32 s41, s40, 24576
buffer_load_dwordx4 v[64:67], v8, s[8:11], s41 offen sc1
s_add_u32 s41, s40, 28672
buffer_load_dwordx4 v[68:71], v8, s[8:11], s41 offen sc1
s_waitcnt vmcnt(7)
v_mfma_f32_16x16x32_bf16 v[160:163], v[40:43], v[16:19], 0
s_waitcnt vmcnt(6)
v_mfma_f32_16x16x32_bf16 v[160:163], v[44:47], v[16:19], v[160:163]
s_waitcnt vmcnt(5)
v_mfma_f32_16x16x32_bf16 v[160:163], v[48:51], v[16:19], v[160:163]
s_waitcnt vmcnt(4)
v_mfma_f32_16x16x32_bf16 v[160:163], v[52:55], v[16:19], v[160:163]
s_waitcnt vmcnt(3)
v_mfma_f32_16x16x32_bf16 v[160:163], v[56:59], v[16:19], v[160:163]
s_waitcnt vmcnt(2)
v_mfma_f32_16x16x32_bf16 v[160:163], v[60:63], v[16:19], v[160:163]
s_waitcnt vmcnt(1)
v_mfma_f32_16x16x32_bf16 v[160:163], v[64:67], v[16:19], v[160:163]
s_waitcnt vmcnt(0)
v_mfma_f32_16x16x32_bf16 v[160:163], v[68:71], v[16:19], v[160:163]
s_nop 7
ds_write_b32 v9, v160 offset:0
ds_write_b32 v9, v161 offset:16
ds_write_b32 v9, v162 offset:32
ds_write_b32 v9, v163 offset:48
s_waitcnt lgkmcnt(0)
s_barrier
v_lshlrev_b32 v147, 1, v10
ds_read_b64 v[148:149], v147 offset:8192
s_waitcnt lgkmcnt(0)
v_lshlrev_b32 v150, 16, v152
v_and_b32 v151, 0xffff0000, v152
v_accvgpr_read_b32 v144, a240
v_accvgpr_read_b32 v145, a241
v_cvt_pk_bf16_f32 v148, v148, v148
v_and_b32 v148, 0xffff0000, v148
v_mul_f32 v148, v148, v144
v_cvt_pk_bf16_f32 v148, v148, v148
v_and_b32 v148, 0xffff0000, v148
v_add_f32 v150, v150, v148
v_cvt_pk_bf16_f32 v150, v150, v150
v_and_b32 v150, 0xffff0000, v150
v_cvt_pk_bf16_f32 v149, v149, v149
v_and_b32 v149, 0xffff0000, v149
v_mul_f32 v149, v149, v145
v_cvt_pk_bf16_f32 v149, v149, v149
v_and_b32 v149, 0xffff0000, v149
v_add_f32 v151, v151, v149
v_cvt_pk_bf16_f32 v151, v151, v151
v_and_b32 v151, 0xffff0000, v151
v_accvgpr_write_b32 a248, v150
v_accvgpr_write_b32 a249, v151
v_add_f32 v156, v150, v151
v_mul_f32 v157, v150, v150
v_fmac_f32 v157, v151, v151
v_add_f32_dpp v156, v156, v156 quad_perm:[1,0,3,2] row_mask:0xf bank_mask:0xf
s_nop 1
v_add_f32_dpp v156, v156, v156 quad_perm:[2,3,0,1] row_mask:0xf bank_mask:0xf
s_nop 1
v_add_f32_dpp v156, v156, v156 row_half_mirror row_mask:0xf bank_mask:0xf
s_nop 1
v_add_f32_dpp v156, v156, v156 row_mirror row_mask:0xf bank_mask:0xf
v_mov_b32 v155, v156
s_nop 1
v_permlane16_swap_b32 v156, v155
v_add_f32 v156, v156, v155
v_mov_b32 v155, v156
s_nop 1
v_permlane32_swap_b32 v156, v155
v_add_f32 v156, v156, v155
v_add_f32_dpp v157, v157, v157 quad_perm:[1,0,3,2] row_mask:0xf bank_mask:0xf
s_nop 1
v_add_f32_dpp v157, v157, v157 quad_perm:[2,3,0,1] row_mask:0xf bank_mask:0xf
s_nop 1
v_add_f32_dpp v157, v157, v157 row_half_mirror row_mask:0xf bank_mask:0xf
s_nop 1
v_add_f32_dpp v157, v157, v157 row_mirror row_mask:0xf bank_mask:0xf
v_mov_b32 v155, v157
s_nop 1
v_permlane16_swap_b32 v157, v155
v_add_f32 v157, v157, v155
v_mov_b32 v155, v157
s_nop 1
v_permlane32_swap_b32 v157, v155
v_add_f32 v157, v157, v155
v_mov_b32 v155, 10328
ds_write_b64 v155, v[156:157]
s_waitcnt lgkmcnt(0)
s_barrier
v_mov_b32 v155, 10304
ds_read_b128 v[160:163], v155
ds_read_b128 v[164:167], v155 offset:16
s_waitcnt lgkmcnt(0)
v_add_f32 v156, v160, v162
v_add_f32 v157, v161, v163
v_add_f32 v156, v156, v164
v_add_f32 v157, v157, v165
v_add_f32 v156, v156, v166
v_add_f32 v157, v157, v167
v_mul_f32 v156, 0x3b000000, v156
v_mul_f32 v157, 0x3b000000, v157
v_fma_f32 v157, -v156, v156, v157
v_max_f32 v157, 0, v157
v_cvt_pk_bf16_f32 v156, v156, v156
v_and_b32 v156, 0xffff0000, v156
v_cvt_pk_bf16_f32 v157, v157, v157
v_and_b32 v157, 0xffff0000, v157
v_add_f32 v157, 0x3727c5ac, v157
v_cvt_pk_bf16_f32 v157, v157, v157
v_and_b32 v157, 0xffff0000, v157
v_sqrt_f32 v157, v157
s_nop 0
v_cvt_pk_bf16_f32 v157, v157, v157
v_and_b32 v157, 0xffff0000, v157
v_rcp_f32 v157, v157
v_accvgpr_read_b32 v144, a244
v_accvgpr_read_b32 v145, a245
v_accvgpr_read_b32 v148, a242
v_accvgpr_read_b32 v149, a243
v_sub_f32 v150, v150, v156
v_mul_f32 v150, v150, v157
v_fma_f32 v150, v150, v144, v148
v_sub_f32 v151, v151, v156
v_mul_f32 v151, v151, v157
v_fma_f32 v151, v151, v145, v149
v_cvt_pk_bf16_f32 v150, v150, v151
s_add_u32 s40, s38, 0x200000
buffer_store_dword v150, v11, s[8:11], s40 offen sc1
s_waitcnt vmcnt(0)
s_barrier
s_barrier
s_add_u32 s40, s38, 0x206000
s_mov_b32 m0, 57344
s_add_u32 s41, s40, 0
buffer_load_dwordx4 v2, s[8:11], s41 offen sc1 lds
s_mov_b32 m0, 58368
s_add_u32 s41, s40, 1024
buffer_load_dwordx4 v2, s[8:11], s41 offen sc1 lds
s_mov_b32 m0, 59392
s_add_u32 s41, s40, 2048
buffer_load_dwordx4 v2, s[8:11], s41 offen sc1 lds
s_mov_b32 m0, 60416
s_add_u32 s41, s40, 3072
buffer_load_dwordx4 v2, s[8:11], s41 offen sc1 lds
s_mov_b32 m0, 61440
s_add_u32 s41, s40, 4096
buffer_load_dwordx4 v2, s[8:11], s41 offen sc1 lds
s_mov_b32 m0, 62464
s_add_u32 s41, s40, 5120
buffer_load_dwordx4 v2, s[8:11], s41 offen sc1 lds
s_mov_b32 m0, 63488
s_add_u32 s41, s40, 6144
buffer_load_dwordx4 v2, s[8:11], s41 offen sc1 lds
s_mov_b32 m0, 64512
s_add_u32 s41, s40, 7168
buffer_load_dwordx4 v2, s[8:11], s41 offen sc1 lds
s_waitcnt vmcnt(0)
s_barrier
s_barrier
ds_read_b128 v[40:43], v2 offset:12288
ds_read_b128 v[44:47], v2 offset:13312
ds_read_b128 v[48:51], v2 offset:14336
s_waitcnt lgkmcnt(2)
v_mfma_f32_32x32x16_bf16 v[192:207], v[40:43], a[128:131], 0
v_mfma_f32_32x32x16_bf16 v[208:223], v[40:43], a[140:143], 0
v_mfma_f32_32x32x16_bf16 v[224:239], v[40:43], a[152:155], 0
v_mfma_f32_32x32x16_bf16 v[240:255], v[40:43], a[164:167], 0
s_waitcnt lgkmcnt(1)
v_mfma_f32_32x32x16_bf16 v[192:207], v[44:47], a[132:135], v[192:207]
v_mfma_f32_32x32x16_bf16 v[208:223], v[44:47], a[144:147], v[208:223]
v_mfma_f32_32x32x16_bf16 v[224:239], v[44:47], a[156:159], v[224:239]
v_mfma_f32_32x32x16_bf16 v[240:255], v[44:47], a[168:171], v[240:255]
s_waitcnt lgkmcnt(0)
v_mfma_f32_32x32x16_bf16 v[192:207], v[48:51], a[136:139], v[192:207]
v_mfma_f32_32x32x16_bf16 v[208:223], v[48:51], a[148:151], v[208:223]
v_mfma_f32_32x32x16_bf16 v[224:239], v[48:51], a[160:163], v[224:239]
v_mfma_f32_32x32x16_bf16 v[240:255], v[48:51], a[172:175], v[240:255]
s_lshl_b32 s40, s68, 10
s_add_u32 s40, s40, s38
s_add_u32 s40, s40, 0x100300
s_nop 6
v_cvt_pk_bf16_f32 v40, v192, v208
s_add_u32 s41, s40, s48
buffer_store_dword v40, v7, s[8:11], s41 offen offset:0 sc1
v_cvt_pk_bf16_f32 v41, v193, v209
s_add_u32 s42, s40, s49
buffer_store_dword v41, v7, s[8:11], s42 offen offset:0 sc1
v_cvt_pk_bf16_f32 v42, v194, v210
s_add_u32 s41, s40, s50
buffer_store_dword v42, v7, s[8:11], s41 offen offset:0 sc1
v_cvt_pk_bf16_f32 v43, v195, v211
s_add_u32 s42, s40, s51
buffer_store_dword v43, v7, s[8:11], s42 offen offset:0 sc1
v_cvt_pk_bf16_f32 v44, v196, v212
s_add_u32 s41, s40, s52
buffer_store_dword v44, v7, s[8:11], s41 offen offset:0 sc1
v_cvt_pk_bf16_f32 v45, v197, v213
s_add_u32 s42, s40, s53
buffer_store_dword v45, v7, s[8:11], s42 offen offset:0 sc1
v_cvt_pk_bf16_f32 v46, v198, v214
s_add_u32 s41, s40, s54
buffer_store_dword v46, v7, s[8:11], s41 offen offset:0 sc1
v_cvt_pk_bf16_f32 v47, v199, v215
s_add_u32 s42, s40, s55
buffer_store_dword v47, v7, s[8:11], s42 offen offset:0 sc1
v_cvt_pk_bf16_f32 v40, v200, v216
s_add_u32 s41, s40, s56
buffer_store_dword v40, v7, s[8:11], s41 offen offset:0 sc1
v_cvt_pk_bf16_f32 v41, v201, v217
s_add_u32 s42, s40, s57
buffer_store_dword v41, v7, s[8:11], s42 offen offset:0 sc1
v_cvt_pk_bf16_f32 v42, v202, v218
s_add_u32 s41, s40, s58
buffer_store_dword v42, v7, s[8:11], s41 offen offset:0 sc1
v_cvt_pk_bf16_f32 v43, v203, v219
s_add_u32 s42, s40, s59
buffer_store_dword v43, v7, s[8:11], s42 offen offset:0 sc1
v_cvt_pk_bf16_f32 v44, v204, v220
s_add_u32 s41, s40, s60
buffer_store_dword v44, v7, s[8:11], s41 offen offset:0 sc1
v_cvt_pk_bf16_f32 v45, v205, v221
s_add_u32 s42, s40, s61
buffer_store_dword v45, v7, s[8:11], s42 offen offset:0 sc1
v_cvt_pk_bf16_f32 v46, v206, v222
s_add_u32 s41, s40, s62
buffer_store_dword v46, v7, s[8:11], s41 offen offset:0 sc1
v_cvt_pk_bf16_f32 v47, v207, v223
s_add_u32 s42, s40, s63
buffer_store_dword v47, v7, s[8:11], s42 offen offset:0 sc1
v_cvt_pk_bf16_f32 v40, v224, v240
s_add_u32 s41, s40, s48
buffer_store_dword v40, v7, s[8:11], s41 offen offset:128 sc1
v_cvt_pk_bf16_f32 v41, v225, v241
s_add_u32 s42, s40, s49
buffer_store_dword v41, v7, s[8:11], s42 offen offset:128 sc1
v_cvt_pk_bf16_f32 v42, v226, v242
s_add_u32 s41, s40, s50
buffer_store_dword v42, v7, s[8:11], s41 offen offset:128 sc1
v_cvt_pk_bf16_f32 v43, v227, v243
s_add_u32 s42, s40, s51
buffer_store_dword v43, v7, s[8:11], s42 offen offset:128 sc1
v_cvt_pk_bf16_f32 v44, v228, v244
s_add_u32 s41, s40, s52
buffer_store_dword v44, v7, s[8:11], s41 offen offset:128 sc1
v_cvt_pk_bf16_f32 v45, v229, v245
s_add_u32 s42, s40, s53
buffer_store_dword v45, v7, s[8:11], s42 offen offset:128 sc1
v_cvt_pk_bf16_f32 v46, v230, v246
s_add_u32 s41, s40, s54
buffer_store_dword v46, v7, s[8:11], s41 offen offset:128 sc1
v_cvt_pk_bf16_f32 v47, v231, v247
s_add_u32 s42, s40, s55
buffer_store_dword v47, v7, s[8:11], s42 offen offset:128 sc1
v_cvt_pk_bf16_f32 v40, v232, v248
s_add_u32 s41, s40, s56
buffer_store_dword v40, v7, s[8:11], s41 offen offset:128 sc1
v_cvt_pk_bf16_f32 v41, v233, v249
s_add_u32 s42, s40, s57
buffer_store_dword v41, v7, s[8:11], s42 offen offset:128 sc1
v_cvt_pk_bf16_f32 v42, v234, v250
s_add_u32 s41, s40, s58
buffer_store_dword v42, v7, s[8:11], s41 offen offset:128 sc1
v_cvt_pk_bf16_f32 v43, v235, v251
s_add_u32 s42, s40, s59
buffer_store_dword v43, v7, s[8:11], s42 offen offset:128 sc1
v_cvt_pk_bf16_f32 v44, v236, v252
s_add_u32 s41, s40, s60
buffer_store_dword v44, v7, s[8:11], s41 offen offset:128 sc1
v_cvt_pk_bf16_f32 v45, v237, v253
s_add_u32 s42, s40, s61
buffer_store_dword v45, v7, s[8:11], s42 offen offset:128 sc1
v_cvt_pk_bf16_f32 v46, v238, v254
s_add_u32 s41, s40, s62
buffer_store_dword v46, v7, s[8:11], s41 offen offset:128 sc1
v_cvt_pk_bf16_f32 v47, v239, v255
s_add_u32 s42, s40, s63
buffer_store_dword v47, v7, s[8:11], s42 offen offset:128 sc1
s_waitcnt vmcnt(0)
s_barrier
s_barrier
s_lshl_b32 s40, s68, 15
s_add_u32 s40, s40, s38
s_add_u32 s40, s40, 0x100300
s_add_u32 s41, s40, 0
buffer_load_dwordx4 v[40:43], v8, s[8:11], s41 offen sc1
s_add_u32 s41, s40, 4096
buffer_load_dwordx4 v[44:47], v8, s[8:11], s41 offen sc1
s_add_u32 s41, s40, 8192
buffer_load_dwordx4 v[48:51], v8, s[8:11], s41 offen sc1
s_add_u32 s41, s40, 12288
buffer_load_dwordx4 v[52:55], v8, s[8:11], s41 offen sc1
s_add_u32 s41, s40, 16384
buffer_load_dwordx4 v[56:59], v8, s[8:11], s41 offen sc1
s_add_u32 s41, s40, 20480
buffer_load_dwordx4 v[60:63], v8, s[8:11], s41 offen sc1
s_add_u32 s41, s40, 24576
buffer_load_dwordx4 v[64:67], v8, s[8:11], s41 offen sc1
s_add_u32 s41, s40, 28672
buffer_load_dwordx4 v[68:71], v8, s[8:11], s41 offen sc1
s_waitcnt vmcnt(7)
v_mfma_f32_16x16x32_bf16 v[160:163], v[40:43], v[16:19], 0
s_waitcnt vmcnt(6)
v_mfma_f32_16x16x32_bf16 v[160:163], v[44:47], v[16:19], v[160:163]
s_waitcnt vmcnt(5)
v_mfma_f32_16x16x32_bf16 v[160:163], v[48:51], v[16:19], v[160:163]
s_waitcnt vmcnt(4)
v_mfma_f32_16x16x32_bf16 v[160:163], v[52:55], v[16:19], v[160:163]
s_waitcnt vmcnt(3)
v_mfma_f32_16x16x32_bf16 v[160:163], v[56:59], v[16:19], v[160:163]
s_waitcnt vmcnt(2)
v_mfma_f32_16x16x32_bf16 v[160:163], v[60:63], v[16:19], v[160:163]
s_waitcnt vmcnt(1)
v_mfma_f32_16x16x32_bf16 v[160:163], v[64:67], v[16:19], v[160:163]
s_waitcnt vmcnt(0)
v_mfma_f32_16x16x32_bf16 v[160:163], v[68:71], v[16:19], v[160:163]
s_nop 7
ds_write_b32 v9, v160 offset:0
ds_write_b32 v9, v161 offset:16
ds_write_b32 v9, v162 offset:32
ds_write_b32 v9, v163 offset:48
s_waitcnt lgkmcnt(0)
s_barrier
v_lshlrev_b32 v147, 1, v10
ds_read_b64 v[148:149], v147 offset:8192
s_waitcnt lgkmcnt(0)
v_accvgpr_read_b32 v144, a246
v_accvgpr_read_b32 v145, a247
v_accvgpr_read_b32 v150, a248
v_accvgpr_read_b32 v151, a249
v_cvt_pk_bf16_f32 v148, v148, v148
v_and_b32 v148, 0xffff0000, v148
v_mul_f32 v148, v148, v144
v_cvt_pk_bf16_f32 v148, v148, v148
v_and_b32 v148, 0xffff0000, v148
v_add_f32 v150, v150, v148
v_cvt_pk_bf16_f32 v149, v149, v149
v_and_b32 v149, 0xffff0000, v149
v_mul_f32 v149, v149, v145
v_cvt_pk_bf16_f32 v149, v149, v149
v_and_b32 v149, 0xffff0000, v149
v_add_f32 v151, v151, v149
v_cvt_pk_bf16_f32 v150, v150, v151
s_lshl_b32 s40, s36, 5
s_add_u32 s40, s40, s68
s_lshl_b32 s40, s40, 10
buffer_store_dword v150, v10, s[4:7], s40 offen
s_add_u32 s36, s36, 7
s_add_u32 s37, s37, 1
s_branch L_tail_w3_s
L_tailend_w3_s:
s_waitcnt vmcnt(0)
s_endpgm
.section .rodata,"a"
.p2align 6
.amdhsa_kernel adaLN_cond__memory_aug_recurrent_mem_tr__dense_activation_relu__prompt_kernel
  .amdhsa_next_free_vgpr 512
  .amdhsa_next_free_sgpr 102
  .amdhsa_accum_offset 256
  .amdhsa_group_segment_fixed_size 0
  .amdhsa_kernarg_size 120
  .amdhsa_user_sgpr_count 2
  .amdhsa_user_sgpr_kernarg_segment_ptr 1
  .amdhsa_system_sgpr_workgroup_id_x 1
.end_amdhsa_kernel
```
